```python
import torch

def _softmax(x, axis=-1):
    return torch.softmax(x, dim=axis)

def _gelu(x):
    return torch.nn.functional.gelu(x, approximate='tanh')

def _silu(x):
    return torch.nn.functional.silu(x)

def _sigmoid(x):
    return torch.sigmoid(x)

def _layernorm(x, axis=-1, eps=1e-05):
    m = x.mean(dim=axis, keepdim=True)
    v = x.var(dim=axis, keepdim=True, unbiased=False)
    return (x - m) / torch.sqrt(v + eps)

def _scatter_add(tgt, idx, src, axis=0):
    return tgt.clone().index_add_(axis, idx, src)

def _segment_sum(src, seg, n):
    out = torch.zeros((n,) + src.shape[1:], dtype=src.dtype)
    return out.index_add_(0, seg, src)

def _pad(x, pw):
    flat = tuple((v for pair in reversed(pw) for v in pair))
    return torch.nn.functional.pad(x, flat)
kernel_name = 'concat_heads__memory_aug_recurrent_mem_tr__sliding_local_dilated__prompt'

def setup_inputs():

    _w = lambda a: (lambda t: t.to(torch.bfloat16) if t.is_floating_point() else t)(torch.as_tensor(a))

    def _A_setup():
        B, S, Dm = (1, 2048, 640)
        H, Dh = (32, 192)
        M, seg = (8, 32)
        seg = min(seg, S)
        S = S // seg * seg
        return {'x': _w((lambda *s: torch.randn(*s, dtype=torch.bfloat16) * 0.05)(B, S, Dm)), 'mem0': _w((lambda *s: torch.randn(*s, dtype=torch.bfloat16) * 1.6)(B, M, Dm)), 'Wq': _w((lambda *s: torch.randn(*s, dtype=torch.bfloat16) * 0.8)(Dm, H, Dh) * Dm ** (-0.5)), 'Wk': _w((lambda *s: torch.randn(*s, dtype=torch.bfloat16) * 0.8)(Dm, H, Dh) * Dm ** (-0.5)), 'Wv': _w((lambda *s: torch.randn(*s, dtype=torch.bfloat16) * 1.6)(Dm, H, Dh) * Dm ** (-0.5)), 'Wo': _w((lambda *s: torch.randn(*s, dtype=torch.bfloat16) * 1.6)(H, Dh, Dm) * (H * Dh) ** (-0.5)), 'seg_len': seg}
    _A_in = _A_setup()

    def _B_setup():
        B, S, D = (1, 2048, 640)
        return {'x': _w((lambda *s: torch.randn(*s, dtype=torch.bfloat16) * 0.2)(B, S, D)), 'wqkv': _w((lambda *s: torch.randn(*s, dtype=torch.bfloat16) * 0.2)(D, 3 * D)), 'wo': _w((lambda *s: torch.randn(*s, dtype=torch.bfloat16) * 0.05)(D, D))}
    _B_in = _B_setup()
    return {'A_x': _A_in['x'], 'A_mem0': _A_in['mem0'], 'A_Wq': _A_in['Wq'], 'A_Wk': _A_in['Wk'], 'A_Wv': _A_in['Wv'], 'A_Wo': _A_in['Wo'], 'A_seg_len': _A_in['seg_len'], 'B_x': _B_in['x'], 'B_wqkv': _B_in['wqkv'], 'B_wo': _B_in['wo']}

def reference(A_x, A_mem0, A_Wq, A_Wk, A_Wv, A_Wo, A_seg_len, B_x, B_wqkv, B_wo):

    def _A_ref(x, mem0, Wq, Wk, Wv, Wo, seg_len):
        B, S, Dm = x.shape
        H, Dh = (Wq.shape[1], Wq.shape[2])
        M = mem0.shape[1]
        scale = Dh ** (-0.5)
        n_seg = S // seg_len
        L = M + seg_len
        idx = torch.arange(L)
        mask = (idx[:, None] < M) | (idx[:, None] >= idx[None, :])
        mem = mem0
        outs = []
        for s in range(n_seg):
            xs = x[:, s * seg_len:(s + 1) * seg_len, :].clone()
            h = torch.concatenate([mem, xs], axis=1)
            q = torch.einsum('btd,dhe->bhte', h, Wq)
            k = torch.einsum('btd,dhe->bhte', h, Wk)
            v = torch.einsum('btd,dhe->bhte', h, Wv)
            scores = torch.einsum('bhqe,bhke->bhqk', q, k) * scale
            scores = torch.where(mask[None, None], scores, -1000000000.0)
            p = _softmax(scores, axis=-1)
            o = torch.einsum('bhqk,bhke->bhqe', p, v)
            o = torch.einsum('bhte,hed->btd', o, Wo)
            mem = o[:, :M, :].clone()
            outs.append(o[:, M:, :])
        return torch.concatenate(outs, axis=1)

    def _B_ref(x, wqkv, wo):
        B, S, D = x.shape
        H = 32
        Dh = D // H
        W, dil = (8, 2)
        qkv = (lambda x, *d: x.permute(*d))((x @ wqkv).reshape(B, S, 3, H, Dh), 2, 0, 3, 1, 4)
        q, k, v = (qkv[0], qkv[1], qkv[2])
        scale = Dh ** (-0.5)
        pos = torch.arange(S)
        off = torch.arange(W) * dil
        idx = pos[:, None] - off[None, :]
        mask = idx >= 0
        idx_c = torch.where(mask, idx, 0).reshape(-1)
        kg = k[:, :, idx_c, :].reshape(B, H, S, W, Dh)
        vg = v[:, :, idx_c, :].reshape(B, H, S, W, Dh)
        logits = torch.einsum('bhsd,bhswd->bhsw', q, kg) * scale
        logits = torch.where(mask[None, None, :, :], logits, -1000000000.0)
        attn = _softmax(logits, axis=-1)
        o = torch.einsum('bhsw,bhswd->bhsd', attn, vg)
        return (lambda x, *d: x.permute(*d))(o, 0, 2, 1, 3).reshape(B, S, D) @ wo
    a = _A_ref(A_x, A_mem0, A_Wq, A_Wk, A_Wv, A_Wo, A_seg_len)
    b = _B_ref(B_x, B_wqkv, B_wo)
    return torch.concatenate([a, b], axis=-1)
```

```asm
; @launch grid=(256,1,1) block=(256,1,1) lds=163840
.amdgcn_target "amdgcn-amd-amdhsa--gfx950"
.text
.globl concat_heads__memory_aug_recurrent_mem_tr__sliding_local_dilated__prompt_kernel
.p2align 8
.type concat_heads__memory_aug_recurrent_mem_tr__sliding_local_dilated__prompt_kernel,@function
concat_heads__memory_aug_recurrent_mem_tr__sliding_local_dilated__prompt_kernel:
L_code_start:
	s_cmp_ge_u32 s2, 256
	s_cbranch_scc1 L_end
	s_load_dwordx16 s[8:23], s[0:1], 0
	s_load_dwordx8 s[24:31], s[0:1], 64
	s_load_dwordx2 s[32:33], s[0:1], 96
	s_getreg_b32 s3, hwreg(HW_REG_XCC_ID, 0, 4)
	v_lshrrev_b32 v1, 6, v0
	v_and_b32 v0, 63, v0
	v_readfirstlane_b32 s5, v1
	s_and_b32 s3, s3, 7
	s_mov_b32 s34, 0
	v_mov_b32 v3, 163824
	s_getpc_b64 s[44:45]
	s_and_b32 s44, s44, 0xffffff00
	s_and_b32 s45, s45, 0xffff
	s_mov_b32 s46, L_code_end-L_code_start
	s_mov_b32 s47, 0x20000
	s_bfe_u32 s7, s2, 0x30003
	s_lshl_b32 s7, s7, 13
	v_lshlrev_b32 v6, 7, v0
	v_add_u32 v7, 0x10000, v6
	s_waitcnt lgkmcnt(0)
	s_mov_b32 s40, s30
	s_and_b32 s41, s31, 0xffff
	s_mov_b32 s42, 0x100
	s_mov_b32 s43, 0x20000
	s_add_u32 s32, s32, 0x1fffff
	s_addc_u32 s33, s33, 0
	s_and_b32 s32, s32, 0xffe00000
	s_mov_b32 s36, s32
	s_and_b32 s37, s33, 0xffff
	s_mov_b32 s38, 0xfe00000
	s_mov_b32 s39, 0x20000
	s_cmp_lg_u32 s5, 0
	s_cbranch_scc1 L_tk
	s_lshl_b32 s6, s3, 2
	v_mov_b32 v4, 1
	v_mov_b32 v5, 0
	v_mov_b32 v2, s6
	s_mov_b64 exec, 1
	buffer_atomic_add v4, v2, s[40:43], 0 offen sc0
	s_mov_b64 exec, -1
	buffer_load_dword v255, v6, s[44:47], s7 offen
	buffer_load_dword v255, v7, s[44:47], s7 offen
	s_mov_b64 exec, 1
	s_waitcnt vmcnt(2)
	ds_write_b64 v3, v[4:5]
	s_waitcnt lgkmcnt(0)
	s_mov_b64 exec, -1
L_tk:
	s_barrier
	ds_read_b32 v1, v3
	s_waitcnt lgkmcnt(0)
	v_readfirstlane_b32 s4, v1
	s_nop 0
	s_cmp_ge_u32 s4, 32
	s_cbranch_scc1 L_end
	s_cmp_lt_u32 s3, 3
	s_cbranch_scc1 L_chain
	s_mov_b32 s61, s4
	s_cmp_lg_u32 s3, 3
	s_cbranch_scc1 L_noprobe
	s_cmp_lg_u32 s5, 0
	s_cbranch_scc1 L_prs_1
	s_lshl_b32 s62, s61, 2
	s_add_u32 s62, s62, 0
	s_lshl_b32 s62, s62, 19
	s_add_u32 s64, s61, 3
	s_bfe_u32 s65, s64, 0x10001
	s_lshl_b32 s65, s65, 14
	s_and_b32 s64, s64, 1
	s_lshl_b32 s64, s64, 12
	s_add_u32 s64, s64, s65
	s_add_u32 s62, s62, s64
	s_add_u32 s62, s62, 0x1f8000
	v_lshl_add_u32 v4, v0, 2, s62
	v_add_u32 v5, 8192, v4
	s_mov_b32 s62, -1
	s_mov_b32 s63, -1
	s_memtime s[64:65]
	buffer_store_dword v4, v4, s[36:39], 0 offen sc1
	s_waitcnt vmcnt(0)
	s_memtime s[66:67]
	s_waitcnt lgkmcnt(0)
	s_sub_u32 s64, s66, s64
	s_min_u32 s62, s62, s64
	s_memtime s[64:65]
	buffer_store_dword v4, v5, s[36:39], 0 offen sc1
	s_waitcnt vmcnt(0)
	s_memtime s[66:67]
	s_waitcnt lgkmcnt(0)
	s_sub_u32 s64, s66, s64
	s_min_u32 s63, s63, s64
	s_memtime s[64:65]
	buffer_store_dword v4, v4, s[36:39], 0 offen sc1
	s_waitcnt vmcnt(0)
	s_memtime s[66:67]
	s_waitcnt lgkmcnt(0)
	s_sub_u32 s64, s66, s64
	s_min_u32 s62, s62, s64
	s_memtime s[64:65]
	buffer_store_dword v4, v5, s[36:39], 0 offen sc1
	s_waitcnt vmcnt(0)
	s_memtime s[66:67]
	s_waitcnt lgkmcnt(0)
	s_sub_u32 s64, s66, s64
	s_min_u32 s63, s63, s64
	s_memtime s[64:65]
	buffer_store_dword v4, v4, s[36:39], 0 offen sc1
	s_waitcnt vmcnt(0)
	s_memtime s[66:67]
	s_waitcnt lgkmcnt(0)
	s_sub_u32 s64, s66, s64
	s_min_u32 s62, s62, s64
	s_memtime s[64:65]
	buffer_store_dword v4, v5, s[36:39], 0 offen sc1
	s_waitcnt vmcnt(0)
	s_memtime s[66:67]
	s_waitcnt lgkmcnt(0)
	s_sub_u32 s64, s66, s64
	s_min_u32 s63, s63, s64
	s_memtime s[64:65]
	buffer_store_dword v4, v4, s[36:39], 0 offen sc1
	s_waitcnt vmcnt(0)
	s_memtime s[66:67]
	s_waitcnt lgkmcnt(0)
	s_sub_u32 s64, s66, s64
	s_min_u32 s62, s62, s64
	s_memtime s[64:65]
	buffer_store_dword v4, v5, s[36:39], 0 offen sc1
	s_waitcnt vmcnt(0)
	s_memtime s[66:67]
	s_waitcnt lgkmcnt(0)
	s_sub_u32 s64, s66, s64
	s_min_u32 s63, s63, s64
	s_cmp_lt_u32 s63, s62
	s_cselect_b32 s62, 1, 0
	s_lshl_b32 s62, s62, s61
	v_mov_b32 v4, s62
	v_mov_b32 v5, 100
	s_mov_b64 exec, 1
	buffer_atomic_or v4, v5, s[40:43], 0 offen
	s_waitcnt vmcnt(0)
	s_mov_b64 exec, -1
L_prs_1:
L_noprobe:
	s_mov_b32 s60, s4
	s_cmp_lg_u32 s3, 3
	s_cbranch_scc1 L_d_2
	s_cmp_ge_u32 s4, 16
	s_cbranch_scc1 L_d_6
	s_branch L_attn
L_d_6:
	s_branch L_b
L_d_2:
	s_cmp_lt_u32 s4, 20
	s_cbranch_scc1 L_d_3
	s_sub_u32 s60, s4, 21
	s_lshl_b32 s60, s60, 2
	s_add_u32 s60, s60, s3
	s_branch L_proj
L_d_3:
	s_and_b32 s60, s3, 1
	s_mov_b32 s61, s4
	s_cmp_lt_u32 s3, 6
	s_cbranch_scc1 L_d_4
	s_branch L_op
L_d_4:
	s_lshl_b32 s61, s4, 1
	s_add_u32 s60, s60, s61
	s_cmp_lt_u32 s4, 8
	s_cbranch_scc0 L_d_5
	s_branch L_b
L_d_5:
	s_add_u32 s60, s60, 32
	s_branch L_proj
L_idle:
	s_lshl_b32 s6, s5, 12
	s_add_u32 s6, s6, 96
	v_mov_b32 v4, s6
	v_mov_b32 v5, 1
	s_mov_b64 exec, 1
	buffer_atomic_add v5, v4, s[40:43], 0 offen
	s_mov_b64 exec, -1
L_end:
	s_endpgm
L_chain:
	s_mov_b32 s44, s12
	s_and_b32 s45, s13, 0xffff
	s_mov_b32 s46, 0x780000
	s_mov_b32 s47, 0x20000
	s_mov_b32 s48, s14
	s_and_b32 s49, s15, 0xffff
	s_mov_b32 s50, 0x780000
	s_mov_b32 s51, 0x20000
	s_mov_b32 s52, s16
	s_and_b32 s53, s17, 0xffff
	s_mov_b32 s54, 0x780000
	s_mov_b32 s55, 0x20000
	s_mov_b32 s56, s18
	s_and_b32 s57, s19, 0xffff
	s_mov_b32 s58, 0x780000
	s_mov_b32 s59, 0x20000
	s_mov_b32 s60, s10
	s_and_b32 s61, s11, 0xffff
	s_mov_b32 s62, 0x2800
	s_mov_b32 s63, 0x20000
	v_and_b32 v40, 15, v0
	v_lshrrev_b32 v41, 4, v0
	v_bfe_u32 v42, v0, 2, 2
	v_and_b32 v43, 3, v0
	v_lshlrev_b32 v1, 4, v0
	s_lshl_b32 s67, s5, 10
	v_add_u32 v2, s67, v1
	v_accvgpr_write_b32 a252, -1
	v_accvgpr_write_b32 a253, -1
	v_accvgpr_write_b32 a254, -1
	v_accvgpr_write_b32 a255, -1
	s_lshl_b32 s66, s3, 5
	s_add_u32 s66, s66, s4
	s_lshl_b32 s67, s66, 12
	s_add_u32 s67, s67, 0x4000000
	buffer_store_dwordx4 a[252:255], v2, s[36:39], s67 offen
	v_add_u32 v5, s67, v1
	s_lshl_b32 s67, s66, 8
	s_add_u32 s67, s67, 0x4060000
	v_lshlrev_b32 v44, 2, v0
	buffer_store_dword a252, v44, s[36:39], s67 offen
	s_lshl_b32 s70, s4, 2
	s_add_u32 s70, s70, 3
	s_lshl_b32 s70, s70, 19
	s_add_u32 s67, s4, 3
	s_bfe_u32 s68, s67, 0x10001
	s_lshl_b32 s68, s68, 14
	s_and_b32 s67, s67, 1
	s_lshl_b32 s67, s67, 12
	s_add_u32 s67, s67, s68
	s_add_u32 s70, s70, s67
	s_lshl_b32 s67, s3, 8
	s_add_u32 s70, s70, s67
	s_add_u32 s70, s70, 3072
	v_lshl_add_u32 v22, v0, 2, s70
	v_mov_b32 v44, 0
	s_movk_i32 s70, 0x2000
	buffer_store_dword v44, v22, s[36:39], 0 offen sc1
	buffer_store_dword v44, v22, s[36:39], s70 offen sc1
	s_mul_i32 s64, s3, 3
	s_add_u32 s64, s64, 1
	s_min_u32 s67, s5, 2
	s_cmp_eq_u32 s3, 0
	s_cselect_b32 s64, 0, s64
	s_cselect_b32 s67, s5, s67
	s_add_u32 s65, s64, s67
	s_add_u32 s8, s64, 0
	s_sub_u32 s68, s8, 10
	s_cmp_ge_u32 s8, 10
	s_cselect_b32 s8, s68, s8
	s_mul_i32 s8, s8, 786432
	s_add_u32 s9, s64, 1
	s_sub_u32 s68, s9, 10
	s_cmp_ge_u32 s9, 10
	s_cselect_b32 s9, s68, s9
	s_mul_i32 s9, s9, 786432
	s_add_u32 s10, s64, 2
	s_sub_u32 s68, s10, 10
	s_cmp_ge_u32 s10, 10
	s_cselect_b32 s10, s68, s10
	s_mul_i32 s10, s10, 786432
	s_add_u32 s11, s64, 3
	s_sub_u32 s68, s11, 10
	s_cmp_ge_u32 s11, 10
	s_cselect_b32 s11, s68, s11
	s_mul_i32 s11, s11, 786432
	s_add_u32 s12, s64, 4
	s_sub_u32 s68, s12, 10
	s_cmp_ge_u32 s12, 10
	s_cselect_b32 s12, s68, s12
	s_mul_i32 s12, s12, 786432
	s_add_u32 s13, s64, 5
	s_sub_u32 s68, s13, 10
	s_cmp_ge_u32 s13, 10
	s_cselect_b32 s13, s68, s13
	s_mul_i32 s13, s13, 786432
	s_add_u32 s14, s64, 6
	s_sub_u32 s68, s14, 10
	s_cmp_ge_u32 s14, 10
	s_cselect_b32 s14, s68, s14
	s_mul_i32 s14, s14, 786432
	s_add_u32 s15, s64, 7
	s_sub_u32 s68, s15, 10
	s_cmp_ge_u32 s15, 10
	s_cselect_b32 s15, s68, s15
	s_mul_i32 s15, s15, 786432
	s_add_u32 s16, s64, 8
	s_sub_u32 s68, s16, 10
	s_cmp_ge_u32 s16, 10
	s_cselect_b32 s16, s68, s16
	s_mul_i32 s16, s16, 786432
	s_add_u32 s17, s64, 9
	s_sub_u32 s68, s17, 10
	s_cmp_ge_u32 s17, 10
	s_cselect_b32 s17, s68, s17
	s_mul_i32 s17, s17, 786432
	v_lshrrev_b32 v44, 3, v0
	s_lshl_b32 s67, s5, 4
	v_add_u32 v45, s67, v44
	v_mul_u32_u24 v45, 12288, v45
	s_mul_i32 s67, s4, 384
	s_lshl_b32 s68, s3, 7
	s_add_u32 s67, s67, s68
	v_add_u32 v45, s67, v45
	v_and_b32 v55, 7, v0
	v_lshrrev_b32 v56, 5, v0
	v_lshlrev_b32 v56, 1, v56
	v_xor_b32 v56, v56, v55
	v_lshl_add_u32 v46, v56, 4, v45
	v_xor_b32 v56, 4, v56
	v_lshl_add_u32 v47, v56, 4, v45
	v_add_u32 v47, 98304, v47
	s_lshl_b32 s69, s5, 11
	s_lshl_b32 s70, s5, 12
	s_add_u32 m0, s69, 0
	s_nop 0
	buffer_load_dwordx4 v46, s[48:51], s8 offen lds
	s_add_u32 m0, s69, 1024
	s_nop 0
	buffer_load_dwordx4 v47, s[48:51], s8 offen lds
	s_add_u32 m0, s69, 8192
	s_nop 0
	buffer_load_dwordx4 v46, s[52:55], s8 offen lds
	s_add_u32 m0, s69, 9216
	s_nop 0
	buffer_load_dwordx4 v47, s[52:55], s8 offen lds
	s_add_u32 m0, s69, 16384
	s_nop 0
	buffer_load_dwordx4 v46, s[48:51], s9 offen lds
	s_add_u32 m0, s69, 17408
	s_nop 0
	buffer_load_dwordx4 v47, s[48:51], s9 offen lds
	s_add_u32 m0, s69, 24576
	s_nop 0
	buffer_load_dwordx4 v46, s[52:55], s9 offen lds
	s_add_u32 m0, s69, 25600
	s_nop 0
	buffer_load_dwordx4 v47, s[52:55], s9 offen lds
	s_bfe_u32 s67, s48, 0x30007
	s_add_u32 s67, s67, s3
	s_sub_u32 s67, 19, s67
	s_mul_i32 s67, s67, 3
	s_and_b32 s67, s67, 7
	s_and_b32 s68, s4, 24
	s_add_u32 s67, s67, s68
	s_cmp_eq_u32 s67, s4
	s_cselect_b32 s77, 0, 10
	s_mul_i32 s67, s67, 384
	s_lshl_b32 s68, s3, 7
	s_add_u32 s67, s67, s68
	s_and_b32 s68, s4, 7
	s_lshl_b32 s68, s68, 2
	s_add_u32 s68, s68, s5
	s_mul_i32 s68, s68, 24576
	s_add_u32 s67, s67, s68
	v_and_b32 v55, 1, v0
	v_mul_u32_u24 v55, 12288, v55
	v_add_u32 v55, s67, v55
	v_mov_b32 v58, 0x40000000
	v_lshrrev_b32 v56, 1, v0
	s_add_u32 s67, s64, 0
	v_add_u32 v56, s67, v56
	v_subrev_u32 v57, 10, v56
	v_min_u32 v56, v56, v57
	v_mul_u32_u24 v56, 786432, v56
	v_add_u32 v56, v56, v55
	v_cmp_gt_u32 vcc, s77, v0
	s_nop 1
	v_cndmask_b32 v62, v58, v56, vcc
	v_lshrrev_b32 v56, 1, v0
	s_add_u32 s67, s64, 5
	v_add_u32 v56, s67, v56
	v_subrev_u32 v57, 10, v56
	v_min_u32 v56, v56, v57
	v_mul_u32_u24 v56, 786432, v56
	v_add_u32 v56, v56, v55
	v_cmp_gt_u32 vcc, s77, v0
	s_nop 1
	v_cndmask_b32 v63, v58, v56, vcc
	buffer_load_dword v68, v62, s[48:51], 0 offen
	buffer_load_dword v68, v62, s[52:55], 0 offen
	s_add_u32 m0, s69, 32768
	s_nop 0
	buffer_load_dwordx4 v46, s[48:51], s10 offen lds
	s_add_u32 m0, s69, 33792
	s_nop 0
	buffer_load_dwordx4 v47, s[48:51], s10 offen lds
	s_add_u32 m0, s69, 40960
	s_nop 0
	buffer_load_dwordx4 v46, s[52:55], s10 offen lds
	s_add_u32 m0, s69, 41984
	s_nop 0
	buffer_load_dwordx4 v47, s[52:55], s10 offen lds
	v_and_b32 v44, 7, v0
	v_mul_u32_u24 v44, 1280, v44
	v_lshl_add_u32 v44, v41, 5, v44
	v_bfe_u32 v45, v0, 3, 1
	v_lshl_add_u32 v44, v45, 4, v44
	s_add_u32 s78, s5, 0
	s_add_u32 s67, s64, s78
	s_sub_u32 s68, s67, 10
	s_cmp_ge_u32 s67, 10
	s_cselect_b32 s67, s68, s67
	s_lshl_b32 s78, s67, 7
	buffer_load_dwordx4 v[120:123], v44, s[60:63], s78 offen
	s_add_u32 s78, s5, 3
	s_add_u32 s67, s64, s78
	s_sub_u32 s68, s67, 10
	s_cmp_ge_u32 s67, 10
	s_cselect_b32 s67, s68, s67
	s_lshl_b32 s78, s67, 7
	buffer_load_dwordx4 v[124:127], v44, s[60:63], s78 offen
	s_lshr_b32 s68, s67, 3
	s_lshl_b32 s68, s68, 13
	s_lshl_b32 s67, s67, 10
	s_add_u32 s67, s67, s68
	s_add_u32 s67, s67, 491520
	v_add_u32 v36, s67, v1
	s_add_u32 s78, s5, 7
	s_add_u32 s67, s64, s78
	s_sub_u32 s68, s67, 10
	s_cmp_ge_u32 s67, 10
	s_cselect_b32 s67, s68, s67
	s_lshl_b32 s78, s67, 7
	buffer_load_dwordx4 v[128:131], v44, s[60:63], s78 offen
	s_lshr_b32 s68, s67, 3
	s_lshl_b32 s68, s68, 13
	s_lshl_b32 s67, s67, 10
	s_add_u32 s67, s67, s68
	s_add_u32 s67, s67, 491520
	v_add_u32 v37, s67, v1
	v_lshrrev_b32 v44, 3, v0
	v_and_b32 v55, 7, v0
	v_mul_u32_u24 v45, 1280, v44
	s_lshl_b32 s67, s65, 7
	s_cmp_eq_u32 s5, 3
	s_cselect_b32 s68, s3, 0
	s_lshl_b32 s68, s68, 28
	s_add_u32 s67, s67, s68
	v_add_u32 v45, s67, v45
	v_lshl_add_u32 v48, v55, 4, v45
	v_xor_b32 v55, 2, v55
	v_lshl_add_u32 v49, v55, 4, v45
	v_add_u32 v49, 20480, v49
	v_lshrrev_b32 v44, 1, v41
	v_and_b32 v45, 1, v41
	v_lshrrev_b32 v55, 1, v42
	v_and_b32 v56, 1, v42
	v_lshlrev_b32 v57, 4, v44
	v_lshl_add_u32 v57, v55, 3, v57
	v_lshl_add_u32 v57, v45, 2, v57
	v_add_u32 v57, v57, v56
	v_lshlrev_b32 v57, 7, v57
	v_lshl_add_u32 v58, v55, 1, v45
	v_xor_b32 v59, s5, v58
	v_lshl_add_u32 v57, v59, 5, v57
	v_lshl_add_u32 v50, v43, 3, v57
	v_lshlrev_b32 v57, 4, v45
	v_lshl_add_u32 v57, v44, 2, v57
	v_add_u32 v57, v57, v56
	v_lshlrev_b32 v57, 7, v57
	s_lshl_b32 s67, s5, 12
	v_add_u32 v57, s67, v57
	v_lshlrev_b32 v58, 1, v58
	v_xor_b32 v58, v58, v43
	v_lshl_add_u32 v51, v58, 4, v57
	v_add_u32 v52, 8, v51
	s_add_u32 s67, s3, 0
	s_sub_u32 s68, s67, 3
	s_cmp_ge_u32 s67, 3
	s_cselect_b32 s67, s68, s67
	s_mov_b32 s74, s67
	s_lshl_b32 s67, s67, 6
	s_mul_i32 s68, s4, 192
	s_add_u32 s67, s67, s68
	s_mul_i32 s71, s67, 1280
	s_add_u32 s67, s3, 1
	s_sub_u32 s68, s67, 3
	s_cmp_ge_u32 s67, 3
	s_cselect_b32 s67, s68, s67
	s_mov_b32 s75, s67
	s_lshl_b32 s67, s67, 6
	s_mul_i32 s68, s4, 192
	s_add_u32 s67, s67, s68
	s_mul_i32 s72, s67, 1280
	s_add_u32 s67, s3, 2
	s_sub_u32 s68, s67, 3
	s_cmp_ge_u32 s67, 3
	s_cselect_b32 s67, s68, s67
	s_mov_b32 s76, s67
	s_lshl_b32 s67, s67, 6
	s_mul_i32 s68, s4, 192
	s_add_u32 s67, s67, s68
	s_mul_i32 s73, s67, 1280
	s_waitcnt vmcnt(17)
	s_barrier
	s_lshl_b32 s6, s5, 12
	s_add_u32 s6, s6, 96
	v_mov_b32 v44, s6
	v_mov_b32 v45, 1
	s_mov_b64 exec, 1
	buffer_atomic_add v45, v44, s[40:43], 0 offen
	s_mov_b64 exec, -1
	s_add_u32 m0, s69, 49152
	s_nop 0
	buffer_load_dwordx4 v46, s[48:51], s11 offen lds
	s_add_u32 m0, s69, 50176
	s_nop 0
	buffer_load_dwordx4 v47, s[48:51], s11 offen lds
	s_add_u32 m0, s69, 57344
	s_nop 0
	buffer_load_dwordx4 v46, s[52:55], s11 offen lds
	s_add_u32 m0, s69, 58368
	s_nop 0
	buffer_load_dwordx4 v47, s[52:55], s11 offen lds
	s_add_u32 m0, s69, 65536
	s_nop 0
	buffer_load_dwordx4 v46, s[48:51], s12 offen lds
	s_add_u32 m0, s69, 66560
	s_nop 0
	buffer_load_dwordx4 v47, s[48:51], s12 offen lds
	s_add_u32 m0, s69, 73728
	s_nop 0
	buffer_load_dwordx4 v46, s[52:55], s12 offen lds
	s_add_u32 m0, s69, 74752
	s_nop 0
	buffer_load_dwordx4 v47, s[52:55], s12 offen lds
	s_waitcnt vmcnt(22) lgkmcnt(0)
	s_barrier
	v_add_u32 v53, 0, v50
	ds_read_b64_tr_b16 a[80:81], v53 offset:0
	ds_read_b64_tr_b16 a[82:83], v53 offset:256
	ds_read_b64_tr_b16 a[84:85], v53 offset:4096
	ds_read_b64_tr_b16 a[86:87], v53 offset:4352
	ds_read_b64_tr_b16 a[160:161], v53 offset:8192
	ds_read_b64_tr_b16 a[162:163], v53 offset:8448
	ds_read_b64_tr_b16 a[164:165], v53 offset:12288
	ds_read_b64_tr_b16 a[166:167], v53 offset:12544
	buffer_load_dword v68, v63, s[48:51], 0 offen
	buffer_load_dword v68, v63, s[52:55], 0 offen
	s_add_u32 m0, s69, 81920
	s_nop 0
	buffer_load_dwordx4 v46, s[48:51], s13 offen lds
	s_add_u32 m0, s69, 82944
	s_nop 0
	buffer_load_dwordx4 v47, s[48:51], s13 offen lds
	s_add_u32 m0, s69, 90112
	s_nop 0
	buffer_load_dwordx4 v46, s[52:55], s13 offen lds
	s_add_u32 m0, s69, 91136
	s_nop 0
	buffer_load_dwordx4 v47, s[52:55], s13 offen lds
	s_waitcnt vmcnt(24) lgkmcnt(0)
	s_barrier
	v_add_u32 v53, 16384, v50
	ds_read_b64_tr_b16 a[88:89], v53 offset:0
	ds_read_b64_tr_b16 a[90:91], v53 offset:256
	ds_read_b64_tr_b16 a[92:93], v53 offset:4096
	ds_read_b64_tr_b16 a[94:95], v53 offset:4352
	ds_read_b64_tr_b16 a[168:169], v53 offset:8192
	ds_read_b64_tr_b16 a[170:171], v53 offset:8448
	ds_read_b64_tr_b16 a[172:173], v53 offset:12288
	ds_read_b64_tr_b16 a[174:175], v53 offset:12544
	s_add_u32 m0, s69, 98304
	s_nop 0
	buffer_load_dwordx4 v46, s[48:51], s14 offen lds
	s_add_u32 m0, s69, 99328
	s_nop 0
	buffer_load_dwordx4 v47, s[48:51], s14 offen lds
	s_add_u32 m0, s69, 106496
	s_nop 0
	buffer_load_dwordx4 v46, s[52:55], s14 offen lds
	s_add_u32 m0, s69, 107520
	s_nop 0
	buffer_load_dwordx4 v47, s[52:55], s14 offen lds
	s_waitcnt vmcnt(22) lgkmcnt(0)
	s_barrier
	v_add_u32 v53, 32768, v50
	ds_read_b64_tr_b16 a[96:97], v53 offset:0
	ds_read_b64_tr_b16 a[98:99], v53 offset:256
	ds_read_b64_tr_b16 a[100:101], v53 offset:4096
	ds_read_b64_tr_b16 a[102:103], v53 offset:4352
	ds_read_b64_tr_b16 a[176:177], v53 offset:8192
	ds_read_b64_tr_b16 a[178:179], v53 offset:8448
	ds_read_b64_tr_b16 a[180:181], v53 offset:12288
	ds_read_b64_tr_b16 a[182:183], v53 offset:12544
	s_add_u32 m0, s69, 114688
	s_nop 0
	buffer_load_dwordx4 v46, s[48:51], s15 offen lds
	s_add_u32 m0, s69, 115712
	s_nop 0
	buffer_load_dwordx4 v47, s[48:51], s15 offen lds
	s_add_u32 m0, s69, 122880
	s_nop 0
	buffer_load_dwordx4 v46, s[52:55], s15 offen lds
	s_add_u32 m0, s69, 123904
	s_nop 0
	buffer_load_dwordx4 v47, s[52:55], s15 offen lds
	s_waitcnt vmcnt(18) lgkmcnt(0)
	s_barrier
	v_add_u32 v53, 49152, v50
	ds_read_b64_tr_b16 a[104:105], v53 offset:0
	ds_read_b64_tr_b16 a[106:107], v53 offset:256
	ds_read_b64_tr_b16 a[108:109], v53 offset:4096
	ds_read_b64_tr_b16 a[110:111], v53 offset:4352
	ds_read_b64_tr_b16 a[184:185], v53 offset:8192
	ds_read_b64_tr_b16 a[186:187], v53 offset:8448
	ds_read_b64_tr_b16 a[188:189], v53 offset:12288
	ds_read_b64_tr_b16 a[190:191], v53 offset:12544
	s_add_u32 m0, s69, 131072
	s_nop 0
	buffer_load_dwordx4 v46, s[48:51], s16 offen lds
	s_add_u32 m0, s69, 132096
	s_nop 0
	buffer_load_dwordx4 v47, s[48:51], s16 offen lds
	s_add_u32 m0, s69, 139264
	s_nop 0
	buffer_load_dwordx4 v46, s[52:55], s16 offen lds
	s_add_u32 m0, s69, 140288
	s_nop 0
	buffer_load_dwordx4 v47, s[52:55], s16 offen lds
	s_waitcnt vmcnt(18) lgkmcnt(0)
	s_barrier
	v_add_u32 v53, 65536, v50
	ds_read_b64_tr_b16 a[112:113], v53 offset:0
	ds_read_b64_tr_b16 a[114:115], v53 offset:256
	ds_read_b64_tr_b16 a[116:117], v53 offset:4096
	ds_read_b64_tr_b16 a[118:119], v53 offset:4352
	ds_read_b64_tr_b16 a[192:193], v53 offset:8192
	ds_read_b64_tr_b16 a[194:195], v53 offset:8448
	ds_read_b64_tr_b16 a[196:197], v53 offset:12288
	ds_read_b64_tr_b16 a[198:199], v53 offset:12544
	buffer_load_dword v68, v62, s[44:47], 0 offen
	s_add_u32 m0, s69, 0
	s_nop 0
	buffer_load_dwordx4 v46, s[48:51], s17 offen lds
	s_add_u32 m0, s69, 1024
	s_nop 0
	buffer_load_dwordx4 v47, s[48:51], s17 offen lds
	s_add_u32 m0, s69, 8192
	s_nop 0
	buffer_load_dwordx4 v46, s[52:55], s17 offen lds
	s_add_u32 m0, s69, 9216
	s_nop 0
	buffer_load_dwordx4 v47, s[52:55], s17 offen lds
	s_waitcnt vmcnt(17) lgkmcnt(0)
	s_barrier
	v_add_u32 v53, 81920, v50
	ds_read_b64_tr_b16 a[120:121], v53 offset:0
	ds_read_b64_tr_b16 a[122:123], v53 offset:256
	ds_read_b64_tr_b16 a[124:125], v53 offset:4096
	ds_read_b64_tr_b16 a[126:127], v53 offset:4352
	ds_read_b64_tr_b16 a[200:201], v53 offset:8192
	ds_read_b64_tr_b16 a[202:203], v53 offset:8448
	ds_read_b64_tr_b16 a[204:205], v53 offset:12288
	ds_read_b64_tr_b16 a[206:207], v53 offset:12544
	s_add_u32 m0, s69, 16384
	s_nop 0
	buffer_load_dwordx4 v46, s[44:47], s8 offen nt lds
	s_add_u32 m0, s69, 17408
	s_nop 0
	buffer_load_dwordx4 v47, s[44:47], s8 offen nt lds
	s_add_u32 m0, s69, 24576
	s_nop 0
	buffer_load_dwordx4 v46, s[44:47], s9 offen nt lds
	s_add_u32 m0, s69, 25600
	s_nop 0
	buffer_load_dwordx4 v47, s[44:47], s9 offen nt lds
	s_waitcnt vmcnt(17) lgkmcnt(0)
	s_barrier
	v_add_u32 v53, 98304, v50
	ds_read_b64_tr_b16 a[128:129], v53 offset:0
	ds_read_b64_tr_b16 a[130:131], v53 offset:256
	ds_read_b64_tr_b16 a[132:133], v53 offset:4096
	ds_read_b64_tr_b16 a[134:135], v53 offset:4352
	ds_read_b64_tr_b16 a[208:209], v53 offset:8192
	ds_read_b64_tr_b16 a[210:211], v53 offset:8448
	ds_read_b64_tr_b16 a[212:213], v53 offset:12288
	ds_read_b64_tr_b16 a[214:215], v53 offset:12544
	buffer_load_dword v68, v63, s[44:47], 0 offen
	s_add_u32 m0, s69, 32768
	s_nop 0
	buffer_load_dwordx4 v46, s[44:47], s10 offen nt lds
	s_add_u32 m0, s69, 33792
	s_nop 0
	buffer_load_dwordx4 v47, s[44:47], s10 offen nt lds
	s_add_u32 m0, s69, 40960
	s_nop 0
	buffer_load_dwordx4 v46, s[44:47], s11 offen nt lds
	s_add_u32 m0, s69, 41984
	s_nop 0
	buffer_load_dwordx4 v47, s[44:47], s11 offen nt lds
	s_waitcnt vmcnt(18) lgkmcnt(0)
	s_barrier
	v_add_u32 v53, 114688, v50
	ds_read_b64_tr_b16 a[136:137], v53 offset:0
	ds_read_b64_tr_b16 a[138:139], v53 offset:256
	ds_read_b64_tr_b16 a[140:141], v53 offset:4096
	ds_read_b64_tr_b16 a[142:143], v53 offset:4352
	ds_read_b64_tr_b16 a[216:217], v53 offset:8192
	ds_read_b64_tr_b16 a[218:219], v53 offset:8448
	ds_read_b64_tr_b16 a[220:221], v53 offset:12288
	ds_read_b64_tr_b16 a[222:223], v53 offset:12544
	s_add_u32 m0, s69, 49152
	s_nop 0
	buffer_load_dwordx4 v46, s[44:47], s12 offen nt lds
	s_add_u32 m0, s69, 50176
	s_nop 0
	buffer_load_dwordx4 v47, s[44:47], s12 offen nt lds
	s_add_u32 m0, s69, 57344
	s_nop 0
	buffer_load_dwordx4 v46, s[44:47], s13 offen nt lds
	s_add_u32 m0, s69, 58368
	s_nop 0
	buffer_load_dwordx4 v47, s[44:47], s13 offen nt lds
	s_waitcnt vmcnt(18) lgkmcnt(0)
	s_barrier
	v_add_u32 v53, 131072, v50
	ds_read_b64_tr_b16 a[144:145], v53 offset:0
	ds_read_b64_tr_b16 a[146:147], v53 offset:256
	ds_read_b64_tr_b16 a[148:149], v53 offset:4096
	ds_read_b64_tr_b16 a[150:151], v53 offset:4352
	ds_read_b64_tr_b16 a[224:225], v53 offset:8192
	ds_read_b64_tr_b16 a[226:227], v53 offset:8448
	ds_read_b64_tr_b16 a[228:229], v53 offset:12288
	ds_read_b64_tr_b16 a[230:231], v53 offset:12544
	s_add_u32 m0, s69, 65536
	s_nop 0
	buffer_load_dwordx4 v46, s[44:47], s14 offen nt lds
	s_add_u32 m0, s69, 66560
	s_nop 0
	buffer_load_dwordx4 v47, s[44:47], s14 offen nt lds
	s_add_u32 m0, s69, 73728
	s_nop 0
	buffer_load_dwordx4 v46, s[44:47], s15 offen nt lds
	s_add_u32 m0, s69, 74752
	s_nop 0
	buffer_load_dwordx4 v47, s[44:47], s15 offen nt lds
	s_waitcnt vmcnt(17) lgkmcnt(0)
	s_barrier
	v_add_u32 v53, 0, v50
	ds_read_b64_tr_b16 a[152:153], v53 offset:0
	ds_read_b64_tr_b16 a[154:155], v53 offset:256
	ds_read_b64_tr_b16 a[156:157], v53 offset:4096
	ds_read_b64_tr_b16 a[158:159], v53 offset:4352
	ds_read_b64_tr_b16 a[232:233], v53 offset:8192
	ds_read_b64_tr_b16 a[234:235], v53 offset:8448
	ds_read_b64_tr_b16 a[236:237], v53 offset:12288
	ds_read_b64_tr_b16 a[238:239], v53 offset:12544
	s_add_u32 m0, s69, 81920
	s_nop 0
	buffer_load_dwordx4 v46, s[44:47], s16 offen nt lds
	s_add_u32 m0, s69, 82944
	s_nop 0
	buffer_load_dwordx4 v47, s[44:47], s16 offen nt lds
	s_add_u32 m0, s69, 90112
	s_nop 0
	buffer_load_dwordx4 v46, s[44:47], s17 offen nt lds
	s_add_u32 m0, s69, 91136
	s_nop 0
	buffer_load_dwordx4 v47, s[44:47], s17 offen nt lds
	s_waitcnt vmcnt(17) lgkmcnt(0)
	s_barrier
	v_add_u32 v53, 16384, v50
	ds_read_b64_tr_b16 a[0:1], v53 offset:0
	ds_read_b64_tr_b16 a[2:3], v53 offset:256
	ds_read_b64_tr_b16 a[4:5], v53 offset:4096
	ds_read_b64_tr_b16 a[6:7], v53 offset:4352
	ds_read_b64_tr_b16 a[8:9], v53 offset:8192
	ds_read_b64_tr_b16 a[10:11], v53 offset:8448
	ds_read_b64_tr_b16 a[12:13], v53 offset:12288
	ds_read_b64_tr_b16 a[14:15], v53 offset:12544
	s_add_u32 m0, s70, 98304
	s_add_u32 s67, s71, 0
	buffer_load_dwordx4 v48, s[56:59], s67 offen nt lds
	s_add_u32 m0, s70, 99328
	s_add_u32 s67, s71, 10240
	buffer_load_dwordx4 v48, s[56:59], s67 offen nt lds
	s_add_u32 m0, s70, 100352
	s_add_u32 s67, s71, 0
	buffer_load_dwordx4 v49, s[56:59], s67 offen nt lds
	s_add_u32 m0, s70, 101376
	s_add_u32 s67, s71, 10240
	buffer_load_dwordx4 v49, s[56:59], s67 offen nt lds
	v_mov_b32 v67, 128
	buffer_load_dwordx3 v[64:66], v67, s[40:43], 0 offen sc1
	s_waitcnt vmcnt(17) lgkmcnt(0)
	s_barrier
	v_add_u32 v53, 32768, v50
	ds_read_b64_tr_b16 a[16:17], v53 offset:0
	ds_read_b64_tr_b16 a[18:19], v53 offset:256
	ds_read_b64_tr_b16 a[20:21], v53 offset:4096
	ds_read_b64_tr_b16 a[22:23], v53 offset:4352
	ds_read_b64_tr_b16 a[24:25], v53 offset:8192
	ds_read_b64_tr_b16 a[26:27], v53 offset:8448
	ds_read_b64_tr_b16 a[28:29], v53 offset:12288
	ds_read_b64_tr_b16 a[30:31], v53 offset:12544
	s_add_u32 m0, s70, 114688
	s_add_u32 s67, s71, 40960
	buffer_load_dwordx4 v48, s[56:59], s67 offen nt lds
	s_add_u32 m0, s70, 115712
	s_add_u32 s67, s71, 51200
	buffer_load_dwordx4 v48, s[56:59], s67 offen nt lds
	s_add_u32 m0, s70, 116736
	s_add_u32 s67, s71, 40960
	buffer_load_dwordx4 v49, s[56:59], s67 offen nt lds
	s_add_u32 m0, s70, 117760
	s_add_u32 s67, s71, 51200
	buffer_load_dwordx4 v49, s[56:59], s67 offen nt lds
	s_waitcnt vmcnt(17) lgkmcnt(0)
	s_barrier
	v_add_u32 v53, 49152, v50
	ds_read_b64_tr_b16 a[32:33], v53 offset:0
	ds_read_b64_tr_b16 a[34:35], v53 offset:256
	ds_read_b64_tr_b16 a[36:37], v53 offset:4096
	ds_read_b64_tr_b16 a[38:39], v53 offset:4352
	ds_read_b64_tr_b16 a[40:41], v53 offset:8192
	ds_read_b64_tr_b16 a[42:43], v53 offset:8448
	ds_read_b64_tr_b16 a[44:45], v53 offset:12288
	ds_read_b64_tr_b16 a[46:47], v53 offset:12544
	s_add_u32 m0, s70, 131072
	s_add_u32 s67, s72, 0
	buffer_load_dwordx4 v48, s[56:59], s67 offen nt lds
	s_add_u32 m0, s70, 132096
	s_add_u32 s67, s72, 10240
	buffer_load_dwordx4 v48, s[56:59], s67 offen nt lds
	s_add_u32 m0, s70, 133120
	s_add_u32 s67, s72, 0
	buffer_load_dwordx4 v49, s[56:59], s67 offen nt lds
	s_add_u32 m0, s70, 134144
	s_add_u32 s67, s72, 10240
	buffer_load_dwordx4 v49, s[56:59], s67 offen nt lds
	s_waitcnt vmcnt(17) lgkmcnt(0)
	s_barrier
	v_add_u32 v53, 65536, v50
	ds_read_b64_tr_b16 a[48:49], v53 offset:0
	ds_read_b64_tr_b16 a[50:51], v53 offset:256
	ds_read_b64_tr_b16 a[52:53], v53 offset:4096
	ds_read_b64_tr_b16 a[54:55], v53 offset:4352
	ds_read_b64_tr_b16 a[56:57], v53 offset:8192
	ds_read_b64_tr_b16 a[58:59], v53 offset:8448
	ds_read_b64_tr_b16 a[60:61], v53 offset:12288
	ds_read_b64_tr_b16 a[62:63], v53 offset:12544
	s_add_u32 m0, s70, 0
	s_add_u32 s67, s72, 40960
	buffer_load_dwordx4 v48, s[56:59], s67 offen nt lds
	s_add_u32 m0, s70, 1024
	s_add_u32 s67, s72, 51200
	buffer_load_dwordx4 v48, s[56:59], s67 offen nt lds
	s_add_u32 m0, s70, 2048
	s_add_u32 s67, s72, 40960
	buffer_load_dwordx4 v49, s[56:59], s67 offen nt lds
	s_add_u32 m0, s70, 3072
	s_add_u32 s67, s72, 51200
	buffer_load_dwordx4 v49, s[56:59], s67 offen nt lds
	s_waitcnt vmcnt(17) lgkmcnt(0)
	s_barrier
	v_add_u32 v53, 81920, v50
	ds_read_b64_tr_b16 a[64:65], v53 offset:0
	ds_read_b64_tr_b16 a[66:67], v53 offset:256
	ds_read_b64_tr_b16 a[68:69], v53 offset:4096
	ds_read_b64_tr_b16 a[70:71], v53 offset:4352
	ds_read_b64_tr_b16 a[72:73], v53 offset:8192
	ds_read_b64_tr_b16 a[74:75], v53 offset:8448
	ds_read_b64_tr_b16 a[76:77], v53 offset:12288
	ds_read_b64_tr_b16 a[78:79], v53 offset:12544
	s_add_u32 m0, s70, 16384
	s_add_u32 s67, s73, 0
	buffer_load_dwordx4 v48, s[56:59], s67 offen nt lds
	s_add_u32 m0, s70, 17408
	s_add_u32 s67, s73, 10240
	buffer_load_dwordx4 v48, s[56:59], s67 offen nt lds
	s_add_u32 m0, s70, 18432
	s_add_u32 s67, s73, 0
	buffer_load_dwordx4 v49, s[56:59], s67 offen nt lds
	s_add_u32 m0, s70, 19456
	s_add_u32 s67, s73, 10240
	buffer_load_dwordx4 v49, s[56:59], s67 offen nt lds
	s_waitcnt vmcnt(17) lgkmcnt(0)
	s_barrier
	v_add_u32 v53, 98304, v51
	v_add_u32 v54, 98304, v52
	ds_read_b64_tr_b16 v[160:161], v53 offset:0
	ds_read_b64_tr_b16 v[162:163], v53 offset:256
	ds_read_b64_tr_b16 v[164:165], v53 offset:1024
	ds_read_b64_tr_b16 v[166:167], v53 offset:1280
	ds_read_b64_tr_b16 v[168:169], v54 offset:0
	ds_read_b64_tr_b16 v[170:171], v54 offset:256
	ds_read_b64_tr_b16 v[172:173], v54 offset:1024
	ds_read_b64_tr_b16 v[174:175], v54 offset:1280
	s_add_u32 m0, s70, 32768
	s_add_u32 s67, s73, 40960
	buffer_load_dwordx4 v48, s[56:59], s67 offen nt lds
	s_add_u32 m0, s70, 33792
	s_add_u32 s67, s73, 51200
	buffer_load_dwordx4 v48, s[56:59], s67 offen nt lds
	s_add_u32 m0, s70, 34816
	s_add_u32 s67, s73, 40960
	buffer_load_dwordx4 v49, s[56:59], s67 offen nt lds
	s_add_u32 m0, s70, 35840
	s_add_u32 s67, s73, 51200
	buffer_load_dwordx4 v49, s[56:59], s67 offen nt lds
	s_waitcnt vmcnt(16) lgkmcnt(0)
	s_barrier
	v_add_u32 v53, 114688, v51
	v_add_u32 v54, 114688, v52
	ds_read_b64_tr_b16 v[176:177], v53 offset:0
	ds_read_b64_tr_b16 v[178:179], v53 offset:256
	ds_read_b64_tr_b16 v[180:181], v53 offset:1024
	ds_read_b64_tr_b16 v[182:183], v53 offset:1280
	ds_read_b64_tr_b16 v[184:185], v54 offset:0
	ds_read_b64_tr_b16 v[186:187], v54 offset:256
	ds_read_b64_tr_b16 v[188:189], v54 offset:1024
	ds_read_b64_tr_b16 v[190:191], v54 offset:1280
	s_waitcnt vmcnt(20)
	v_and_b32 v44, 7, v0
	v_bfe_u32 v45, v0, 3, 1
	v_and_b32 v55, 1, v41
	v_lshrrev_b32 v56, 1, v41
	v_lshlrev_b32 v57, 3, v55
	v_lshl_add_u32 v57, v56, 2, v57
	v_cmp_ne_u32 vcc, 0, v45
	s_lshl_b32 s67, s5, 8
	v_lshlrev_b32 v6, 2, v0
	v_add_u32 v7, s67, v6
	s_add_u32 s67, s67, 12288
	v_lshl_add_u32 v58, v40, 4, v57
	v_add_u32 v9, s67, v58
	s_lshl_b32 s67, s5, 9
	s_add_u32 s67, s67, 13312
	v_lshlrev_b32 v58, 3, v41
	v_lshl_add_u32 v58, v40, 5, v58
	v_add_u32 v10, s67, v58
	v_lshl_add_u32 v58, v41, 2, v42
	v_and_b32 v59, 1, v0
	v_lshlrev_b32 v59, 3, v59
	v_lshl_add_u32 v59, v58, 4, v59
	v_add_u32 v11, 12288, v59
	v_lshlrev_b32 v59, 3, v43
	v_lshl_add_u32 v59, v58, 5, v59
	v_add_u32 v12, 13312, v59
	v_lshlrev_b32 v58, 3, v0
	v_add_u32 v23, 24576, v58
	v_lshlrev_b32 v58, 7, v41
	v_lshl_add_u32 v58, v44, 4, v58
	v_add_u32 v14, 16384, v58
	s_lshr_b32 s67, s5, 1
	s_lshl_b32 s67, s67, 9
	s_and_b32 s68, s5, 1
	s_lshl_b32 s68, s68, 3
	s_add_u32 s67, s67, s68
	v_add_u32 v58, s67, v14
	v_lshl_add_u32 v13, v45, 12, v58
	s_lshl_b32 s67, s5, 3
	v_lshl_add_u32 v58, v56, 2, v42
	v_add_u32 v58, s67, v58
	v_add_u32 v59, s4, v58
	v_and_b32 v59, 31, v59
	v_lshlrev_b32 v58, 12, v58
	v_lshl_add_u32 v58, v59, 7, v58
	v_lshl_add_u32 v59, v55, 2, v43
	v_lshl_add_u32 v58, v59, 4, v58
	s_lshl_b32 s67, s3, 17
	s_add_u32 s67, s67, 0x4000000
	v_add_u32 v4, s67, v58
	v_mov_b32 v58, 0x4444
	v_mov_b32 v59, 0xeeee
	v_cndmask_b32 v21, v58, v59, vcc
	v_and_b32 v58, 1, v0
	v_lshlrev_b32 v58, 4, v58
	v_mov_b32 v59, 0x3f80
	v_lshlrev_b32 v58, v58, v59
	v_lshrrev_b32 v59, 1, v44
	v_cmp_eq_u32 vcc, 0, v59
	s_nop 1
	v_cndmask_b32 v60, 0, v58, vcc
	v_accvgpr_write_b32 a240, v60
	v_cmp_eq_u32 vcc, 1, v59
	s_nop 1
	v_cndmask_b32 v60, 0, v58, vcc
	v_accvgpr_write_b32 a241, v60
	v_cmp_eq_u32 vcc, 2, v59
	s_nop 1
	v_cndmask_b32 v60, 0, v58, vcc
	v_accvgpr_write_b32 a242, v60
	v_cmp_eq_u32 vcc, 3, v59
	s_nop 1
	v_cndmask_b32 v60, 0, v58, vcc
	v_accvgpr_write_b32 a243, v60
	v_mov_b32 v59, 0x3f803f80
	v_accvgpr_write_b32 a244, v59
	v_accvgpr_write_b32 a245, v59
	v_accvgpr_write_b32 a246, v59
	v_accvgpr_write_b32 a247, v59
	v_mov_b32 v29, 0
	v_mov_b32 v30, 0
	v_mov_b32 v31, 0
	v_mov_b32 v100, 0
	v_mov_b32 v101, 0
	v_mov_b32 v102, 0
	v_mov_b32 v103, 0
	v_mov_b32 v104, 0
	v_mov_b32 v105, 0
	v_mov_b32 v106, 0
	v_mov_b32 v107, 0
	v_readfirstlane_b32 s6, v64
	s_nop 0
	s_cmp_ge_u32 s6, 256
	s_cbranch_scc1 L_swok_8
	v_mov_b32 v67, 128
L_sw_7:
	buffer_load_dwordx3 v[64:66], v67, s[40:43], 0 offen sc1
	s_waitcnt vmcnt(0)
	v_readfirstlane_b32 s6, v64
	s_nop 0
	s_cmp_ge_u32 s6, 256
	s_cbranch_scc1 L_swok_8
	s_sleep 4
	s_add_u32 s34, s34, 1
	s_cmp_lt_u32 s34, 0x40000
	s_cbranch_scc1 L_sw_7
	s_endpgm
L_swok_8:
	v_readfirstlane_b32 s72, v65
	v_readfirstlane_b32 s73, v66
	s_mul_i32 s67, s3, 3
	s_add_u32 s67, s67, 1
	s_cmp_eq_u32 s3, 0
	s_cselect_b32 s67, 0, s67
	s_lshr_b32 s77, s4, 3
	s_add_u32 s67, s67, s77
	s_cmp_ge_u32 s4, 24
	s_cselect_b32 s77, s3, 0
	s_add_u32 s78, s77, 9
	s_cmp_lg_u32 s77, 0
	s_cselect_b32 s67, s78, s67
	s_lshr_b32 s77, s67, 3
	s_lshl_b32 s77, s77, 14
	s_and_b32 s67, s67, 7
	s_lshl_b32 s67, s67, 10
	s_add_u32 s67, s67, s77
	s_and_b32 s77, s4, 7
	s_lshl_b32 s77, s77, 7
	s_add_u32 s67, s67, s77
	v_cmp_ne_u32 vcc, 0, v45
	s_and_b32 s20, s72, 1
	s_lshl_b32 s20, s20, 13
	s_add_u32 s20, s20, 0x180000
	s_and_b32 s21, s72, 16
	s_lshl_b32 s21, s21, 9
	s_add_u32 s21, s21, 0x980000
	v_mov_b32 v60, s20
	v_mov_b32 v61, s21
	v_cndmask_b32 v60, v60, v61, vcc
	s_mov_b32 s24, 0
	v_lshl_add_u32 v59, v55, 2, v43
	v_lshlrev_b32 v59, 4, v59
	v_bfe_u32 v61, v0, 2, 1
	v_lshl_add_u32 v59, v61, 3, v59
	v_lshl_add_u32 v59, v56, 2, v59
	v_add3_u32 v3, v59, v60, s67
	s_lshl_b32 s77, s3, 13
	s_add_u32 s77, s77, 0x4060000
	s_lshl_b32 s67, s4, 7
	s_add_u32 s67, s67, s77
	v_lshl_add_u32 v59, v45, 12, v59
	v_add_u32 v8, s67, v59
	s_lshl_b32 s64, s4, 2
	s_add_u32 s64, s64, 1
	s_lshl_b32 s64, s64, 19
	s_lshr_b32 s66, s72, s4
	s_xor_b32 s66, s66, 0
	s_and_b32 s66, s66, 1
	s_lshl_b32 s66, s66, 13
	s_add_u32 s64, s64, s66
	s_add_u32 s66, s4, s74
	s_bfe_u32 s67, s66, 0x10001
	s_lshl_b32 s67, s67, 14
	s_and_b32 s66, s66, 1
	s_lshl_b32 s66, s66, 12
	s_add_u32 s66, s66, s67
	s_add_u32 s64, s64, s66
	v_add_u32 v19, s64, v2
	s_lshl_b32 s64, s4, 2
	s_add_u32 s64, s64, 2
	s_lshl_b32 s64, s64, 19
	s_lshr_b32 s66, s72, s4
	s_xor_b32 s66, s66, 0
	s_and_b32 s66, s66, 1
	s_lshl_b32 s66, s66, 13
	s_add_u32 s64, s64, s66
	s_add_u32 s66, s4, s74
	s_bfe_u32 s67, s66, 0x10001
	s_lshl_b32 s67, s67, 14
	s_and_b32 s66, s66, 1
	s_lshl_b32 s66, s66, 12
	s_add_u32 s66, s66, s67
	s_add_u32 s65, s64, s66
	v_add_u32 v16, s65, v2
	s_add_u32 s66, s4, s75
	s_bfe_u32 s67, s66, 0x10001
	s_lshl_b32 s67, s67, 14
	s_and_b32 s66, s66, 1
	s_lshl_b32 s66, s66, 12
	s_add_u32 s66, s66, s67
	s_add_u32 s65, s64, s66
	v_add_u32 v17, s65, v2
	s_add_u32 s66, s4, s76
	s_bfe_u32 s67, s66, 0x10001
	s_lshl_b32 s67, s67, 14
	s_and_b32 s66, s66, 1
	s_lshl_b32 s66, s66, 12
	s_add_u32 s66, s66, s67
	s_add_u32 s65, s64, s66
	v_add_u32 v18, s65, v2
	s_lshl_b32 s64, s4, 2
	s_add_u32 s64, s64, 0
	s_lshl_b32 s64, s64, 19
	s_lshr_b32 s66, s72, s4
	s_xor_b32 s66, s66, 0
	s_and_b32 s66, s66, 1
	s_lshl_b32 s66, s66, 13
	s_add_u32 s64, s64, s66
	v_add_u32 v22, s66, v22
	v_mov_b32 v60, 0xfe00000
	v_cmp_gt_u32 vcc, 16, v0
	s_nop 1
	v_cndmask_b32 v22, v60, v22, vcc
	s_add_u32 s66, s4, 3
	s_bfe_u32 s67, s66, 0x10001
	s_lshl_b32 s67, s67, 14
	s_and_b32 s66, s66, 1
	s_lshl_b32 s66, s66, 12
	s_add_u32 s66, s66, s67
	s_add_u32 s65, s64, s66
	s_lshl_b32 s66, s3, 10
	s_add_u32 s13, s65, s66
	s_add_u32 s66, s65, 1605632
	v_min_u32 v60, 5, v0
	v_lshl_add_u32 v20, v60, 7, s66
	s_add_u32 s65, s65, 1575936
	v_mov_b32 v38, 0xfe00000
	s_lshl_b32 s66, s75, 8
	s_add_u32 s66, s66, s65
	v_writelane_b32 v38, s66, 0
	s_lshl_b32 s66, s76, 8
	s_add_u32 s66, s66, s65
	v_writelane_b32 v38, s66, 1
	s_add_u32 s66, s4, s74
	s_bfe_u32 s67, s66, 0x10001
	s_lshl_b32 s67, s67, 14
	s_and_b32 s66, s66, 1
	s_lshl_b32 s66, s66, 12
	s_add_u32 s66, s66, s67
	s_add_u32 s65, s64, s66
	s_lshr_b32 s66, s4, 2
	s_add_u32 s66, s66, 0
	s_and_b32 s66, s66, 3
	s_mul_i32 s66, s66, 768
	s_bitcmp0_b32 s4, 4
	s_cselect_b32 s67, 0x400, 0
	s_add_u32 s66, s66, s67
	s_add_u32 s8, s65, s66
	s_lshr_b32 s66, s4, 2
	s_add_u32 s66, s66, 1
	s_and_b32 s66, s66, 3
	s_mul_i32 s66, s66, 768
	s_bitcmp0_b32 s4, 4
	s_cselect_b32 s67, 0x400, 0
	s_add_u32 s66, s66, s67
	s_add_u32 s9, s65, s66
	s_lshr_b32 s66, s4, 2
	s_add_u32 s66, s66, 2
	s_and_b32 s66, s66, 3
	s_mul_i32 s66, s66, 768
	s_bitcmp0_b32 s4, 4
	s_cselect_b32 s67, 0x400, 0
	s_add_u32 s66, s66, s67
	s_add_u32 s10, s65, s66
	s_lshr_b32 s66, s4, 2
	s_add_u32 s66, s66, 3
	s_and_b32 s66, s66, 3
	s_mul_i32 s66, s66, 768
	s_bitcmp0_b32 s4, 4
	s_cselect_b32 s67, 0x400, 0
	s_add_u32 s66, s66, s67
	s_add_u32 s11, s65, s66
	s_bfe_u32 s66, s4, 0x10004
	s_mul_i32 s66, s66, 3072
	s_add_u32 s12, s65, s66
	s_add_u32 s66, s4, s75
	s_bfe_u32 s67, s66, 0x10001
	s_lshl_b32 s67, s67, 14
	s_and_b32 s66, s66, 1
	s_lshl_b32 s66, s66, 12
	s_add_u32 s66, s66, s67
	s_add_u32 s14, s64, s66
	s_bfe_u32 s66, s4, 0x10004
	s_mul_i32 s66, s66, 3072
	s_add_u32 s16, s14, s66
	s_add_u32 s66, s4, s76
	s_bfe_u32 s67, s66, 0x10001
	s_lshl_b32 s67, s67, 14
	s_and_b32 s66, s66, 1
	s_lshl_b32 s66, s66, 12
	s_add_u32 s66, s66, s67
	s_add_u32 s15, s64, s66
	s_bfe_u32 s66, s4, 0x10004
	s_mul_i32 s66, s66, 3072
	s_add_u32 s17, s15, s66
	s_lshr_b32 s70, s4, 2
	s_add_u32 s70, s70, 0
	s_and_b32 s70, s70, 3
	s_mul_i32 s70, s70, 768
	s_bitcmp0_b32 s4, 4
	s_cselect_b32 s71, 0x400, 0
	s_add_u32 s70, s70, s71
	s_add_u32 s64, s14, s70
	s_lshr_b32 s70, s4, 2
	s_add_u32 s70, s70, 1
	s_and_b32 s70, s70, 3
	s_mul_i32 s70, s70, 768
	s_bitcmp0_b32 s4, 4
	s_cselect_b32 s71, 0x400, 0
	s_add_u32 s70, s70, s71
	s_add_u32 s66, s14, s70
	s_lshr_b32 s70, s4, 2
	s_add_u32 s70, s70, 2
	s_and_b32 s70, s70, 3
	s_mul_i32 s70, s70, 768
	s_bitcmp0_b32 s4, 4
	s_cselect_b32 s71, 0x400, 0
	s_add_u32 s70, s70, s71
	s_add_u32 s68, s14, s70
	s_lshr_b32 s70, s4, 2
	s_add_u32 s70, s70, 0
	s_and_b32 s70, s70, 3
	s_mul_i32 s70, s70, 768
	s_bitcmp0_b32 s4, 4
	s_cselect_b32 s71, 0x400, 0
	s_add_u32 s70, s70, s71
	s_add_u32 s65, s15, s70
	s_lshr_b32 s70, s4, 2
	s_add_u32 s70, s70, 1
	s_and_b32 s70, s70, 3
	s_mul_i32 s70, s70, 768
	s_bitcmp0_b32 s4, 4
	s_cselect_b32 s71, 0x400, 0
	s_add_u32 s70, s70, s71
	s_add_u32 s67, s15, s70
	s_lshr_b32 s70, s4, 2
	s_add_u32 s70, s70, 2
	s_and_b32 s70, s70, 3
	s_mul_i32 s70, s70, 768
	s_bitcmp0_b32 s4, 4
	s_cselect_b32 s71, 0x400, 0
	s_add_u32 s70, s70, s71
	s_add_u32 s69, s15, s70
	v_cmp_ne_u32 s[6:7], 0, v45
	s_mov_b32 s60, 0
	s_mov_b32 s61, 0
	s_mov_b32 s26, 0
	s_cmp_eq_u32 s3, 0
	s_cselect_b32 s18, -2, 0
	v_mov_b32 v39, s18
	s_cmp_ge_u32 s4, 24
	s_cselect_b32 s18, s3, 0
	s_mov_b32 s62, 0x3dd53b95
	s_mov_b32 s79, 0x3f80
	s_mov_b32 s35, 0x3f800000
	s_mov_b32 s76, 0
	s_mov_b32 s33, 0
	s_mov_b32 s78, 1
	v_and_b32 v58, 31, v0
	v_lshlrev_b32 v58, 2, v58
	v_min_u32 v59, 55, v0
	v_lshl_add_u32 v33, v59, 7, v58
	v_mov_b32 v32, v33
	v_mov_b32 v15, v1
	s_mov_b32 s27, 1
	v_mov_b32 v80, 0
	v_mov_b32 v81, 0
	v_mov_b32 v82, 0
	v_mov_b32 v83, 0
	v_mov_b32 v84, 0
	v_mov_b32 v85, 0
	v_mov_b32 v86, 0
	v_mov_b32 v87, 0
	v_mov_b32 v88, 0
	v_mov_b32 v89, 0
	v_mov_b32 v90, 0
	v_mov_b32 v91, 0
	v_mov_b32 v148, 0
	v_mov_b32 v149, 0
	v_mov_b32 v150, 0
	v_mov_b32 v151, 0
	v_mov_b32 v152, 0
	v_mov_b32 v153, 0
	v_mov_b32 v154, 0
	v_mov_b32 v155, 0
	s_waitcnt vmcnt(12) lgkmcnt(0)
	s_barrier
	v_add_u32 v53, 131072, v51
	v_add_u32 v54, 131072, v52
	ds_read_b64_tr_b16 v[192:193], v53 offset:0
	ds_read_b64_tr_b16 v[194:195], v53 offset:256
	ds_read_b64_tr_b16 v[196:197], v53 offset:1024
	ds_read_b64_tr_b16 v[198:199], v53 offset:1280
	ds_read_b64_tr_b16 v[200:201], v54 offset:0
	ds_read_b64_tr_b16 v[202:203], v54 offset:256
	ds_read_b64_tr_b16 v[204:205], v54 offset:1024
	ds_read_b64_tr_b16 v[206:207], v54 offset:1280
	s_waitcnt vmcnt(8) lgkmcnt(0)
	s_barrier
	v_add_u32 v53, 0, v51
	v_add_u32 v54, 0, v52
	ds_read_b64_tr_b16 v[208:209], v53 offset:0
	ds_read_b64_tr_b16 v[210:211], v53 offset:256
	ds_read_b64_tr_b16 v[212:213], v53 offset:1024
	ds_read_b64_tr_b16 v[214:215], v53 offset:1280
	ds_read_b64_tr_b16 v[216:217], v54 offset:0
	ds_read_b64_tr_b16 v[218:219], v54 offset:256
	ds_read_b64_tr_b16 v[220:221], v54 offset:1024
	ds_read_b64_tr_b16 v[222:223], v54 offset:1280
	buffer_load_dword v34, v20, s[36:39], 0 offen sc1
	s_waitcnt vmcnt(5) lgkmcnt(0)
	s_barrier
	v_add_u32 v53, 16384, v51
	v_add_u32 v54, 16384, v52
	ds_read_b64_tr_b16 v[224:225], v53 offset:0
	ds_read_b64_tr_b16 v[226:227], v53 offset:256
	ds_read_b64_tr_b16 v[228:229], v53 offset:1024
	ds_read_b64_tr_b16 v[230:231], v53 offset:1280
	ds_read_b64_tr_b16 v[232:233], v54 offset:0
	ds_read_b64_tr_b16 v[234:235], v54 offset:256
	ds_read_b64_tr_b16 v[236:237], v54 offset:1024
	ds_read_b64_tr_b16 v[238:239], v54 offset:1280
	s_waitcnt vmcnt(1) lgkmcnt(0)
	s_barrier
	v_add_u32 v53, 32768, v51
	v_add_u32 v54, 32768, v52
	ds_read_b64_tr_b16 v[240:241], v53 offset:0
	ds_read_b64_tr_b16 v[242:243], v53 offset:256
	ds_read_b64_tr_b16 v[244:245], v53 offset:1024
	ds_read_b64_tr_b16 v[246:247], v53 offset:1280
	ds_read_b64_tr_b16 v[248:249], v54 offset:0
	ds_read_b64_tr_b16 v[250:251], v54 offset:256
	ds_read_b64_tr_b16 v[252:253], v54 offset:1024
	ds_read_b64_tr_b16 v[254:255], v54 offset:1280
	s_waitcnt vmcnt(0)
	v_cmp_gt_u32 vcc, s78, v34
	s_cbranch_vccz L_fwok_10
L_fw_9:
	buffer_load_dword v34, v20, s[36:39], 0 offen sc1
	s_waitcnt vmcnt(0)
	v_cmp_gt_u32 vcc, s78, v34
	s_cbranch_vccz L_fwok_10
	s_add_u32 s34, s34, 1
	s_cmp_lt_u32 s34, 0x40000
	s_cbranch_scc1 L_fw_9
	s_endpgm
L_fwok_10:
	buffer_load_dwordx4 v[92:95], v19, s[36:39], 0 offen offset:0 sc1
	buffer_load_dwordx4 v[96:99], v19, s[36:39], 0 offen offset:2048 sc1
	buffer_load_dwordx4 v[108:111], v16, s[36:39], 0 offen sc1
	buffer_load_dwordx4 v[112:115], v17, s[36:39], 0 offen sc1
	buffer_load_dwordx4 v[116:119], v18, s[36:39], 0 offen sc1
	s_waitcnt lgkmcnt(0)
	s_barrier
	ds_write_b128 v2, v[120:123] offset:0
	ds_write_b128 v2, v[124:127] offset:32768
	ds_write_b128 v2, v[128:131] offset:36864
	s_mov_b32 s78, 2
	s_waitcnt vmcnt(0) lgkmcnt(0)
	s_barrier
	v_mov_b32 v34, 1
	s_mov_b32 s31, 0
	s_cmp_lg_u32 s5, 3
	s_cbranch_scc1 L_cw3_11
	v_mov_b32 v92, 0
	v_mov_b32 v93, 0
	v_mov_b32 v94, 0
	v_mov_b32 v95, 0
	v_mov_b32 v96, 0
	v_mov_b32 v97, 0
	v_mov_b32 v98, 0
	v_mov_b32 v99, 0
	v_writelane_b32 v99, 1, 0
	v_writelane_b32 v99, 1, 1
L_cw3_11:
	s_cmp_eq_u32 s5, 1
	s_cbranch_scc1 L_c1_own
	s_cmp_eq_u32 s5, 2
	s_cbranch_scc1 L_c2_own
	s_cmp_eq_u32 s5, 3
	s_cbranch_scc1 L_c3_own
	s_branch L_c0_own
.p2align 6
L_c0_ag:
	s_add_u32 s60, s60, 1
	s_xor_b32 s61, s61, 1
	s_mov_b32 s27, 0
	s_mov_b32 s28, 0
	s_mov_b32 s19, 0
	s_cmp_eq_u32 s3, 0
	s_cselect_b32 s26, s61, s60
	v_mov_b32 v15, v1
	v_mov_b32 v32, v33
	s_nop 15
	s_nop 15
	s_nop 15
	s_nop 15
	s_nop 5
	buffer_load_dwordx4 v[120:123], v2, s[36:39], s77 offen sc1
	s_nop 15
	s_nop 15
	s_nop 3
	buffer_load_dwordx4 v[124:127], v2, s[36:39], s77 offen sc1
	s_mov_b32 m0, 32768
	s_nop 0
	buffer_load_dwordx4 v36, s[36:39], s20 offen sc1 lds
	s_mov_b32 m0, 36864
	s_nop 0
	buffer_load_dwordx4 v37, s[36:39], s20 offen sc1 lds
	s_waitcnt vmcnt(3)
	v_max3_u32 v144, v120, v121, v122
	v_max_u32 v144, v144, v123
	v_cmp_eq_u32 vcc, -1, v144
	ds_write_b128 v2, v[120:123] offset:0
	s_cbranch_vccnz L_of_12
L_ook_13:
	s_xor_b32 s77, s77, 0x1000
	s_mov_b32 m0, 49152
	s_nop 0
	buffer_load_dwordx4 v36, s[36:39], s21 offen sc1 lds
	s_mov_b32 m0, 53248
	s_nop 0
	buffer_load_dwordx4 v37, s[36:39], s21 offen sc1 lds
	s_waitcnt lgkmcnt(0)
	s_barrier
L_c0_own:
	ds_read_b128 v[40:43], v1 offset:0
	ds_read_b128 v[44:47], v1 offset:1024
	ds_read_b128 v[48:51], v1 offset:2048
	buffer_load_dwordx4 v[112:115], v17, s[36:39], s76 offen sc1
	s_waitcnt lgkmcnt(2)
	v_smfmac_f32_16x16x64_bf16 v[80:83], v[40:43], a[0:7], v21
	v_smfmac_f32_16x16x64_bf16 v[84:87], v[40:43], a[80:87], v21
	s_waitcnt lgkmcnt(1)
	v_smfmac_f32_16x16x64_bf16 v[80:83], v[44:47], a[8:15], v21
	v_smfmac_f32_16x16x64_bf16 v[84:87], v[44:47], a[88:95], v21
	buffer_load_dwordx4 v[116:119], v18, s[36:39], s76 offen sc1
	s_waitcnt lgkmcnt(0)
	v_smfmac_f32_16x16x64_bf16 v[80:83], v[48:51], a[16:23], v21
	v_smfmac_f32_16x16x64_bf16 v[84:87], v[48:51], a[96:103], v21
	buffer_load_dword v39, v20, s[36:39], s31 offen sc1
	v_smfmac_f32_16x16x64_bf16 v[88:91], v[40:43], a[160:167], v21
	v_smfmac_f32_16x16x64_bf16 v[88:91], v[44:47], a[168:175], v21
	v_smfmac_f32_16x16x64_bf16 v[88:91], v[48:51], a[176:183], v21
	s_waitcnt vmcnt(5)
	s_barrier
L_c0_top:
	ds_read_b128 v[52:55], v15 offset:32768
	ds_read_b32 v144, v32 offset:32768
	ds_read_b128 v[56:59], v15 offset:33792
	ds_read_b128 v[60:63], v15 offset:34816
	ds_read_b128 v[64:67], v15 offset:35840
	ds_read_b128 v[68:71], v15 offset:36864
	s_waitcnt lgkmcnt(5)
	v_smfmac_f32_16x16x64_bf16 v[80:83], v[52:55], a[24:31], v21
	ds_read_b128 v[72:75], v15 offset:37888
	s_waitcnt lgkmcnt(5)
	v_cmp_eq_u32 vcc, -1, v144
	s_waitcnt lgkmcnt(4)
	v_smfmac_f32_16x16x64_bf16 v[80:83], v[56:59], a[32:39], v21
	ds_read_b128 v[76:79], v15 offset:38912
	s_cbranch_vccnz L_cf_14
L_cok_15:
	s_waitcnt lgkmcnt(4)
	v_smfmac_f32_16x16x64_bf16 v[80:83], v[60:63], a[40:47], v21
	s_waitcnt lgkmcnt(3)
	v_smfmac_f32_16x16x64_bf16 v[80:83], v[64:67], a[48:55], v21
	s_waitcnt lgkmcnt(2)
	v_smfmac_f32_16x16x64_bf16 v[80:83], v[68:71], a[56:63], v21
	s_waitcnt lgkmcnt(1)
	v_smfmac_f32_16x16x64_bf16 v[80:83], v[72:75], a[64:71], v21
	s_waitcnt lgkmcnt(0)
	v_smfmac_f32_16x16x64_bf16 v[80:83], v[76:79], a[72:79], v21
	s_nop 0
	v_smfmac_f32_16x16x64_bf16 v[84:87], v[52:55], a[104:111], v21
	s_nop 0
	v_smfmac_f32_16x16x64_bf16 v[84:87], v[56:59], a[112:119], v21
	s_nop 0
	v_smfmac_f32_16x16x64_bf16 v[84:87], v[60:63], a[120:127], v21
	s_nop 0
	v_smfmac_f32_16x16x64_bf16 v[84:87], v[64:67], a[128:135], v21
	v_permlane32_swap_b32 v80, v82
	v_smfmac_f32_16x16x64_bf16 v[84:87], v[68:71], a[136:143], v21
	v_permlane32_swap_b32 v81, v83
	v_smfmac_f32_16x16x64_bf16 v[84:87], v[72:75], a[144:151], v21
	v_add_f32 v80, v80, v82
	v_smfmac_f32_16x16x64_bf16 v[84:87], v[76:79], a[152:159], v21
	v_add_f32 v81, v81, v83
	v_cmp_u_f32 vcc, v80, v81
	v_cvt_pk_bf16_f32 v82, v80, v81
	ds_write_b32 v9, v82
	s_nop 2
	s_cbranch_vccnz L_af_16
L_aok_17:
	v_permlane32_swap_b32 v84, v86
	v_permlane32_swap_b32 v85, v87
	v_pk_add_f32 v[84:85], v[84:85], v[86:87]
	v_cvt_pk_bf16_f32 v101, v84, v85
	ds_write_b32 v10, v101
	v_smfmac_f32_16x16x64_bf16 v[88:91], v[52:55], a[184:191], v21
	v_min_u32 v101, -2, v101
	v_smfmac_f32_16x16x64_bf16 v[88:91], v[56:59], a[192:199], v21
	buffer_store_dword v101, v7, s[36:39], s13 offen sc1
	v_smfmac_f32_16x16x64_bf16 v[88:91], v[60:63], a[200:207], v21
	s_waitcnt lgkmcnt(0)
	s_barrier
	ds_read_b64_tr_b16 v[120:121], v11 offset:0
	ds_read_b64_tr_b16 v[122:123], v11 offset:256
	ds_read_b64_tr_b16 v[124:125], v11 offset:512
	ds_read_b64_tr_b16 v[126:127], v11 offset:768
	v_smfmac_f32_16x16x64_bf16 v[88:91], v[64:67], a[208:215], v21
	v_smfmac_f32_16x16x64_bf16 v[88:91], v[68:71], a[216:223], v21
	s_waitcnt lgkmcnt(2)
	v_mfma_f32_16x16x32_bf16 v[128:131], v[92:95], v[120:123], 0
	s_waitcnt lgkmcnt(0)
	v_mfma_f32_16x16x32_bf16 v[128:131], v[96:99], v[124:127], v[128:131]
	s_nop 7
	v_cndmask_b32 v128, v128, v130, s[6:7]
	v_cndmask_b32 v129, v129, v131, s[6:7]
	v_cvt_pk_bf16_f32 v130, v128, v129
	v_min_u32 v130, -2, v130
	buffer_store_dword v130, v7, s[36:39], s8 offen sc1
	v_smfmac_f32_16x16x64_bf16 v[88:91], v[72:75], a[224:231], v21
	ds_write_b64 v23, v[128:129] offset:0
	v_smfmac_f32_16x16x64_bf16 v[88:91], v[76:79], a[232:239], v21
	s_nop 7
	v_permlane32_swap_b32 v88, v90
	v_permlane32_swap_b32 v89, v91
	v_pk_add_f32 v[88:89], v[88:89], v[90:91]
	v_cvt_pk_bf16_f32 v100, v88, v89
	v_min_u32 v100, -2, v100
	buffer_store_dword v100, v7, s[36:39], s12 offen sc1
	s_cmp_eq_u32 s60, 63
	s_cbranch_scc1 L_c0_fin
	s_waitcnt vmcnt(3)
	v_max_u32 v34, v34, v39
	v_cmp_gt_u32 vcc, s78, v34
	s_cbranch_vccnz L_fw_18
L_fwok_19:
	s_waitcnt lgkmcnt(0)
	s_barrier
	s_nop 15
	s_nop 7
	buffer_load_dword v132, v6, s[36:39], s64 offen offset:0 sc1
	buffer_load_dword v133, v6, s[36:39], s64 offen offset:256 sc1
	buffer_load_dword v134, v6, s[36:39], s64 offen offset:512 sc1
	buffer_load_dword v135, v6, s[36:39], s65 offen offset:0 sc1
	buffer_load_dword v136, v6, s[36:39], s65 offen offset:256 sc1
	buffer_load_dword v137, v6, s[36:39], s65 offen offset:512 sc1
	ds_read_b64 v[120:121], v23 offset:0
	ds_read_b64 v[122:123], v23 offset:512
	ds_read_b64 v[124:125], v23 offset:1024
	s_add_u32 s78, s60, 3
	s_min_u32 s78, s78, 64
	s_add_u32 s76, s76, 32768
	s_and_b32 s76, s76, 0x7ffff
	s_nop 15
	s_nop 15
	s_nop 0
	buffer_load_dword v102, v7, s[36:39], s16 offen sc1
	buffer_load_dword v104, v7, s[36:39], s17 offen sc1
	s_waitcnt vmcnt(5) lgkmcnt(0)
	v_dot2_f32_bf16 v40, v132, s79, v120
	v_dot2_f32_bf16 v41, v132, s35, v121
	v_dot2_f32_bf16 v42, v133, s79, v122
	v_dot2_f32_bf16 v43, v133, s35, v123
	v_add_f32 v44, v124, v134
	s_waitcnt vmcnt(2) lgkmcnt(0)
	v_dot2_f32_bf16 v40, v135, s79, v40
	v_dot2_f32_bf16 v41, v135, s35, v41
	v_dot2_f32_bf16 v42, v136, s79, v42
	v_dot2_f32_bf16 v43, v136, s35, v43
	v_add_f32 v44, v44, v137
	v_max3_u32 v144, v132, v133, v134
	v_max3_f32 v46, v44, v40, v41
	v_max3_f32 v46, v46, v42, v43
	v_max3_u32 v144, v144, v135, v136
	v_max_u32 v144, v144, v137
	v_max_f32_dpp v47, v46, v46 row_ror:8 row_mask:0xf bank_mask:0xf
	v_max_f32_dpp v46, v46, v46 row_ror:8 row_mask:0xf bank_mask:0xf
	v_cmp_eq_u32 vcc, -1, v144
	s_nop 0
	v_permlane16_swap_b32 v46, v47
	v_max_f32 v48, v46, v47
	v_max_f32 v47, v46, v47
	s_cbranch_vccnz L_sf_20
L_sok_21:
	buffer_load_dwordx4 v[96:99], v19, s[36:39], s76 offen offset:2048 sc1
	v_permlane32_swap_b32 v48, v47
	v_max_f32 v46, v48, v47
	v_mul_f32 v46, s62, v46
	v_pk_fma_f32 v[40:41], v[40:41], s[62:63], v[46:47] op_sel_hi:[1,0,0] neg_lo:[0,0,1] neg_hi:[0,0,1]
	v_pk_fma_f32 v[42:43], v[42:43], s[62:63], v[46:47] op_sel_hi:[1,0,0] neg_lo:[0,0,1] neg_hi:[0,0,1]
	v_exp_f32 v40, v40
	v_exp_f32 v41, v41
	v_exp_f32 v42, v42
	v_cvt_pk_bf16_f32 v24, v40, v41
	v_exp_f32 v43, v43
	v_fma_f32 v44, v44, s62, -v46
	v_cvt_pk_bf16_f32 v26, v42, v43
	v_mov_b32_dpp v25, v24 row_ror:8 row_mask:0xf bank_mask:0xf
	v_exp_f32 v44, v44
	v_mov_b32_dpp v27, v26 row_ror:8 row_mask:0xf bank_mask:0xf
	s_nop 0
	v_mov_b32_dpp v45, v44 row_ror:8 row_mask:0xf bank_mask:0xf
	v_mfma_f32_16x16x32_bf16 v[120:123], v[108:111], v[24:27], 0
	v_cvt_pk_bf16_f32 v28, v44, v45
	s_waitcnt vmcnt(1)
	v_max_u32 v144, v102, v104
	v_mfma_f32_16x16x32_bf16 v[124:127], v[112:115], v[24:27], 0
	v_cmp_eq_u32 vcc, -1, v144
	v_mfma_f32_16x16x32_bf16 v[128:131], v[116:119], v[24:27], 0
	s_cbranch_vccnz L_vf_22
L_vok_23:
	v_mfma_f32_16x16x32_bf16 v[120:123], v[100:103], v[28:31], v[120:123]
	buffer_load_dwordx4 v[108:111], v16, s[36:39], s76 offen sc1
	s_nop 0
	v_mfma_f32_16x16x32_bf16 v[124:127], v[102:105], v[28:31], v[124:127]
	buffer_load_dwordx4 v[92:95], v19, s[36:39], s76 offen offset:0 sc1
	s_nop 0
	v_mfma_f32_16x16x32_bf16 v[128:131], v[104:107], v[28:31], v[128:131]
	s_nop 1
	v_cvt_pk_bf16_f32 v120, v120, v121
	v_cvt_pk_bf16_f32 v121, v122, v123
	ds_write_b64 v13, v[120:121] offset:0
	v_cvt_pk_bf16_f32 v124, v124, v125
	v_cvt_pk_bf16_f32 v125, v126, v127
	ds_write_b64 v13, v[124:125] offset:1024
	v_cvt_pk_bf16_f32 v128, v128, v129
	v_cvt_pk_bf16_f32 v129, v130, v131
	ds_write_b64 v13, v[128:129] offset:2048
	v_mfma_f32_16x16x32_bf16 v[52:55], v[24:27], a[244:247], 0
	v_mfma_f32_16x16x32_bf16 v[52:55], v[28:31], a[244:247], v[52:55]
	s_waitcnt lgkmcnt(0)
	s_barrier
	ds_read_b128 v[56:59], v14 offset:0
	ds_read_b128 v[60:63], v14 offset:512
	ds_read_b128 v[64:67], v14 offset:1024
	s_waitcnt lgkmcnt(2)
	v_smfmac_f32_16x16x64_bf16 v[148:151], v[56:59], v[160:167], v21
	ds_read_b128 v[68:71], v14 offset:1536
	v_smfmac_f32_16x16x64_bf16 v[152:155], v[56:59], v[168:175], v21
	ds_read_b128 v[72:75], v14 offset:2048
	s_waitcnt lgkmcnt(3)
	v_smfmac_f32_16x16x64_bf16 v[148:151], v[60:63], v[176:183], v21
	ds_read_b128 v[76:79], v14 offset:2560
	v_smfmac_f32_16x16x64_bf16 v[152:155], v[60:63], v[184:191], v21
	s_waitcnt lgkmcnt(3)
	v_smfmac_f32_16x16x64_bf16 v[148:151], v[64:67], v[192:199], v21
	s_waitcnt lgkmcnt(2)
	v_smfmac_f32_16x16x64_bf16 v[148:151], v[68:71], v[208:215], v21
	s_waitcnt lgkmcnt(1)
	v_smfmac_f32_16x16x64_bf16 v[148:151], v[72:75], v[224:231], v21
	s_waitcnt lgkmcnt(0)
	v_smfmac_f32_16x16x64_bf16 v[148:151], v[76:79], v[240:247], v21
	v_smfmac_f32_16x16x64_bf16 v[152:155], v[64:67], v[200:207], v21
	v_rcp_f32 v52, v52
	v_smfmac_f32_16x16x64_bf16 v[152:155], v[68:71], v[216:223], v21
	v_rcp_f32 v53, v53
	v_smfmac_f32_16x16x64_bf16 v[152:155], v[72:75], v[232:239], v21
	v_rcp_f32 v54, v54
	v_smfmac_f32_16x16x64_bf16 v[152:155], v[76:79], v[248:255], v21
	v_rcp_f32 v55, v55
	v_mul_f32 v148, v148, v52
	v_mul_f32 v149, v149, v53
	v_mul_f32 v150, v150, v54
	v_mul_f32 v151, v151, v55
	v_cvt_pk_bf16_f32 v156, v148, v149
	v_cvt_pk_bf16_f32 v157, v150, v151
	v_and_or_b32 v156, v156, -2, s61
	v_pk_mul_f32 v[152:153], v[152:153], v[52:53]
	v_pk_mul_f32 v[154:155], v[154:155], v[54:55]
	v_cvt_pk_bf16_f32 v158, v152, v153
	v_cvt_pk_bf16_f32 v159, v154, v155
	buffer_store_dwordx4 v[156:159], v4, s[36:39], 0 offen
	v_mov_b64 v[148:149], 0
	v_mov_b64 v[150:151], 0
	v_mov_b64 v[152:153], 0
	v_mov_b64 v[154:155], 0
	v_mov_b64 v[80:81], 0
	v_mov_b64 v[82:83], 0
	v_mov_b64 v[84:85], 0
	v_mov_b64 v[86:87], 0
	v_mov_b64 v[88:89], 0
	v_mov_b64 v[90:91], 0
	v_add_u32 v6, 32768, v6
	v_add_u32 v7, 32768, v7
	v_add_u32 v36, 32768, v36
	v_add_u32 v37, 32768, v37
	v_and_b32 v6, 0x7ffff, v6
	v_and_b32 v7, 0x7ffff, v7
	v_and_b32 v36, 0x7ffff, v36
	v_and_b32 v37, 0x7ffff, v37
	v_cmp_gt_u32 vcc, s78, v34
	s_nop 0
	s_cmp_eq_u64 vcc, 0
	s_cselect_b32 s31, 0xfe00000, 0
	s_barrier
	s_branch L_c0_ag
L_c0_fin:
	s_waitcnt vmcnt(0)
	s_barrier
	s_endpgm
L_of_12:
	s_waitcnt vmcnt(2)
	v_max3_u32 v144, v124, v125, v126
	v_max_u32 v144, v144, v127
	v_cmp_eq_u32 vcc, -1, v144
	s_cbranch_vccnz L_of_25
L_of_26:
	ds_write_b128 v2, v[124:127] offset:0
	s_branch L_ook_13
L_of_25:
	buffer_load_dwordx4 v[124:127], v2, s[36:39], s77 offen sc1
	s_waitcnt vmcnt(0)
	v_max3_u32 v144, v124, v125, v126
	v_max_u32 v144, v144, v127
	v_cmp_eq_u32 vcc, -1, v144
	s_cbranch_vccnz L_of_24
	s_branch L_of_26
L_of_24:
	s_add_u32 s34, s34, 1
	s_cmp_lt_u32 s34, 0x40000
	s_cbranch_scc1 L_of_25
	s_endpgm
L_cf_14:
	s_or_b32 s2, s27, s19
	s_cbranch_scc1 L_cd_29
	s_mov_b32 s19, 1
	s_mov_b32 s28, 16384
	v_add_u32 v15, 16384, v1
	v_add_u32 v32, 16384, v33
	s_nop 0
	v_mov_b64 v[80:81], 0
	v_mov_b64 v[82:83], 0
	v_mov_b64 v[84:85], 0
	v_mov_b64 v[86:87], 0
	v_smfmac_f32_16x16x64_bf16 v[80:83], v[40:43], a[0:7], v21
	s_nop 0
	v_smfmac_f32_16x16x64_bf16 v[84:87], v[40:43], a[80:87], v21
	v_smfmac_f32_16x16x64_bf16 v[80:83], v[44:47], a[8:15], v21
	v_smfmac_f32_16x16x64_bf16 v[84:87], v[44:47], a[88:95], v21
	v_smfmac_f32_16x16x64_bf16 v[80:83], v[48:51], a[16:23], v21
	v_smfmac_f32_16x16x64_bf16 v[84:87], v[48:51], a[96:103], v21
	s_waitcnt vmcnt(3) lgkmcnt(0)
	s_barrier
	s_branch L_c0_top
L_cd_29:
	s_cmp_lg_u32 s27, 0
	s_cbranch_scc1 L_cok_15
	s_cmp_lg_u32 s19, 1
	s_cbranch_scc1 L_cd_29_2
	s_mov_b32 s19, 2
	s_mov_b32 m0, 65536
	s_nop 0
	buffer_load_dwordx4 v36, s[36:39], s20 offen sc1 lds
	s_mov_b32 m0, 69632
	s_nop 0
	buffer_load_dwordx4 v37, s[36:39], s20 offen sc1 lds
L_cd_29_2:
	s_cmp_lg_u32 s27, 0
	s_cbranch_scc1 L_cok_15
	s_xor_b32 s29, s28, 32768
	s_bitcmp1_b32 s29, 14
	s_cselect_b32 s30, s21, s20
	s_add_u32 m0, s29, 32768
	s_nop 0
	buffer_load_dwordx4 v36, s[36:39], s30 offen sc1 lds
	s_add_u32 m0, s29, 36864
	s_nop 0
	buffer_load_dwordx4 v37, s[36:39], s30 offen sc1 lds
	s_add_u32 s28, s28, 16384
	s_and_b32 s28, s28, 65535
	v_add_u32 v15, s28, v1
	v_add_u32 v32, s28, v33
	v_mov_b64 v[80:81], 0
	v_mov_b64 v[82:83], 0
	v_mov_b64 v[84:85], 0
	v_mov_b64 v[86:87], 0
	v_smfmac_f32_16x16x64_bf16 v[80:83], v[40:43], a[0:7], v21
	s_nop 0
	v_smfmac_f32_16x16x64_bf16 v[84:87], v[40:43], a[80:87], v21
	v_smfmac_f32_16x16x64_bf16 v[80:83], v[44:47], a[8:15], v21
	v_smfmac_f32_16x16x64_bf16 v[84:87], v[44:47], a[88:95], v21
	v_smfmac_f32_16x16x64_bf16 v[80:83], v[48:51], a[16:23], v21
	v_smfmac_f32_16x16x64_bf16 v[84:87], v[48:51], a[96:103], v21
	s_cmp_lg_u32 s19, 0
	s_cbranch_scc1 L_c2_30
	s_mov_b32 s19, 1
	s_waitcnt vmcnt(5) lgkmcnt(0)
	s_barrier
	s_branch L_c0_top
L_c2_30:
	s_add_u32 s34, s34, 1
	s_cmp_lt_u32 s34, 0x40000
	s_waitcnt vmcnt(2) lgkmcnt(0)
	s_barrier
	s_cbranch_scc1 L_c0_top
	s_endpgm
L_af_16:
	s_cmp_lg_u32 s27, 0
	s_cbranch_scc1 L_aok_17
	v_max3_u32 v144, v52, v53, v54
	v_max3_u32 v144, v144, v55, v56
	v_max3_u32 v144, v144, v57, v58
	v_max3_u32 v144, v144, v59, v60
	v_max3_u32 v144, v144, v61, v62
	v_max3_u32 v144, v144, v63, v64
	v_max3_u32 v144, v144, v65, v66
	v_max3_u32 v144, v144, v67, v68
	v_max3_u32 v144, v144, v69, v70
	v_max3_u32 v144, v144, v71, v72
	v_max3_u32 v144, v144, v73, v74
	v_max3_u32 v144, v144, v75, v76
	v_max3_u32 v144, v144, v77, v78
	v_max_u32 v144, v144, v79
	v_cmp_eq_u32 vcc, -1, v144
	s_cbranch_vccnz L_af_31
	s_branch L_aok_17
L_af_31:
	s_nop 7
	v_mov_b64 v[80:81], 0
	v_mov_b64 v[82:83], 0
	v_mov_b64 v[84:85], 0
	v_mov_b64 v[86:87], 0
	v_smfmac_f32_16x16x64_bf16 v[80:83], v[40:43], a[0:7], v21
	s_nop 0
	v_smfmac_f32_16x16x64_bf16 v[84:87], v[40:43], a[80:87], v21
	v_smfmac_f32_16x16x64_bf16 v[80:83], v[44:47], a[8:15], v21
	v_smfmac_f32_16x16x64_bf16 v[84:87], v[44:47], a[88:95], v21
	v_smfmac_f32_16x16x64_bf16 v[80:83], v[48:51], a[16:23], v21
	v_smfmac_f32_16x16x64_bf16 v[84:87], v[48:51], a[96:103], v21
	s_waitcnt vmcnt(0) lgkmcnt(0)
	s_barrier
L_af_27:
	buffer_load_dwordx4 v[120:123], v36, s[36:39], s20 offen sc1
	buffer_load_dwordx4 v[124:127], v37, s[36:39], s20 offen sc1
	s_waitcnt vmcnt(0)
	v_max3_u32 v144, v120, v121, v122
	v_max3_u32 v144, v144, v123, v124
	v_max3_u32 v144, v144, v125, v126
	v_max_u32 v144, v144, v127
	v_cmp_eq_u32 vcc, -1, v144
	s_cbranch_vccnz L_af_28
	ds_write_b128 v2, v[120:123] offset:32768
	ds_write_b128 v2, v[124:127] offset:36864
	v_mov_b32 v15, v1
	v_mov_b32 v32, v33
	s_mov_b32 s27, 1
	s_waitcnt lgkmcnt(0)
	s_barrier
	s_branch L_c0_top
L_af_28:
	s_add_u32 s34, s34, 1
	s_cmp_lt_u32 s34, 0x40000
	s_cbranch_scc1 L_af_27
	s_endpgm
L_fw_18:
	buffer_load_dword v34, v20, s[36:39], 0 offen sc1
	s_waitcnt vmcnt(0)
	v_cmp_gt_u32 vcc, s78, v34
	s_cbranch_vccz L_fwok_19
	s_add_u32 s34, s34, 1
	s_cmp_lt_u32 s34, 0x40000
	s_cbranch_scc1 L_fw_18
	s_endpgm
L_sf_20:
	buffer_load_dword v132, v6, s[36:39], s64 offen offset:0 sc1
	buffer_load_dword v133, v6, s[36:39], s64 offen offset:256 sc1
	buffer_load_dword v134, v6, s[36:39], s64 offen offset:512 sc1
	buffer_load_dword v135, v6, s[36:39], s65 offen offset:0 sc1
	buffer_load_dword v136, v6, s[36:39], s65 offen offset:256 sc1
	buffer_load_dword v137, v6, s[36:39], s65 offen offset:512 sc1
L_sf_32:
	buffer_load_dword v102, v7, s[36:39], s16 offen sc1
	buffer_load_dword v104, v7, s[36:39], s17 offen sc1
	buffer_load_dword v138, v6, s[36:39], s64 offen offset:0 sc1
	buffer_load_dword v139, v6, s[36:39], s64 offen offset:256 sc1
	buffer_load_dword v140, v6, s[36:39], s64 offen offset:512 sc1
	buffer_load_dword v141, v6, s[36:39], s65 offen offset:0 sc1
	buffer_load_dword v142, v6, s[36:39], s65 offen offset:256 sc1
	buffer_load_dword v143, v6, s[36:39], s65 offen offset:512 sc1
	s_waitcnt vmcnt(8)
	v_dot2_f32_bf16 v40, v132, s79, v120
	v_dot2_f32_bf16 v41, v132, s35, v121
	v_dot2_f32_bf16 v42, v133, s79, v122
	v_dot2_f32_bf16 v43, v133, s35, v123
	v_add_f32 v44, v124, v134
	v_dot2_f32_bf16 v40, v135, s79, v40
	v_dot2_f32_bf16 v41, v135, s35, v41
	v_dot2_f32_bf16 v42, v136, s79, v42
	v_dot2_f32_bf16 v43, v136, s35, v43
	v_add_f32 v44, v44, v137
	v_max3_u32 v144, v132, v133, v134
	v_max3_f32 v46, v44, v40, v41
	v_max3_f32 v46, v46, v42, v43
	v_max3_u32 v144, v144, v135, v136
	v_max_u32 v144, v144, v137
	v_max_f32_dpp v47, v46, v46 row_ror:8 row_mask:0xf bank_mask:0xf
	v_max_f32_dpp v46, v46, v46 row_ror:8 row_mask:0xf bank_mask:0xf
	v_cmp_eq_u32 vcc, -1, v144
	s_nop 0
	v_permlane16_swap_b32 v46, v47
	v_max_f32 v48, v46, v47
	v_max_f32 v47, v46, v47
	s_cbranch_vccz L_sok_21
	buffer_load_dword v102, v7, s[36:39], s16 offen sc1
	buffer_load_dword v104, v7, s[36:39], s17 offen sc1
	buffer_load_dword v132, v6, s[36:39], s64 offen offset:0 sc1
	buffer_load_dword v133, v6, s[36:39], s64 offen offset:256 sc1
	buffer_load_dword v134, v6, s[36:39], s64 offen offset:512 sc1
	buffer_load_dword v135, v6, s[36:39], s65 offen offset:0 sc1
	buffer_load_dword v136, v6, s[36:39], s65 offen offset:256 sc1
	buffer_load_dword v137, v6, s[36:39], s65 offen offset:512 sc1
	s_waitcnt vmcnt(8)
	v_dot2_f32_bf16 v40, v138, s79, v120
	v_dot2_f32_bf16 v41, v138, s35, v121
	v_dot2_f32_bf16 v42, v139, s79, v122
	v_dot2_f32_bf16 v43, v139, s35, v123
	v_add_f32 v44, v124, v140
	v_dot2_f32_bf16 v40, v141, s79, v40
	v_dot2_f32_bf16 v41, v141, s35, v41
	v_dot2_f32_bf16 v42, v142, s79, v42
	v_dot2_f32_bf16 v43, v142, s35, v43
	v_add_f32 v44, v44, v143
	v_max3_u32 v144, v138, v139, v140
	v_max3_f32 v46, v44, v40, v41
	v_max3_f32 v46, v46, v42, v43
	v_max3_u32 v144, v144, v141, v142
	v_max_u32 v144, v144, v143
	v_max_f32_dpp v47, v46, v46 row_ror:8 row_mask:0xf bank_mask:0xf
	v_max_f32_dpp v46, v46, v46 row_ror:8 row_mask:0xf bank_mask:0xf
	v_cmp_eq_u32 vcc, -1, v144
	s_nop 0
	v_permlane16_swap_b32 v46, v47
	v_max_f32 v48, v46, v47
	v_max_f32 v47, v46, v47
	s_cbranch_vccz L_sok_21
	s_add_u32 s34, s34, 1
	s_cmp_lt_u32 s34, 0x40000
	s_cbranch_scc1 L_sf_32
	s_endpgm
L_vf_22:
L_vf3_34:
	buffer_load_dword v102, v7, s[36:39], s16 offen sc1
	buffer_load_dword v104, v7, s[36:39], s17 offen sc1
	s_waitcnt vmcnt(0)
	v_max_u32 v144, v102, v104
	v_cmp_eq_u32 vcc, -1, v144
	s_cbranch_vccnz L_vf2_33
	s_branch L_vok_23
L_vf2_33:
	s_add_u32 s34, s34, 1
	s_cmp_lt_u32 s34, 0x40000
	s_cbranch_scc1 L_vf3_34
	s_endpgm
.p2align 6
L_c1_ag:
	s_add_u32 s60, s60, 1
	s_xor_b32 s61, s61, 1
	s_mov_b32 s27, 0
	s_mov_b32 s28, 0
	s_mov_b32 s19, 0
	s_cmp_eq_u32 s3, 0
	s_cselect_b32 s26, s61, s60
	v_mov_b32 v15, v1
	v_mov_b32 v32, v33
	s_nop 15
	s_nop 15
	s_nop 15
	s_nop 15
	s_nop 5
	buffer_load_dwordx4 v[120:123], v2, s[36:39], s77 offen sc1
	s_nop 15
	s_nop 15
	s_nop 3
	buffer_load_dwordx4 v[124:127], v2, s[36:39], s77 offen sc1
	s_mov_b32 m0, 33792
	s_nop 0
	buffer_load_dwordx4 v36, s[36:39], s20 offen sc1 lds
	s_mov_b32 m0, 37888
	s_nop 0
	buffer_load_dwordx4 v37, s[36:39], s20 offen sc1 lds
	s_waitcnt vmcnt(3)
	v_max3_u32 v144, v120, v121, v122
	v_max_u32 v144, v144, v123
	v_cmp_eq_u32 vcc, -1, v144
	ds_write_b128 v2, v[120:123] offset:0
	s_cbranch_vccnz L_of_35
L_ook_36:
	s_xor_b32 s77, s77, 0x1000
	s_mov_b32 m0, 50176
	s_nop 0
	buffer_load_dwordx4 v36, s[36:39], s21 offen sc1 lds
	s_mov_b32 m0, 54272
	s_nop 0
	buffer_load_dwordx4 v37, s[36:39], s21 offen sc1 lds
	s_waitcnt lgkmcnt(0)
	s_barrier
L_c1_own:
	ds_read_b128 v[40:43], v1 offset:0
	ds_read_b128 v[44:47], v1 offset:1024
	ds_read_b128 v[48:51], v1 offset:2048
	buffer_load_dwordx4 v[112:115], v17, s[36:39], s76 offen sc1
	s_waitcnt lgkmcnt(2)
	v_smfmac_f32_16x16x64_bf16 v[80:83], v[40:43], a[0:7], v21
	v_smfmac_f32_16x16x64_bf16 v[84:87], v[40:43], a[80:87], v21
	s_waitcnt lgkmcnt(1)
	v_smfmac_f32_16x16x64_bf16 v[80:83], v[44:47], a[8:15], v21
	v_smfmac_f32_16x16x64_bf16 v[84:87], v[44:47], a[88:95], v21
	buffer_load_dwordx4 v[116:119], v18, s[36:39], s76 offen sc1
	s_waitcnt lgkmcnt(0)
	v_smfmac_f32_16x16x64_bf16 v[80:83], v[48:51], a[16:23], v21
	v_smfmac_f32_16x16x64_bf16 v[84:87], v[48:51], a[96:103], v21
	v_smfmac_f32_16x16x64_bf16 v[88:91], v[40:43], a[160:167], v21
	v_smfmac_f32_16x16x64_bf16 v[88:91], v[44:47], a[168:175], v21
	v_smfmac_f32_16x16x64_bf16 v[88:91], v[48:51], a[176:183], v21
	s_waitcnt vmcnt(4)
	s_barrier
L_c1_top:
	ds_read_b128 v[52:55], v15 offset:32768
	ds_read_b32 v144, v32 offset:32768
	ds_read_b128 v[56:59], v15 offset:33792
	ds_read_b128 v[60:63], v15 offset:34816
	ds_read_b128 v[64:67], v15 offset:35840
	ds_read_b128 v[68:71], v15 offset:36864
	s_waitcnt lgkmcnt(5)
	v_smfmac_f32_16x16x64_bf16 v[80:83], v[52:55], a[24:31], v21
	ds_read_b128 v[72:75], v15 offset:37888
	s_waitcnt lgkmcnt(5)
	v_cmp_eq_u32 vcc, -1, v144
	s_waitcnt lgkmcnt(4)
	v_smfmac_f32_16x16x64_bf16 v[80:83], v[56:59], a[32:39], v21
	ds_read_b128 v[76:79], v15 offset:38912
	s_cbranch_vccnz L_cf_37
L_cok_38:
	s_waitcnt lgkmcnt(4)
	v_smfmac_f32_16x16x64_bf16 v[80:83], v[60:63], a[40:47], v21
	s_waitcnt lgkmcnt(3)
	v_smfmac_f32_16x16x64_bf16 v[80:83], v[64:67], a[48:55], v21
	s_waitcnt lgkmcnt(2)
	v_smfmac_f32_16x16x64_bf16 v[80:83], v[68:71], a[56:63], v21
	s_waitcnt lgkmcnt(1)
	v_smfmac_f32_16x16x64_bf16 v[80:83], v[72:75], a[64:71], v21
	s_waitcnt lgkmcnt(0)
	v_smfmac_f32_16x16x64_bf16 v[80:83], v[76:79], a[72:79], v21
	s_nop 0
	v_smfmac_f32_16x16x64_bf16 v[84:87], v[52:55], a[104:111], v21
	s_nop 0
	v_smfmac_f32_16x16x64_bf16 v[84:87], v[56:59], a[112:119], v21
	s_nop 0
	v_smfmac_f32_16x16x64_bf16 v[84:87], v[60:63], a[120:127], v21
	s_nop 0
	v_smfmac_f32_16x16x64_bf16 v[84:87], v[64:67], a[128:135], v21
	v_permlane32_swap_b32 v80, v82
	v_smfmac_f32_16x16x64_bf16 v[84:87], v[68:71], a[136:143], v21
	v_permlane32_swap_b32 v81, v83
	v_smfmac_f32_16x16x64_bf16 v[84:87], v[72:75], a[144:151], v21
	v_add_f32 v80, v80, v82
	v_smfmac_f32_16x16x64_bf16 v[84:87], v[76:79], a[152:159], v21
	v_add_f32 v81, v81, v83
	v_cmp_u_f32 vcc, v80, v81
	v_cvt_pk_bf16_f32 v82, v80, v81
	ds_write_b32 v9, v82
	s_nop 2
	s_cbranch_vccnz L_af_39
L_aok_40:
	v_permlane32_swap_b32 v84, v86
	v_permlane32_swap_b32 v85, v87
	v_pk_add_f32 v[84:85], v[84:85], v[86:87]
	v_cvt_pk_bf16_f32 v101, v84, v85
	ds_write_b32 v10, v101
	v_smfmac_f32_16x16x64_bf16 v[88:91], v[52:55], a[184:191], v21
	v_min_u32 v101, -2, v101
	v_smfmac_f32_16x16x64_bf16 v[88:91], v[56:59], a[192:199], v21
	buffer_store_dword v101, v7, s[36:39], s13 offen sc1
	v_smfmac_f32_16x16x64_bf16 v[88:91], v[60:63], a[200:207], v21
	s_waitcnt lgkmcnt(0)
	s_barrier
	ds_read_b64_tr_b16 v[120:121], v11 offset:0
	ds_read_b64_tr_b16 v[122:123], v11 offset:256
	ds_read_b64_tr_b16 v[124:125], v11 offset:512
	ds_read_b64_tr_b16 v[126:127], v11 offset:768
	v_smfmac_f32_16x16x64_bf16 v[88:91], v[64:67], a[208:215], v21
	v_smfmac_f32_16x16x64_bf16 v[88:91], v[68:71], a[216:223], v21
	s_waitcnt lgkmcnt(2)
	v_mfma_f32_16x16x32_bf16 v[128:131], v[92:95], v[120:123], 0
	s_waitcnt lgkmcnt(0)
	v_mfma_f32_16x16x32_bf16 v[128:131], v[96:99], v[124:127], v[128:131]
	s_nop 7
	v_cndmask_b32 v128, v128, v130, s[6:7]
	v_cndmask_b32 v129, v129, v131, s[6:7]
	v_cvt_pk_bf16_f32 v130, v128, v129
	v_min_u32 v130, -2, v130
	buffer_store_dword v130, v7, s[36:39], s8 offen sc1
	v_smfmac_f32_16x16x64_bf16 v[88:91], v[72:75], a[224:231], v21
	ds_write_b64 v23, v[128:129] offset:512
	v_smfmac_f32_16x16x64_bf16 v[88:91], v[76:79], a[232:239], v21
	s_nop 7
	v_permlane32_swap_b32 v88, v90
	v_permlane32_swap_b32 v89, v91
	v_pk_add_f32 v[88:89], v[88:89], v[90:91]
	v_cvt_pk_bf16_f32 v100, v88, v89
	v_min_u32 v100, -2, v100
	buffer_store_dword v100, v7, s[36:39], s12 offen sc1
	s_cmp_eq_u32 s60, 63
	s_cbranch_scc1 L_c1_fin
	s_waitcnt lgkmcnt(0)
	s_barrier
	s_nop 15
	s_nop 7
	buffer_load_dword v132, v6, s[36:39], s64 offen offset:0 sc1
	buffer_load_dword v133, v6, s[36:39], s64 offen offset:256 sc1
	buffer_load_dword v134, v6, s[36:39], s64 offen offset:512 sc1
	buffer_load_dword v135, v6, s[36:39], s65 offen offset:0 sc1
	buffer_load_dword v136, v6, s[36:39], s65 offen offset:256 sc1
	buffer_load_dword v137, v6, s[36:39], s65 offen offset:512 sc1
	ds_read_b64 v[120:121], v23 offset:0
	ds_read_b64 v[122:123], v23 offset:512
	ds_read_b64 v[124:125], v23 offset:1024
	s_add_u32 s78, s60, 3
	s_min_u32 s78, s78, 64
	s_add_u32 s76, s76, 32768
	s_and_b32 s76, s76, 0x7ffff
	s_nop 15
	s_nop 15
	s_nop 0
	buffer_load_dword v102, v7, s[36:39], s16 offen sc1
	buffer_load_dword v104, v7, s[36:39], s17 offen sc1
	s_waitcnt vmcnt(5) lgkmcnt(0)
	v_dot2_f32_bf16 v40, v132, s79, v120
	v_dot2_f32_bf16 v41, v132, s35, v121
	v_dot2_f32_bf16 v42, v133, s79, v122
	v_dot2_f32_bf16 v43, v133, s35, v123
	v_add_f32 v44, v124, v134
	s_waitcnt vmcnt(2) lgkmcnt(0)
	v_dot2_f32_bf16 v40, v135, s79, v40
	v_dot2_f32_bf16 v41, v135, s35, v41
	v_dot2_f32_bf16 v42, v136, s79, v42
	v_dot2_f32_bf16 v43, v136, s35, v43
	v_add_f32 v44, v44, v137
	v_max3_u32 v144, v132, v133, v134
	v_max3_f32 v46, v44, v40, v41
	v_max3_f32 v46, v46, v42, v43
	v_max3_u32 v144, v144, v135, v136
	v_max_u32 v144, v144, v137
	v_max_f32_dpp v47, v46, v46 row_ror:8 row_mask:0xf bank_mask:0xf
	v_max_f32_dpp v46, v46, v46 row_ror:8 row_mask:0xf bank_mask:0xf
	v_cmp_eq_u32 vcc, -1, v144
	s_nop 0
	v_permlane16_swap_b32 v46, v47
	v_max_f32 v48, v46, v47
	v_max_f32 v47, v46, v47
	s_cbranch_vccnz L_sf_41
L_sok_42:
	buffer_load_dwordx4 v[96:99], v19, s[36:39], s76 offen offset:2048 sc1
	v_permlane32_swap_b32 v48, v47
	v_max_f32 v46, v48, v47
	v_mul_f32 v46, s62, v46
	v_pk_fma_f32 v[40:41], v[40:41], s[62:63], v[46:47] op_sel_hi:[1,0,0] neg_lo:[0,0,1] neg_hi:[0,0,1]
	v_pk_fma_f32 v[42:43], v[42:43], s[62:63], v[46:47] op_sel_hi:[1,0,0] neg_lo:[0,0,1] neg_hi:[0,0,1]
	v_exp_f32 v40, v40
	v_exp_f32 v41, v41
	v_exp_f32 v42, v42
	v_cvt_pk_bf16_f32 v24, v40, v41
	v_exp_f32 v43, v43
	v_fma_f32 v44, v44, s62, -v46
	v_cvt_pk_bf16_f32 v26, v42, v43
	v_mov_b32_dpp v25, v24 row_ror:8 row_mask:0xf bank_mask:0xf
	v_exp_f32 v44, v44
	v_mov_b32_dpp v27, v26 row_ror:8 row_mask:0xf bank_mask:0xf
	s_nop 0
	v_mov_b32_dpp v45, v44 row_ror:8 row_mask:0xf bank_mask:0xf
	v_mfma_f32_16x16x32_bf16 v[120:123], v[108:111], v[24:27], 0
	v_cvt_pk_bf16_f32 v28, v44, v45
	s_waitcnt vmcnt(1)
	v_max_u32 v144, v102, v104
	v_mfma_f32_16x16x32_bf16 v[124:127], v[112:115], v[24:27], 0
	v_cmp_eq_u32 vcc, -1, v144
	v_mfma_f32_16x16x32_bf16 v[128:131], v[116:119], v[24:27], 0
	s_cbranch_vccnz L_vf_43
L_vok_44:
	v_mfma_f32_16x16x32_bf16 v[120:123], v[100:103], v[28:31], v[120:123]
	buffer_load_dwordx4 v[108:111], v16, s[36:39], s76 offen sc1
	s_nop 0
	v_mfma_f32_16x16x32_bf16 v[124:127], v[102:105], v[28:31], v[124:127]
	buffer_load_dwordx4 v[92:95], v19, s[36:39], s76 offen offset:0 sc1
	s_nop 0
	v_mfma_f32_16x16x32_bf16 v[128:131], v[104:107], v[28:31], v[128:131]
	s_nop 1
	v_cvt_pk_bf16_f32 v120, v120, v121
	v_cvt_pk_bf16_f32 v121, v122, v123
	ds_write_b64 v13, v[120:121] offset:0
	v_cvt_pk_bf16_f32 v124, v124, v125
	v_cvt_pk_bf16_f32 v125, v126, v127
	ds_write_b64 v13, v[124:125] offset:1024
	v_cvt_pk_bf16_f32 v128, v128, v129
	v_cvt_pk_bf16_f32 v129, v130, v131
	ds_write_b64 v13, v[128:129] offset:2048
	v_mfma_f32_16x16x32_bf16 v[52:55], v[24:27], a[244:247], 0
	v_mfma_f32_16x16x32_bf16 v[52:55], v[28:31], a[244:247], v[52:55]
	s_waitcnt lgkmcnt(0)
	s_barrier
	ds_read_b128 v[56:59], v14 offset:0
	ds_read_b128 v[60:63], v14 offset:512
	ds_read_b128 v[64:67], v14 offset:1024
	buffer_store_dword v34, v22, s[36:39], 0 offen offset:128 sc1
	s_waitcnt lgkmcnt(2)
	v_smfmac_f32_16x16x64_bf16 v[148:151], v[56:59], v[160:167], v21
	ds_read_b128 v[68:71], v14 offset:1536
	v_smfmac_f32_16x16x64_bf16 v[152:155], v[56:59], v[168:175], v21
	ds_read_b128 v[72:75], v14 offset:2048
	s_waitcnt lgkmcnt(3)
	v_smfmac_f32_16x16x64_bf16 v[148:151], v[60:63], v[176:183], v21
	ds_read_b128 v[76:79], v14 offset:2560
	v_smfmac_f32_16x16x64_bf16 v[152:155], v[60:63], v[184:191], v21
	s_waitcnt lgkmcnt(3)
	v_smfmac_f32_16x16x64_bf16 v[148:151], v[64:67], v[192:199], v21
	s_waitcnt lgkmcnt(2)
	v_smfmac_f32_16x16x64_bf16 v[148:151], v[68:71], v[208:215], v21
	s_waitcnt lgkmcnt(1)
	v_smfmac_f32_16x16x64_bf16 v[148:151], v[72:75], v[224:231], v21
	s_waitcnt lgkmcnt(0)
	v_smfmac_f32_16x16x64_bf16 v[148:151], v[76:79], v[240:247], v21
	v_smfmac_f32_16x16x64_bf16 v[152:155], v[64:67], v[200:207], v21
	v_rcp_f32 v52, v52
	v_smfmac_f32_16x16x64_bf16 v[152:155], v[68:71], v[216:223], v21
	v_rcp_f32 v53, v53
	v_smfmac_f32_16x16x64_bf16 v[152:155], v[72:75], v[232:239], v21
	v_rcp_f32 v54, v54
	v_smfmac_f32_16x16x64_bf16 v[152:155], v[76:79], v[248:255], v21
	v_rcp_f32 v55, v55
	v_mul_f32 v148, v148, v52
	v_mul_f32 v149, v149, v53
	v_mul_f32 v150, v150, v54
	v_mul_f32 v151, v151, v55
	v_cvt_pk_bf16_f32 v156, v148, v149
	v_cvt_pk_bf16_f32 v157, v150, v151
	v_and_or_b32 v156, v156, -2, s61
	v_pk_mul_f32 v[152:153], v[152:153], v[52:53]
	v_pk_mul_f32 v[154:155], v[154:155], v[54:55]
	v_cvt_pk_bf16_f32 v158, v152, v153
	v_cvt_pk_bf16_f32 v159, v154, v155
	buffer_store_dwordx4 v[156:159], v4, s[36:39], 0 offen
	v_mov_b64 v[148:149], 0
	v_mov_b64 v[150:151], 0
	v_mov_b64 v[152:153], 0
	v_mov_b64 v[154:155], 0
	v_mov_b64 v[80:81], 0
	v_mov_b64 v[82:83], 0
	v_mov_b64 v[84:85], 0
	v_mov_b64 v[86:87], 0
	v_mov_b64 v[88:89], 0
	v_mov_b64 v[90:91], 0
	v_add_u32 v6, 32768, v6
	v_add_u32 v7, 32768, v7
	v_add_u32 v36, 32768, v36
	v_add_u32 v37, 32768, v37
	v_and_b32 v6, 0x7ffff, v6
	v_and_b32 v7, 0x7ffff, v7
	v_and_b32 v36, 0x7ffff, v36
	v_and_b32 v37, 0x7ffff, v37
	v_add_u32 v34, 1, v34
	s_barrier
	s_branch L_c1_ag
L_c1_fin:
	s_waitcnt vmcnt(0)
	s_barrier
	v_mov_b32 v34, 64
	buffer_store_dword v34, v22, s[36:39], 0 offen offset:128 sc1
	s_endpgm
L_of_35:
	s_waitcnt vmcnt(2)
	v_max3_u32 v144, v124, v125, v126
	v_max_u32 v144, v144, v127
	v_cmp_eq_u32 vcc, -1, v144
	s_cbranch_vccnz L_of_46
L_of_47:
	ds_write_b128 v2, v[124:127] offset:0
	s_branch L_ook_36
L_of_46:
	buffer_load_dwordx4 v[124:127], v2, s[36:39], s77 offen sc1
	s_waitcnt vmcnt(0)
	v_max3_u32 v144, v124, v125, v126
	v_max_u32 v144, v144, v127
	v_cmp_eq_u32 vcc, -1, v144
	s_cbranch_vccnz L_of_45
	s_branch L_of_47
L_of_45:
	s_add_u32 s34, s34, 1
	s_cmp_lt_u32 s34, 0x40000
	s_cbranch_scc1 L_of_46
	s_endpgm
L_cf_37:
	s_or_b32 s2, s27, s19
	s_cbranch_scc1 L_cd_50
	s_mov_b32 s19, 1
	s_mov_b32 s28, 16384
	v_add_u32 v15, 16384, v1
	v_add_u32 v32, 16384, v33
	s_nop 0
	v_mov_b64 v[80:81], 0
	v_mov_b64 v[82:83], 0
	v_mov_b64 v[84:85], 0
	v_mov_b64 v[86:87], 0
	v_smfmac_f32_16x16x64_bf16 v[80:83], v[40:43], a[0:7], v21
	s_nop 0
	v_smfmac_f32_16x16x64_bf16 v[84:87], v[40:43], a[80:87], v21
	v_smfmac_f32_16x16x64_bf16 v[80:83], v[44:47], a[8:15], v21
	v_smfmac_f32_16x16x64_bf16 v[84:87], v[44:47], a[88:95], v21
	v_smfmac_f32_16x16x64_bf16 v[80:83], v[48:51], a[16:23], v21
	v_smfmac_f32_16x16x64_bf16 v[84:87], v[48:51], a[96:103], v21
	s_waitcnt vmcnt(2) lgkmcnt(0)
	s_barrier
	s_branch L_c1_top
L_cd_50:
	s_cmp_lg_u32 s27, 0
	s_cbranch_scc1 L_cok_38
	s_cmp_lg_u32 s19, 1
	s_cbranch_scc1 L_cd_50_2
	s_mov_b32 s19, 2
	s_mov_b32 m0, 66560
	s_nop 0
	buffer_load_dwordx4 v36, s[36:39], s20 offen sc1 lds
	s_mov_b32 m0, 70656
	s_nop 0
	buffer_load_dwordx4 v37, s[36:39], s20 offen sc1 lds
L_cd_50_2:
	s_cmp_lg_u32 s27, 0
	s_cbranch_scc1 L_cok_38
	s_xor_b32 s29, s28, 32768
	s_bitcmp1_b32 s29, 14
	s_cselect_b32 s30, s21, s20
	s_add_u32 m0, s29, 33792
	s_nop 0
	buffer_load_dwordx4 v36, s[36:39], s30 offen sc1 lds
	s_add_u32 m0, s29, 37888
	s_nop 0
	buffer_load_dwordx4 v37, s[36:39], s30 offen sc1 lds
	s_add_u32 s28, s28, 16384
	s_and_b32 s28, s28, 65535
	v_add_u32 v15, s28, v1
	v_add_u32 v32, s28, v33
	v_mov_b64 v[80:81], 0
	v_mov_b64 v[82:83], 0
	v_mov_b64 v[84:85], 0
	v_mov_b64 v[86:87], 0
	v_smfmac_f32_16x16x64_bf16 v[80:83], v[40:43], a[0:7], v21
	s_nop 0
	v_smfmac_f32_16x16x64_bf16 v[84:87], v[40:43], a[80:87], v21
	v_smfmac_f32_16x16x64_bf16 v[80:83], v[44:47], a[8:15], v21
	v_smfmac_f32_16x16x64_bf16 v[84:87], v[44:47], a[88:95], v21
	v_smfmac_f32_16x16x64_bf16 v[80:83], v[48:51], a[16:23], v21
	v_smfmac_f32_16x16x64_bf16 v[84:87], v[48:51], a[96:103], v21
	s_cmp_lg_u32 s19, 0
	s_cbranch_scc1 L_c2_51
	s_mov_b32 s19, 1
	s_waitcnt vmcnt(4) lgkmcnt(0)
	s_barrier
	s_branch L_c1_top
L_c2_51:
	s_add_u32 s34, s34, 1
	s_cmp_lt_u32 s34, 0x40000
	s_waitcnt vmcnt(2) lgkmcnt(0)
	s_barrier
	s_cbranch_scc1 L_c1_top
	s_endpgm
L_af_39:
	s_cmp_lg_u32 s27, 0
	s_cbranch_scc1 L_aok_40
	v_max3_u32 v144, v52, v53, v54
	v_max3_u32 v144, v144, v55, v56
	v_max3_u32 v144, v144, v57, v58
	v_max3_u32 v144, v144, v59, v60
	v_max3_u32 v144, v144, v61, v62
	v_max3_u32 v144, v144, v63, v64
	v_max3_u32 v144, v144, v65, v66
	v_max3_u32 v144, v144, v67, v68
	v_max3_u32 v144, v144, v69, v70
	v_max3_u32 v144, v144, v71, v72
	v_max3_u32 v144, v144, v73, v74
	v_max3_u32 v144, v144, v75, v76
	v_max3_u32 v144, v144, v77, v78
	v_max_u32 v144, v144, v79
	v_cmp_eq_u32 vcc, -1, v144
	s_cbranch_vccnz L_af_52
	s_branch L_aok_40
L_af_52:
	s_nop 7
	v_mov_b64 v[80:81], 0
	v_mov_b64 v[82:83], 0
	v_mov_b64 v[84:85], 0
	v_mov_b64 v[86:87], 0
	v_smfmac_f32_16x16x64_bf16 v[80:83], v[40:43], a[0:7], v21
	s_nop 0
	v_smfmac_f32_16x16x64_bf16 v[84:87], v[40:43], a[80:87], v21
	v_smfmac_f32_16x16x64_bf16 v[80:83], v[44:47], a[8:15], v21
	v_smfmac_f32_16x16x64_bf16 v[84:87], v[44:47], a[88:95], v21
	v_smfmac_f32_16x16x64_bf16 v[80:83], v[48:51], a[16:23], v21
	v_smfmac_f32_16x16x64_bf16 v[84:87], v[48:51], a[96:103], v21
	s_waitcnt vmcnt(0) lgkmcnt(0)
	s_barrier
L_af_48:
	buffer_load_dwordx4 v[120:123], v36, s[36:39], s20 offen sc1
	buffer_load_dwordx4 v[124:127], v37, s[36:39], s20 offen sc1
	s_waitcnt vmcnt(0)
	v_max3_u32 v144, v120, v121, v122
	v_max3_u32 v144, v144, v123, v124
	v_max3_u32 v144, v144, v125, v126
	v_max_u32 v144, v144, v127
	v_cmp_eq_u32 vcc, -1, v144
	s_cbranch_vccnz L_af_49
	ds_write_b128 v2, v[120:123] offset:32768
	ds_write_b128 v2, v[124:127] offset:36864
	v_mov_b32 v15, v1
	v_mov_b32 v32, v33
	s_mov_b32 s27, 1
	s_waitcnt lgkmcnt(0)
	s_barrier
	s_branch L_c1_top
L_af_49:
	s_add_u32 s34, s34, 1
	s_cmp_lt_u32 s34, 0x40000
	s_cbranch_scc1 L_af_48
	s_endpgm
L_sf_41:
	buffer_load_dword v132, v6, s[36:39], s64 offen offset:0 sc1
	buffer_load_dword v133, v6, s[36:39], s64 offen offset:256 sc1
	buffer_load_dword v134, v6, s[36:39], s64 offen offset:512 sc1
	buffer_load_dword v135, v6, s[36:39], s65 offen offset:0 sc1
	buffer_load_dword v136, v6, s[36:39], s65 offen offset:256 sc1
	buffer_load_dword v137, v6, s[36:39], s65 offen offset:512 sc1
L_sf_53:
	buffer_load_dword v102, v7, s[36:39], s16 offen sc1
	buffer_load_dword v104, v7, s[36:39], s17 offen sc1
	buffer_load_dword v138, v6, s[36:39], s64 offen offset:0 sc1
	buffer_load_dword v139, v6, s[36:39], s64 offen offset:256 sc1
	buffer_load_dword v140, v6, s[36:39], s64 offen offset:512 sc1
	buffer_load_dword v141, v6, s[36:39], s65 offen offset:0 sc1
	buffer_load_dword v142, v6, s[36:39], s65 offen offset:256 sc1
	buffer_load_dword v143, v6, s[36:39], s65 offen offset:512 sc1
	s_waitcnt vmcnt(8)
	v_dot2_f32_bf16 v40, v132, s79, v120
	v_dot2_f32_bf16 v41, v132, s35, v121
	v_dot2_f32_bf16 v42, v133, s79, v122
	v_dot2_f32_bf16 v43, v133, s35, v123
	v_add_f32 v44, v124, v134
	v_dot2_f32_bf16 v40, v135, s79, v40
	v_dot2_f32_bf16 v41, v135, s35, v41
	v_dot2_f32_bf16 v42, v136, s79, v42
	v_dot2_f32_bf16 v43, v136, s35, v43
	v_add_f32 v44, v44, v137
	v_max3_u32 v144, v132, v133, v134
	v_max3_f32 v46, v44, v40, v41
	v_max3_f32 v46, v46, v42, v43
	v_max3_u32 v144, v144, v135, v136
	v_max_u32 v144, v144, v137
	v_max_f32_dpp v47, v46, v46 row_ror:8 row_mask:0xf bank_mask:0xf
	v_max_f32_dpp v46, v46, v46 row_ror:8 row_mask:0xf bank_mask:0xf
	v_cmp_eq_u32 vcc, -1, v144
	s_nop 0
	v_permlane16_swap_b32 v46, v47
	v_max_f32 v48, v46, v47
	v_max_f32 v47, v46, v47
	s_cbranch_vccz L_sok_42
	buffer_load_dword v102, v7, s[36:39], s16 offen sc1
	buffer_load_dword v104, v7, s[36:39], s17 offen sc1
	buffer_load_dword v132, v6, s[36:39], s64 offen offset:0 sc1
	buffer_load_dword v133, v6, s[36:39], s64 offen offset:256 sc1
	buffer_load_dword v134, v6, s[36:39], s64 offen offset:512 sc1
	buffer_load_dword v135, v6, s[36:39], s65 offen offset:0 sc1
	buffer_load_dword v136, v6, s[36:39], s65 offen offset:256 sc1
	buffer_load_dword v137, v6, s[36:39], s65 offen offset:512 sc1
	s_waitcnt vmcnt(8)
	v_dot2_f32_bf16 v40, v138, s79, v120
	v_dot2_f32_bf16 v41, v138, s35, v121
	v_dot2_f32_bf16 v42, v139, s79, v122
	v_dot2_f32_bf16 v43, v139, s35, v123
	v_add_f32 v44, v124, v140
	v_dot2_f32_bf16 v40, v141, s79, v40
	v_dot2_f32_bf16 v41, v141, s35, v41
	v_dot2_f32_bf16 v42, v142, s79, v42
	v_dot2_f32_bf16 v43, v142, s35, v43
	v_add_f32 v44, v44, v143
	v_max3_u32 v144, v138, v139, v140
	v_max3_f32 v46, v44, v40, v41
	v_max3_f32 v46, v46, v42, v43
	v_max3_u32 v144, v144, v141, v142
	v_max_u32 v144, v144, v143
	v_max_f32_dpp v47, v46, v46 row_ror:8 row_mask:0xf bank_mask:0xf
	v_max_f32_dpp v46, v46, v46 row_ror:8 row_mask:0xf bank_mask:0xf
	v_cmp_eq_u32 vcc, -1, v144
	s_nop 0
	v_permlane16_swap_b32 v46, v47
	v_max_f32 v48, v46, v47
	v_max_f32 v47, v46, v47
	s_cbranch_vccz L_sok_42
	s_add_u32 s34, s34, 1
	s_cmp_lt_u32 s34, 0x40000
	s_cbranch_scc1 L_sf_53
	s_endpgm
L_vf_43:
L_vf3_55:
	buffer_load_dword v102, v7, s[36:39], s16 offen sc1
	buffer_load_dword v104, v7, s[36:39], s17 offen sc1
	s_waitcnt vmcnt(0)
	v_max_u32 v144, v102, v104
	v_cmp_eq_u32 vcc, -1, v144
	s_cbranch_vccnz L_vf2_54
	s_branch L_vok_44
L_vf2_54:
	s_add_u32 s34, s34, 1
	s_cmp_lt_u32 s34, 0x40000
	s_cbranch_scc1 L_vf3_55
	s_endpgm
.p2align 6
L_c2_ag:
	s_add_u32 s60, s60, 1
	s_xor_b32 s61, s61, 1
	s_mov_b32 s27, 0
	s_mov_b32 s28, 0
	s_mov_b32 s19, 0
	s_cmp_eq_u32 s3, 0
	s_cselect_b32 s26, s61, s60
	v_mov_b32 v15, v1
	v_mov_b32 v32, v33
	s_nop 15
	s_nop 15
	s_nop 15
	s_nop 15
	s_nop 5
	buffer_load_dwordx4 v[120:123], v2, s[36:39], s77 offen sc1
	s_nop 15
	s_nop 15
	s_nop 3
	buffer_load_dwordx4 v[124:127], v2, s[36:39], s77 offen sc1
	s_mov_b32 m0, 34816
	s_nop 0
	buffer_load_dwordx4 v36, s[36:39], s20 offen sc1 lds
	s_mov_b32 m0, 38912
	s_nop 0
	buffer_load_dwordx4 v37, s[36:39], s20 offen sc1 lds
	s_waitcnt vmcnt(3)
	v_max3_u32 v144, v120, v121, v122
	v_max_u32 v144, v144, v123
	v_cmp_eq_u32 vcc, -1, v144
	ds_write_b128 v2, v[120:123] offset:0
	s_cbranch_vccnz L_of_56
L_ook_57:
	s_xor_b32 s77, s77, 0x1000
	s_mov_b32 m0, 51200
	s_nop 0
	buffer_load_dwordx4 v36, s[36:39], s21 offen sc1 lds
	s_mov_b32 m0, 55296
	s_nop 0
	buffer_load_dwordx4 v37, s[36:39], s21 offen sc1 lds
	s_waitcnt lgkmcnt(0)
	s_barrier
L_c2_own:
	ds_read_b128 v[40:43], v1 offset:0
	ds_read_b128 v[44:47], v1 offset:1024
	ds_read_b128 v[48:51], v1 offset:2048
	buffer_load_dwordx4 v[112:115], v17, s[36:39], s76 offen sc1
	s_waitcnt lgkmcnt(2)
	v_smfmac_f32_16x16x64_bf16 v[80:83], v[40:43], a[0:7], v21
	v_smfmac_f32_16x16x64_bf16 v[84:87], v[40:43], a[80:87], v21
	s_waitcnt lgkmcnt(1)
	v_smfmac_f32_16x16x64_bf16 v[80:83], v[44:47], a[8:15], v21
	v_smfmac_f32_16x16x64_bf16 v[84:87], v[44:47], a[88:95], v21
	buffer_load_dwordx4 v[116:119], v18, s[36:39], s76 offen sc1
	s_waitcnt lgkmcnt(0)
	v_smfmac_f32_16x16x64_bf16 v[80:83], v[48:51], a[16:23], v21
	v_smfmac_f32_16x16x64_bf16 v[84:87], v[48:51], a[96:103], v21
	v_smfmac_f32_16x16x64_bf16 v[88:91], v[40:43], a[160:167], v21
	v_smfmac_f32_16x16x64_bf16 v[88:91], v[44:47], a[168:175], v21
	v_smfmac_f32_16x16x64_bf16 v[88:91], v[48:51], a[176:183], v21
	s_waitcnt vmcnt(4)
	s_barrier
L_c2_top:
	ds_read_b128 v[52:55], v15 offset:32768
	ds_read_b32 v144, v32 offset:32768
	ds_read_b128 v[56:59], v15 offset:33792
	ds_read_b128 v[60:63], v15 offset:34816
	ds_read_b128 v[64:67], v15 offset:35840
	ds_read_b128 v[68:71], v15 offset:36864
	s_waitcnt lgkmcnt(5)
	v_smfmac_f32_16x16x64_bf16 v[80:83], v[52:55], a[24:31], v21
	ds_read_b128 v[72:75], v15 offset:37888
	s_waitcnt lgkmcnt(5)
	v_cmp_eq_u32 vcc, -1, v144
	s_waitcnt lgkmcnt(4)
	v_smfmac_f32_16x16x64_bf16 v[80:83], v[56:59], a[32:39], v21
	ds_read_b128 v[76:79], v15 offset:38912
	s_cbranch_vccnz L_cf_58
L_cok_59:
	s_waitcnt lgkmcnt(4)
	v_smfmac_f32_16x16x64_bf16 v[80:83], v[60:63], a[40:47], v21
	s_waitcnt lgkmcnt(3)
	v_smfmac_f32_16x16x64_bf16 v[80:83], v[64:67], a[48:55], v21
	s_waitcnt lgkmcnt(2)
	v_smfmac_f32_16x16x64_bf16 v[80:83], v[68:71], a[56:63], v21
	s_waitcnt lgkmcnt(1)
	v_smfmac_f32_16x16x64_bf16 v[80:83], v[72:75], a[64:71], v21
	s_waitcnt lgkmcnt(0)
	v_smfmac_f32_16x16x64_bf16 v[80:83], v[76:79], a[72:79], v21
	s_nop 0
	v_smfmac_f32_16x16x64_bf16 v[84:87], v[52:55], a[104:111], v21
	s_nop 0
	v_smfmac_f32_16x16x64_bf16 v[84:87], v[56:59], a[112:119], v21
	s_nop 0
	v_smfmac_f32_16x16x64_bf16 v[84:87], v[60:63], a[120:127], v21
	s_nop 0
	v_smfmac_f32_16x16x64_bf16 v[84:87], v[64:67], a[128:135], v21
	v_permlane32_swap_b32 v80, v82
	v_smfmac_f32_16x16x64_bf16 v[84:87], v[68:71], a[136:143], v21
	v_permlane32_swap_b32 v81, v83
	v_smfmac_f32_16x16x64_bf16 v[84:87], v[72:75], a[144:151], v21
	v_add_f32 v80, v80, v82
	v_smfmac_f32_16x16x64_bf16 v[84:87], v[76:79], a[152:159], v21
	v_add_f32 v81, v81, v83
	v_cmp_u_f32 vcc, v80, v81
	v_cvt_pk_bf16_f32 v82, v80, v81
	ds_write_b32 v9, v82
	s_nop 2
	s_cbranch_vccnz L_af_60
L_aok_61:
	v_permlane32_swap_b32 v84, v86
	v_permlane32_swap_b32 v85, v87
	v_pk_add_f32 v[84:85], v[84:85], v[86:87]
	v_cvt_pk_bf16_f32 v101, v84, v85
	ds_write_b32 v10, v101
	v_smfmac_f32_16x16x64_bf16 v[88:91], v[52:55], a[184:191], v21
	v_min_u32 v101, -2, v101
	v_smfmac_f32_16x16x64_bf16 v[88:91], v[56:59], a[192:199], v21
	buffer_store_dword v101, v7, s[36:39], s13 offen sc1
	v_smfmac_f32_16x16x64_bf16 v[88:91], v[60:63], a[200:207], v21
	s_waitcnt lgkmcnt(0)
	s_barrier
	ds_read_b64_tr_b16 v[120:121], v11 offset:0
	ds_read_b64_tr_b16 v[122:123], v11 offset:256
	ds_read_b64_tr_b16 v[92:93], v12 offset:0
	ds_read_b64_tr_b16 v[94:95], v12 offset:512
	ds_read_b64_tr_b16 v[124:125], v11 offset:512
	ds_read_b64_tr_b16 v[126:127], v11 offset:768
	ds_read_b64_tr_b16 v[96:97], v12 offset:1024
	ds_read_b64_tr_b16 v[98:99], v12 offset:1536
	v_smfmac_f32_16x16x64_bf16 v[88:91], v[64:67], a[208:215], v21
	s_waitcnt lgkmcnt(4)
	v_mfma_f32_16x16x32_bf16 v[128:131], v[92:95], v[120:123], 0
	s_waitcnt lgkmcnt(0)
	v_mfma_f32_16x16x32_bf16 v[128:131], v[96:99], v[124:127], v[128:131]
	s_nop 7
	v_cndmask_b32 v128, v128, v129, s[6:7]
	v_min_u32 v130, -2, v128
	buffer_store_dword v130, v7, s[36:39], s8 offen sc1
	v_smfmac_f32_16x16x64_bf16 v[88:91], v[68:71], a[216:223], v21
	ds_write_b64 v23, v[128:129] offset:1024
	v_smfmac_f32_16x16x64_bf16 v[88:91], v[72:75], a[224:231], v21
	v_smfmac_f32_16x16x64_bf16 v[88:91], v[76:79], a[232:239], v21
	s_nop 7
	v_permlane32_swap_b32 v88, v90
	v_permlane32_swap_b32 v89, v91
	v_pk_add_f32 v[88:89], v[88:89], v[90:91]
	v_cvt_pk_bf16_f32 v100, v88, v89
	v_min_u32 v100, -2, v100
	buffer_store_dword v100, v7, s[36:39], s12 offen sc1
	s_cmp_eq_u32 s60, 63
	s_cbranch_scc1 L_c2_fin
	s_waitcnt lgkmcnt(0)
	s_barrier
	s_nop 15
	s_nop 7
	buffer_load_dword v132, v6, s[36:39], s64 offen offset:0 sc1
	buffer_load_dword v133, v6, s[36:39], s64 offen offset:256 sc1
	buffer_load_dword v134, v6, s[36:39], s64 offen offset:512 sc1
	buffer_load_dword v135, v6, s[36:39], s65 offen offset:0 sc1
	buffer_load_dword v136, v6, s[36:39], s65 offen offset:256 sc1
	buffer_load_dword v137, v6, s[36:39], s65 offen offset:512 sc1
	ds_read_b64 v[120:121], v23 offset:0
	ds_read_b64 v[122:123], v23 offset:512
	ds_read_b64 v[124:125], v23 offset:1024
	s_add_u32 s78, s60, 3
	s_min_u32 s78, s78, 64
	s_add_u32 s76, s76, 32768
	s_and_b32 s76, s76, 0x7ffff
	s_nop 15
	s_nop 15
	s_nop 0
	buffer_load_dword v102, v7, s[36:39], s16 offen sc1
	buffer_load_dword v104, v7, s[36:39], s17 offen sc1
	s_waitcnt vmcnt(5) lgkmcnt(0)
	v_dot2_f32_bf16 v40, v132, s79, v120
	v_dot2_f32_bf16 v41, v132, s35, v121
	v_dot2_f32_bf16 v42, v133, s79, v122
	v_dot2_f32_bf16 v43, v133, s35, v123
	v_add_f32 v44, v124, v134
	s_waitcnt vmcnt(2) lgkmcnt(0)
	v_dot2_f32_bf16 v40, v135, s79, v40
	v_dot2_f32_bf16 v41, v135, s35, v41
	v_dot2_f32_bf16 v42, v136, s79, v42
	v_dot2_f32_bf16 v43, v136, s35, v43
	v_add_f32 v44, v44, v137
	v_max3_u32 v144, v132, v133, v134
	v_max3_f32 v46, v44, v40, v41
	v_max3_f32 v46, v46, v42, v43
	v_max3_u32 v144, v144, v135, v136
	v_max_u32 v144, v144, v137
	v_max_f32_dpp v47, v46, v46 row_ror:8 row_mask:0xf bank_mask:0xf
	v_max_f32_dpp v46, v46, v46 row_ror:8 row_mask:0xf bank_mask:0xf
	v_cmp_eq_u32 vcc, -1, v144
	s_nop 0
	v_permlane16_swap_b32 v46, v47
	v_max_f32 v48, v46, v47
	v_max_f32 v47, v46, v47
	s_cbranch_vccnz L_sf_62
L_sok_63:
	s_nop 0
	v_permlane32_swap_b32 v48, v47
	v_max_f32 v46, v48, v47
	v_mul_f32 v46, s62, v46
	v_pk_fma_f32 v[40:41], v[40:41], s[62:63], v[46:47] op_sel_hi:[1,0,0] neg_lo:[0,0,1] neg_hi:[0,0,1]
	v_pk_fma_f32 v[42:43], v[42:43], s[62:63], v[46:47] op_sel_hi:[1,0,0] neg_lo:[0,0,1] neg_hi:[0,0,1]
	v_exp_f32 v40, v40
	v_exp_f32 v41, v41
	v_exp_f32 v42, v42
	v_cvt_pk_bf16_f32 v24, v40, v41
	v_exp_f32 v43, v43
	v_fma_f32 v44, v44, s62, -v46
	v_cvt_pk_bf16_f32 v26, v42, v43
	v_mov_b32_dpp v25, v24 row_ror:8 row_mask:0xf bank_mask:0xf
	v_exp_f32 v44, v44
	v_mov_b32_dpp v27, v26 row_ror:8 row_mask:0xf bank_mask:0xf
	s_nop 0
	v_mov_b32_dpp v45, v44 row_ror:8 row_mask:0xf bank_mask:0xf
	v_mfma_f32_16x16x32_bf16 v[120:123], v[108:111], v[24:27], 0
	v_cvt_pk_bf16_f32 v28, v44, v45
	s_waitcnt vmcnt(0)
	v_max_u32 v144, v102, v104
	v_mfma_f32_16x16x32_bf16 v[124:127], v[112:115], v[24:27], 0
	v_cmp_eq_u32 vcc, -1, v144
	v_mfma_f32_16x16x32_bf16 v[128:131], v[116:119], v[24:27], 0
	s_cbranch_vccnz L_vf_64
L_vok_65:
	v_mfma_f32_16x16x32_bf16 v[120:123], v[100:103], v[28:31], v[120:123]
	buffer_load_dwordx4 v[108:111], v16, s[36:39], s76 offen sc1
	s_nop 0
	v_mfma_f32_16x16x32_bf16 v[124:127], v[102:105], v[28:31], v[124:127]
	s_nop 1
	v_mfma_f32_16x16x32_bf16 v[128:131], v[104:107], v[28:31], v[128:131]
	s_nop 1
	v_cvt_pk_bf16_f32 v120, v120, v121
	v_cvt_pk_bf16_f32 v121, v122, v123
	ds_write_b64 v13, v[120:121] offset:0
	v_cvt_pk_bf16_f32 v124, v124, v125
	v_cvt_pk_bf16_f32 v125, v126, v127
	ds_write_b64 v13, v[124:125] offset:1024
	v_cvt_pk_bf16_f32 v128, v128, v129
	v_cvt_pk_bf16_f32 v129, v130, v131
	ds_write_b64 v13, v[128:129] offset:2048
	v_mfma_f32_16x16x32_bf16 v[52:55], v[24:27], a[244:247], 0
	v_mfma_f32_16x16x32_bf16 v[52:55], v[28:31], a[244:247], v[52:55]
	s_waitcnt lgkmcnt(0)
	s_barrier
	ds_read_b128 v[56:59], v14 offset:0
	ds_read_b128 v[60:63], v14 offset:512
	ds_read_b128 v[64:67], v14 offset:1024
	s_waitcnt lgkmcnt(2)
	v_smfmac_f32_16x16x64_bf16 v[148:151], v[56:59], v[160:167], v21
	ds_read_b128 v[68:71], v14 offset:1536
	v_smfmac_f32_16x16x64_bf16 v[152:155], v[56:59], v[168:175], v21
	ds_read_b128 v[72:75], v14 offset:2048
	s_waitcnt lgkmcnt(3)
	v_smfmac_f32_16x16x64_bf16 v[148:151], v[60:63], v[176:183], v21
	ds_read_b128 v[76:79], v14 offset:2560
	v_smfmac_f32_16x16x64_bf16 v[152:155], v[60:63], v[184:191], v21
	s_waitcnt lgkmcnt(3)
	v_smfmac_f32_16x16x64_bf16 v[148:151], v[64:67], v[192:199], v21
	s_waitcnt lgkmcnt(2)
	v_smfmac_f32_16x16x64_bf16 v[148:151], v[68:71], v[208:215], v21
	s_waitcnt lgkmcnt(1)
	v_smfmac_f32_16x16x64_bf16 v[148:151], v[72:75], v[224:231], v21
	s_waitcnt lgkmcnt(0)
	v_smfmac_f32_16x16x64_bf16 v[148:151], v[76:79], v[240:247], v21
	v_smfmac_f32_16x16x64_bf16 v[152:155], v[64:67], v[200:207], v21
	v_rcp_f32 v52, v52
	v_smfmac_f32_16x16x64_bf16 v[152:155], v[68:71], v[216:223], v21
	v_rcp_f32 v53, v53
	v_smfmac_f32_16x16x64_bf16 v[152:155], v[72:75], v[232:239], v21
	v_rcp_f32 v54, v54
	v_smfmac_f32_16x16x64_bf16 v[152:155], v[76:79], v[248:255], v21
	v_rcp_f32 v55, v55
	v_mul_f32 v148, v148, v52
	v_mul_f32 v149, v149, v53
	v_mul_f32 v150, v150, v54
	v_mul_f32 v151, v151, v55
	v_cvt_pk_bf16_f32 v156, v148, v149
	v_cvt_pk_bf16_f32 v157, v150, v151
	v_and_or_b32 v156, v156, -2, s61
	v_pk_mul_f32 v[152:153], v[152:153], v[52:53]
	v_pk_mul_f32 v[154:155], v[154:155], v[54:55]
	v_cvt_pk_bf16_f32 v158, v152, v153
	v_cvt_pk_bf16_f32 v159, v154, v155
	buffer_store_dwordx4 v[156:159], v4, s[36:39], 0 offen
	v_mov_b64 v[148:149], 0
	v_mov_b64 v[150:151], 0
	v_mov_b64 v[152:153], 0
	v_mov_b64 v[154:155], 0
	v_mov_b64 v[80:81], 0
	v_mov_b64 v[82:83], 0
	v_mov_b64 v[84:85], 0
	v_mov_b64 v[86:87], 0
	v_mov_b64 v[88:89], 0
	v_mov_b64 v[90:91], 0
	v_add_u32 v6, 32768, v6
	v_add_u32 v7, 32768, v7
	v_add_u32 v36, 32768, v36
	v_add_u32 v37, 32768, v37
	v_and_b32 v6, 0x7ffff, v6
	v_and_b32 v7, 0x7ffff, v7
	v_and_b32 v36, 0x7ffff, v36
	v_and_b32 v37, 0x7ffff, v37
	s_barrier
	s_branch L_c2_ag
L_c2_fin:
	s_waitcnt vmcnt(0)
	s_barrier
	s_endpgm
L_of_56:
	s_waitcnt vmcnt(2)
	v_max3_u32 v144, v124, v125, v126
	v_max_u32 v144, v144, v127
	v_cmp_eq_u32 vcc, -1, v144
	s_cbranch_vccnz L_of_67
L_of_68:
	ds_write_b128 v2, v[124:127] offset:0
	s_branch L_ook_57
L_of_67:
	buffer_load_dwordx4 v[124:127], v2, s[36:39], s77 offen sc1
	s_waitcnt vmcnt(0)
	v_max3_u32 v144, v124, v125, v126
	v_max_u32 v144, v144, v127
	v_cmp_eq_u32 vcc, -1, v144
	s_cbranch_vccnz L_of_66
	s_branch L_of_68
L_of_66:
	s_add_u32 s34, s34, 1
	s_cmp_lt_u32 s34, 0x40000
	s_cbranch_scc1 L_of_67
	s_endpgm
L_cf_58:
	s_or_b32 s2, s27, s19
	s_cbranch_scc1 L_cd_71
	s_mov_b32 s19, 1
	s_mov_b32 s28, 16384
	v_add_u32 v15, 16384, v1
	v_add_u32 v32, 16384, v33
	s_nop 0
	v_mov_b64 v[80:81], 0
	v_mov_b64 v[82:83], 0
	v_mov_b64 v[84:85], 0
	v_mov_b64 v[86:87], 0
	v_smfmac_f32_16x16x64_bf16 v[80:83], v[40:43], a[0:7], v21
	s_nop 0
	v_smfmac_f32_16x16x64_bf16 v[84:87], v[40:43], a[80:87], v21
	v_smfmac_f32_16x16x64_bf16 v[80:83], v[44:47], a[8:15], v21
	v_smfmac_f32_16x16x64_bf16 v[84:87], v[44:47], a[88:95], v21
	v_smfmac_f32_16x16x64_bf16 v[80:83], v[48:51], a[16:23], v21
	v_smfmac_f32_16x16x64_bf16 v[84:87], v[48:51], a[96:103], v21
	s_waitcnt vmcnt(2) lgkmcnt(0)
	s_barrier
	s_branch L_c2_top
L_cd_71:
	s_cmp_lg_u32 s27, 0
	s_cbranch_scc1 L_cok_59
	s_cmp_lg_u32 s19, 1
	s_cbranch_scc1 L_cd_71_2
	s_mov_b32 s19, 2
	s_mov_b32 m0, 67584
	s_nop 0
	buffer_load_dwordx4 v36, s[36:39], s20 offen sc1 lds
	s_mov_b32 m0, 71680
	s_nop 0
	buffer_load_dwordx4 v37, s[36:39], s20 offen sc1 lds
L_cd_71_2:
	s_cmp_lg_u32 s27, 0
	s_cbranch_scc1 L_cok_59
	s_xor_b32 s29, s28, 32768
	s_bitcmp1_b32 s29, 14
	s_cselect_b32 s30, s21, s20
	s_add_u32 m0, s29, 34816
	s_nop 0
	buffer_load_dwordx4 v36, s[36:39], s30 offen sc1 lds
	s_add_u32 m0, s29, 38912
	s_nop 0
	buffer_load_dwordx4 v37, s[36:39], s30 offen sc1 lds
	s_add_u32 s28, s28, 16384
	s_and_b32 s28, s28, 65535
	v_add_u32 v15, s28, v1
	v_add_u32 v32, s28, v33
	v_mov_b64 v[80:81], 0
	v_mov_b64 v[82:83], 0
	v_mov_b64 v[84:85], 0
	v_mov_b64 v[86:87], 0
	v_smfmac_f32_16x16x64_bf16 v[80:83], v[40:43], a[0:7], v21
	s_nop 0
	v_smfmac_f32_16x16x64_bf16 v[84:87], v[40:43], a[80:87], v21
	v_smfmac_f32_16x16x64_bf16 v[80:83], v[44:47], a[8:15], v21
	v_smfmac_f32_16x16x64_bf16 v[84:87], v[44:47], a[88:95], v21
	v_smfmac_f32_16x16x64_bf16 v[80:83], v[48:51], a[16:23], v21
	v_smfmac_f32_16x16x64_bf16 v[84:87], v[48:51], a[96:103], v21
	s_cmp_lg_u32 s19, 0
	s_cbranch_scc1 L_c2_72
	s_mov_b32 s19, 1
	s_waitcnt vmcnt(4) lgkmcnt(0)
	s_barrier
	s_branch L_c2_top
L_c2_72:
	s_add_u32 s34, s34, 1
	s_cmp_lt_u32 s34, 0x40000
	s_waitcnt vmcnt(2) lgkmcnt(0)
	s_barrier
	s_cbranch_scc1 L_c2_top
	s_endpgm
L_af_60:
	s_cmp_lg_u32 s27, 0
	s_cbranch_scc1 L_aok_61
	v_max3_u32 v144, v52, v53, v54
	v_max3_u32 v144, v144, v55, v56
	v_max3_u32 v144, v144, v57, v58
	v_max3_u32 v144, v144, v59, v60
	v_max3_u32 v144, v144, v61, v62
	v_max3_u32 v144, v144, v63, v64
	v_max3_u32 v144, v144, v65, v66
	v_max3_u32 v144, v144, v67, v68
	v_max3_u32 v144, v144, v69, v70
	v_max3_u32 v144, v144, v71, v72
	v_max3_u32 v144, v144, v73, v74
	v_max3_u32 v144, v144, v75, v76
	v_max3_u32 v144, v144, v77, v78
	v_max_u32 v144, v144, v79
	v_cmp_eq_u32 vcc, -1, v144
	s_cbranch_vccnz L_af_73
	s_branch L_aok_61
L_af_73:
	s_nop 7
	v_mov_b64 v[80:81], 0
	v_mov_b64 v[82:83], 0
	v_mov_b64 v[84:85], 0
	v_mov_b64 v[86:87], 0
	v_smfmac_f32_16x16x64_bf16 v[80:83], v[40:43], a[0:7], v21
	s_nop 0
	v_smfmac_f32_16x16x64_bf16 v[84:87], v[40:43], a[80:87], v21
	v_smfmac_f32_16x16x64_bf16 v[80:83], v[44:47], a[8:15], v21
	v_smfmac_f32_16x16x64_bf16 v[84:87], v[44:47], a[88:95], v21
	v_smfmac_f32_16x16x64_bf16 v[80:83], v[48:51], a[16:23], v21
	v_smfmac_f32_16x16x64_bf16 v[84:87], v[48:51], a[96:103], v21
	s_waitcnt vmcnt(0) lgkmcnt(0)
	s_barrier
L_af_69:
	buffer_load_dwordx4 v[120:123], v36, s[36:39], s20 offen sc1
	buffer_load_dwordx4 v[124:127], v37, s[36:39], s20 offen sc1
	s_waitcnt vmcnt(0)
	v_max3_u32 v144, v120, v121, v122
	v_max3_u32 v144, v144, v123, v124
	v_max3_u32 v144, v144, v125, v126
	v_max_u32 v144, v144, v127
	v_cmp_eq_u32 vcc, -1, v144
	s_cbranch_vccnz L_af_70
	ds_write_b128 v2, v[120:123] offset:32768
	ds_write_b128 v2, v[124:127] offset:36864
	v_mov_b32 v15, v1
	v_mov_b32 v32, v33
	s_mov_b32 s27, 1
	s_waitcnt lgkmcnt(0)
	s_barrier
	s_branch L_c2_top
L_af_70:
	s_add_u32 s34, s34, 1
	s_cmp_lt_u32 s34, 0x40000
	s_cbranch_scc1 L_af_69
	s_endpgm
L_sf_62:
	buffer_load_dword v132, v6, s[36:39], s64 offen offset:0 sc1
	buffer_load_dword v133, v6, s[36:39], s64 offen offset:256 sc1
	buffer_load_dword v134, v6, s[36:39], s64 offen offset:512 sc1
	buffer_load_dword v135, v6, s[36:39], s65 offen offset:0 sc1
	buffer_load_dword v136, v6, s[36:39], s65 offen offset:256 sc1
	buffer_load_dword v137, v6, s[36:39], s65 offen offset:512 sc1
L_sf_74:
	buffer_load_dword v102, v7, s[36:39], s16 offen sc1
	buffer_load_dword v104, v7, s[36:39], s17 offen sc1
	buffer_load_dword v138, v6, s[36:39], s64 offen offset:0 sc1
	buffer_load_dword v139, v6, s[36:39], s64 offen offset:256 sc1
	buffer_load_dword v140, v6, s[36:39], s64 offen offset:512 sc1
	buffer_load_dword v141, v6, s[36:39], s65 offen offset:0 sc1
	buffer_load_dword v142, v6, s[36:39], s65 offen offset:256 sc1
	buffer_load_dword v143, v6, s[36:39], s65 offen offset:512 sc1
	s_waitcnt vmcnt(8)
	v_dot2_f32_bf16 v40, v132, s79, v120
	v_dot2_f32_bf16 v41, v132, s35, v121
	v_dot2_f32_bf16 v42, v133, s79, v122
	v_dot2_f32_bf16 v43, v133, s35, v123
	v_add_f32 v44, v124, v134
	v_dot2_f32_bf16 v40, v135, s79, v40
	v_dot2_f32_bf16 v41, v135, s35, v41
	v_dot2_f32_bf16 v42, v136, s79, v42
	v_dot2_f32_bf16 v43, v136, s35, v43
	v_add_f32 v44, v44, v137
	v_max3_u32 v144, v132, v133, v134
	v_max3_f32 v46, v44, v40, v41
	v_max3_f32 v46, v46, v42, v43
	v_max3_u32 v144, v144, v135, v136
	v_max_u32 v144, v144, v137
	v_max_f32_dpp v47, v46, v46 row_ror:8 row_mask:0xf bank_mask:0xf
	v_max_f32_dpp v46, v46, v46 row_ror:8 row_mask:0xf bank_mask:0xf
	v_cmp_eq_u32 vcc, -1, v144
	s_nop 0
	v_permlane16_swap_b32 v46, v47
	v_max_f32 v48, v46, v47
	v_max_f32 v47, v46, v47
	s_cbranch_vccz L_sok_63
	buffer_load_dword v102, v7, s[36:39], s16 offen sc1
	buffer_load_dword v104, v7, s[36:39], s17 offen sc1
	buffer_load_dword v132, v6, s[36:39], s64 offen offset:0 sc1
	buffer_load_dword v133, v6, s[36:39], s64 offen offset:256 sc1
	buffer_load_dword v134, v6, s[36:39], s64 offen offset:512 sc1
	buffer_load_dword v135, v6, s[36:39], s65 offen offset:0 sc1
	buffer_load_dword v136, v6, s[36:39], s65 offen offset:256 sc1
	buffer_load_dword v137, v6, s[36:39], s65 offen offset:512 sc1
	s_waitcnt vmcnt(8)
	v_dot2_f32_bf16 v40, v138, s79, v120
	v_dot2_f32_bf16 v41, v138, s35, v121
	v_dot2_f32_bf16 v42, v139, s79, v122
	v_dot2_f32_bf16 v43, v139, s35, v123
	v_add_f32 v44, v124, v140
	v_dot2_f32_bf16 v40, v141, s79, v40
	v_dot2_f32_bf16 v41, v141, s35, v41
	v_dot2_f32_bf16 v42, v142, s79, v42
	v_dot2_f32_bf16 v43, v142, s35, v43
	v_add_f32 v44, v44, v143
	v_max3_u32 v144, v138, v139, v140
	v_max3_f32 v46, v44, v40, v41
	v_max3_f32 v46, v46, v42, v43
	v_max3_u32 v144, v144, v141, v142
	v_max_u32 v144, v144, v143
	v_max_f32_dpp v47, v46, v46 row_ror:8 row_mask:0xf bank_mask:0xf
	v_max_f32_dpp v46, v46, v46 row_ror:8 row_mask:0xf bank_mask:0xf
	v_cmp_eq_u32 vcc, -1, v144
	s_nop 0
	v_permlane16_swap_b32 v46, v47
	v_max_f32 v48, v46, v47
	v_max_f32 v47, v46, v47
	s_cbranch_vccz L_sok_63
	s_add_u32 s34, s34, 1
	s_cmp_lt_u32 s34, 0x40000
	s_cbranch_scc1 L_sf_74
	s_endpgm
L_vf_64:
L_vf3_76:
	buffer_load_dword v102, v7, s[36:39], s16 offen sc1
	buffer_load_dword v104, v7, s[36:39], s17 offen sc1
	s_waitcnt vmcnt(0)
	v_max_u32 v144, v102, v104
	v_cmp_eq_u32 vcc, -1, v144
	s_cbranch_vccnz L_vf2_75
	s_branch L_vok_65
L_vf2_75:
	s_add_u32 s34, s34, 1
	s_cmp_lt_u32 s34, 0x40000
	s_cbranch_scc1 L_vf3_76
	s_endpgm
.p2align 6
L_c3_ag:
	s_add_u32 s60, s60, 1
	s_xor_b32 s61, s61, 1
	s_mov_b32 s27, 0
	s_mov_b32 s28, 0
	s_mov_b32 s19, 0
	s_cmp_eq_u32 s3, 0
	s_cselect_b32 s26, s61, s60
	v_mov_b32 v15, v1
	v_mov_b32 v32, v33
	s_mov_b32 s24, s76
	s_nop 15
	s_nop 15
	s_nop 15
	s_nop 15
	s_nop 15
	s_nop 15
	s_nop 11
	s_mov_b32 m0, 35840
	s_nop 0
	buffer_load_dwordx4 v36, s[36:39], s20 offen sc1 lds
	s_waitcnt vmcnt(1)
	s_nop 15
	s_nop 13
	s_mov_b32 m0, 52224
	s_nop 0
	buffer_load_dwordx4 v36, s[36:39], s21 offen sc1 lds
	s_waitcnt lgkmcnt(0)
	s_barrier
L_c3_own:
	ds_read_b128 v[40:43], v1 offset:0
	ds_read_b128 v[44:47], v1 offset:1024
	ds_read_b128 v[48:51], v1 offset:2048
	buffer_load_dwordx4 v[112:115], v17, s[36:39], s76 offen sc1
	s_waitcnt lgkmcnt(2)
	v_smfmac_f32_16x16x64_bf16 v[80:83], v[40:43], a[0:7], v21
	v_smfmac_f32_16x16x64_bf16 v[84:87], v[40:43], a[80:87], v21
	s_waitcnt lgkmcnt(1)
	v_smfmac_f32_16x16x64_bf16 v[80:83], v[44:47], a[8:15], v21
	v_smfmac_f32_16x16x64_bf16 v[84:87], v[44:47], a[88:95], v21
	buffer_load_dwordx4 v[116:119], v18, s[36:39], s76 offen sc1
	s_waitcnt lgkmcnt(0)
	v_smfmac_f32_16x16x64_bf16 v[80:83], v[48:51], a[16:23], v21
	v_smfmac_f32_16x16x64_bf16 v[84:87], v[48:51], a[96:103], v21
	v_smfmac_f32_16x16x64_bf16 v[88:91], v[40:43], a[160:167], v21
	v_smfmac_f32_16x16x64_bf16 v[88:91], v[44:47], a[168:175], v21
	v_smfmac_f32_16x16x64_bf16 v[88:91], v[48:51], a[176:183], v21
	s_waitcnt vmcnt(3)
	s_barrier
L_c3_top:
	ds_read_b128 v[52:55], v15 offset:32768
	ds_read_b32 v144, v32 offset:32768
	ds_read_b128 v[56:59], v15 offset:33792
	ds_read_b128 v[60:63], v15 offset:34816
	ds_read_b128 v[64:67], v15 offset:35840
	ds_read_b128 v[68:71], v15 offset:36864
	s_waitcnt lgkmcnt(5)
	v_smfmac_f32_16x16x64_bf16 v[80:83], v[52:55], a[24:31], v21
	ds_read_b128 v[72:75], v15 offset:37888
	s_waitcnt lgkmcnt(5)
	v_cmp_eq_u32 vcc, -1, v144
	s_waitcnt lgkmcnt(4)
	v_smfmac_f32_16x16x64_bf16 v[80:83], v[56:59], a[32:39], v21
	ds_read_b128 v[76:79], v15 offset:38912
	s_cbranch_vccnz L_cf_77
L_cok_78:
	buffer_store_dword v34, v22, s[36:39], 0 offen sc1
	s_waitcnt lgkmcnt(4)
	v_smfmac_f32_16x16x64_bf16 v[80:83], v[60:63], a[40:47], v21
	s_waitcnt lgkmcnt(3)
	v_smfmac_f32_16x16x64_bf16 v[80:83], v[64:67], a[48:55], v21
	s_waitcnt lgkmcnt(2)
	v_smfmac_f32_16x16x64_bf16 v[80:83], v[68:71], a[56:63], v21
	s_waitcnt lgkmcnt(1)
	v_smfmac_f32_16x16x64_bf16 v[80:83], v[72:75], a[64:71], v21
	buffer_atomic_umax v92, v38, s[36:39], 0 offen sc0
	s_waitcnt lgkmcnt(0)
	v_smfmac_f32_16x16x64_bf16 v[80:83], v[76:79], a[72:79], v21
	s_nop 0
	v_smfmac_f32_16x16x64_bf16 v[84:87], v[52:55], a[104:111], v21
	s_nop 0
	v_smfmac_f32_16x16x64_bf16 v[84:87], v[56:59], a[112:119], v21
	buffer_atomic_umax v93, v38, s[36:39], 0 offen sc0
	v_smfmac_f32_16x16x64_bf16 v[84:87], v[60:63], a[120:127], v21
	s_nop 0
	v_smfmac_f32_16x16x64_bf16 v[84:87], v[64:67], a[128:135], v21
	v_permlane32_swap_b32 v80, v82
	v_smfmac_f32_16x16x64_bf16 v[84:87], v[68:71], a[136:143], v21
	buffer_atomic_umax v94, v38, s[36:39], 0 offen sc0
	v_permlane32_swap_b32 v81, v83
	v_smfmac_f32_16x16x64_bf16 v[84:87], v[72:75], a[144:151], v21
	v_add_f32 v80, v80, v82
	v_smfmac_f32_16x16x64_bf16 v[84:87], v[76:79], a[152:159], v21
	v_add_f32 v81, v81, v83
	v_cmp_u_f32 vcc, v80, v81
	v_cvt_pk_bf16_f32 v82, v80, v81
	ds_write_b32 v9, v82
	s_nop 2
	s_cbranch_vccnz L_af_79
L_aok_80:
	v_permlane32_swap_b32 v84, v86
	v_permlane32_swap_b32 v85, v87
	v_pk_add_f32 v[84:85], v[84:85], v[86:87]
	v_cvt_pk_bf16_f32 v101, v84, v85
	ds_write_b32 v10, v101
	buffer_atomic_umax v95, v38, s[36:39], 0 offen sc0
	v_smfmac_f32_16x16x64_bf16 v[88:91], v[52:55], a[184:191], v21
	v_min_u32 v101, -2, v101
	v_smfmac_f32_16x16x64_bf16 v[88:91], v[56:59], a[192:199], v21
	buffer_store_dword v101, v7, s[36:39], s13 offen sc1
	v_smfmac_f32_16x16x64_bf16 v[88:91], v[60:63], a[200:207], v21
	buffer_atomic_umax v96, v38, s[36:39], 0 offen sc0
	s_waitcnt lgkmcnt(0)
	s_barrier
	v_smfmac_f32_16x16x64_bf16 v[88:91], v[64:67], a[208:215], v21
	v_smfmac_f32_16x16x64_bf16 v[88:91], v[68:71], a[216:223], v21
	v_smfmac_f32_16x16x64_bf16 v[88:91], v[72:75], a[224:231], v21
	v_smfmac_f32_16x16x64_bf16 v[88:91], v[76:79], a[232:239], v21
	buffer_atomic_umax v97, v38, s[36:39], 0 offen sc0
	s_nop 6
	v_permlane32_swap_b32 v88, v90
	v_permlane32_swap_b32 v89, v91
	v_pk_add_f32 v[88:89], v[88:89], v[90:91]
	v_cvt_pk_bf16_f32 v100, v88, v89
	v_min_u32 v100, -2, v100
	buffer_store_dword v100, v7, s[36:39], s12 offen sc1
	s_cmp_eq_u32 s60, 63
	s_cbranch_scc1 L_c3_fin
	s_waitcnt vmcnt(7)
	v_cmp_gt_u32 vcc, v99, v92
	s_cbranch_vccnz L_hf_83
L_hok_81:
	s_waitcnt lgkmcnt(0)
	s_barrier
	s_nop 15
	s_nop 7
	buffer_load_dword v132, v6, s[36:39], s64 offen offset:0 sc1
	buffer_load_dword v133, v6, s[36:39], s64 offen offset:256 sc1
	buffer_load_dword v134, v6, s[36:39], s64 offen offset:512 sc1
	buffer_load_dword v135, v6, s[36:39], s65 offen offset:0 sc1
	buffer_load_dword v136, v6, s[36:39], s65 offen offset:256 sc1
	buffer_load_dword v137, v6, s[36:39], s65 offen offset:512 sc1
	ds_read_b64 v[120:121], v23 offset:0
	ds_read_b64 v[122:123], v23 offset:512
	ds_read_b64 v[124:125], v23 offset:1024
	s_add_u32 s78, s60, 3
	s_min_u32 s78, s78, 64
	s_add_u32 s76, s76, 32768
	s_and_b32 s76, s76, 0x7ffff
	s_nop 15
	s_nop 15
	s_nop 0
	buffer_load_dword v102, v7, s[36:39], s16 offen sc1
	buffer_load_dword v104, v7, s[36:39], s17 offen sc1
	s_waitcnt vmcnt(5) lgkmcnt(0)
	v_dot2_f32_bf16 v40, v132, s79, v120
	v_dot2_f32_bf16 v41, v132, s35, v121
	v_dot2_f32_bf16 v42, v133, s79, v122
	v_dot2_f32_bf16 v43, v133, s35, v123
	v_add_f32 v44, v124, v134
	s_waitcnt vmcnt(2) lgkmcnt(0)
	v_dot2_f32_bf16 v40, v135, s79, v40
	v_dot2_f32_bf16 v41, v135, s35, v41
	v_dot2_f32_bf16 v42, v136, s79, v42
	v_dot2_f32_bf16 v43, v136, s35, v43
	v_add_f32 v44, v44, v137
	v_max3_u32 v144, v132, v133, v134
	v_max3_f32 v46, v44, v40, v41
	v_max3_f32 v46, v46, v42, v43
	v_max3_u32 v144, v144, v135, v136
	v_max_u32 v144, v144, v137
	v_max_f32_dpp v47, v46, v46 row_ror:8 row_mask:0xf bank_mask:0xf
	v_max_f32_dpp v46, v46, v46 row_ror:8 row_mask:0xf bank_mask:0xf
	v_cmp_eq_u32 vcc, -1, v144
	s_nop 0
	v_permlane16_swap_b32 v46, v47
	v_max_f32 v48, v46, v47
	v_max_f32 v47, v46, v47
	s_cbranch_vccnz L_sf_84
L_sok_85:
	s_nop 0
	v_permlane32_swap_b32 v48, v47
	v_max_f32 v46, v48, v47
	v_mul_f32 v46, s62, v46
	v_pk_fma_f32 v[40:41], v[40:41], s[62:63], v[46:47] op_sel_hi:[1,0,0] neg_lo:[0,0,1] neg_hi:[0,0,1]
	v_pk_fma_f32 v[42:43], v[42:43], s[62:63], v[46:47] op_sel_hi:[1,0,0] neg_lo:[0,0,1] neg_hi:[0,0,1]
	v_exp_f32 v40, v40
	v_exp_f32 v41, v41
	v_exp_f32 v42, v42
	v_cvt_pk_bf16_f32 v24, v40, v41
	v_exp_f32 v43, v43
	v_fma_f32 v44, v44, s62, -v46
	v_cvt_pk_bf16_f32 v26, v42, v43
	v_mov_b32_dpp v25, v24 row_ror:8 row_mask:0xf bank_mask:0xf
	v_exp_f32 v44, v44
	v_mov_b32_dpp v27, v26 row_ror:8 row_mask:0xf bank_mask:0xf
	s_nop 0
	v_mov_b32_dpp v45, v44 row_ror:8 row_mask:0xf bank_mask:0xf
	v_mfma_f32_16x16x32_bf16 v[120:123], v[108:111], v[24:27], 0
	v_cvt_pk_bf16_f32 v28, v44, v45
	s_waitcnt vmcnt(0)
	v_max_u32 v144, v102, v104
	v_mfma_f32_16x16x32_bf16 v[124:127], v[112:115], v[24:27], 0
	v_cmp_eq_u32 vcc, -1, v144
	v_mfma_f32_16x16x32_bf16 v[128:131], v[116:119], v[24:27], 0
	s_cbranch_vccnz L_vf_86
L_vok_87:
	v_mfma_f32_16x16x32_bf16 v[120:123], v[100:103], v[28:31], v[120:123]
	buffer_load_dwordx4 v[108:111], v16, s[36:39], s76 offen sc1
	s_nop 0
	v_mfma_f32_16x16x32_bf16 v[124:127], v[102:105], v[28:31], v[124:127]
	s_nop 1
	v_mfma_f32_16x16x32_bf16 v[128:131], v[104:107], v[28:31], v[128:131]
	s_nop 1
	v_cvt_pk_bf16_f32 v120, v120, v121
	v_cvt_pk_bf16_f32 v121, v122, v123
	ds_write_b64 v13, v[120:121] offset:0
	v_cvt_pk_bf16_f32 v124, v124, v125
	v_cvt_pk_bf16_f32 v125, v126, v127
	ds_write_b64 v13, v[124:125] offset:1024
	v_cvt_pk_bf16_f32 v128, v128, v129
	v_cvt_pk_bf16_f32 v129, v130, v131
	ds_write_b64 v13, v[128:129] offset:2048
	v_mfma_f32_16x16x32_bf16 v[52:55], v[24:27], a[244:247], 0
	v_mfma_f32_16x16x32_bf16 v[52:55], v[28:31], a[244:247], v[52:55]
	s_waitcnt lgkmcnt(0)
	s_barrier
	ds_read_b128 v[56:59], v14 offset:0
	ds_read_b128 v[60:63], v14 offset:512
	ds_read_b128 v[64:67], v14 offset:1024
	s_waitcnt lgkmcnt(2)
	v_smfmac_f32_16x16x64_bf16 v[148:151], v[56:59], v[160:167], v21
	ds_read_b128 v[68:71], v14 offset:1536
	v_smfmac_f32_16x16x64_bf16 v[152:155], v[56:59], v[168:175], v21
	ds_read_b128 v[72:75], v14 offset:2048
	s_waitcnt lgkmcnt(3)
	v_smfmac_f32_16x16x64_bf16 v[148:151], v[60:63], v[176:183], v21
	ds_read_b128 v[76:79], v14 offset:2560
	v_smfmac_f32_16x16x64_bf16 v[152:155], v[60:63], v[184:191], v21
	s_waitcnt lgkmcnt(3)
	v_smfmac_f32_16x16x64_bf16 v[148:151], v[64:67], v[192:199], v21
	s_waitcnt lgkmcnt(2)
	v_smfmac_f32_16x16x64_bf16 v[148:151], v[68:71], v[208:215], v21
	s_waitcnt lgkmcnt(1)
	v_smfmac_f32_16x16x64_bf16 v[148:151], v[72:75], v[224:231], v21
	s_waitcnt lgkmcnt(0)
	v_smfmac_f32_16x16x64_bf16 v[148:151], v[76:79], v[240:247], v21
	v_smfmac_f32_16x16x64_bf16 v[152:155], v[64:67], v[200:207], v21
	v_rcp_f32 v52, v52
	v_smfmac_f32_16x16x64_bf16 v[152:155], v[68:71], v[216:223], v21
	v_rcp_f32 v53, v53
	v_smfmac_f32_16x16x64_bf16 v[152:155], v[72:75], v[232:239], v21
	v_rcp_f32 v54, v54
	v_smfmac_f32_16x16x64_bf16 v[152:155], v[76:79], v[248:255], v21
	v_rcp_f32 v55, v55
	v_mul_f32 v148, v148, v52
	v_mul_f32 v149, v149, v53
	v_mul_f32 v150, v150, v54
	v_mul_f32 v151, v151, v55
	v_cvt_pk_bf16_f32 v156, v148, v149
	v_cvt_pk_bf16_f32 v157, v150, v151
	v_and_or_b32 v156, v156, v39, s26
	v_pk_mul_f32 v[152:153], v[152:153], v[52:53]
	v_pk_mul_f32 v[154:155], v[154:155], v[54:55]
	v_cvt_pk_bf16_f32 v158, v152, v153
	v_cvt_pk_bf16_f32 v159, v154, v155
	buffer_store_dwordx4 v[156:159], v4, s[36:39], 0 offen
	v_mov_b64 v[148:149], 0
	v_mov_b64 v[150:151], 0
	v_mov_b64 v[152:153], 0
	v_mov_b64 v[154:155], 0
	v_mov_b64 v[80:81], 0
	v_mov_b64 v[82:83], 0
	v_mov_b64 v[84:85], 0
	v_mov_b64 v[86:87], 0
	v_mov_b64 v[88:89], 0
	v_mov_b64 v[90:91], 0
	v_add_u32 v6, 32768, v6
	v_add_u32 v7, 32768, v7
	v_add_u32 v36, 32768, v36
	v_and_b32 v6, 0x7ffff, v6
	v_and_b32 v7, 0x7ffff, v7
	v_and_b32 v36, 0x7ffff, v36
	s_add_u32 s2, s60, 2
	v_mov_b32 v34, s2
	s_mov_b32 s31, 3
	v_writelane_b32 v99, s2, 0
	v_writelane_b32 v99, s2, 1
	s_nop 15
	s_nop 15
	s_nop 2
	buffer_load_dwordx4 v[40:43], v5, s[36:39], 0 offen offset:0 sc1
	buffer_load_dwordx4 v[44:47], v5, s[36:39], 0 offen offset:1024 sc1
	buffer_load_dwordx4 v[48:51], v5, s[36:39], 0 offen offset:2048 sc1
	buffer_load_dwordx4 v[52:55], v5, s[36:39], 0 offen offset:3072 sc1
	s_nop 15
	s_nop 13
L_rs_91:
	s_sub_u32 s31, s31, 1
	s_cbranch_scc1 L_rss_89
L_rsb_90:
	buffer_load_dwordx4 v[56:59], v5, s[36:39], 0 offen offset:0 sc1
	buffer_load_dwordx4 v[60:63], v5, s[36:39], 0 offen offset:1024 sc1
	buffer_load_dwordx4 v[64:67], v5, s[36:39], 0 offen offset:2048 sc1
	buffer_load_dwordx4 v[68:71], v5, s[36:39], 0 offen offset:3072 sc1
	s_waitcnt vmcnt(7)
	v_mfma_f32_16x16x32_bf16 v[72:75], v[40:43], a[240:243], 0
	s_waitcnt vmcnt(6)
	v_mfma_f32_16x16x32_bf16 v[72:75], v[44:47], a[240:243], v[72:75]
	v_bitop3_b32 v144, v40, v44, s61 bitop3:0x7e
	s_waitcnt vmcnt(5)
	v_mfma_f32_16x16x32_bf16 v[72:75], v[48:51], a[240:243], v[72:75]
	s_waitcnt vmcnt(4)
	v_mfma_f32_16x16x32_bf16 v[72:75], v[52:55], a[240:243], v[72:75]
	v_bitop3_b32 v145, v48, v52, s61 bitop3:0x7e
	v_bitop3_b32 v144, v144, v145, 1 bitop3:0xa8
	v_cmp_ne_u32 vcc, 0, v144
	s_nop 3
	s_cbranch_vccnz L_rs_92
	v_permlane32_swap_b32 v72, v74
	v_permlane32_swap_b32 v73, v75
	v_pk_add_f32 v[72:73], v[72:73], v[74:75]
	v_cvt_pk_bf16_f32 v72, v72, v73
	v_min_u32 v72, -2, v72
	buffer_store_dword v72, v3, s[36:39], s24 offen sc1
	v_cndmask_b32 v73, v72, -1, s[6:7]
	buffer_store_dword v73, v8, s[36:39], 0 offen
	s_barrier
	s_branch L_rsj_88
L_rs_92:
	buffer_load_dwordx4 v[40:43], v5, s[36:39], 0 offen offset:0 sc1
	buffer_load_dwordx4 v[44:47], v5, s[36:39], 0 offen offset:1024 sc1
	buffer_load_dwordx4 v[48:51], v5, s[36:39], 0 offen offset:2048 sc1
	buffer_load_dwordx4 v[52:55], v5, s[36:39], 0 offen offset:3072 sc1
	s_waitcnt vmcnt(7)
	v_mfma_f32_16x16x32_bf16 v[72:75], v[56:59], a[240:243], 0
	s_waitcnt vmcnt(6)
	v_mfma_f32_16x16x32_bf16 v[72:75], v[60:63], a[240:243], v[72:75]
	v_bitop3_b32 v144, v56, v60, s61 bitop3:0x7e
	s_waitcnt vmcnt(5)
	v_mfma_f32_16x16x32_bf16 v[72:75], v[64:67], a[240:243], v[72:75]
	s_waitcnt vmcnt(4)
	v_mfma_f32_16x16x32_bf16 v[72:75], v[68:71], a[240:243], v[72:75]
	v_bitop3_b32 v145, v64, v68, s61 bitop3:0x7e
	v_bitop3_b32 v144, v144, v145, 1 bitop3:0xa8
	v_cmp_ne_u32 vcc, 0, v144
	s_nop 3
	s_cbranch_vccnz L_rs_91
	v_permlane32_swap_b32 v72, v74
	v_permlane32_swap_b32 v73, v75
	v_pk_add_f32 v[72:73], v[72:73], v[74:75]
	v_cvt_pk_bf16_f32 v72, v72, v73
	v_min_u32 v72, -2, v72
	buffer_store_dword v72, v3, s[36:39], s24 offen sc1
	v_cndmask_b32 v73, v72, -1, s[6:7]
	buffer_store_dword v73, v8, s[36:39], 0 offen
	s_barrier
	s_branch L_rsj_88
L_rss_89:
	s_mov_b32 s31, 3
	s_cmp_eq_u32 s18, 0
	s_cbranch_scc1 L_rsr_93
	v_min3_i32 v144, v56, v60, v64
	v_min_i32 v144, v144, v68
	v_cmp_gt_i32 vcc, s60, v144
	s_cbranch_vccnz L_rsr_93
	s_barrier
	s_branch L_rsj_88
L_rsr_93:
	s_add_u32 s34, s34, 1
	s_cmp_lt_u32 s34, 0x40000
	s_cbranch_scc1 L_rsb_90
	s_endpgm
L_rsj_88:
	v_xor_b32 v8, 0x1000, v8
	s_branch L_c3_ag
L_c3_fin:
	s_waitcnt vmcnt(0)
	s_barrier
	s_endpgm
L_cf_77:
	s_or_b32 s2, s27, s19
	s_cbranch_scc1 L_cd_96
	s_mov_b32 s19, 1
	s_mov_b32 s28, 16384
	v_add_u32 v15, 16384, v1
	v_add_u32 v32, 16384, v33
	s_nop 0
	v_mov_b64 v[80:81], 0
	v_mov_b64 v[82:83], 0
	v_mov_b64 v[84:85], 0
	v_mov_b64 v[86:87], 0
	v_smfmac_f32_16x16x64_bf16 v[80:83], v[40:43], a[0:7], v21
	s_nop 0
	v_smfmac_f32_16x16x64_bf16 v[84:87], v[40:43], a[80:87], v21
	v_smfmac_f32_16x16x64_bf16 v[80:83], v[44:47], a[8:15], v21
	v_smfmac_f32_16x16x64_bf16 v[84:87], v[44:47], a[88:95], v21
	v_smfmac_f32_16x16x64_bf16 v[80:83], v[48:51], a[16:23], v21
	v_smfmac_f32_16x16x64_bf16 v[84:87], v[48:51], a[96:103], v21
	s_waitcnt vmcnt(2) lgkmcnt(0)
	s_barrier
	s_branch L_c3_top
L_cd_96:
	s_cmp_lg_u32 s27, 0
	s_cbranch_scc1 L_cok_78
	s_cmp_lg_u32 s19, 1
	s_cbranch_scc1 L_cd_96_2
	s_mov_b32 s19, 2
	s_mov_b32 m0, 68608
	s_nop 0
	buffer_load_dwordx4 v36, s[36:39], s20 offen sc1 lds
L_cd_96_2:
	s_cmp_lg_u32 s27, 0
	s_cbranch_scc1 L_cok_78
	s_xor_b32 s29, s28, 32768
	s_bitcmp1_b32 s29, 14
	s_cselect_b32 s30, s21, s20
	s_add_u32 m0, s29, 35840
	s_nop 0
	buffer_load_dwordx4 v36, s[36:39], s30 offen sc1 lds
	s_add_u32 s28, s28, 16384
	s_and_b32 s28, s28, 65535
	v_add_u32 v15, s28, v1
	v_add_u32 v32, s28, v33
	v_mov_b64 v[80:81], 0
	v_mov_b64 v[82:83], 0
	v_mov_b64 v[84:85], 0
	v_mov_b64 v[86:87], 0
	v_smfmac_f32_16x16x64_bf16 v[80:83], v[40:43], a[0:7], v21
	s_nop 0
	v_smfmac_f32_16x16x64_bf16 v[84:87], v[40:43], a[80:87], v21
	v_smfmac_f32_16x16x64_bf16 v[80:83], v[44:47], a[8:15], v21
	v_smfmac_f32_16x16x64_bf16 v[84:87], v[44:47], a[88:95], v21
	v_smfmac_f32_16x16x64_bf16 v[80:83], v[48:51], a[16:23], v21
	v_smfmac_f32_16x16x64_bf16 v[84:87], v[48:51], a[96:103], v21
	s_cmp_lg_u32 s19, 0
	s_cbranch_scc1 L_c2_97
	s_mov_b32 s19, 1
	s_waitcnt vmcnt(3) lgkmcnt(0)
	s_barrier
	s_branch L_c3_top
L_c2_97:
	s_add_u32 s34, s34, 1
	s_cmp_lt_u32 s34, 0x40000
	s_waitcnt vmcnt(1) lgkmcnt(0)
	s_barrier
	s_cbranch_scc1 L_c3_top
	s_endpgm
L_af_79:
	s_cmp_lg_u32 s27, 0
	s_cbranch_scc1 L_aok_80
	v_max3_u32 v144, v52, v53, v54
	v_max3_u32 v144, v144, v55, v56
	v_max3_u32 v144, v144, v57, v58
	v_max3_u32 v144, v144, v59, v60
	v_max3_u32 v144, v144, v61, v62
	v_max3_u32 v144, v144, v63, v64
	v_max3_u32 v144, v144, v65, v66
	v_max3_u32 v144, v144, v67, v68
	v_max3_u32 v144, v144, v69, v70
	v_max3_u32 v144, v144, v71, v72
	v_max3_u32 v144, v144, v73, v74
	v_max3_u32 v144, v144, v75, v76
	v_max3_u32 v144, v144, v77, v78
	v_max_u32 v144, v144, v79
	v_cmp_eq_u32 vcc, -1, v144
	s_cbranch_vccnz L_af_98
	s_branch L_aok_80
L_af_98:
	s_nop 7
	v_mov_b64 v[80:81], 0
	v_mov_b64 v[82:83], 0
	v_mov_b64 v[84:85], 0
	v_mov_b64 v[86:87], 0
	v_smfmac_f32_16x16x64_bf16 v[80:83], v[40:43], a[0:7], v21
	s_nop 0
	v_smfmac_f32_16x16x64_bf16 v[84:87], v[40:43], a[80:87], v21
	v_smfmac_f32_16x16x64_bf16 v[80:83], v[44:47], a[8:15], v21
	v_smfmac_f32_16x16x64_bf16 v[84:87], v[44:47], a[88:95], v21
	v_smfmac_f32_16x16x64_bf16 v[80:83], v[48:51], a[16:23], v21
	v_smfmac_f32_16x16x64_bf16 v[84:87], v[48:51], a[96:103], v21
	s_waitcnt vmcnt(0) lgkmcnt(0)
	s_barrier
L_af_94:
	buffer_load_dwordx4 v[120:123], v36, s[36:39], s20 offen sc1
	s_waitcnt vmcnt(0)
	v_max3_u32 v144, v120, v121, v122
	v_max_u32 v144, v144, v123
	v_cmp_eq_u32 vcc, -1, v144
	s_cbranch_vccnz L_af_95
	ds_write_b128 v2, v[120:123] offset:32768
	v_mov_b32 v15, v1
	v_mov_b32 v32, v33
	s_mov_b32 s27, 1
	s_waitcnt lgkmcnt(0)
	s_barrier
	s_branch L_c3_top
L_af_95:
	s_add_u32 s34, s34, 1
	s_cmp_lt_u32 s34, 0x40000
	s_cbranch_scc1 L_af_94
	s_endpgm
L_hf_83:
	buffer_atomic_umax v92, v38, s[36:39], 0 offen sc0
	s_waitcnt vmcnt(7)
	v_cmp_gt_u32 vcc, v99, v93
	s_cbranch_vccz L_hok_81
	buffer_atomic_umax v93, v38, s[36:39], 0 offen sc0
	s_waitcnt vmcnt(7)
	v_cmp_gt_u32 vcc, v99, v94
	s_cbranch_vccz L_hok_81
	buffer_atomic_umax v94, v38, s[36:39], 0 offen sc0
	s_waitcnt vmcnt(7)
	v_cmp_gt_u32 vcc, v99, v95
	s_cbranch_vccz L_hok_81
	buffer_atomic_umax v95, v38, s[36:39], 0 offen sc0
	s_waitcnt vmcnt(6)
	v_cmp_gt_u32 vcc, v99, v96
	s_cbranch_vccz L_hok_81
	buffer_atomic_umax v96, v38, s[36:39], 0 offen sc0
	s_waitcnt vmcnt(6)
	v_cmp_gt_u32 vcc, v99, v97
	s_cbranch_vccz L_hok_81
L_hl_82:
	buffer_atomic_umax v97, v38, s[36:39], 0 offen sc0
	s_waitcnt vmcnt(5)
	v_cmp_gt_u32 vcc, v99, v92
	s_cbranch_vccz L_hok_81
	buffer_atomic_umax v92, v38, s[36:39], 0 offen sc0
	s_waitcnt vmcnt(5)
	v_cmp_gt_u32 vcc, v99, v93
	s_cbranch_vccz L_hok_81
	buffer_atomic_umax v93, v38, s[36:39], 0 offen sc0
	s_waitcnt vmcnt(5)
	v_cmp_gt_u32 vcc, v99, v94
	s_cbranch_vccz L_hok_81
	buffer_atomic_umax v94, v38, s[36:39], 0 offen sc0
	s_waitcnt vmcnt(5)
	v_cmp_gt_u32 vcc, v99, v95
	s_cbranch_vccz L_hok_81
	buffer_atomic_umax v95, v38, s[36:39], 0 offen sc0
	s_waitcnt vmcnt(5)
	v_cmp_gt_u32 vcc, v99, v96
	s_cbranch_vccz L_hok_81
	buffer_atomic_umax v96, v38, s[36:39], 0 offen sc0
	s_waitcnt vmcnt(5)
	v_cmp_gt_u32 vcc, v99, v97
	s_cbranch_vccz L_hok_81
	s_add_u32 s34, s34, 1
	s_cmp_lt_u32 s34, 0x40000
	s_cbranch_scc1 L_hl_82
	s_endpgm
L_sf_84:
	buffer_load_dword v132, v6, s[36:39], s64 offen offset:0 sc1
	buffer_load_dword v133, v6, s[36:39], s64 offen offset:256 sc1
	buffer_load_dword v134, v6, s[36:39], s64 offen offset:512 sc1
	buffer_load_dword v135, v6, s[36:39], s65 offen offset:0 sc1
	buffer_load_dword v136, v6, s[36:39], s65 offen offset:256 sc1
	buffer_load_dword v137, v6, s[36:39], s65 offen offset:512 sc1
L_sf_99:
	buffer_load_dword v102, v7, s[36:39], s16 offen sc1
	buffer_load_dword v104, v7, s[36:39], s17 offen sc1
	buffer_load_dword v138, v6, s[36:39], s64 offen offset:0 sc1
	buffer_load_dword v139, v6, s[36:39], s64 offen offset:256 sc1
	buffer_load_dword v140, v6, s[36:39], s64 offen offset:512 sc1
	buffer_load_dword v141, v6, s[36:39], s65 offen offset:0 sc1
	buffer_load_dword v142, v6, s[36:39], s65 offen offset:256 sc1
	buffer_load_dword v143, v6, s[36:39], s65 offen offset:512 sc1
	s_waitcnt vmcnt(8)
	v_dot2_f32_bf16 v40, v132, s79, v120
	v_dot2_f32_bf16 v41, v132, s35, v121
	v_dot2_f32_bf16 v42, v133, s79, v122
	v_dot2_f32_bf16 v43, v133, s35, v123
	v_add_f32 v44, v124, v134
	v_dot2_f32_bf16 v40, v135, s79, v40
	v_dot2_f32_bf16 v41, v135, s35, v41
	v_dot2_f32_bf16 v42, v136, s79, v42
	v_dot2_f32_bf16 v43, v136, s35, v43
	v_add_f32 v44, v44, v137
	v_max3_u32 v144, v132, v133, v134
	v_max3_f32 v46, v44, v40, v41
	v_max3_f32 v46, v46, v42, v43
	v_max3_u32 v144, v144, v135, v136
	v_max_u32 v144, v144, v137
	v_max_f32_dpp v47, v46, v46 row_ror:8 row_mask:0xf bank_mask:0xf
	v_max_f32_dpp v46, v46, v46 row_ror:8 row_mask:0xf bank_mask:0xf
	v_cmp_eq_u32 vcc, -1, v144
	s_nop 0
	v_permlane16_swap_b32 v46, v47
	v_max_f32 v48, v46, v47
	v_max_f32 v47, v46, v47
	s_cbranch_vccz L_sok_85
	buffer_load_dword v102, v7, s[36:39], s16 offen sc1
	buffer_load_dword v104, v7, s[36:39], s17 offen sc1
	buffer_load_dword v132, v6, s[36:39], s64 offen offset:0 sc1
	buffer_load_dword v133, v6, s[36:39], s64 offen offset:256 sc1
	buffer_load_dword v134, v6, s[36:39], s64 offen offset:512 sc1
	buffer_load_dword v135, v6, s[36:39], s65 offen offset:0 sc1
	buffer_load_dword v136, v6, s[36:39], s65 offen offset:256 sc1
	buffer_load_dword v137, v6, s[36:39], s65 offen offset:512 sc1
	s_waitcnt vmcnt(8)
	v_dot2_f32_bf16 v40, v138, s79, v120
	v_dot2_f32_bf16 v41, v138, s35, v121
	v_dot2_f32_bf16 v42, v139, s79, v122
	v_dot2_f32_bf16 v43, v139, s35, v123
	v_add_f32 v44, v124, v140
	v_dot2_f32_bf16 v40, v141, s79, v40
	v_dot2_f32_bf16 v41, v141, s35, v41
	v_dot2_f32_bf16 v42, v142, s79, v42
	v_dot2_f32_bf16 v43, v142, s35, v43
	v_add_f32 v44, v44, v143
	v_max3_u32 v144, v138, v139, v140
	v_max3_f32 v46, v44, v40, v41
	v_max3_f32 v46, v46, v42, v43
	v_max3_u32 v144, v144, v141, v142
	v_max_u32 v144, v144, v143
	v_max_f32_dpp v47, v46, v46 row_ror:8 row_mask:0xf bank_mask:0xf
	v_max_f32_dpp v46, v46, v46 row_ror:8 row_mask:0xf bank_mask:0xf
	v_cmp_eq_u32 vcc, -1, v144
	s_nop 0
	v_permlane16_swap_b32 v46, v47
	v_max_f32 v48, v46, v47
	v_max_f32 v47, v46, v47
	s_cbranch_vccz L_sok_85
	s_add_u32 s34, s34, 1
	s_cmp_lt_u32 s34, 0x40000
	s_cbranch_scc1 L_sf_99
	s_endpgm
L_vf_86:
L_vf3_101:
	buffer_load_dword v102, v7, s[36:39], s16 offen sc1
	buffer_load_dword v104, v7, s[36:39], s17 offen sc1
	s_waitcnt vmcnt(0)
	v_max_u32 v144, v102, v104
	v_cmp_eq_u32 vcc, -1, v144
	s_cbranch_vccnz L_vf2_100
	s_branch L_vok_87
L_vf2_100:
	s_add_u32 s34, s34, 1
	s_cmp_lt_u32 s34, 0x40000
	s_cbranch_scc1 L_vf3_101
	s_endpgm
L_proj:
	s_cmp_lt_u32 s60, 24
	s_cbranch_scc1 L_pk_102
	s_cmp_lt_u32 s60, 48
	s_cbranch_scc1 L_pv_103
	s_mov_b32 s61, 2
	s_sub_u32 s62, s60, 48
	s_mov_b32 s44, s12
	s_and_b32 s45, s13, 0xffff
	s_mov_b32 s46, 0x780000
	s_mov_b32 s47, 0x20000
	s_branch L_pj_104
L_pv_103:
	s_mov_b32 s61, 1
	s_sub_u32 s62, s60, 24
	s_mov_b32 s44, s16
	s_and_b32 s45, s17, 0xffff
	s_mov_b32 s46, 0x780000
	s_mov_b32 s47, 0x20000
	s_branch L_pj_104
L_pk_102:
	s_mov_b32 s61, 0
	s_sub_u32 s62, s60, 0
	s_mov_b32 s44, s14
	s_and_b32 s45, s15, 0xffff
	s_mov_b32 s46, 0x780000
	s_mov_b32 s47, 0x20000
L_pj_104:
	s_mov_b32 s48, s8
	s_and_b32 s49, s9, 0xffff
	s_mov_b32 s50, 0x280000
	s_mov_b32 s51, 0x20000
	s_lshl_b32 s62, s62, 2
	s_add_u32 s62, s62, s5
	s_mul_i32 s63, s62, 171
	s_lshr_b32 s63, s63, 9
	s_mul_i32 s64, s63, 3
	s_sub_u32 s64, s62, s64
	s_mov_b32 s71, s63
	s_mov_b32 s72, s64
	s_lshl_b32 s73, s71, 2
	s_add_u32 s73, s73, 3
	s_lshl_b32 s73, s73, 19
	s_add_u32 s78, s71, 3
	s_bfe_u32 s79, s78, 0x10001
	s_lshl_b32 s79, s79, 14
	s_and_b32 s78, s78, 1
	s_lshl_b32 s78, s78, 12
	s_add_u32 s78, s78, s79
	s_add_u32 s73, s73, s78
	s_add_u32 s73, s73, 32768
	s_mul_i32 s6, s61, 3
	s_add_u32 s6, s6, s64
	s_lshl_b32 s6, s6, 7
	s_add_u32 s6, s6, s73
	s_movk_i32 s7, 0x2000
	v_lshl_add_u32 v12, v0, 2, s6
	s_lshl_b32 s6, s63, 8
	s_add_u32 s6, s6, 0x4090000
	v_and_b32 v20, 1, v0
	v_lshl_add_u32 v104, v20, 7, s6
	v_mov_b32 v20, 0
	v_mov_b32 v105, 0
	s_mov_b64 exec, 0xffff
	buffer_store_dword v20, v12, s[36:39], 0 offen sc1
	buffer_store_dword v20, v12, s[36:39], s7 offen sc1
	s_mov_b64 exec, -1
	v_lshrrev_b32 v20, 3, v0
	v_mul_u32_u24 v21, 12288, v20
	s_lshl_b32 s6, s62, 7
	v_add_u32 v21, s6, v21
	v_and_b32 v22, 7, v0
	v_and_b32 v23, 2, v20
	v_xor_b32 v22, v22, v23
	v_lshl_add_u32 v1, v22, 4, v21
	v_xor_b32 v22, 4, v22
	v_lshl_add_u32 v2, v22, 4, v21
	v_add_u32 v2, 98304, v2
	s_mul_i32 s65, s5, 20480
	s_add_u32 s65, s65, 81920
	v_lshrrev_b32 v20, 4, v0
	v_bfe_u32 v21, v0, 2, 2
	v_and_b32 v22, 3, v0
	v_lshlrev_b32 v23, 10, v20
	v_lshl_add_u32 v23, v21, 7, v23
	v_lshl_add_u32 v23, v22, 3, v23
	v_add_u32 v23, s65, v23
	v_and_b32 v24, 1, v20
	v_lshrrev_b32 v25, 1, v21
	v_lshl_add_u32 v24, v24, 1, v25
	v_xor_b32 v25, 0, v24
	v_lshl_add_u32 v4, v25, 5, v23
	v_xor_b32 v25, 1, v24
	v_lshl_add_u32 v5, v25, 5, v23
	v_xor_b32 v25, 2, v24
	v_lshl_add_u32 v6, v25, 5, v23
	v_xor_b32 v25, 3, v24
	v_lshl_add_u32 v7, v25, 5, v23
	v_lshrrev_b32 v23, 2, v0
	v_mul_u32_u24 v23, 1280, v23
	v_sub_u32 v24, 0, v20
	v_and_b32 v24, 3, v24
	v_xor_b32 v24, v24, v22
	v_lshl_add_u32 v23, v24, 4, v23
	s_mul_i32 s6, s5, 320
	v_add_u32 v8, s6, v23
	v_add_u32 v9, 20480, v8
	v_sub_u32 v24, 0, v21
	v_and_b32 v24, 3, v24
	v_xor_b32 v24, v24, v20
	v_and_b32 v23, 15, v0
	v_lshlrev_b32 v23, 6, v23
	v_lshl_add_u32 v10, v24, 4, v23
	s_mul_i32 s67, s5, 10240
	s_mov_b32 s68, 0
	s_mov_b32 s66, 0
	s_mov_b32 s70, 0
	s_barrier
	s_cmp_eq_u32 s61, 0
	s_cbranch_scc1 L_ps_105
	s_cmp_eq_u32 s61, 1
	s_cbranch_scc1 L_ps_106
	s_waitcnt vmcnt(0)
	s_barrier
	s_lshl_b32 s6, s5, 12
	s_add_u32 s6, s6, 96
	v_mov_b32 v150, s6
	v_mov_b32 v151, 1
	s_mov_b64 exec, 1
	buffer_atomic_add v151, v150, s[40:43], 0 offen
	s_mov_b64 exec, -1
	v_mov_b32 v153, 128
L_sw_107:
	buffer_load_dwordx3 v[150:152], v153, s[40:43], 0 offen sc1
	s_waitcnt vmcnt(0)
	v_readfirstlane_b32 s6, v150
	s_nop 0
	s_cmp_ge_u32 s6, 256
	s_cbranch_scc1 L_swok_108
	s_sleep 4
	s_add_u32 s34, s34, 1
	s_cmp_lt_u32 s34, 0x40000
	s_cbranch_scc1 L_sw_107
	s_endpgm
L_swok_108:
	s_add_u32 m0, s67, 0
	s_nop 0
	buffer_load_dwordx4 v8, s[48:51], s68 offen offset:0 lds
	s_add_u32 m0, s67, 1024
	s_nop 0
	buffer_load_dwordx4 v9, s[48:51], s68 offen offset:0 lds
	s_add_u32 m0, s67, 1984
	s_nop 0
	buffer_load_dwordx4 v8, s[48:51], s68 offen offset:64 lds
	s_add_u32 m0, s67, 3008
	s_nop 0
	buffer_load_dwordx4 v9, s[48:51], s68 offen offset:64 lds
	s_add_u32 m0, s67, 3968
	s_nop 0
	buffer_load_dwordx4 v8, s[48:51], s68 offen offset:128 lds
	s_add_u32 m0, s67, 4992
	s_nop 0
	buffer_load_dwordx4 v9, s[48:51], s68 offen offset:128 lds
	s_add_u32 m0, s67, 5952
	s_nop 0
	buffer_load_dwordx4 v8, s[48:51], s68 offen offset:192 lds
	s_add_u32 m0, s67, 6976
	s_nop 0
	buffer_load_dwordx4 v9, s[48:51], s68 offen offset:192 lds
	s_add_u32 m0, s67, 7936
	s_nop 0
	buffer_load_dwordx4 v8, s[48:51], s68 offen offset:256 lds
	s_add_u32 m0, s67, 8960
	s_nop 0
	buffer_load_dwordx4 v9, s[48:51], s68 offen offset:256 lds
	s_add_u32 s67, s67, 40960
	s_add_u32 s68, s68, 40960
	s_add_u32 m0, s65, 0
	s_mov_b32 s63, 7471104
	buffer_load_dwordx4 v1, s[44:47], s63 offen nt lds
	s_add_u32 m0, s65, 1024
	s_mov_b32 s63, 7471104
	buffer_load_dwordx4 v2, s[44:47], s63 offen nt lds
	s_add_u32 m0, s65, 2048
	s_mov_b32 s63, 7667712
	buffer_load_dwordx4 v1, s[44:47], s63 offen nt lds
	s_add_u32 m0, s65, 3072
	s_mov_b32 s63, 7667712
	buffer_load_dwordx4 v2, s[44:47], s63 offen nt lds
	s_add_u32 m0, s65, 4096
	s_mov_b32 s63, 7077888
	buffer_load_dwordx4 v1, s[44:47], s63 offen nt lds
	s_add_u32 m0, s65, 5120
	s_mov_b32 s63, 7077888
	buffer_load_dwordx4 v2, s[44:47], s63 offen nt lds
	s_add_u32 m0, s65, 6144
	s_mov_b32 s63, 7274496
	buffer_load_dwordx4 v1, s[44:47], s63 offen nt lds
	s_add_u32 m0, s65, 7168
	s_mov_b32 s63, 7274496
	buffer_load_dwordx4 v2, s[44:47], s63 offen nt lds
	v_add_u32 v13, 40960, v10
	s_waitcnt vmcnt(4)
	ds_read_b64_tr_b16 v[240:241], v4 offset:0
	ds_read_b64_tr_b16 v[242:243], v4 offset:512
	ds_read_b64_tr_b16 v[244:245], v5 offset:0
	ds_read_b64_tr_b16 v[246:247], v5 offset:512
	ds_read_b64_tr_b16 v[248:249], v6 offset:0
	ds_read_b64_tr_b16 v[250:251], v6 offset:512
	ds_read_b64_tr_b16 v[252:253], v7 offset:0
	ds_read_b64_tr_b16 v[254:255], v7 offset:512
	s_waitcnt lgkmcnt(0)
	s_add_u32 m0, s65, 8192
	s_mov_b32 s63, 6684672
	buffer_load_dwordx4 v1, s[44:47], s63 offen nt lds
	s_add_u32 m0, s65, 9216
	s_mov_b32 s63, 6684672
	buffer_load_dwordx4 v2, s[44:47], s63 offen nt lds
	s_add_u32 m0, s65, 10240
	s_mov_b32 s63, 6881280
	buffer_load_dwordx4 v1, s[44:47], s63 offen nt lds
	s_add_u32 m0, s65, 11264
	s_mov_b32 s63, 6881280
	buffer_load_dwordx4 v2, s[44:47], s63 offen nt lds
	s_waitcnt vmcnt(4)
	ds_read_b64_tr_b16 v[224:225], v4 offset:4096
	ds_read_b64_tr_b16 v[226:227], v4 offset:4608
	ds_read_b64_tr_b16 v[228:229], v5 offset:4096
	ds_read_b64_tr_b16 v[230:231], v5 offset:4608
	ds_read_b64_tr_b16 v[232:233], v6 offset:4096
	ds_read_b64_tr_b16 v[234:235], v6 offset:4608
	ds_read_b64_tr_b16 v[236:237], v7 offset:4096
	ds_read_b64_tr_b16 v[238:239], v7 offset:4608
	s_waitcnt lgkmcnt(0)
	s_add_u32 m0, s67, 0
	s_nop 0
	buffer_load_dwordx4 v8, s[48:51], s68 offen offset:0 lds
	s_add_u32 m0, s67, 1024
	s_nop 0
	buffer_load_dwordx4 v9, s[48:51], s68 offen offset:0 lds
	s_add_u32 m0, s67, 1984
	s_nop 0
	buffer_load_dwordx4 v8, s[48:51], s68 offen offset:64 lds
	s_add_u32 m0, s67, 3008
	s_nop 0
	buffer_load_dwordx4 v9, s[48:51], s68 offen offset:64 lds
	s_add_u32 m0, s67, 3968
	s_nop 0
	buffer_load_dwordx4 v8, s[48:51], s68 offen offset:128 lds
	s_add_u32 m0, s67, 4992
	s_nop 0
	buffer_load_dwordx4 v9, s[48:51], s68 offen offset:128 lds
	s_add_u32 m0, s67, 5952
	s_nop 0
	buffer_load_dwordx4 v8, s[48:51], s68 offen offset:192 lds
	s_add_u32 m0, s67, 6976
	s_nop 0
	buffer_load_dwordx4 v9, s[48:51], s68 offen offset:192 lds
	s_add_u32 m0, s67, 7936
	s_nop 0
	buffer_load_dwordx4 v8, s[48:51], s68 offen offset:256 lds
	s_add_u32 m0, s67, 8960
	s_nop 0
	buffer_load_dwordx4 v9, s[48:51], s68 offen offset:256 lds
	s_add_u32 s67, s67, 40960
	s_add_u32 s68, s68, 40960
	s_add_u32 m0, s65, 12288
	s_mov_b32 s63, 6291456
	buffer_load_dwordx4 v1, s[44:47], s63 offen nt lds
	s_add_u32 m0, s65, 13312
	s_mov_b32 s63, 6291456
	buffer_load_dwordx4 v2, s[44:47], s63 offen nt lds
	s_add_u32 m0, s65, 14336
	s_mov_b32 s63, 6488064
	buffer_load_dwordx4 v1, s[44:47], s63 offen nt lds
	s_add_u32 m0, s65, 15360
	s_mov_b32 s63, 6488064
	buffer_load_dwordx4 v2, s[44:47], s63 offen nt lds
	s_waitcnt vmcnt(14)
	ds_read_b64_tr_b16 v[208:209], v4 offset:8192
	ds_read_b64_tr_b16 v[210:211], v4 offset:8704
	ds_read_b64_tr_b16 v[212:213], v5 offset:8192
	ds_read_b64_tr_b16 v[214:215], v5 offset:8704
	ds_read_b64_tr_b16 v[216:217], v6 offset:8192
	ds_read_b64_tr_b16 v[218:219], v6 offset:8704
	ds_read_b64_tr_b16 v[220:221], v7 offset:8192
	ds_read_b64_tr_b16 v[222:223], v7 offset:8704
	s_waitcnt lgkmcnt(0)
	s_add_u32 m0, s65, 16384
	s_mov_b32 s63, 5898240
	buffer_load_dwordx4 v1, s[44:47], s63 offen nt lds
	s_add_u32 m0, s65, 17408
	s_mov_b32 s63, 5898240
	buffer_load_dwordx4 v2, s[44:47], s63 offen nt lds
	s_add_u32 m0, s65, 18432
	s_mov_b32 s63, 6094848
	buffer_load_dwordx4 v1, s[44:47], s63 offen nt lds
	s_add_u32 m0, s65, 19456
	s_mov_b32 s63, 6094848
	buffer_load_dwordx4 v2, s[44:47], s63 offen nt lds
	s_waitcnt vmcnt(4)
	ds_read_b64_tr_b16 v[192:193], v4 offset:12288
	ds_read_b64_tr_b16 v[194:195], v4 offset:12800
	ds_read_b64_tr_b16 v[196:197], v5 offset:12288
	ds_read_b64_tr_b16 v[198:199], v5 offset:12800
	ds_read_b64_tr_b16 v[200:201], v6 offset:12288
	ds_read_b64_tr_b16 v[202:203], v6 offset:12800
	ds_read_b64_tr_b16 v[204:205], v7 offset:12288
	ds_read_b64_tr_b16 v[206:207], v7 offset:12800
	s_waitcnt lgkmcnt(0)
	s_add_u32 m0, s65, 0
	s_mov_b32 s63, 5505024
	buffer_load_dwordx4 v1, s[44:47], s63 offen nt lds
	s_add_u32 m0, s65, 1024
	s_mov_b32 s63, 5505024
	buffer_load_dwordx4 v2, s[44:47], s63 offen nt lds
	s_add_u32 m0, s65, 2048
	s_mov_b32 s63, 5701632
	buffer_load_dwordx4 v1, s[44:47], s63 offen nt lds
	s_add_u32 m0, s65, 3072
	s_mov_b32 s63, 5701632
	buffer_load_dwordx4 v2, s[44:47], s63 offen nt lds
	s_waitcnt vmcnt(4)
	ds_read_b64_tr_b16 a[240:241], v4 offset:16384
	ds_read_b64_tr_b16 a[242:243], v4 offset:16896
	ds_read_b64_tr_b16 a[244:245], v5 offset:16384
	ds_read_b64_tr_b16 a[246:247], v5 offset:16896
	ds_read_b64_tr_b16 a[248:249], v6 offset:16384
	ds_read_b64_tr_b16 a[250:251], v6 offset:16896
	ds_read_b64_tr_b16 a[252:253], v7 offset:16384
	ds_read_b64_tr_b16 a[254:255], v7 offset:16896
	s_waitcnt lgkmcnt(0)
	s_add_u32 m0, s65, 4096
	s_mov_b32 s63, 5111808
	buffer_load_dwordx4 v1, s[44:47], s63 offen nt lds
	s_add_u32 m0, s65, 5120
	s_mov_b32 s63, 5111808
	buffer_load_dwordx4 v2, s[44:47], s63 offen nt lds
	s_add_u32 m0, s65, 6144
	s_mov_b32 s63, 5308416
	buffer_load_dwordx4 v1, s[44:47], s63 offen nt lds
	s_add_u32 m0, s65, 7168
	s_mov_b32 s63, 5308416
	buffer_load_dwordx4 v2, s[44:47], s63 offen nt lds
	s_waitcnt vmcnt(4)
	ds_read_b64_tr_b16 a[224:225], v4 offset:0
	ds_read_b64_tr_b16 a[226:227], v4 offset:512
	ds_read_b64_tr_b16 a[228:229], v5 offset:0
	ds_read_b64_tr_b16 a[230:231], v5 offset:512
	ds_read_b64_tr_b16 a[232:233], v6 offset:0
	ds_read_b64_tr_b16 a[234:235], v6 offset:512
	ds_read_b64_tr_b16 a[236:237], v7 offset:0
	ds_read_b64_tr_b16 a[238:239], v7 offset:512
	s_waitcnt lgkmcnt(0)
	s_add_u32 m0, s65, 8192
	s_mov_b32 s63, 4718592
	buffer_load_dwordx4 v1, s[44:47], s63 offen nt lds
	s_add_u32 m0, s65, 9216
	s_mov_b32 s63, 4718592
	buffer_load_dwordx4 v2, s[44:47], s63 offen nt lds
	s_add_u32 m0, s65, 10240
	s_mov_b32 s63, 4915200
	buffer_load_dwordx4 v1, s[44:47], s63 offen nt lds
	s_add_u32 m0, s65, 11264
	s_mov_b32 s63, 4915200
	buffer_load_dwordx4 v2, s[44:47], s63 offen nt lds
	s_waitcnt vmcnt(4)
	ds_read_b64_tr_b16 a[208:209], v4 offset:4096
	ds_read_b64_tr_b16 a[210:211], v4 offset:4608
	ds_read_b64_tr_b16 a[212:213], v5 offset:4096
	ds_read_b64_tr_b16 a[214:215], v5 offset:4608
	ds_read_b64_tr_b16 a[216:217], v6 offset:4096
	ds_read_b64_tr_b16 a[218:219], v6 offset:4608
	ds_read_b64_tr_b16 a[220:221], v7 offset:4096
	ds_read_b64_tr_b16 a[222:223], v7 offset:4608
	s_waitcnt lgkmcnt(0)
	s_add_u32 m0, s65, 12288
	s_mov_b32 s63, 4325376
	buffer_load_dwordx4 v1, s[44:47], s63 offen nt lds
	s_add_u32 m0, s65, 13312
	s_mov_b32 s63, 4325376
	buffer_load_dwordx4 v2, s[44:47], s63 offen nt lds
	s_add_u32 m0, s65, 14336
	s_mov_b32 s63, 4521984
	buffer_load_dwordx4 v1, s[44:47], s63 offen nt lds
	s_add_u32 m0, s65, 15360
	s_mov_b32 s63, 4521984
	buffer_load_dwordx4 v2, s[44:47], s63 offen nt lds
	s_waitcnt vmcnt(24)
	s_barrier
	ds_read_b128 v[48:51], v10 offset:38912
	ds_read_b128 v[52:55], v10 offset:39936
	ds_read_b128 v[56:59], v13 offset:38912
	ds_read_b128 v[60:63], v13 offset:39936
	ds_read_b128 v[64:67], v10 offset:36864
	ds_read_b128 v[68:71], v10 offset:37888
	ds_read_b128 v[72:75], v13 offset:36864
	ds_read_b128 v[76:79], v13 offset:37888
	s_waitcnt lgkmcnt(4)
	v_mfma_f32_16x16x32_bf16 v[16:19], v[240:243], v[48:51], 0
	v_mfma_f32_16x16x32_bf16 v[24:27], v[244:247], v[48:51], 0
	v_mfma_f32_16x16x32_bf16 v[32:35], v[248:251], v[48:51], 0
	v_mfma_f32_16x16x32_bf16 v[40:43], v[252:255], v[48:51], 0
	v_mfma_f32_16x16x32_bf16 v[20:23], v[240:243], v[52:55], 0
	v_mfma_f32_16x16x32_bf16 v[28:31], v[244:247], v[52:55], 0
	v_mfma_f32_16x16x32_bf16 v[36:39], v[248:251], v[52:55], 0
	v_mfma_f32_16x16x32_bf16 v[44:47], v[252:255], v[52:55], 0
	v_mfma_f32_16x16x32_bf16 v[112:115], v[240:243], v[56:59], 0
	v_mfma_f32_16x16x32_bf16 v[120:123], v[244:247], v[56:59], 0
	v_mfma_f32_16x16x32_bf16 v[128:131], v[248:251], v[56:59], 0
	v_mfma_f32_16x16x32_bf16 v[136:139], v[252:255], v[56:59], 0
	v_mfma_f32_16x16x32_bf16 v[116:119], v[240:243], v[60:63], 0
	v_mfma_f32_16x16x32_bf16 v[124:127], v[244:247], v[60:63], 0
	v_mfma_f32_16x16x32_bf16 v[132:135], v[248:251], v[60:63], 0
	v_mfma_f32_16x16x32_bf16 v[140:143], v[252:255], v[60:63], 0
	ds_read_b128 v[48:51], v10 offset:34816
	ds_read_b128 v[52:55], v10 offset:35840
	ds_read_b128 v[56:59], v13 offset:34816
	ds_read_b128 v[60:63], v13 offset:35840
	s_waitcnt lgkmcnt(4)
	v_mfma_f32_16x16x32_bf16 v[16:19], v[224:227], v[64:67], v[16:19]
	v_mfma_f32_16x16x32_bf16 v[24:27], v[228:231], v[64:67], v[24:27]
	v_mfma_f32_16x16x32_bf16 v[32:35], v[232:235], v[64:67], v[32:35]
	v_mfma_f32_16x16x32_bf16 v[40:43], v[236:239], v[64:67], v[40:43]
	v_mfma_f32_16x16x32_bf16 v[20:23], v[224:227], v[68:71], v[20:23]
	v_mfma_f32_16x16x32_bf16 v[28:31], v[228:231], v[68:71], v[28:31]
	v_mfma_f32_16x16x32_bf16 v[36:39], v[232:235], v[68:71], v[36:39]
	v_mfma_f32_16x16x32_bf16 v[44:47], v[236:239], v[68:71], v[44:47]
	v_mfma_f32_16x16x32_bf16 v[112:115], v[224:227], v[72:75], v[112:115]
	v_mfma_f32_16x16x32_bf16 v[120:123], v[228:231], v[72:75], v[120:123]
	v_mfma_f32_16x16x32_bf16 v[128:131], v[232:235], v[72:75], v[128:131]
	v_mfma_f32_16x16x32_bf16 v[136:139], v[236:239], v[72:75], v[136:139]
	v_mfma_f32_16x16x32_bf16 v[116:119], v[224:227], v[76:79], v[116:119]
	v_mfma_f32_16x16x32_bf16 v[124:127], v[228:231], v[76:79], v[124:127]
	v_mfma_f32_16x16x32_bf16 v[132:135], v[232:235], v[76:79], v[132:135]
	v_mfma_f32_16x16x32_bf16 v[140:143], v[236:239], v[76:79], v[140:143]
	s_waitcnt vmcnt(4)
	ds_read_b64_tr_b16 a[192:193], v4 offset:8192
	ds_read_b64_tr_b16 a[194:195], v4 offset:8704
	ds_read_b64_tr_b16 a[196:197], v5 offset:8192
	ds_read_b64_tr_b16 a[198:199], v5 offset:8704
	ds_read_b64_tr_b16 a[200:201], v6 offset:8192
	ds_read_b64_tr_b16 a[202:203], v6 offset:8704
	ds_read_b64_tr_b16 a[204:205], v7 offset:8192
	ds_read_b64_tr_b16 a[206:207], v7 offset:8704
	s_waitcnt lgkmcnt(0)
	s_add_u32 m0, s65, 16384
	s_mov_b32 s63, 3932160
	buffer_load_dwordx4 v1, s[44:47], s63 offen nt lds
	s_add_u32 m0, s65, 17408
	s_mov_b32 s63, 3932160
	buffer_load_dwordx4 v2, s[44:47], s63 offen nt lds
	s_add_u32 m0, s65, 18432
	s_mov_b32 s63, 4128768
	buffer_load_dwordx4 v1, s[44:47], s63 offen nt lds
	s_add_u32 m0, s65, 19456
	s_mov_b32 s63, 4128768
	buffer_load_dwordx4 v2, s[44:47], s63 offen nt lds
	ds_read_b128 v[64:67], v10 offset:32768
	ds_read_b128 v[68:71], v10 offset:33792
	ds_read_b128 v[72:75], v13 offset:32768
	ds_read_b128 v[76:79], v13 offset:33792
	s_waitcnt lgkmcnt(4)
	v_mfma_f32_16x16x32_bf16 v[16:19], v[208:211], v[48:51], v[16:19]
	v_mfma_f32_16x16x32_bf16 v[24:27], v[212:215], v[48:51], v[24:27]
	v_mfma_f32_16x16x32_bf16 v[32:35], v[216:219], v[48:51], v[32:35]
	v_mfma_f32_16x16x32_bf16 v[40:43], v[220:223], v[48:51], v[40:43]
	v_mfma_f32_16x16x32_bf16 v[20:23], v[208:211], v[52:55], v[20:23]
	v_mfma_f32_16x16x32_bf16 v[28:31], v[212:215], v[52:55], v[28:31]
	v_mfma_f32_16x16x32_bf16 v[36:39], v[216:219], v[52:55], v[36:39]
	v_mfma_f32_16x16x32_bf16 v[44:47], v[220:223], v[52:55], v[44:47]
	v_mfma_f32_16x16x32_bf16 v[112:115], v[208:211], v[56:59], v[112:115]
	v_mfma_f32_16x16x32_bf16 v[120:123], v[212:215], v[56:59], v[120:123]
	v_mfma_f32_16x16x32_bf16 v[128:131], v[216:219], v[56:59], v[128:131]
	v_mfma_f32_16x16x32_bf16 v[136:139], v[220:223], v[56:59], v[136:139]
	v_mfma_f32_16x16x32_bf16 v[116:119], v[208:211], v[60:63], v[116:119]
	v_mfma_f32_16x16x32_bf16 v[124:127], v[212:215], v[60:63], v[124:127]
	v_mfma_f32_16x16x32_bf16 v[132:135], v[216:219], v[60:63], v[132:135]
	v_mfma_f32_16x16x32_bf16 v[140:143], v[220:223], v[60:63], v[140:143]
	ds_read_b128 v[48:51], v10 offset:30720
	ds_read_b128 v[52:55], v10 offset:31744
	ds_read_b128 v[56:59], v13 offset:30720
	ds_read_b128 v[60:63], v13 offset:31744
	s_waitcnt lgkmcnt(4)
	v_mfma_f32_16x16x32_bf16 v[16:19], v[192:195], v[64:67], v[16:19]
	v_mfma_f32_16x16x32_bf16 v[24:27], v[196:199], v[64:67], v[24:27]
	v_mfma_f32_16x16x32_bf16 v[32:35], v[200:203], v[64:67], v[32:35]
	v_mfma_f32_16x16x32_bf16 v[40:43], v[204:207], v[64:67], v[40:43]
	v_mfma_f32_16x16x32_bf16 v[20:23], v[192:195], v[68:71], v[20:23]
	v_mfma_f32_16x16x32_bf16 v[28:31], v[196:199], v[68:71], v[28:31]
	v_mfma_f32_16x16x32_bf16 v[36:39], v[200:203], v[68:71], v[36:39]
	v_mfma_f32_16x16x32_bf16 v[44:47], v[204:207], v[68:71], v[44:47]
	v_mfma_f32_16x16x32_bf16 v[112:115], v[192:195], v[72:75], v[112:115]
	v_mfma_f32_16x16x32_bf16 v[120:123], v[196:199], v[72:75], v[120:123]
	v_mfma_f32_16x16x32_bf16 v[128:131], v[200:203], v[72:75], v[128:131]
	v_mfma_f32_16x16x32_bf16 v[136:139], v[204:207], v[72:75], v[136:139]
	v_mfma_f32_16x16x32_bf16 v[116:119], v[192:195], v[76:79], v[116:119]
	v_mfma_f32_16x16x32_bf16 v[124:127], v[196:199], v[76:79], v[124:127]
	v_mfma_f32_16x16x32_bf16 v[132:135], v[200:203], v[76:79], v[132:135]
	v_mfma_f32_16x16x32_bf16 v[140:143], v[204:207], v[76:79], v[140:143]
	s_waitcnt vmcnt(4)
	ds_read_b64_tr_b16 a[176:177], v4 offset:12288
	ds_read_b64_tr_b16 a[178:179], v4 offset:12800
	ds_read_b64_tr_b16 a[180:181], v5 offset:12288
	ds_read_b64_tr_b16 a[182:183], v5 offset:12800
	ds_read_b64_tr_b16 a[184:185], v6 offset:12288
	ds_read_b64_tr_b16 a[186:187], v6 offset:12800
	ds_read_b64_tr_b16 a[188:189], v7 offset:12288
	ds_read_b64_tr_b16 a[190:191], v7 offset:12800
	s_waitcnt lgkmcnt(0)
	s_add_u32 m0, s65, 0
	s_mov_b32 s63, 3538944
	buffer_load_dwordx4 v1, s[44:47], s63 offen nt lds
	s_add_u32 m0, s65, 1024
	s_mov_b32 s63, 3538944
	buffer_load_dwordx4 v2, s[44:47], s63 offen nt lds
	s_add_u32 m0, s65, 2048
	s_mov_b32 s63, 3735552
	buffer_load_dwordx4 v1, s[44:47], s63 offen nt lds
	s_add_u32 m0, s65, 3072
	s_mov_b32 s63, 3735552
	buffer_load_dwordx4 v2, s[44:47], s63 offen nt lds
	ds_read_b128 v[64:67], v10 offset:28672
	ds_read_b128 v[68:71], v10 offset:29696
	ds_read_b128 v[72:75], v13 offset:28672
	ds_read_b128 v[76:79], v13 offset:29696
	s_waitcnt lgkmcnt(4)
	v_mfma_f32_16x16x32_bf16 v[16:19], a[240:243], v[48:51], v[16:19]
	v_mfma_f32_16x16x32_bf16 v[24:27], a[244:247], v[48:51], v[24:27]
	v_mfma_f32_16x16x32_bf16 v[32:35], a[248:251], v[48:51], v[32:35]
	v_mfma_f32_16x16x32_bf16 v[40:43], a[252:255], v[48:51], v[40:43]
	v_mfma_f32_16x16x32_bf16 v[20:23], a[240:243], v[52:55], v[20:23]
	v_mfma_f32_16x16x32_bf16 v[28:31], a[244:247], v[52:55], v[28:31]
	v_mfma_f32_16x16x32_bf16 v[36:39], a[248:251], v[52:55], v[36:39]
	v_mfma_f32_16x16x32_bf16 v[44:47], a[252:255], v[52:55], v[44:47]
	v_mfma_f32_16x16x32_bf16 v[112:115], a[240:243], v[56:59], v[112:115]
	v_mfma_f32_16x16x32_bf16 v[120:123], a[244:247], v[56:59], v[120:123]
	v_mfma_f32_16x16x32_bf16 v[128:131], a[248:251], v[56:59], v[128:131]
	v_mfma_f32_16x16x32_bf16 v[136:139], a[252:255], v[56:59], v[136:139]
	v_mfma_f32_16x16x32_bf16 v[116:119], a[240:243], v[60:63], v[116:119]
	v_mfma_f32_16x16x32_bf16 v[124:127], a[244:247], v[60:63], v[124:127]
	v_mfma_f32_16x16x32_bf16 v[132:135], a[248:251], v[60:63], v[132:135]
	v_mfma_f32_16x16x32_bf16 v[140:143], a[252:255], v[60:63], v[140:143]
	ds_read_b128 v[48:51], v10 offset:26624
	ds_read_b128 v[52:55], v10 offset:27648
	ds_read_b128 v[56:59], v13 offset:26624
	ds_read_b128 v[60:63], v13 offset:27648
	s_waitcnt lgkmcnt(4)
	v_mfma_f32_16x16x32_bf16 v[16:19], a[224:227], v[64:67], v[16:19]
	v_mfma_f32_16x16x32_bf16 v[24:27], a[228:231], v[64:67], v[24:27]
	v_mfma_f32_16x16x32_bf16 v[32:35], a[232:235], v[64:67], v[32:35]
	v_mfma_f32_16x16x32_bf16 v[40:43], a[236:239], v[64:67], v[40:43]
	v_mfma_f32_16x16x32_bf16 v[20:23], a[224:227], v[68:71], v[20:23]
	v_mfma_f32_16x16x32_bf16 v[28:31], a[228:231], v[68:71], v[28:31]
	v_mfma_f32_16x16x32_bf16 v[36:39], a[232:235], v[68:71], v[36:39]
	v_mfma_f32_16x16x32_bf16 v[44:47], a[236:239], v[68:71], v[44:47]
	v_mfma_f32_16x16x32_bf16 v[112:115], a[224:227], v[72:75], v[112:115]
	v_mfma_f32_16x16x32_bf16 v[120:123], a[228:231], v[72:75], v[120:123]
	v_mfma_f32_16x16x32_bf16 v[128:131], a[232:235], v[72:75], v[128:131]
	v_mfma_f32_16x16x32_bf16 v[136:139], a[236:239], v[72:75], v[136:139]
	v_mfma_f32_16x16x32_bf16 v[116:119], a[224:227], v[76:79], v[116:119]
	v_mfma_f32_16x16x32_bf16 v[124:127], a[228:231], v[76:79], v[124:127]
	v_mfma_f32_16x16x32_bf16 v[132:135], a[232:235], v[76:79], v[132:135]
	v_mfma_f32_16x16x32_bf16 v[140:143], a[236:239], v[76:79], v[140:143]
	s_waitcnt vmcnt(4)
	ds_read_b64_tr_b16 a[160:161], v4 offset:16384
	ds_read_b64_tr_b16 a[162:163], v4 offset:16896
	ds_read_b64_tr_b16 a[164:165], v5 offset:16384
	ds_read_b64_tr_b16 a[166:167], v5 offset:16896
	ds_read_b64_tr_b16 a[168:169], v6 offset:16384
	ds_read_b64_tr_b16 a[170:171], v6 offset:16896
	ds_read_b64_tr_b16 a[172:173], v7 offset:16384
	ds_read_b64_tr_b16 a[174:175], v7 offset:16896
	s_waitcnt lgkmcnt(0)
	s_add_u32 m0, s65, 4096
	s_mov_b32 s63, 3145728
	buffer_load_dwordx4 v1, s[44:47], s63 offen nt lds
	s_add_u32 m0, s65, 5120
	s_mov_b32 s63, 3145728
	buffer_load_dwordx4 v2, s[44:47], s63 offen nt lds
	s_add_u32 m0, s65, 6144
	s_mov_b32 s63, 3342336
	buffer_load_dwordx4 v1, s[44:47], s63 offen nt lds
	s_add_u32 m0, s65, 7168
	s_mov_b32 s63, 3342336
	buffer_load_dwordx4 v2, s[44:47], s63 offen nt lds
	ds_read_b128 v[64:67], v10 offset:24576
	ds_read_b128 v[68:71], v10 offset:25600
	ds_read_b128 v[72:75], v13 offset:24576
	ds_read_b128 v[76:79], v13 offset:25600
	s_waitcnt lgkmcnt(4)
	v_mfma_f32_16x16x32_bf16 v[16:19], a[208:211], v[48:51], v[16:19]
	v_mfma_f32_16x16x32_bf16 v[24:27], a[212:215], v[48:51], v[24:27]
	v_mfma_f32_16x16x32_bf16 v[32:35], a[216:219], v[48:51], v[32:35]
	v_mfma_f32_16x16x32_bf16 v[40:43], a[220:223], v[48:51], v[40:43]
	v_mfma_f32_16x16x32_bf16 v[20:23], a[208:211], v[52:55], v[20:23]
	v_mfma_f32_16x16x32_bf16 v[28:31], a[212:215], v[52:55], v[28:31]
	v_mfma_f32_16x16x32_bf16 v[36:39], a[216:219], v[52:55], v[36:39]
	v_mfma_f32_16x16x32_bf16 v[44:47], a[220:223], v[52:55], v[44:47]
	v_mfma_f32_16x16x32_bf16 v[112:115], a[208:211], v[56:59], v[112:115]
	v_mfma_f32_16x16x32_bf16 v[120:123], a[212:215], v[56:59], v[120:123]
	v_mfma_f32_16x16x32_bf16 v[128:131], a[216:219], v[56:59], v[128:131]
	v_mfma_f32_16x16x32_bf16 v[136:139], a[220:223], v[56:59], v[136:139]
	v_mfma_f32_16x16x32_bf16 v[116:119], a[208:211], v[60:63], v[116:119]
	v_mfma_f32_16x16x32_bf16 v[124:127], a[212:215], v[60:63], v[124:127]
	v_mfma_f32_16x16x32_bf16 v[132:135], a[216:219], v[60:63], v[132:135]
	v_mfma_f32_16x16x32_bf16 v[140:143], a[220:223], v[60:63], v[140:143]
	ds_read_b128 v[48:51], v10 offset:22528
	ds_read_b128 v[52:55], v10 offset:23552
	ds_read_b128 v[56:59], v13 offset:22528
	ds_read_b128 v[60:63], v13 offset:23552
	s_waitcnt lgkmcnt(4)
	v_mfma_f32_16x16x32_bf16 v[16:19], a[192:195], v[64:67], v[16:19]
	v_mfma_f32_16x16x32_bf16 v[24:27], a[196:199], v[64:67], v[24:27]
	v_mfma_f32_16x16x32_bf16 v[32:35], a[200:203], v[64:67], v[32:35]
	v_mfma_f32_16x16x32_bf16 v[40:43], a[204:207], v[64:67], v[40:43]
	v_mfma_f32_16x16x32_bf16 v[20:23], a[192:195], v[68:71], v[20:23]
	v_mfma_f32_16x16x32_bf16 v[28:31], a[196:199], v[68:71], v[28:31]
	v_mfma_f32_16x16x32_bf16 v[36:39], a[200:203], v[68:71], v[36:39]
	v_mfma_f32_16x16x32_bf16 v[44:47], a[204:207], v[68:71], v[44:47]
	v_mfma_f32_16x16x32_bf16 v[112:115], a[192:195], v[72:75], v[112:115]
	v_mfma_f32_16x16x32_bf16 v[120:123], a[196:199], v[72:75], v[120:123]
	v_mfma_f32_16x16x32_bf16 v[128:131], a[200:203], v[72:75], v[128:131]
	v_mfma_f32_16x16x32_bf16 v[136:139], a[204:207], v[72:75], v[136:139]
	v_mfma_f32_16x16x32_bf16 v[116:119], a[192:195], v[76:79], v[116:119]
	v_mfma_f32_16x16x32_bf16 v[124:127], a[196:199], v[76:79], v[124:127]
	v_mfma_f32_16x16x32_bf16 v[132:135], a[200:203], v[76:79], v[132:135]
	v_mfma_f32_16x16x32_bf16 v[140:143], a[204:207], v[76:79], v[140:143]
	s_waitcnt vmcnt(4)
	ds_read_b64_tr_b16 a[144:145], v4 offset:0
	ds_read_b64_tr_b16 a[146:147], v4 offset:512
	ds_read_b64_tr_b16 a[148:149], v5 offset:0
	ds_read_b64_tr_b16 a[150:151], v5 offset:512
	ds_read_b64_tr_b16 a[152:153], v6 offset:0
	ds_read_b64_tr_b16 a[154:155], v6 offset:512
	ds_read_b64_tr_b16 a[156:157], v7 offset:0
	ds_read_b64_tr_b16 a[158:159], v7 offset:512
	s_waitcnt lgkmcnt(0)
	s_add_u32 m0, s65, 8192
	s_mov_b32 s63, 2752512
	buffer_load_dwordx4 v1, s[44:47], s63 offen nt lds
	s_add_u32 m0, s65, 9216
	s_mov_b32 s63, 2752512
	buffer_load_dwordx4 v2, s[44:47], s63 offen nt lds
	s_add_u32 m0, s65, 10240
	s_mov_b32 s63, 2949120
	buffer_load_dwordx4 v1, s[44:47], s63 offen nt lds
	s_add_u32 m0, s65, 11264
	s_mov_b32 s63, 2949120
	buffer_load_dwordx4 v2, s[44:47], s63 offen nt lds
	ds_read_b128 v[64:67], v10 offset:20480
	ds_read_b128 v[68:71], v10 offset:21504
	ds_read_b128 v[72:75], v13 offset:20480
	ds_read_b128 v[76:79], v13 offset:21504
	s_waitcnt lgkmcnt(4)
	v_mfma_f32_16x16x32_bf16 v[16:19], a[176:179], v[48:51], v[16:19]
	v_mfma_f32_16x16x32_bf16 v[24:27], a[180:183], v[48:51], v[24:27]
	v_mfma_f32_16x16x32_bf16 v[32:35], a[184:187], v[48:51], v[32:35]
	v_mfma_f32_16x16x32_bf16 v[40:43], a[188:191], v[48:51], v[40:43]
	v_mfma_f32_16x16x32_bf16 v[20:23], a[176:179], v[52:55], v[20:23]
	v_mfma_f32_16x16x32_bf16 v[28:31], a[180:183], v[52:55], v[28:31]
	v_mfma_f32_16x16x32_bf16 v[36:39], a[184:187], v[52:55], v[36:39]
	v_mfma_f32_16x16x32_bf16 v[44:47], a[188:191], v[52:55], v[44:47]
	v_mfma_f32_16x16x32_bf16 v[112:115], a[176:179], v[56:59], v[112:115]
	v_mfma_f32_16x16x32_bf16 v[120:123], a[180:183], v[56:59], v[120:123]
	v_mfma_f32_16x16x32_bf16 v[128:131], a[184:187], v[56:59], v[128:131]
	v_mfma_f32_16x16x32_bf16 v[136:139], a[188:191], v[56:59], v[136:139]
	v_mfma_f32_16x16x32_bf16 v[116:119], a[176:179], v[60:63], v[116:119]
	v_mfma_f32_16x16x32_bf16 v[124:127], a[180:183], v[60:63], v[124:127]
	v_mfma_f32_16x16x32_bf16 v[132:135], a[184:187], v[60:63], v[132:135]
	v_mfma_f32_16x16x32_bf16 v[140:143], a[188:191], v[60:63], v[140:143]
	ds_read_b128 v[48:51], v10 offset:18432
	ds_read_b128 v[52:55], v10 offset:19456
	ds_read_b128 v[56:59], v13 offset:18432
	ds_read_b128 v[60:63], v13 offset:19456
	s_waitcnt lgkmcnt(4)
	v_mfma_f32_16x16x32_bf16 v[16:19], a[160:163], v[64:67], v[16:19]
	v_mfma_f32_16x16x32_bf16 v[24:27], a[164:167], v[64:67], v[24:27]
	v_mfma_f32_16x16x32_bf16 v[32:35], a[168:171], v[64:67], v[32:35]
	v_mfma_f32_16x16x32_bf16 v[40:43], a[172:175], v[64:67], v[40:43]
	v_mfma_f32_16x16x32_bf16 v[20:23], a[160:163], v[68:71], v[20:23]
	v_mfma_f32_16x16x32_bf16 v[28:31], a[164:167], v[68:71], v[28:31]
	v_mfma_f32_16x16x32_bf16 v[36:39], a[168:171], v[68:71], v[36:39]
	v_mfma_f32_16x16x32_bf16 v[44:47], a[172:175], v[68:71], v[44:47]
	v_mfma_f32_16x16x32_bf16 v[112:115], a[160:163], v[72:75], v[112:115]
	v_mfma_f32_16x16x32_bf16 v[120:123], a[164:167], v[72:75], v[120:123]
	v_mfma_f32_16x16x32_bf16 v[128:131], a[168:171], v[72:75], v[128:131]
	v_mfma_f32_16x16x32_bf16 v[136:139], a[172:175], v[72:75], v[136:139]
	v_mfma_f32_16x16x32_bf16 v[116:119], a[160:163], v[76:79], v[116:119]
	v_mfma_f32_16x16x32_bf16 v[124:127], a[164:167], v[76:79], v[124:127]
	v_mfma_f32_16x16x32_bf16 v[132:135], a[168:171], v[76:79], v[132:135]
	v_mfma_f32_16x16x32_bf16 v[140:143], a[172:175], v[76:79], v[140:143]
	s_waitcnt vmcnt(4)
	ds_read_b64_tr_b16 a[128:129], v4 offset:4096
	ds_read_b64_tr_b16 a[130:131], v4 offset:4608
	ds_read_b64_tr_b16 a[132:133], v5 offset:4096
	ds_read_b64_tr_b16 a[134:135], v5 offset:4608
	ds_read_b64_tr_b16 a[136:137], v6 offset:4096
	ds_read_b64_tr_b16 a[138:139], v6 offset:4608
	ds_read_b64_tr_b16 a[140:141], v7 offset:4096
	ds_read_b64_tr_b16 a[142:143], v7 offset:4608
	s_waitcnt lgkmcnt(0)
	s_add_u32 m0, s65, 12288
	s_mov_b32 s63, 2359296
	buffer_load_dwordx4 v1, s[44:47], s63 offen nt lds
	s_add_u32 m0, s65, 13312
	s_mov_b32 s63, 2359296
	buffer_load_dwordx4 v2, s[44:47], s63 offen nt lds
	s_add_u32 m0, s65, 14336
	s_mov_b32 s63, 2555904
	buffer_load_dwordx4 v1, s[44:47], s63 offen nt lds
	s_add_u32 m0, s65, 15360
	s_mov_b32 s63, 2555904
	buffer_load_dwordx4 v2, s[44:47], s63 offen nt lds
	ds_read_b128 v[64:67], v10 offset:16384
	ds_read_b128 v[68:71], v10 offset:17408
	ds_read_b128 v[72:75], v13 offset:16384
	ds_read_b128 v[76:79], v13 offset:17408
	s_waitcnt lgkmcnt(4)
	v_mfma_f32_16x16x32_bf16 v[16:19], a[144:147], v[48:51], v[16:19]
	v_mfma_f32_16x16x32_bf16 v[24:27], a[148:151], v[48:51], v[24:27]
	v_mfma_f32_16x16x32_bf16 v[32:35], a[152:155], v[48:51], v[32:35]
	v_mfma_f32_16x16x32_bf16 v[40:43], a[156:159], v[48:51], v[40:43]
	v_mfma_f32_16x16x32_bf16 v[20:23], a[144:147], v[52:55], v[20:23]
	v_mfma_f32_16x16x32_bf16 v[28:31], a[148:151], v[52:55], v[28:31]
	v_mfma_f32_16x16x32_bf16 v[36:39], a[152:155], v[52:55], v[36:39]
	v_mfma_f32_16x16x32_bf16 v[44:47], a[156:159], v[52:55], v[44:47]
	v_mfma_f32_16x16x32_bf16 v[112:115], a[144:147], v[56:59], v[112:115]
	v_mfma_f32_16x16x32_bf16 v[120:123], a[148:151], v[56:59], v[120:123]
	v_mfma_f32_16x16x32_bf16 v[128:131], a[152:155], v[56:59], v[128:131]
	v_mfma_f32_16x16x32_bf16 v[136:139], a[156:159], v[56:59], v[136:139]
	v_mfma_f32_16x16x32_bf16 v[116:119], a[144:147], v[60:63], v[116:119]
	v_mfma_f32_16x16x32_bf16 v[124:127], a[148:151], v[60:63], v[124:127]
	v_mfma_f32_16x16x32_bf16 v[132:135], a[152:155], v[60:63], v[132:135]
	v_mfma_f32_16x16x32_bf16 v[140:143], a[156:159], v[60:63], v[140:143]
	ds_read_b128 v[48:51], v10 offset:14336
	ds_read_b128 v[52:55], v10 offset:15360
	ds_read_b128 v[56:59], v13 offset:14336
	ds_read_b128 v[60:63], v13 offset:15360
	s_waitcnt lgkmcnt(4)
	v_mfma_f32_16x16x32_bf16 v[16:19], a[128:131], v[64:67], v[16:19]
	v_mfma_f32_16x16x32_bf16 v[24:27], a[132:135], v[64:67], v[24:27]
	v_mfma_f32_16x16x32_bf16 v[32:35], a[136:139], v[64:67], v[32:35]
	v_mfma_f32_16x16x32_bf16 v[40:43], a[140:143], v[64:67], v[40:43]
	v_mfma_f32_16x16x32_bf16 v[20:23], a[128:131], v[68:71], v[20:23]
	v_mfma_f32_16x16x32_bf16 v[28:31], a[132:135], v[68:71], v[28:31]
	v_mfma_f32_16x16x32_bf16 v[36:39], a[136:139], v[68:71], v[36:39]
	v_mfma_f32_16x16x32_bf16 v[44:47], a[140:143], v[68:71], v[44:47]
	v_mfma_f32_16x16x32_bf16 v[112:115], a[128:131], v[72:75], v[112:115]
	v_mfma_f32_16x16x32_bf16 v[120:123], a[132:135], v[72:75], v[120:123]
	v_mfma_f32_16x16x32_bf16 v[128:131], a[136:139], v[72:75], v[128:131]
	v_mfma_f32_16x16x32_bf16 v[136:139], a[140:143], v[72:75], v[136:139]
	v_mfma_f32_16x16x32_bf16 v[116:119], a[128:131], v[76:79], v[116:119]
	v_mfma_f32_16x16x32_bf16 v[124:127], a[132:135], v[76:79], v[124:127]
	v_mfma_f32_16x16x32_bf16 v[132:135], a[136:139], v[76:79], v[132:135]
	v_mfma_f32_16x16x32_bf16 v[140:143], a[140:143], v[76:79], v[140:143]
	s_waitcnt vmcnt(4)
	ds_read_b64_tr_b16 a[112:113], v4 offset:8192
	ds_read_b64_tr_b16 a[114:115], v4 offset:8704
	ds_read_b64_tr_b16 a[116:117], v5 offset:8192
	ds_read_b64_tr_b16 a[118:119], v5 offset:8704
	ds_read_b64_tr_b16 a[120:121], v6 offset:8192
	ds_read_b64_tr_b16 a[122:123], v6 offset:8704
	ds_read_b64_tr_b16 a[124:125], v7 offset:8192
	ds_read_b64_tr_b16 a[126:127], v7 offset:8704
	s_waitcnt lgkmcnt(0)
	s_add_u32 m0, s65, 16384
	s_mov_b32 s63, 1966080
	buffer_load_dwordx4 v1, s[44:47], s63 offen nt lds
	s_add_u32 m0, s65, 17408
	s_mov_b32 s63, 1966080
	buffer_load_dwordx4 v2, s[44:47], s63 offen nt lds
	s_add_u32 m0, s65, 18432
	s_mov_b32 s63, 2162688
	buffer_load_dwordx4 v1, s[44:47], s63 offen nt lds
	s_add_u32 m0, s65, 19456
	s_mov_b32 s63, 2162688
	buffer_load_dwordx4 v2, s[44:47], s63 offen nt lds
	ds_read_b128 v[64:67], v10 offset:12288
	ds_read_b128 v[68:71], v10 offset:13312
	ds_read_b128 v[72:75], v13 offset:12288
	ds_read_b128 v[76:79], v13 offset:13312
	s_waitcnt lgkmcnt(4)
	v_mfma_f32_16x16x32_bf16 v[16:19], a[112:115], v[48:51], v[16:19]
	v_mfma_f32_16x16x32_bf16 v[24:27], a[116:119], v[48:51], v[24:27]
	v_mfma_f32_16x16x32_bf16 v[32:35], a[120:123], v[48:51], v[32:35]
	v_mfma_f32_16x16x32_bf16 v[40:43], a[124:127], v[48:51], v[40:43]
	v_mfma_f32_16x16x32_bf16 v[20:23], a[112:115], v[52:55], v[20:23]
	v_mfma_f32_16x16x32_bf16 v[28:31], a[116:119], v[52:55], v[28:31]
	v_mfma_f32_16x16x32_bf16 v[36:39], a[120:123], v[52:55], v[36:39]
	v_mfma_f32_16x16x32_bf16 v[44:47], a[124:127], v[52:55], v[44:47]
	v_mfma_f32_16x16x32_bf16 v[112:115], a[112:115], v[56:59], v[112:115]
	v_mfma_f32_16x16x32_bf16 v[120:123], a[116:119], v[56:59], v[120:123]
	v_mfma_f32_16x16x32_bf16 v[128:131], a[120:123], v[56:59], v[128:131]
	v_mfma_f32_16x16x32_bf16 v[136:139], a[124:127], v[56:59], v[136:139]
	v_mfma_f32_16x16x32_bf16 v[116:119], a[112:115], v[60:63], v[116:119]
	v_mfma_f32_16x16x32_bf16 v[124:127], a[116:119], v[60:63], v[124:127]
	v_mfma_f32_16x16x32_bf16 v[132:135], a[120:123], v[60:63], v[132:135]
	v_mfma_f32_16x16x32_bf16 v[140:143], a[124:127], v[60:63], v[140:143]
	s_waitcnt vmcnt(4)
	ds_read_b64_tr_b16 a[96:97], v4 offset:12288
	ds_read_b64_tr_b16 a[98:99], v4 offset:12800
	ds_read_b64_tr_b16 a[100:101], v5 offset:12288
	ds_read_b64_tr_b16 a[102:103], v5 offset:12800
	ds_read_b64_tr_b16 a[104:105], v6 offset:12288
	ds_read_b64_tr_b16 a[106:107], v6 offset:12800
	ds_read_b64_tr_b16 a[108:109], v7 offset:12288
	ds_read_b64_tr_b16 a[110:111], v7 offset:12800
	s_waitcnt lgkmcnt(0)
	s_add_u32 m0, s65, 0
	s_mov_b32 s63, 1572864
	buffer_load_dwordx4 v1, s[44:47], s63 offen nt lds
	s_add_u32 m0, s65, 1024
	s_mov_b32 s63, 1572864
	buffer_load_dwordx4 v2, s[44:47], s63 offen nt lds
	s_add_u32 m0, s65, 2048
	s_mov_b32 s63, 1769472
	buffer_load_dwordx4 v1, s[44:47], s63 offen nt lds
	s_add_u32 m0, s65, 3072
	s_mov_b32 s63, 1769472
	buffer_load_dwordx4 v2, s[44:47], s63 offen nt lds
	ds_read_b128 v[48:51], v10 offset:10240
	ds_read_b128 v[52:55], v10 offset:11264
	ds_read_b128 v[56:59], v13 offset:10240
	ds_read_b128 v[60:63], v13 offset:11264
	s_waitcnt lgkmcnt(4)
	v_mfma_f32_16x16x32_bf16 v[16:19], a[96:99], v[64:67], v[16:19]
	v_mfma_f32_16x16x32_bf16 v[24:27], a[100:103], v[64:67], v[24:27]
	v_mfma_f32_16x16x32_bf16 v[32:35], a[104:107], v[64:67], v[32:35]
	v_mfma_f32_16x16x32_bf16 v[40:43], a[108:111], v[64:67], v[40:43]
	v_mfma_f32_16x16x32_bf16 v[20:23], a[96:99], v[68:71], v[20:23]
	v_mfma_f32_16x16x32_bf16 v[28:31], a[100:103], v[68:71], v[28:31]
	v_mfma_f32_16x16x32_bf16 v[36:39], a[104:107], v[68:71], v[36:39]
	v_mfma_f32_16x16x32_bf16 v[44:47], a[108:111], v[68:71], v[44:47]
	v_mfma_f32_16x16x32_bf16 v[112:115], a[96:99], v[72:75], v[112:115]
	v_mfma_f32_16x16x32_bf16 v[120:123], a[100:103], v[72:75], v[120:123]
	v_mfma_f32_16x16x32_bf16 v[128:131], a[104:107], v[72:75], v[128:131]
	v_mfma_f32_16x16x32_bf16 v[136:139], a[108:111], v[72:75], v[136:139]
	v_mfma_f32_16x16x32_bf16 v[116:119], a[96:99], v[76:79], v[116:119]
	v_mfma_f32_16x16x32_bf16 v[124:127], a[100:103], v[76:79], v[124:127]
	v_mfma_f32_16x16x32_bf16 v[132:135], a[104:107], v[76:79], v[132:135]
	v_mfma_f32_16x16x32_bf16 v[140:143], a[108:111], v[76:79], v[140:143]
	s_waitcnt vmcnt(4)
	ds_read_b64_tr_b16 a[80:81], v4 offset:16384
	ds_read_b64_tr_b16 a[82:83], v4 offset:16896
	ds_read_b64_tr_b16 a[84:85], v5 offset:16384
	ds_read_b64_tr_b16 a[86:87], v5 offset:16896
	ds_read_b64_tr_b16 a[88:89], v6 offset:16384
	ds_read_b64_tr_b16 a[90:91], v6 offset:16896
	ds_read_b64_tr_b16 a[92:93], v7 offset:16384
	ds_read_b64_tr_b16 a[94:95], v7 offset:16896
	s_waitcnt lgkmcnt(0)
	s_add_u32 m0, s65, 4096
	s_mov_b32 s63, 1179648
	buffer_load_dwordx4 v1, s[44:47], s63 offen nt lds
	s_add_u32 m0, s65, 5120
	s_mov_b32 s63, 1179648
	buffer_load_dwordx4 v2, s[44:47], s63 offen nt lds
	s_add_u32 m0, s65, 6144
	s_mov_b32 s63, 1376256
	buffer_load_dwordx4 v1, s[44:47], s63 offen nt lds
	s_add_u32 m0, s65, 7168
	s_mov_b32 s63, 1376256
	buffer_load_dwordx4 v2, s[44:47], s63 offen nt lds
	ds_read_b128 v[64:67], v10 offset:8192
	ds_read_b128 v[68:71], v10 offset:9216
	ds_read_b128 v[72:75], v13 offset:8192
	ds_read_b128 v[76:79], v13 offset:9216
	s_waitcnt lgkmcnt(4)
	v_mfma_f32_16x16x32_bf16 v[16:19], a[80:83], v[48:51], v[16:19]
	v_mfma_f32_16x16x32_bf16 v[24:27], a[84:87], v[48:51], v[24:27]
	v_mfma_f32_16x16x32_bf16 v[32:35], a[88:91], v[48:51], v[32:35]
	v_mfma_f32_16x16x32_bf16 v[40:43], a[92:95], v[48:51], v[40:43]
	v_mfma_f32_16x16x32_bf16 v[20:23], a[80:83], v[52:55], v[20:23]
	v_mfma_f32_16x16x32_bf16 v[28:31], a[84:87], v[52:55], v[28:31]
	v_mfma_f32_16x16x32_bf16 v[36:39], a[88:91], v[52:55], v[36:39]
	v_mfma_f32_16x16x32_bf16 v[44:47], a[92:95], v[52:55], v[44:47]
	v_mfma_f32_16x16x32_bf16 v[112:115], a[80:83], v[56:59], v[112:115]
	v_mfma_f32_16x16x32_bf16 v[120:123], a[84:87], v[56:59], v[120:123]
	v_mfma_f32_16x16x32_bf16 v[128:131], a[88:91], v[56:59], v[128:131]
	v_mfma_f32_16x16x32_bf16 v[136:139], a[92:95], v[56:59], v[136:139]
	v_mfma_f32_16x16x32_bf16 v[116:119], a[80:83], v[60:63], v[116:119]
	v_mfma_f32_16x16x32_bf16 v[124:127], a[84:87], v[60:63], v[124:127]
	v_mfma_f32_16x16x32_bf16 v[132:135], a[88:91], v[60:63], v[132:135]
	v_mfma_f32_16x16x32_bf16 v[140:143], a[92:95], v[60:63], v[140:143]
	s_waitcnt vmcnt(4)
	ds_read_b64_tr_b16 a[64:65], v4 offset:0
	ds_read_b64_tr_b16 a[66:67], v4 offset:512
	ds_read_b64_tr_b16 a[68:69], v5 offset:0
	ds_read_b64_tr_b16 a[70:71], v5 offset:512
	ds_read_b64_tr_b16 a[72:73], v6 offset:0
	ds_read_b64_tr_b16 a[74:75], v6 offset:512
	ds_read_b64_tr_b16 a[76:77], v7 offset:0
	ds_read_b64_tr_b16 a[78:79], v7 offset:512
	s_waitcnt lgkmcnt(0)
	s_add_u32 m0, s65, 8192
	s_mov_b32 s63, 786432
	buffer_load_dwordx4 v1, s[44:47], s63 offen nt lds
	s_add_u32 m0, s65, 9216
	s_mov_b32 s63, 786432
	buffer_load_dwordx4 v2, s[44:47], s63 offen nt lds
	s_add_u32 m0, s65, 10240
	s_mov_b32 s63, 983040
	buffer_load_dwordx4 v1, s[44:47], s63 offen nt lds
	s_add_u32 m0, s65, 11264
	s_mov_b32 s63, 983040
	buffer_load_dwordx4 v2, s[44:47], s63 offen nt lds
	ds_read_b128 v[48:51], v10 offset:6144
	ds_read_b128 v[52:55], v10 offset:7168
	ds_read_b128 v[56:59], v13 offset:6144
	ds_read_b128 v[60:63], v13 offset:7168
	s_waitcnt lgkmcnt(4)
	v_mfma_f32_16x16x32_bf16 v[16:19], a[64:67], v[64:67], v[16:19]
	v_mfma_f32_16x16x32_bf16 v[24:27], a[68:71], v[64:67], v[24:27]
	v_mfma_f32_16x16x32_bf16 v[32:35], a[72:75], v[64:67], v[32:35]
	v_mfma_f32_16x16x32_bf16 v[40:43], a[76:79], v[64:67], v[40:43]
	v_mfma_f32_16x16x32_bf16 v[20:23], a[64:67], v[68:71], v[20:23]
	v_mfma_f32_16x16x32_bf16 v[28:31], a[68:71], v[68:71], v[28:31]
	v_mfma_f32_16x16x32_bf16 v[36:39], a[72:75], v[68:71], v[36:39]
	v_mfma_f32_16x16x32_bf16 v[44:47], a[76:79], v[68:71], v[44:47]
	v_mfma_f32_16x16x32_bf16 v[112:115], a[64:67], v[72:75], v[112:115]
	v_mfma_f32_16x16x32_bf16 v[120:123], a[68:71], v[72:75], v[120:123]
	v_mfma_f32_16x16x32_bf16 v[128:131], a[72:75], v[72:75], v[128:131]
	v_mfma_f32_16x16x32_bf16 v[136:139], a[76:79], v[72:75], v[136:139]
	v_mfma_f32_16x16x32_bf16 v[116:119], a[64:67], v[76:79], v[116:119]
	v_mfma_f32_16x16x32_bf16 v[124:127], a[68:71], v[76:79], v[124:127]
	v_mfma_f32_16x16x32_bf16 v[132:135], a[72:75], v[76:79], v[132:135]
	v_mfma_f32_16x16x32_bf16 v[140:143], a[76:79], v[76:79], v[140:143]
	s_waitcnt vmcnt(4)
	ds_read_b64_tr_b16 a[48:49], v4 offset:4096
	ds_read_b64_tr_b16 a[50:51], v4 offset:4608
	ds_read_b64_tr_b16 a[52:53], v5 offset:4096
	ds_read_b64_tr_b16 a[54:55], v5 offset:4608
	ds_read_b64_tr_b16 a[56:57], v6 offset:4096
	ds_read_b64_tr_b16 a[58:59], v6 offset:4608
	ds_read_b64_tr_b16 a[60:61], v7 offset:4096
	ds_read_b64_tr_b16 a[62:63], v7 offset:4608
	s_waitcnt lgkmcnt(0)
	s_add_u32 m0, s65, 12288
	s_mov_b32 s63, 393216
	buffer_load_dwordx4 v1, s[44:47], s63 offen nt lds
	s_add_u32 m0, s65, 13312
	s_mov_b32 s63, 393216
	buffer_load_dwordx4 v2, s[44:47], s63 offen nt lds
	s_add_u32 m0, s65, 14336
	s_mov_b32 s63, 589824
	buffer_load_dwordx4 v1, s[44:47], s63 offen nt lds
	s_add_u32 m0, s65, 15360
	s_mov_b32 s63, 589824
	buffer_load_dwordx4 v2, s[44:47], s63 offen nt lds
	ds_read_b128 v[64:67], v10 offset:4096
	ds_read_b128 v[68:71], v10 offset:5120
	ds_read_b128 v[72:75], v13 offset:4096
	ds_read_b128 v[76:79], v13 offset:5120
	s_waitcnt lgkmcnt(4)
	v_mfma_f32_16x16x32_bf16 v[16:19], a[48:51], v[48:51], v[16:19]
	v_mfma_f32_16x16x32_bf16 v[24:27], a[52:55], v[48:51], v[24:27]
	v_mfma_f32_16x16x32_bf16 v[32:35], a[56:59], v[48:51], v[32:35]
	v_mfma_f32_16x16x32_bf16 v[40:43], a[60:63], v[48:51], v[40:43]
	v_mfma_f32_16x16x32_bf16 v[20:23], a[48:51], v[52:55], v[20:23]
	v_mfma_f32_16x16x32_bf16 v[28:31], a[52:55], v[52:55], v[28:31]
	v_mfma_f32_16x16x32_bf16 v[36:39], a[56:59], v[52:55], v[36:39]
	v_mfma_f32_16x16x32_bf16 v[44:47], a[60:63], v[52:55], v[44:47]
	v_mfma_f32_16x16x32_bf16 v[112:115], a[48:51], v[56:59], v[112:115]
	v_mfma_f32_16x16x32_bf16 v[120:123], a[52:55], v[56:59], v[120:123]
	v_mfma_f32_16x16x32_bf16 v[128:131], a[56:59], v[56:59], v[128:131]
	v_mfma_f32_16x16x32_bf16 v[136:139], a[60:63], v[56:59], v[136:139]
	v_mfma_f32_16x16x32_bf16 v[116:119], a[48:51], v[60:63], v[116:119]
	v_mfma_f32_16x16x32_bf16 v[124:127], a[52:55], v[60:63], v[124:127]
	v_mfma_f32_16x16x32_bf16 v[132:135], a[56:59], v[60:63], v[132:135]
	v_mfma_f32_16x16x32_bf16 v[140:143], a[60:63], v[60:63], v[140:143]
	s_waitcnt vmcnt(4)
	ds_read_b64_tr_b16 a[32:33], v4 offset:8192
	ds_read_b64_tr_b16 a[34:35], v4 offset:8704
	ds_read_b64_tr_b16 a[36:37], v5 offset:8192
	ds_read_b64_tr_b16 a[38:39], v5 offset:8704
	ds_read_b64_tr_b16 a[40:41], v6 offset:8192
	ds_read_b64_tr_b16 a[42:43], v6 offset:8704
	ds_read_b64_tr_b16 a[44:45], v7 offset:8192
	ds_read_b64_tr_b16 a[46:47], v7 offset:8704
	s_waitcnt lgkmcnt(0)
	s_add_u32 m0, s65, 16384
	s_mov_b32 s63, 0
	buffer_load_dwordx4 v1, s[44:47], s63 offen nt lds
	s_add_u32 m0, s65, 17408
	s_mov_b32 s63, 0
	buffer_load_dwordx4 v2, s[44:47], s63 offen nt lds
	s_add_u32 m0, s65, 18432
	s_mov_b32 s63, 196608
	buffer_load_dwordx4 v1, s[44:47], s63 offen nt lds
	s_add_u32 m0, s65, 19456
	s_mov_b32 s63, 196608
	buffer_load_dwordx4 v2, s[44:47], s63 offen nt lds
	ds_read_b128 v[48:51], v10 offset:2048
	ds_read_b128 v[52:55], v10 offset:3072
	ds_read_b128 v[56:59], v13 offset:2048
	ds_read_b128 v[60:63], v13 offset:3072
	s_waitcnt lgkmcnt(4)
	v_mfma_f32_16x16x32_bf16 v[16:19], a[32:35], v[64:67], v[16:19]
	v_mfma_f32_16x16x32_bf16 v[24:27], a[36:39], v[64:67], v[24:27]
	v_mfma_f32_16x16x32_bf16 v[32:35], a[40:43], v[64:67], v[32:35]
	v_mfma_f32_16x16x32_bf16 v[40:43], a[44:47], v[64:67], v[40:43]
	v_mfma_f32_16x16x32_bf16 v[20:23], a[32:35], v[68:71], v[20:23]
	v_mfma_f32_16x16x32_bf16 v[28:31], a[36:39], v[68:71], v[28:31]
	v_mfma_f32_16x16x32_bf16 v[36:39], a[40:43], v[68:71], v[36:39]
	v_mfma_f32_16x16x32_bf16 v[44:47], a[44:47], v[68:71], v[44:47]
	v_mfma_f32_16x16x32_bf16 v[112:115], a[32:35], v[72:75], v[112:115]
	v_mfma_f32_16x16x32_bf16 v[120:123], a[36:39], v[72:75], v[120:123]
	v_mfma_f32_16x16x32_bf16 v[128:131], a[40:43], v[72:75], v[128:131]
	v_mfma_f32_16x16x32_bf16 v[136:139], a[44:47], v[72:75], v[136:139]
	v_mfma_f32_16x16x32_bf16 v[116:119], a[32:35], v[76:79], v[116:119]
	v_mfma_f32_16x16x32_bf16 v[124:127], a[36:39], v[76:79], v[124:127]
	v_mfma_f32_16x16x32_bf16 v[132:135], a[40:43], v[76:79], v[132:135]
	v_mfma_f32_16x16x32_bf16 v[140:143], a[44:47], v[76:79], v[140:143]
	s_waitcnt vmcnt(4)
	ds_read_b64_tr_b16 a[16:17], v4 offset:12288
	ds_read_b64_tr_b16 a[18:19], v4 offset:12800
	ds_read_b64_tr_b16 a[20:21], v5 offset:12288
	ds_read_b64_tr_b16 a[22:23], v5 offset:12800
	ds_read_b64_tr_b16 a[24:25], v6 offset:12288
	ds_read_b64_tr_b16 a[26:27], v6 offset:12800
	ds_read_b64_tr_b16 a[28:29], v7 offset:12288
	ds_read_b64_tr_b16 a[30:31], v7 offset:12800
	s_waitcnt lgkmcnt(0)
	ds_read_b128 v[64:67], v10 offset:0
	ds_read_b128 v[68:71], v10 offset:1024
	ds_read_b128 v[72:75], v13 offset:0
	ds_read_b128 v[76:79], v13 offset:1024
	s_waitcnt lgkmcnt(4)
	v_mfma_f32_16x16x32_bf16 v[16:19], a[16:19], v[48:51], v[16:19]
	v_mfma_f32_16x16x32_bf16 v[24:27], a[20:23], v[48:51], v[24:27]
	v_mfma_f32_16x16x32_bf16 v[32:35], a[24:27], v[48:51], v[32:35]
	v_mfma_f32_16x16x32_bf16 v[40:43], a[28:31], v[48:51], v[40:43]
	v_mfma_f32_16x16x32_bf16 v[20:23], a[16:19], v[52:55], v[20:23]
	v_mfma_f32_16x16x32_bf16 v[28:31], a[20:23], v[52:55], v[28:31]
	v_mfma_f32_16x16x32_bf16 v[36:39], a[24:27], v[52:55], v[36:39]
	v_mfma_f32_16x16x32_bf16 v[44:47], a[28:31], v[52:55], v[44:47]
	v_mfma_f32_16x16x32_bf16 v[112:115], a[16:19], v[56:59], v[112:115]
	v_mfma_f32_16x16x32_bf16 v[120:123], a[20:23], v[56:59], v[120:123]
	v_mfma_f32_16x16x32_bf16 v[128:131], a[24:27], v[56:59], v[128:131]
	v_mfma_f32_16x16x32_bf16 v[136:139], a[28:31], v[56:59], v[136:139]
	v_mfma_f32_16x16x32_bf16 v[116:119], a[16:19], v[60:63], v[116:119]
	v_mfma_f32_16x16x32_bf16 v[124:127], a[20:23], v[60:63], v[124:127]
	v_mfma_f32_16x16x32_bf16 v[132:135], a[24:27], v[60:63], v[132:135]
	v_mfma_f32_16x16x32_bf16 v[140:143], a[28:31], v[60:63], v[140:143]
	v_readfirstlane_b32 s6, v150
	s_nop 0
	s_cmp_ge_u32 s6, 256
	s_cbranch_scc1 L_swok_110
	v_mov_b32 v153, 128
L_sw_109:
	buffer_load_dwordx3 v[150:152], v153, s[40:43], 0 offen sc1
	s_waitcnt vmcnt(0)
	v_readfirstlane_b32 s6, v150
	s_nop 0
	s_cmp_ge_u32 s6, 256
	s_cbranch_scc1 L_swok_110
	s_sleep 4
	s_add_u32 s34, s34, 1
	s_cmp_lt_u32 s34, 0x40000
	s_cbranch_scc1 L_sw_109
	s_endpgm
L_swok_110:
	v_readfirstlane_b32 s74, v151
	v_readfirstlane_b32 s75, v152
	s_add_u32 s80, s61, 1
	s_cmp_eq_u32 s61, 2
	s_cselect_b32 s80, s72, s80
	s_cselect_b32 s81, 1, 0
	s_cselect_b32 s83, 3, s72
	s_lshl_b32 s73, s71, 2
	s_add_u32 s73, s73, s80
	s_lshl_b32 s73, s73, 19
	s_lshr_b32 s78, s74, s71
	s_xor_b32 s78, s78, s81
	s_and_b32 s78, s78, 1
	s_lshl_b32 s78, s78, 13
	s_add_u32 s73, s73, s78
	s_add_u32 s78, s71, s83
	s_bfe_u32 s79, s78, 0x10001
	s_lshl_b32 s79, s79, 14
	s_and_b32 s78, s78, 1
	s_lshl_b32 s78, s78, 12
	s_add_u32 s78, s78, s79
	s_add_u32 s73, s73, s78
	v_lshl_add_u32 v11, v0, 4, s73
	s_lshl_b32 s73, s71, 2
	s_add_u32 s73, s73, 0
	s_lshl_b32 s73, s73, 19
	s_lshr_b32 s78, s74, s71
	s_xor_b32 s78, s78, 0
	s_and_b32 s78, s78, 1
	s_lshl_b32 s78, s78, 13
	s_add_u32 s73, s73, s78
	v_add_u32 v12, s78, v12
	s_cmp_eq_u32 s61, 2
	s_cselect_b32 s73, 0xfe00000, s73
	s_add_u32 s78, s71, s72
	s_bfe_u32 s79, s78, 0x10001
	s_lshl_b32 s79, s79, 14
	s_and_b32 s78, s78, 1
	s_lshl_b32 s78, s78, 12
	s_add_u32 s78, s78, s79
	s_add_u32 s77, s73, s78
	s_add_u32 s78, s71, 3
	s_bfe_u32 s79, s78, 0x10001
	s_lshl_b32 s79, s79, 14
	s_and_b32 s78, s78, 1
	s_lshl_b32 s78, s78, 12
	s_add_u32 s78, s78, s79
	s_add_u32 s73, s73, s78
	s_lshl_b32 s78, s61, 11
	s_add_u32 s77, s77, s78
	v_lshl_add_u32 v96, v0, 4, s77
	s_lshl_b32 s78, s72, 10
	s_add_u32 s73, s73, s78
	v_lshl_add_u32 v97, v0, 4, s73
	v_cmp_le_u32 vcc, 32, v0
	s_and_b32 s78, s74, 1
	s_lshl_b32 s78, s78, 13
	s_add_u32 s78, s78, 0x180000
	s_and_b32 s79, s74, 16
	s_lshl_b32 s79, s79, 9
	s_add_u32 s79, s79, 0x980000
	v_mov_b32 v150, s78
	v_mov_b32 v151, s79
	v_cndmask_b32 v150, v150, v151, vcc
	s_mul_i32 s73, s72, 3
	s_add_u32 s73, s73, 1
	s_cmp_eq_u32 s72, 0
	s_cselect_b32 s73, 0, s73
	s_lshr_b32 s78, s71, 3
	s_add_u32 s73, s73, s78
	s_cmp_ge_u32 s71, 24
	s_cselect_b32 s78, s72, 0
	s_add_u32 s79, s78, 9
	s_cmp_lg_u32 s78, 0
	s_cselect_b32 s73, s79, s73
	s_lshr_b32 s78, s73, 3
	s_lshl_b32 s78, s78, 14
	s_and_b32 s73, s73, 7
	s_lshl_b32 s73, s73, 10
	s_add_u32 s73, s73, s78
	s_and_b32 s78, s71, 7
	s_lshl_b32 s78, s78, 7
	s_add_u32 s73, s73, s78
	v_and_b32 v151, 31, v0
	v_lshl_add_u32 v150, v151, 2, v150
	v_add_u32 v99, s73, v150
	s_mov_b32 s69, 0xfe00000
	s_mov_b32 s76, 0
	v_mov_b32 v150, s69
	v_cmp_gt_u32 vcc, 16, v0
	s_nop 1
	v_cndmask_b32 v12, v150, v12, vcc
	v_mov_b32 v100, -1
	v_mov_b32 v101, -1
	v_mov_b32 v102, -1
	v_mov_b32 v103, -1
	buffer_store_dwordx4 v[100:103], v96, s[36:39], s76 offen offset:0 sc1
	buffer_store_dwordx4 v[100:103], v96, s[36:39], s76 offen offset:1024 sc1
	buffer_store_dwordx4 v[100:103], v97, s[36:39], s76 offen sc1
	s_add_u32 s76, s76, 32768
	buffer_store_dwordx4 v[100:103], v96, s[36:39], s76 offen offset:0 sc1
	buffer_store_dwordx4 v[100:103], v96, s[36:39], s76 offen offset:1024 sc1
	buffer_store_dwordx4 v[100:103], v97, s[36:39], s76 offen sc1
	s_add_u32 s76, s76, 32768
	s_waitcnt vmcnt(6)
	ds_read_b64_tr_b16 a[0:1], v4 offset:16384
	ds_read_b64_tr_b16 a[2:3], v4 offset:16896
	ds_read_b64_tr_b16 a[4:5], v5 offset:16384
	ds_read_b64_tr_b16 a[6:7], v5 offset:16896
	ds_read_b64_tr_b16 a[8:9], v6 offset:16384
	ds_read_b64_tr_b16 a[10:11], v6 offset:16896
	ds_read_b64_tr_b16 a[12:13], v7 offset:16384
	ds_read_b64_tr_b16 a[14:15], v7 offset:16896
	s_waitcnt lgkmcnt(0)
	s_waitcnt lgkmcnt(0)
	v_mfma_f32_16x16x32_bf16 v[16:19], a[0:3], v[64:67], v[16:19]
	v_mfma_f32_16x16x32_bf16 v[24:27], a[4:7], v[64:67], v[24:27]
	v_mfma_f32_16x16x32_bf16 v[32:35], a[8:11], v[64:67], v[32:35]
	v_mfma_f32_16x16x32_bf16 v[40:43], a[12:15], v[64:67], v[40:43]
	v_mfma_f32_16x16x32_bf16 v[20:23], a[0:3], v[68:71], v[20:23]
	v_mfma_f32_16x16x32_bf16 v[28:31], a[4:7], v[68:71], v[28:31]
	v_mfma_f32_16x16x32_bf16 v[36:39], a[8:11], v[68:71], v[36:39]
	v_mfma_f32_16x16x32_bf16 v[44:47], a[12:15], v[68:71], v[44:47]
	v_mfma_f32_16x16x32_bf16 v[112:115], a[0:3], v[72:75], v[112:115]
	v_mfma_f32_16x16x32_bf16 v[120:123], a[4:7], v[72:75], v[120:123]
	v_mfma_f32_16x16x32_bf16 v[128:131], a[8:11], v[72:75], v[128:131]
	v_mfma_f32_16x16x32_bf16 v[136:139], a[12:15], v[72:75], v[136:139]
	v_mfma_f32_16x16x32_bf16 v[116:119], a[0:3], v[76:79], v[116:119]
	v_mfma_f32_16x16x32_bf16 v[124:127], a[4:7], v[76:79], v[124:127]
	v_mfma_f32_16x16x32_bf16 v[132:135], a[8:11], v[76:79], v[132:135]
	v_mfma_f32_16x16x32_bf16 v[140:143], a[12:15], v[76:79], v[140:143]
	s_mov_b32 s69, 0
	v_cvt_pk_bf16_f32 v80, v16, v17
	v_cvt_pk_bf16_f32 v81, v18, v19
	v_cvt_pk_bf16_f32 v82, v24, v25
	v_cvt_pk_bf16_f32 v83, v26, v27
	buffer_store_dwordx4 v[80:83], v11, s[36:39], s69 offen offset:0 sc1
	v_cvt_pk_bf16_f32 v84, v20, v21
	v_cvt_pk_bf16_f32 v85, v22, v23
	v_cvt_pk_bf16_f32 v86, v28, v29
	v_cvt_pk_bf16_f32 v87, v30, v31
	buffer_store_dwordx4 v[84:87], v11, s[36:39], s69 offen offset:1024 sc1
	v_cvt_pk_bf16_f32 v88, v32, v33
	v_cvt_pk_bf16_f32 v89, v34, v35
	v_cvt_pk_bf16_f32 v90, v40, v41
	v_cvt_pk_bf16_f32 v91, v42, v43
	buffer_store_dwordx4 v[88:91], v11, s[36:39], s69 offen offset:2048 sc1
	v_cvt_pk_bf16_f32 v92, v36, v37
	v_cvt_pk_bf16_f32 v93, v38, v39
	v_cvt_pk_bf16_f32 v94, v44, v45
	v_cvt_pk_bf16_f32 v95, v46, v47
	buffer_store_dwordx4 v[92:95], v11, s[36:39], s69 offen offset:3072 sc1
	s_mov_b32 s69, 32768
	v_cvt_pk_bf16_f32 v80, v112, v113
	v_cvt_pk_bf16_f32 v81, v114, v115
	v_cvt_pk_bf16_f32 v82, v120, v121
	v_cvt_pk_bf16_f32 v83, v122, v123
	buffer_store_dwordx4 v[80:83], v11, s[36:39], s69 offen offset:0 sc1
	v_cvt_pk_bf16_f32 v84, v116, v117
	v_cvt_pk_bf16_f32 v85, v118, v119
	v_cvt_pk_bf16_f32 v86, v124, v125
	v_cvt_pk_bf16_f32 v87, v126, v127
	buffer_store_dwordx4 v[84:87], v11, s[36:39], s69 offen offset:1024 sc1
	v_cvt_pk_bf16_f32 v88, v128, v129
	v_cvt_pk_bf16_f32 v89, v130, v131
	v_cvt_pk_bf16_f32 v90, v136, v137
	v_cvt_pk_bf16_f32 v91, v138, v139
	buffer_store_dwordx4 v[88:91], v11, s[36:39], s69 offen offset:2048 sc1
	v_cvt_pk_bf16_f32 v92, v132, v133
	v_cvt_pk_bf16_f32 v93, v134, v135
	v_cvt_pk_bf16_f32 v94, v140, v141
	v_cvt_pk_bf16_f32 v95, v142, v143
	buffer_store_dwordx4 v[92:95], v11, s[36:39], s69 offen offset:3072 sc1
	s_barrier
	s_add_u32 m0, s67, 0
	s_nop 0
	buffer_load_dwordx4 v8, s[48:51], s68 offen offset:0 lds
	s_add_u32 m0, s67, 1024
	s_nop 0
	buffer_load_dwordx4 v9, s[48:51], s68 offen offset:0 lds
	s_add_u32 m0, s67, 1984
	s_nop 0
	buffer_load_dwordx4 v8, s[48:51], s68 offen offset:64 lds
	s_add_u32 m0, s67, 3008
	s_nop 0
	buffer_load_dwordx4 v9, s[48:51], s68 offen offset:64 lds
	s_add_u32 m0, s67, 3968
	s_nop 0
	buffer_load_dwordx4 v8, s[48:51], s68 offen offset:128 lds
	s_add_u32 m0, s67, 4992
	s_nop 0
	buffer_load_dwordx4 v9, s[48:51], s68 offen offset:128 lds
	s_add_u32 m0, s67, 5952
	s_nop 0
	buffer_load_dwordx4 v8, s[48:51], s68 offen offset:192 lds
	s_add_u32 m0, s67, 6976
	s_nop 0
	buffer_load_dwordx4 v9, s[48:51], s68 offen offset:192 lds
	s_add_u32 m0, s67, 7936
	s_nop 0
	buffer_load_dwordx4 v8, s[48:51], s68 offen offset:256 lds
	s_add_u32 m0, s67, 8960
	s_nop 0
	buffer_load_dwordx4 v9, s[48:51], s68 offen offset:256 lds
	s_add_u32 s67, s67, 40960
	s_add_u32 s68, s68, 40960
	s_sub_u32 s67, s67, 122880
	s_mov_b32 s69, 0xfe00000
	s_mov_b32 s66, 2
	s_mov_b32 s70, 81920
	v_mov_b32 v106, s66
	s_waitcnt vmcnt(10)
	buffer_store_dword v106, v12, s[36:39], 0 offen sc1
	s_add_u32 m0, s67, 0
	s_nop 0
	buffer_load_dwordx4 v8, s[48:51], s68 offen offset:0 lds
	s_add_u32 m0, s67, 1024
	s_nop 0
	buffer_load_dwordx4 v9, s[48:51], s68 offen offset:0 lds
	s_add_u32 m0, s67, 1984
	s_nop 0
	buffer_load_dwordx4 v8, s[48:51], s68 offen offset:64 lds
	s_add_u32 m0, s67, 3008
	s_nop 0
	buffer_load_dwordx4 v9, s[48:51], s68 offen offset:64 lds
	s_add_u32 m0, s67, 3968
	s_nop 0
	buffer_load_dwordx4 v8, s[48:51], s68 offen offset:128 lds
	s_add_u32 m0, s67, 4992
	s_nop 0
	buffer_load_dwordx4 v9, s[48:51], s68 offen offset:128 lds
	s_add_u32 m0, s67, 5952
	s_nop 0
	buffer_load_dwordx4 v8, s[48:51], s68 offen offset:192 lds
	s_add_u32 m0, s67, 6976
	s_nop 0
	buffer_load_dwordx4 v9, s[48:51], s68 offen offset:192 lds
	s_add_u32 m0, s67, 7936
	s_nop 0
	buffer_load_dwordx4 v8, s[48:51], s68 offen offset:256 lds
	s_add_u32 m0, s67, 8960
	s_nop 0
	buffer_load_dwordx4 v9, s[48:51], s68 offen offset:256 lds
	s_add_u32 s67, s67, 40960
	s_add_u32 s68, s68, 40960
	s_waitcnt vmcnt(11)
	s_branch L_projk
L_ps_105:
	s_add_u32 m0, s65, 0
	s_mov_b32 s63, 7471104
	buffer_load_dwordx4 v1, s[44:47], s63 offen lds
	s_add_u32 m0, s65, 1024
	s_mov_b32 s63, 7471104
	buffer_load_dwordx4 v2, s[44:47], s63 offen lds
	s_add_u32 m0, s65, 2048
	s_mov_b32 s63, 7667712
	buffer_load_dwordx4 v1, s[44:47], s63 offen lds
	s_add_u32 m0, s65, 3072
	s_mov_b32 s63, 7667712
	buffer_load_dwordx4 v2, s[44:47], s63 offen lds
	s_add_u32 m0, s65, 4096
	s_mov_b32 s63, 7077888
	buffer_load_dwordx4 v1, s[44:47], s63 offen lds
	s_add_u32 m0, s65, 5120
	s_mov_b32 s63, 7077888
	buffer_load_dwordx4 v2, s[44:47], s63 offen lds
	s_add_u32 m0, s65, 6144
	s_mov_b32 s63, 7274496
	buffer_load_dwordx4 v1, s[44:47], s63 offen lds
	s_add_u32 m0, s65, 7168
	s_mov_b32 s63, 7274496
	buffer_load_dwordx4 v2, s[44:47], s63 offen lds
	s_add_u32 m0, s65, 8192
	s_mov_b32 s63, 6684672
	buffer_load_dwordx4 v1, s[44:47], s63 offen lds
	s_add_u32 m0, s65, 9216
	s_mov_b32 s63, 6684672
	buffer_load_dwordx4 v2, s[44:47], s63 offen lds
	s_add_u32 m0, s65, 10240
	s_mov_b32 s63, 6881280
	buffer_load_dwordx4 v1, s[44:47], s63 offen lds
	s_add_u32 m0, s65, 11264
	s_mov_b32 s63, 6881280
	buffer_load_dwordx4 v2, s[44:47], s63 offen lds
	s_waitcnt vmcnt(12)
	s_barrier
	s_lshl_b32 s6, s5, 12
	s_add_u32 s6, s6, 96
	v_mov_b32 v150, s6
	v_mov_b32 v151, 1
	s_mov_b64 exec, 1
	buffer_atomic_add v151, v150, s[40:43], 0 offen
	s_mov_b64 exec, -1
	s_add_u32 m0, s67, 0
	s_nop 0
	buffer_load_dwordx4 v8, s[48:51], s68 offen offset:0 lds
	s_add_u32 m0, s67, 1024
	s_nop 0
	buffer_load_dwordx4 v9, s[48:51], s68 offen offset:0 lds
	s_add_u32 m0, s67, 1984
	s_nop 0
	buffer_load_dwordx4 v8, s[48:51], s68 offen offset:64 lds
	s_add_u32 m0, s67, 3008
	s_nop 0
	buffer_load_dwordx4 v9, s[48:51], s68 offen offset:64 lds
	s_add_u32 m0, s67, 3968
	s_nop 0
	buffer_load_dwordx4 v8, s[48:51], s68 offen offset:128 lds
	s_add_u32 m0, s67, 4992
	s_nop 0
	buffer_load_dwordx4 v9, s[48:51], s68 offen offset:128 lds
	s_add_u32 m0, s67, 5952
	s_nop 0
	buffer_load_dwordx4 v8, s[48:51], s68 offen offset:192 lds
	s_add_u32 m0, s67, 6976
	s_nop 0
	buffer_load_dwordx4 v9, s[48:51], s68 offen offset:192 lds
	s_add_u32 m0, s67, 7936
	s_nop 0
	buffer_load_dwordx4 v8, s[48:51], s68 offen offset:256 lds
	s_add_u32 m0, s67, 8960
	s_nop 0
	buffer_load_dwordx4 v9, s[48:51], s68 offen offset:256 lds
	s_add_u32 s67, s67, 40960
	s_add_u32 s68, s68, 40960
	s_add_u32 m0, s65, 12288
	s_mov_b32 s63, 6291456
	buffer_load_dwordx4 v1, s[44:47], s63 offen lds
	s_add_u32 m0, s65, 13312
	s_mov_b32 s63, 6291456
	buffer_load_dwordx4 v2, s[44:47], s63 offen lds
	s_add_u32 m0, s65, 14336
	s_mov_b32 s63, 6488064
	buffer_load_dwordx4 v1, s[44:47], s63 offen lds
	s_add_u32 m0, s65, 15360
	s_mov_b32 s63, 6488064
	buffer_load_dwordx4 v2, s[44:47], s63 offen lds
	s_add_u32 m0, s65, 16384
	s_mov_b32 s63, 5898240
	buffer_load_dwordx4 v1, s[44:47], s63 offen lds
	s_add_u32 m0, s65, 17408
	s_mov_b32 s63, 5898240
	buffer_load_dwordx4 v2, s[44:47], s63 offen lds
	s_add_u32 m0, s65, 18432
	s_mov_b32 s63, 6094848
	buffer_load_dwordx4 v1, s[44:47], s63 offen lds
	s_add_u32 m0, s65, 19456
	s_mov_b32 s63, 6094848
	buffer_load_dwordx4 v2, s[44:47], s63 offen lds
	v_add_u32 v13, 40960, v10
	s_waitcnt vmcnt(27)
	ds_read_b64_tr_b16 v[240:241], v4 offset:0
	ds_read_b64_tr_b16 v[242:243], v4 offset:512
	ds_read_b64_tr_b16 v[244:245], v5 offset:0
	ds_read_b64_tr_b16 v[246:247], v5 offset:512
	ds_read_b64_tr_b16 v[248:249], v6 offset:0
	ds_read_b64_tr_b16 v[250:251], v6 offset:512
	ds_read_b64_tr_b16 v[252:253], v7 offset:0
	ds_read_b64_tr_b16 v[254:255], v7 offset:512
	s_waitcnt lgkmcnt(0)
	s_add_u32 m0, s65, 0
	s_mov_b32 s63, 5505024
	buffer_load_dwordx4 v1, s[44:47], s63 offen lds
	s_add_u32 m0, s65, 1024
	s_mov_b32 s63, 5505024
	buffer_load_dwordx4 v2, s[44:47], s63 offen lds
	s_add_u32 m0, s65, 2048
	s_mov_b32 s63, 5701632
	buffer_load_dwordx4 v1, s[44:47], s63 offen lds
	s_add_u32 m0, s65, 3072
	s_mov_b32 s63, 5701632
	buffer_load_dwordx4 v2, s[44:47], s63 offen lds
	s_waitcnt vmcnt(27)
	ds_read_b64_tr_b16 v[224:225], v4 offset:4096
	ds_read_b64_tr_b16 v[226:227], v4 offset:4608
	ds_read_b64_tr_b16 v[228:229], v5 offset:4096
	ds_read_b64_tr_b16 v[230:231], v5 offset:4608
	ds_read_b64_tr_b16 v[232:233], v6 offset:4096
	ds_read_b64_tr_b16 v[234:235], v6 offset:4608
	ds_read_b64_tr_b16 v[236:237], v7 offset:4096
	ds_read_b64_tr_b16 v[238:239], v7 offset:4608
	s_waitcnt lgkmcnt(0)
	s_add_u32 m0, s67, 0
	s_nop 0
	buffer_load_dwordx4 v8, s[48:51], s68 offen offset:0 lds
	s_add_u32 m0, s67, 1024
	s_nop 0
	buffer_load_dwordx4 v9, s[48:51], s68 offen offset:0 lds
	s_add_u32 m0, s67, 1984
	s_nop 0
	buffer_load_dwordx4 v8, s[48:51], s68 offen offset:64 lds
	s_add_u32 m0, s67, 3008
	s_nop 0
	buffer_load_dwordx4 v9, s[48:51], s68 offen offset:64 lds
	s_add_u32 m0, s67, 3968
	s_nop 0
	buffer_load_dwordx4 v8, s[48:51], s68 offen offset:128 lds
	s_add_u32 m0, s67, 4992
	s_nop 0
	buffer_load_dwordx4 v9, s[48:51], s68 offen offset:128 lds
	s_add_u32 m0, s67, 5952
	s_nop 0
	buffer_load_dwordx4 v8, s[48:51], s68 offen offset:192 lds
	s_add_u32 m0, s67, 6976
	s_nop 0
	buffer_load_dwordx4 v9, s[48:51], s68 offen offset:192 lds
	s_add_u32 m0, s67, 7936
	s_nop 0
	buffer_load_dwordx4 v8, s[48:51], s68 offen offset:256 lds
	s_add_u32 m0, s67, 8960
	s_nop 0
	buffer_load_dwordx4 v9, s[48:51], s68 offen offset:256 lds
	s_add_u32 s67, s67, 40960
	s_add_u32 s68, s68, 40960
	s_add_u32 m0, s65, 4096
	s_mov_b32 s63, 5111808
	buffer_load_dwordx4 v1, s[44:47], s63 offen lds
	s_add_u32 m0, s65, 5120
	s_mov_b32 s63, 5111808
	buffer_load_dwordx4 v2, s[44:47], s63 offen lds
	s_add_u32 m0, s65, 6144
	s_mov_b32 s63, 5308416
	buffer_load_dwordx4 v1, s[44:47], s63 offen lds
	s_add_u32 m0, s65, 7168
	s_mov_b32 s63, 5308416
	buffer_load_dwordx4 v2, s[44:47], s63 offen lds
	s_waitcnt vmcnt(37)
	ds_read_b64_tr_b16 v[208:209], v4 offset:8192
	ds_read_b64_tr_b16 v[210:211], v4 offset:8704
	ds_read_b64_tr_b16 v[212:213], v5 offset:8192
	ds_read_b64_tr_b16 v[214:215], v5 offset:8704
	ds_read_b64_tr_b16 v[216:217], v6 offset:8192
	ds_read_b64_tr_b16 v[218:219], v6 offset:8704
	ds_read_b64_tr_b16 v[220:221], v7 offset:8192
	ds_read_b64_tr_b16 v[222:223], v7 offset:8704
	s_waitcnt lgkmcnt(0)
	s_add_u32 m0, s65, 8192
	s_mov_b32 s63, 4718592
	buffer_load_dwordx4 v1, s[44:47], s63 offen lds
	s_add_u32 m0, s65, 9216
	s_mov_b32 s63, 4718592
	buffer_load_dwordx4 v2, s[44:47], s63 offen lds
	s_add_u32 m0, s65, 10240
	s_mov_b32 s63, 4915200
	buffer_load_dwordx4 v1, s[44:47], s63 offen lds
	s_add_u32 m0, s65, 11264
	s_mov_b32 s63, 4915200
	buffer_load_dwordx4 v2, s[44:47], s63 offen lds
	s_waitcnt vmcnt(26)
	ds_read_b64_tr_b16 v[192:193], v4 offset:12288
	ds_read_b64_tr_b16 v[194:195], v4 offset:12800
	ds_read_b64_tr_b16 v[196:197], v5 offset:12288
	ds_read_b64_tr_b16 v[198:199], v5 offset:12800
	ds_read_b64_tr_b16 v[200:201], v6 offset:12288
	ds_read_b64_tr_b16 v[202:203], v6 offset:12800
	ds_read_b64_tr_b16 v[204:205], v7 offset:12288
	ds_read_b64_tr_b16 v[206:207], v7 offset:12800
	s_waitcnt lgkmcnt(0)
	s_add_u32 m0, s65, 12288
	s_mov_b32 s63, 4325376
	buffer_load_dwordx4 v1, s[44:47], s63 offen lds
	s_add_u32 m0, s65, 13312
	s_mov_b32 s63, 4325376
	buffer_load_dwordx4 v2, s[44:47], s63 offen lds
	s_add_u32 m0, s65, 14336
	s_mov_b32 s63, 4521984
	buffer_load_dwordx4 v1, s[44:47], s63 offen lds
	s_add_u32 m0, s65, 15360
	s_mov_b32 s63, 4521984
	buffer_load_dwordx4 v2, s[44:47], s63 offen lds
	s_waitcnt vmcnt(26)
	ds_read_b64_tr_b16 a[240:241], v4 offset:16384
	ds_read_b64_tr_b16 a[242:243], v4 offset:16896
	ds_read_b64_tr_b16 a[244:245], v5 offset:16384
	ds_read_b64_tr_b16 a[246:247], v5 offset:16896
	ds_read_b64_tr_b16 a[248:249], v6 offset:16384
	ds_read_b64_tr_b16 a[250:251], v6 offset:16896
	ds_read_b64_tr_b16 a[252:253], v7 offset:16384
	ds_read_b64_tr_b16 a[254:255], v7 offset:16896
	s_waitcnt lgkmcnt(0)
	s_add_u32 m0, s65, 16384
	s_mov_b32 s63, 3932160
	buffer_load_dwordx4 v1, s[44:47], s63 offen lds
	s_add_u32 m0, s65, 17408
	s_mov_b32 s63, 3932160
	buffer_load_dwordx4 v2, s[44:47], s63 offen lds
	s_add_u32 m0, s65, 18432
	s_mov_b32 s63, 4128768
	buffer_load_dwordx4 v1, s[44:47], s63 offen lds
	s_add_u32 m0, s65, 19456
	s_mov_b32 s63, 4128768
	buffer_load_dwordx4 v2, s[44:47], s63 offen lds
	s_waitcnt vmcnt(26)
	ds_read_b64_tr_b16 a[224:225], v4 offset:0
	ds_read_b64_tr_b16 a[226:227], v4 offset:512
	ds_read_b64_tr_b16 a[228:229], v5 offset:0
	ds_read_b64_tr_b16 a[230:231], v5 offset:512
	ds_read_b64_tr_b16 a[232:233], v6 offset:0
	ds_read_b64_tr_b16 a[234:235], v6 offset:512
	ds_read_b64_tr_b16 a[236:237], v7 offset:0
	ds_read_b64_tr_b16 a[238:239], v7 offset:512
	s_waitcnt lgkmcnt(0)
	s_add_u32 m0, s65, 0
	s_mov_b32 s63, 3538944
	buffer_load_dwordx4 v1, s[44:47], s63 offen lds
	s_add_u32 m0, s65, 1024
	s_mov_b32 s63, 3538944
	buffer_load_dwordx4 v2, s[44:47], s63 offen lds
	s_add_u32 m0, s65, 2048
	s_mov_b32 s63, 3735552
	buffer_load_dwordx4 v1, s[44:47], s63 offen lds
	s_add_u32 m0, s65, 3072
	s_mov_b32 s63, 3735552
	buffer_load_dwordx4 v2, s[44:47], s63 offen lds
	s_waitcnt vmcnt(16)
	ds_read_b64_tr_b16 a[208:209], v4 offset:4096
	ds_read_b64_tr_b16 a[210:211], v4 offset:4608
	ds_read_b64_tr_b16 a[212:213], v5 offset:4096
	ds_read_b64_tr_b16 a[214:215], v5 offset:4608
	ds_read_b64_tr_b16 a[216:217], v6 offset:4096
	ds_read_b64_tr_b16 a[218:219], v6 offset:4608
	ds_read_b64_tr_b16 a[220:221], v7 offset:4096
	ds_read_b64_tr_b16 a[222:223], v7 offset:4608
	s_waitcnt lgkmcnt(0)
	s_add_u32 m0, s65, 4096
	s_mov_b32 s63, 3145728
	buffer_load_dwordx4 v1, s[44:47], s63 offen lds
	s_add_u32 m0, s65, 5120
	s_mov_b32 s63, 3145728
	buffer_load_dwordx4 v2, s[44:47], s63 offen lds
	s_add_u32 m0, s65, 6144
	s_mov_b32 s63, 3342336
	buffer_load_dwordx4 v1, s[44:47], s63 offen lds
	s_add_u32 m0, s65, 7168
	s_mov_b32 s63, 3342336
	buffer_load_dwordx4 v2, s[44:47], s63 offen lds
	s_waitcnt vmcnt(24)
	s_barrier
	ds_read_b128 v[48:51], v10 offset:38912
	ds_read_b128 v[52:55], v10 offset:39936
	ds_read_b128 v[56:59], v13 offset:38912
	ds_read_b128 v[60:63], v13 offset:39936
	ds_read_b128 v[64:67], v10 offset:36864
	ds_read_b128 v[68:71], v10 offset:37888
	ds_read_b128 v[72:75], v13 offset:36864
	ds_read_b128 v[76:79], v13 offset:37888
	s_waitcnt lgkmcnt(4)
	v_mfma_f32_16x16x32_bf16 v[16:19], v[240:243], v[48:51], 0
	v_mfma_f32_16x16x32_bf16 v[24:27], v[244:247], v[48:51], 0
	v_mfma_f32_16x16x32_bf16 v[32:35], v[248:251], v[48:51], 0
	v_mfma_f32_16x16x32_bf16 v[40:43], v[252:255], v[48:51], 0
	v_mfma_f32_16x16x32_bf16 v[20:23], v[240:243], v[52:55], 0
	v_mfma_f32_16x16x32_bf16 v[28:31], v[244:247], v[52:55], 0
	v_mfma_f32_16x16x32_bf16 v[36:39], v[248:251], v[52:55], 0
	v_mfma_f32_16x16x32_bf16 v[44:47], v[252:255], v[52:55], 0
	v_mfma_f32_16x16x32_bf16 v[112:115], v[240:243], v[56:59], 0
	v_mfma_f32_16x16x32_bf16 v[120:123], v[244:247], v[56:59], 0
	v_mfma_f32_16x16x32_bf16 v[128:131], v[248:251], v[56:59], 0
	v_mfma_f32_16x16x32_bf16 v[136:139], v[252:255], v[56:59], 0
	v_mfma_f32_16x16x32_bf16 v[116:119], v[240:243], v[60:63], 0
	v_mfma_f32_16x16x32_bf16 v[124:127], v[244:247], v[60:63], 0
	v_mfma_f32_16x16x32_bf16 v[132:135], v[248:251], v[60:63], 0
	v_mfma_f32_16x16x32_bf16 v[140:143], v[252:255], v[60:63], 0
	ds_read_b128 v[48:51], v10 offset:34816
	ds_read_b128 v[52:55], v10 offset:35840
	ds_read_b128 v[56:59], v13 offset:34816
	ds_read_b128 v[60:63], v13 offset:35840
	s_waitcnt lgkmcnt(4)
	v_mfma_f32_16x16x32_bf16 v[16:19], v[224:227], v[64:67], v[16:19]
	v_mfma_f32_16x16x32_bf16 v[24:27], v[228:231], v[64:67], v[24:27]
	v_mfma_f32_16x16x32_bf16 v[32:35], v[232:235], v[64:67], v[32:35]
	v_mfma_f32_16x16x32_bf16 v[40:43], v[236:239], v[64:67], v[40:43]
	v_mfma_f32_16x16x32_bf16 v[20:23], v[224:227], v[68:71], v[20:23]
	v_mfma_f32_16x16x32_bf16 v[28:31], v[228:231], v[68:71], v[28:31]
	v_mfma_f32_16x16x32_bf16 v[36:39], v[232:235], v[68:71], v[36:39]
	v_mfma_f32_16x16x32_bf16 v[44:47], v[236:239], v[68:71], v[44:47]
	v_mfma_f32_16x16x32_bf16 v[112:115], v[224:227], v[72:75], v[112:115]
	v_mfma_f32_16x16x32_bf16 v[120:123], v[228:231], v[72:75], v[120:123]
	v_mfma_f32_16x16x32_bf16 v[128:131], v[232:235], v[72:75], v[128:131]
	v_mfma_f32_16x16x32_bf16 v[136:139], v[236:239], v[72:75], v[136:139]
	v_mfma_f32_16x16x32_bf16 v[116:119], v[224:227], v[76:79], v[116:119]
	v_mfma_f32_16x16x32_bf16 v[124:127], v[228:231], v[76:79], v[124:127]
	v_mfma_f32_16x16x32_bf16 v[132:135], v[232:235], v[76:79], v[132:135]
	v_mfma_f32_16x16x32_bf16 v[140:143], v[236:239], v[76:79], v[140:143]
	s_waitcnt vmcnt(16)
	ds_read_b64_tr_b16 a[192:193], v4 offset:8192
	ds_read_b64_tr_b16 a[194:195], v4 offset:8704
	ds_read_b64_tr_b16 a[196:197], v5 offset:8192
	ds_read_b64_tr_b16 a[198:199], v5 offset:8704
	ds_read_b64_tr_b16 a[200:201], v6 offset:8192
	ds_read_b64_tr_b16 a[202:203], v6 offset:8704
	ds_read_b64_tr_b16 a[204:205], v7 offset:8192
	ds_read_b64_tr_b16 a[206:207], v7 offset:8704
	s_waitcnt lgkmcnt(0)
	s_add_u32 m0, s65, 8192
	s_mov_b32 s63, 2752512
	buffer_load_dwordx4 v1, s[44:47], s63 offen lds
	s_add_u32 m0, s65, 9216
	s_mov_b32 s63, 2752512
	buffer_load_dwordx4 v2, s[44:47], s63 offen lds
	s_add_u32 m0, s65, 10240
	s_mov_b32 s63, 2949120
	buffer_load_dwordx4 v1, s[44:47], s63 offen lds
	s_add_u32 m0, s65, 11264
	s_mov_b32 s63, 2949120
	buffer_load_dwordx4 v2, s[44:47], s63 offen lds
	ds_read_b128 v[64:67], v10 offset:32768
	ds_read_b128 v[68:71], v10 offset:33792
	ds_read_b128 v[72:75], v13 offset:32768
	ds_read_b128 v[76:79], v13 offset:33792
	s_waitcnt lgkmcnt(4)
	v_mfma_f32_16x16x32_bf16 v[16:19], v[208:211], v[48:51], v[16:19]
	v_mfma_f32_16x16x32_bf16 v[24:27], v[212:215], v[48:51], v[24:27]
	v_mfma_f32_16x16x32_bf16 v[32:35], v[216:219], v[48:51], v[32:35]
	v_mfma_f32_16x16x32_bf16 v[40:43], v[220:223], v[48:51], v[40:43]
	v_mfma_f32_16x16x32_bf16 v[20:23], v[208:211], v[52:55], v[20:23]
	v_mfma_f32_16x16x32_bf16 v[28:31], v[212:215], v[52:55], v[28:31]
	v_mfma_f32_16x16x32_bf16 v[36:39], v[216:219], v[52:55], v[36:39]
	v_mfma_f32_16x16x32_bf16 v[44:47], v[220:223], v[52:55], v[44:47]
	v_mfma_f32_16x16x32_bf16 v[112:115], v[208:211], v[56:59], v[112:115]
	v_mfma_f32_16x16x32_bf16 v[120:123], v[212:215], v[56:59], v[120:123]
	v_mfma_f32_16x16x32_bf16 v[128:131], v[216:219], v[56:59], v[128:131]
	v_mfma_f32_16x16x32_bf16 v[136:139], v[220:223], v[56:59], v[136:139]
	v_mfma_f32_16x16x32_bf16 v[116:119], v[208:211], v[60:63], v[116:119]
	v_mfma_f32_16x16x32_bf16 v[124:127], v[212:215], v[60:63], v[124:127]
	v_mfma_f32_16x16x32_bf16 v[132:135], v[216:219], v[60:63], v[132:135]
	v_mfma_f32_16x16x32_bf16 v[140:143], v[220:223], v[60:63], v[140:143]
	ds_read_b128 v[48:51], v10 offset:30720
	ds_read_b128 v[52:55], v10 offset:31744
	ds_read_b128 v[56:59], v13 offset:30720
	ds_read_b128 v[60:63], v13 offset:31744
	s_waitcnt lgkmcnt(4)
	v_mfma_f32_16x16x32_bf16 v[16:19], v[192:195], v[64:67], v[16:19]
	v_mfma_f32_16x16x32_bf16 v[24:27], v[196:199], v[64:67], v[24:27]
	v_mfma_f32_16x16x32_bf16 v[32:35], v[200:203], v[64:67], v[32:35]
	v_mfma_f32_16x16x32_bf16 v[40:43], v[204:207], v[64:67], v[40:43]
	v_mfma_f32_16x16x32_bf16 v[20:23], v[192:195], v[68:71], v[20:23]
	v_mfma_f32_16x16x32_bf16 v[28:31], v[196:199], v[68:71], v[28:31]
	v_mfma_f32_16x16x32_bf16 v[36:39], v[200:203], v[68:71], v[36:39]
	v_mfma_f32_16x16x32_bf16 v[44:47], v[204:207], v[68:71], v[44:47]
	v_mfma_f32_16x16x32_bf16 v[112:115], v[192:195], v[72:75], v[112:115]
	v_mfma_f32_16x16x32_bf16 v[120:123], v[196:199], v[72:75], v[120:123]
	v_mfma_f32_16x16x32_bf16 v[128:131], v[200:203], v[72:75], v[128:131]
	v_mfma_f32_16x16x32_bf16 v[136:139], v[204:207], v[72:75], v[136:139]
	v_mfma_f32_16x16x32_bf16 v[116:119], v[192:195], v[76:79], v[116:119]
	v_mfma_f32_16x16x32_bf16 v[124:127], v[196:199], v[76:79], v[124:127]
	v_mfma_f32_16x16x32_bf16 v[132:135], v[200:203], v[76:79], v[132:135]
	v_mfma_f32_16x16x32_bf16 v[140:143], v[204:207], v[76:79], v[140:143]
	s_waitcnt vmcnt(16)
	ds_read_b64_tr_b16 a[176:177], v4 offset:12288
	ds_read_b64_tr_b16 a[178:179], v4 offset:12800
	ds_read_b64_tr_b16 a[180:181], v5 offset:12288
	ds_read_b64_tr_b16 a[182:183], v5 offset:12800
	ds_read_b64_tr_b16 a[184:185], v6 offset:12288
	ds_read_b64_tr_b16 a[186:187], v6 offset:12800
	ds_read_b64_tr_b16 a[188:189], v7 offset:12288
	ds_read_b64_tr_b16 a[190:191], v7 offset:12800
	s_waitcnt lgkmcnt(0)
	s_add_u32 m0, s65, 12288
	s_mov_b32 s63, 2359296
	buffer_load_dwordx4 v1, s[44:47], s63 offen lds
	s_add_u32 m0, s65, 13312
	s_mov_b32 s63, 2359296
	buffer_load_dwordx4 v2, s[44:47], s63 offen lds
	s_add_u32 m0, s65, 14336
	s_mov_b32 s63, 2555904
	buffer_load_dwordx4 v1, s[44:47], s63 offen lds
	s_add_u32 m0, s65, 15360
	s_mov_b32 s63, 2555904
	buffer_load_dwordx4 v2, s[44:47], s63 offen lds
	ds_read_b128 v[64:67], v10 offset:28672
	ds_read_b128 v[68:71], v10 offset:29696
	ds_read_b128 v[72:75], v13 offset:28672
	ds_read_b128 v[76:79], v13 offset:29696
	s_waitcnt lgkmcnt(4)
	v_mfma_f32_16x16x32_bf16 v[16:19], a[240:243], v[48:51], v[16:19]
	v_mfma_f32_16x16x32_bf16 v[24:27], a[244:247], v[48:51], v[24:27]
	v_mfma_f32_16x16x32_bf16 v[32:35], a[248:251], v[48:51], v[32:35]
	v_mfma_f32_16x16x32_bf16 v[40:43], a[252:255], v[48:51], v[40:43]
	v_mfma_f32_16x16x32_bf16 v[20:23], a[240:243], v[52:55], v[20:23]
	v_mfma_f32_16x16x32_bf16 v[28:31], a[244:247], v[52:55], v[28:31]
	v_mfma_f32_16x16x32_bf16 v[36:39], a[248:251], v[52:55], v[36:39]
	v_mfma_f32_16x16x32_bf16 v[44:47], a[252:255], v[52:55], v[44:47]
	v_mfma_f32_16x16x32_bf16 v[112:115], a[240:243], v[56:59], v[112:115]
	v_mfma_f32_16x16x32_bf16 v[120:123], a[244:247], v[56:59], v[120:123]
	v_mfma_f32_16x16x32_bf16 v[128:131], a[248:251], v[56:59], v[128:131]
	v_mfma_f32_16x16x32_bf16 v[136:139], a[252:255], v[56:59], v[136:139]
	v_mfma_f32_16x16x32_bf16 v[116:119], a[240:243], v[60:63], v[116:119]
	v_mfma_f32_16x16x32_bf16 v[124:127], a[244:247], v[60:63], v[124:127]
	v_mfma_f32_16x16x32_bf16 v[132:135], a[248:251], v[60:63], v[132:135]
	v_mfma_f32_16x16x32_bf16 v[140:143], a[252:255], v[60:63], v[140:143]
	ds_read_b128 v[48:51], v10 offset:26624
	ds_read_b128 v[52:55], v10 offset:27648
	ds_read_b128 v[56:59], v13 offset:26624
	ds_read_b128 v[60:63], v13 offset:27648
	s_waitcnt lgkmcnt(4)
	v_mfma_f32_16x16x32_bf16 v[16:19], a[224:227], v[64:67], v[16:19]
	v_mfma_f32_16x16x32_bf16 v[24:27], a[228:231], v[64:67], v[24:27]
	v_mfma_f32_16x16x32_bf16 v[32:35], a[232:235], v[64:67], v[32:35]
	v_mfma_f32_16x16x32_bf16 v[40:43], a[236:239], v[64:67], v[40:43]
	v_mfma_f32_16x16x32_bf16 v[20:23], a[224:227], v[68:71], v[20:23]
	v_mfma_f32_16x16x32_bf16 v[28:31], a[228:231], v[68:71], v[28:31]
	v_mfma_f32_16x16x32_bf16 v[36:39], a[232:235], v[68:71], v[36:39]
	v_mfma_f32_16x16x32_bf16 v[44:47], a[236:239], v[68:71], v[44:47]
	v_mfma_f32_16x16x32_bf16 v[112:115], a[224:227], v[72:75], v[112:115]
	v_mfma_f32_16x16x32_bf16 v[120:123], a[228:231], v[72:75], v[120:123]
	v_mfma_f32_16x16x32_bf16 v[128:131], a[232:235], v[72:75], v[128:131]
	v_mfma_f32_16x16x32_bf16 v[136:139], a[236:239], v[72:75], v[136:139]
	v_mfma_f32_16x16x32_bf16 v[116:119], a[224:227], v[76:79], v[116:119]
	v_mfma_f32_16x16x32_bf16 v[124:127], a[228:231], v[76:79], v[124:127]
	v_mfma_f32_16x16x32_bf16 v[132:135], a[232:235], v[76:79], v[132:135]
	v_mfma_f32_16x16x32_bf16 v[140:143], a[236:239], v[76:79], v[140:143]
	s_waitcnt vmcnt(16)
	ds_read_b64_tr_b16 a[160:161], v4 offset:16384
	ds_read_b64_tr_b16 a[162:163], v4 offset:16896
	ds_read_b64_tr_b16 a[164:165], v5 offset:16384
	ds_read_b64_tr_b16 a[166:167], v5 offset:16896
	ds_read_b64_tr_b16 a[168:169], v6 offset:16384
	ds_read_b64_tr_b16 a[170:171], v6 offset:16896
	ds_read_b64_tr_b16 a[172:173], v7 offset:16384
	ds_read_b64_tr_b16 a[174:175], v7 offset:16896
	s_waitcnt lgkmcnt(0)
	s_add_u32 m0, s65, 16384
	s_mov_b32 s63, 1966080
	buffer_load_dwordx4 v1, s[44:47], s63 offen lds
	s_add_u32 m0, s65, 17408
	s_mov_b32 s63, 1966080
	buffer_load_dwordx4 v2, s[44:47], s63 offen lds
	s_add_u32 m0, s65, 18432
	s_mov_b32 s63, 2162688
	buffer_load_dwordx4 v1, s[44:47], s63 offen lds
	s_add_u32 m0, s65, 19456
	s_mov_b32 s63, 2162688
	buffer_load_dwordx4 v2, s[44:47], s63 offen lds
	ds_read_b128 v[64:67], v10 offset:24576
	ds_read_b128 v[68:71], v10 offset:25600
	ds_read_b128 v[72:75], v13 offset:24576
	ds_read_b128 v[76:79], v13 offset:25600
	s_waitcnt lgkmcnt(4)
	v_mfma_f32_16x16x32_bf16 v[16:19], a[208:211], v[48:51], v[16:19]
	v_mfma_f32_16x16x32_bf16 v[24:27], a[212:215], v[48:51], v[24:27]
	v_mfma_f32_16x16x32_bf16 v[32:35], a[216:219], v[48:51], v[32:35]
	v_mfma_f32_16x16x32_bf16 v[40:43], a[220:223], v[48:51], v[40:43]
	v_mfma_f32_16x16x32_bf16 v[20:23], a[208:211], v[52:55], v[20:23]
	v_mfma_f32_16x16x32_bf16 v[28:31], a[212:215], v[52:55], v[28:31]
	v_mfma_f32_16x16x32_bf16 v[36:39], a[216:219], v[52:55], v[36:39]
	v_mfma_f32_16x16x32_bf16 v[44:47], a[220:223], v[52:55], v[44:47]
	v_mfma_f32_16x16x32_bf16 v[112:115], a[208:211], v[56:59], v[112:115]
	v_mfma_f32_16x16x32_bf16 v[120:123], a[212:215], v[56:59], v[120:123]
	v_mfma_f32_16x16x32_bf16 v[128:131], a[216:219], v[56:59], v[128:131]
	v_mfma_f32_16x16x32_bf16 v[136:139], a[220:223], v[56:59], v[136:139]
	v_mfma_f32_16x16x32_bf16 v[116:119], a[208:211], v[60:63], v[116:119]
	v_mfma_f32_16x16x32_bf16 v[124:127], a[212:215], v[60:63], v[124:127]
	v_mfma_f32_16x16x32_bf16 v[132:135], a[216:219], v[60:63], v[132:135]
	v_mfma_f32_16x16x32_bf16 v[140:143], a[220:223], v[60:63], v[140:143]
	ds_read_b128 v[48:51], v10 offset:22528
	ds_read_b128 v[52:55], v10 offset:23552
	ds_read_b128 v[56:59], v13 offset:22528
	ds_read_b128 v[60:63], v13 offset:23552
	s_waitcnt lgkmcnt(4)
	v_mfma_f32_16x16x32_bf16 v[16:19], a[192:195], v[64:67], v[16:19]
	v_mfma_f32_16x16x32_bf16 v[24:27], a[196:199], v[64:67], v[24:27]
	v_mfma_f32_16x16x32_bf16 v[32:35], a[200:203], v[64:67], v[32:35]
	v_mfma_f32_16x16x32_bf16 v[40:43], a[204:207], v[64:67], v[40:43]
	v_mfma_f32_16x16x32_bf16 v[20:23], a[192:195], v[68:71], v[20:23]
	v_mfma_f32_16x16x32_bf16 v[28:31], a[196:199], v[68:71], v[28:31]
	v_mfma_f32_16x16x32_bf16 v[36:39], a[200:203], v[68:71], v[36:39]
	v_mfma_f32_16x16x32_bf16 v[44:47], a[204:207], v[68:71], v[44:47]
	v_mfma_f32_16x16x32_bf16 v[112:115], a[192:195], v[72:75], v[112:115]
	v_mfma_f32_16x16x32_bf16 v[120:123], a[196:199], v[72:75], v[120:123]
	v_mfma_f32_16x16x32_bf16 v[128:131], a[200:203], v[72:75], v[128:131]
	v_mfma_f32_16x16x32_bf16 v[136:139], a[204:207], v[72:75], v[136:139]
	v_mfma_f32_16x16x32_bf16 v[116:119], a[192:195], v[76:79], v[116:119]
	v_mfma_f32_16x16x32_bf16 v[124:127], a[196:199], v[76:79], v[124:127]
	v_mfma_f32_16x16x32_bf16 v[132:135], a[200:203], v[76:79], v[132:135]
	v_mfma_f32_16x16x32_bf16 v[140:143], a[204:207], v[76:79], v[140:143]
	s_waitcnt vmcnt(16)
	ds_read_b64_tr_b16 a[144:145], v4 offset:0
	ds_read_b64_tr_b16 a[146:147], v4 offset:512
	ds_read_b64_tr_b16 a[148:149], v5 offset:0
	ds_read_b64_tr_b16 a[150:151], v5 offset:512
	ds_read_b64_tr_b16 a[152:153], v6 offset:0
	ds_read_b64_tr_b16 a[154:155], v6 offset:512
	ds_read_b64_tr_b16 a[156:157], v7 offset:0
	ds_read_b64_tr_b16 a[158:159], v7 offset:512
	s_waitcnt lgkmcnt(0)
	s_add_u32 m0, s65, 0
	s_mov_b32 s63, 1572864
	buffer_load_dwordx4 v1, s[44:47], s63 offen lds
	s_add_u32 m0, s65, 1024
	s_mov_b32 s63, 1572864
	buffer_load_dwordx4 v2, s[44:47], s63 offen lds
	s_add_u32 m0, s65, 2048
	s_mov_b32 s63, 1769472
	buffer_load_dwordx4 v1, s[44:47], s63 offen lds
	s_add_u32 m0, s65, 3072
	s_mov_b32 s63, 1769472
	buffer_load_dwordx4 v2, s[44:47], s63 offen lds
	ds_read_b128 v[64:67], v10 offset:20480
	ds_read_b128 v[68:71], v10 offset:21504
	ds_read_b128 v[72:75], v13 offset:20480
	ds_read_b128 v[76:79], v13 offset:21504
	s_waitcnt lgkmcnt(4)
	v_mfma_f32_16x16x32_bf16 v[16:19], a[176:179], v[48:51], v[16:19]
	v_mfma_f32_16x16x32_bf16 v[24:27], a[180:183], v[48:51], v[24:27]
	v_mfma_f32_16x16x32_bf16 v[32:35], a[184:187], v[48:51], v[32:35]
	v_mfma_f32_16x16x32_bf16 v[40:43], a[188:191], v[48:51], v[40:43]
	v_mfma_f32_16x16x32_bf16 v[20:23], a[176:179], v[52:55], v[20:23]
	v_mfma_f32_16x16x32_bf16 v[28:31], a[180:183], v[52:55], v[28:31]
	v_mfma_f32_16x16x32_bf16 v[36:39], a[184:187], v[52:55], v[36:39]
	v_mfma_f32_16x16x32_bf16 v[44:47], a[188:191], v[52:55], v[44:47]
	v_mfma_f32_16x16x32_bf16 v[112:115], a[176:179], v[56:59], v[112:115]
	v_mfma_f32_16x16x32_bf16 v[120:123], a[180:183], v[56:59], v[120:123]
	v_mfma_f32_16x16x32_bf16 v[128:131], a[184:187], v[56:59], v[128:131]
	v_mfma_f32_16x16x32_bf16 v[136:139], a[188:191], v[56:59], v[136:139]
	v_mfma_f32_16x16x32_bf16 v[116:119], a[176:179], v[60:63], v[116:119]
	v_mfma_f32_16x16x32_bf16 v[124:127], a[180:183], v[60:63], v[124:127]
	v_mfma_f32_16x16x32_bf16 v[132:135], a[184:187], v[60:63], v[132:135]
	v_mfma_f32_16x16x32_bf16 v[140:143], a[188:191], v[60:63], v[140:143]
	ds_read_b128 v[48:51], v10 offset:18432
	ds_read_b128 v[52:55], v10 offset:19456
	ds_read_b128 v[56:59], v13 offset:18432
	ds_read_b128 v[60:63], v13 offset:19456
	s_waitcnt lgkmcnt(4)
	v_mfma_f32_16x16x32_bf16 v[16:19], a[160:163], v[64:67], v[16:19]
	v_mfma_f32_16x16x32_bf16 v[24:27], a[164:167], v[64:67], v[24:27]
	v_mfma_f32_16x16x32_bf16 v[32:35], a[168:171], v[64:67], v[32:35]
	v_mfma_f32_16x16x32_bf16 v[40:43], a[172:175], v[64:67], v[40:43]
	v_mfma_f32_16x16x32_bf16 v[20:23], a[160:163], v[68:71], v[20:23]
	v_mfma_f32_16x16x32_bf16 v[28:31], a[164:167], v[68:71], v[28:31]
	v_mfma_f32_16x16x32_bf16 v[36:39], a[168:171], v[68:71], v[36:39]
	v_mfma_f32_16x16x32_bf16 v[44:47], a[172:175], v[68:71], v[44:47]
	v_mfma_f32_16x16x32_bf16 v[112:115], a[160:163], v[72:75], v[112:115]
	v_mfma_f32_16x16x32_bf16 v[120:123], a[164:167], v[72:75], v[120:123]
	v_mfma_f32_16x16x32_bf16 v[128:131], a[168:171], v[72:75], v[128:131]
	v_mfma_f32_16x16x32_bf16 v[136:139], a[172:175], v[72:75], v[136:139]
	v_mfma_f32_16x16x32_bf16 v[116:119], a[160:163], v[76:79], v[116:119]
	v_mfma_f32_16x16x32_bf16 v[124:127], a[164:167], v[76:79], v[124:127]
	v_mfma_f32_16x16x32_bf16 v[132:135], a[168:171], v[76:79], v[132:135]
	v_mfma_f32_16x16x32_bf16 v[140:143], a[172:175], v[76:79], v[140:143]
	s_waitcnt vmcnt(16)
	ds_read_b64_tr_b16 a[128:129], v4 offset:4096
	ds_read_b64_tr_b16 a[130:131], v4 offset:4608
	ds_read_b64_tr_b16 a[132:133], v5 offset:4096
	ds_read_b64_tr_b16 a[134:135], v5 offset:4608
	ds_read_b64_tr_b16 a[136:137], v6 offset:4096
	ds_read_b64_tr_b16 a[138:139], v6 offset:4608
	ds_read_b64_tr_b16 a[140:141], v7 offset:4096
	ds_read_b64_tr_b16 a[142:143], v7 offset:4608
	s_waitcnt lgkmcnt(0)
	s_add_u32 m0, s65, 4096
	s_mov_b32 s63, 1179648
	buffer_load_dwordx4 v1, s[44:47], s63 offen lds
	s_add_u32 m0, s65, 5120
	s_mov_b32 s63, 1179648
	buffer_load_dwordx4 v2, s[44:47], s63 offen lds
	s_add_u32 m0, s65, 6144
	s_mov_b32 s63, 1376256
	buffer_load_dwordx4 v1, s[44:47], s63 offen lds
	s_add_u32 m0, s65, 7168
	s_mov_b32 s63, 1376256
	buffer_load_dwordx4 v2, s[44:47], s63 offen lds
	ds_read_b128 v[64:67], v10 offset:16384
	ds_read_b128 v[68:71], v10 offset:17408
	ds_read_b128 v[72:75], v13 offset:16384
	ds_read_b128 v[76:79], v13 offset:17408
	s_waitcnt lgkmcnt(4)
	v_mfma_f32_16x16x32_bf16 v[16:19], a[144:147], v[48:51], v[16:19]
	v_mfma_f32_16x16x32_bf16 v[24:27], a[148:151], v[48:51], v[24:27]
	v_mfma_f32_16x16x32_bf16 v[32:35], a[152:155], v[48:51], v[32:35]
	v_mfma_f32_16x16x32_bf16 v[40:43], a[156:159], v[48:51], v[40:43]
	v_mfma_f32_16x16x32_bf16 v[20:23], a[144:147], v[52:55], v[20:23]
	v_mfma_f32_16x16x32_bf16 v[28:31], a[148:151], v[52:55], v[28:31]
	v_mfma_f32_16x16x32_bf16 v[36:39], a[152:155], v[52:55], v[36:39]
	v_mfma_f32_16x16x32_bf16 v[44:47], a[156:159], v[52:55], v[44:47]
	v_mfma_f32_16x16x32_bf16 v[112:115], a[144:147], v[56:59], v[112:115]
	v_mfma_f32_16x16x32_bf16 v[120:123], a[148:151], v[56:59], v[120:123]
	v_mfma_f32_16x16x32_bf16 v[128:131], a[152:155], v[56:59], v[128:131]
	v_mfma_f32_16x16x32_bf16 v[136:139], a[156:159], v[56:59], v[136:139]
	v_mfma_f32_16x16x32_bf16 v[116:119], a[144:147], v[60:63], v[116:119]
	v_mfma_f32_16x16x32_bf16 v[124:127], a[148:151], v[60:63], v[124:127]
	v_mfma_f32_16x16x32_bf16 v[132:135], a[152:155], v[60:63], v[132:135]
	v_mfma_f32_16x16x32_bf16 v[140:143], a[156:159], v[60:63], v[140:143]
	ds_read_b128 v[48:51], v10 offset:14336
	ds_read_b128 v[52:55], v10 offset:15360
	ds_read_b128 v[56:59], v13 offset:14336
	ds_read_b128 v[60:63], v13 offset:15360
	s_waitcnt lgkmcnt(4)
	v_mfma_f32_16x16x32_bf16 v[16:19], a[128:131], v[64:67], v[16:19]
	v_mfma_f32_16x16x32_bf16 v[24:27], a[132:135], v[64:67], v[24:27]
	v_mfma_f32_16x16x32_bf16 v[32:35], a[136:139], v[64:67], v[32:35]
	v_mfma_f32_16x16x32_bf16 v[40:43], a[140:143], v[64:67], v[40:43]
	v_mfma_f32_16x16x32_bf16 v[20:23], a[128:131], v[68:71], v[20:23]
	v_mfma_f32_16x16x32_bf16 v[28:31], a[132:135], v[68:71], v[28:31]
	v_mfma_f32_16x16x32_bf16 v[36:39], a[136:139], v[68:71], v[36:39]
	v_mfma_f32_16x16x32_bf16 v[44:47], a[140:143], v[68:71], v[44:47]
	v_mfma_f32_16x16x32_bf16 v[112:115], a[128:131], v[72:75], v[112:115]
	v_mfma_f32_16x16x32_bf16 v[120:123], a[132:135], v[72:75], v[120:123]
	v_mfma_f32_16x16x32_bf16 v[128:131], a[136:139], v[72:75], v[128:131]
	v_mfma_f32_16x16x32_bf16 v[136:139], a[140:143], v[72:75], v[136:139]
	v_mfma_f32_16x16x32_bf16 v[116:119], a[128:131], v[76:79], v[116:119]
	v_mfma_f32_16x16x32_bf16 v[124:127], a[132:135], v[76:79], v[124:127]
	v_mfma_f32_16x16x32_bf16 v[132:135], a[136:139], v[76:79], v[132:135]
	v_mfma_f32_16x16x32_bf16 v[140:143], a[140:143], v[76:79], v[140:143]
	s_waitcnt vmcnt(16)
	ds_read_b64_tr_b16 a[112:113], v4 offset:8192
	ds_read_b64_tr_b16 a[114:115], v4 offset:8704
	ds_read_b64_tr_b16 a[116:117], v5 offset:8192
	ds_read_b64_tr_b16 a[118:119], v5 offset:8704
	ds_read_b64_tr_b16 a[120:121], v6 offset:8192
	ds_read_b64_tr_b16 a[122:123], v6 offset:8704
	ds_read_b64_tr_b16 a[124:125], v7 offset:8192
	ds_read_b64_tr_b16 a[126:127], v7 offset:8704
	s_waitcnt lgkmcnt(0)
	s_add_u32 m0, s65, 8192
	s_mov_b32 s63, 786432
	buffer_load_dwordx4 v1, s[44:47], s63 offen lds
	s_add_u32 m0, s65, 9216
	s_mov_b32 s63, 786432
	buffer_load_dwordx4 v2, s[44:47], s63 offen lds
	s_add_u32 m0, s65, 10240
	s_mov_b32 s63, 983040
	buffer_load_dwordx4 v1, s[44:47], s63 offen lds
	s_add_u32 m0, s65, 11264
	s_mov_b32 s63, 983040
	buffer_load_dwordx4 v2, s[44:47], s63 offen lds
	v_mov_b32 v153, 128
	buffer_load_dwordx3 v[150:152], v153, s[40:43], 0 offen sc1
	ds_read_b128 v[64:67], v10 offset:12288
	ds_read_b128 v[68:71], v10 offset:13312
	ds_read_b128 v[72:75], v13 offset:12288
	ds_read_b128 v[76:79], v13 offset:13312
	s_waitcnt lgkmcnt(4)
	v_mfma_f32_16x16x32_bf16 v[16:19], a[112:115], v[48:51], v[16:19]
	v_mfma_f32_16x16x32_bf16 v[24:27], a[116:119], v[48:51], v[24:27]
	v_mfma_f32_16x16x32_bf16 v[32:35], a[120:123], v[48:51], v[32:35]
	v_mfma_f32_16x16x32_bf16 v[40:43], a[124:127], v[48:51], v[40:43]
	v_mfma_f32_16x16x32_bf16 v[20:23], a[112:115], v[52:55], v[20:23]
	v_mfma_f32_16x16x32_bf16 v[28:31], a[116:119], v[52:55], v[28:31]
	v_mfma_f32_16x16x32_bf16 v[36:39], a[120:123], v[52:55], v[36:39]
	v_mfma_f32_16x16x32_bf16 v[44:47], a[124:127], v[52:55], v[44:47]
	v_mfma_f32_16x16x32_bf16 v[112:115], a[112:115], v[56:59], v[112:115]
	v_mfma_f32_16x16x32_bf16 v[120:123], a[116:119], v[56:59], v[120:123]
	v_mfma_f32_16x16x32_bf16 v[128:131], a[120:123], v[56:59], v[128:131]
	v_mfma_f32_16x16x32_bf16 v[136:139], a[124:127], v[56:59], v[136:139]
	v_mfma_f32_16x16x32_bf16 v[116:119], a[112:115], v[60:63], v[116:119]
	v_mfma_f32_16x16x32_bf16 v[124:127], a[116:119], v[60:63], v[124:127]
	v_mfma_f32_16x16x32_bf16 v[132:135], a[120:123], v[60:63], v[132:135]
	v_mfma_f32_16x16x32_bf16 v[140:143], a[124:127], v[60:63], v[140:143]
	s_waitcnt vmcnt(17)
	ds_read_b64_tr_b16 a[96:97], v4 offset:12288
	ds_read_b64_tr_b16 a[98:99], v4 offset:12800
	ds_read_b64_tr_b16 a[100:101], v5 offset:12288
	ds_read_b64_tr_b16 a[102:103], v5 offset:12800
	ds_read_b64_tr_b16 a[104:105], v6 offset:12288
	ds_read_b64_tr_b16 a[106:107], v6 offset:12800
	ds_read_b64_tr_b16 a[108:109], v7 offset:12288
	ds_read_b64_tr_b16 a[110:111], v7 offset:12800
	s_waitcnt lgkmcnt(0)
	s_add_u32 m0, s65, 12288
	s_mov_b32 s63, 393216
	buffer_load_dwordx4 v1, s[44:47], s63 offen lds
	s_add_u32 m0, s65, 13312
	s_mov_b32 s63, 393216
	buffer_load_dwordx4 v2, s[44:47], s63 offen lds
	s_add_u32 m0, s65, 14336
	s_mov_b32 s63, 589824
	buffer_load_dwordx4 v1, s[44:47], s63 offen lds
	s_add_u32 m0, s65, 15360
	s_mov_b32 s63, 589824
	buffer_load_dwordx4 v2, s[44:47], s63 offen lds
	ds_read_b128 v[48:51], v10 offset:10240
	ds_read_b128 v[52:55], v10 offset:11264
	ds_read_b128 v[56:59], v13 offset:10240
	ds_read_b128 v[60:63], v13 offset:11264
	s_waitcnt lgkmcnt(4)
	v_mfma_f32_16x16x32_bf16 v[16:19], a[96:99], v[64:67], v[16:19]
	v_mfma_f32_16x16x32_bf16 v[24:27], a[100:103], v[64:67], v[24:27]
	v_mfma_f32_16x16x32_bf16 v[32:35], a[104:107], v[64:67], v[32:35]
	v_mfma_f32_16x16x32_bf16 v[40:43], a[108:111], v[64:67], v[40:43]
	v_mfma_f32_16x16x32_bf16 v[20:23], a[96:99], v[68:71], v[20:23]
	v_mfma_f32_16x16x32_bf16 v[28:31], a[100:103], v[68:71], v[28:31]
	v_mfma_f32_16x16x32_bf16 v[36:39], a[104:107], v[68:71], v[36:39]
	v_mfma_f32_16x16x32_bf16 v[44:47], a[108:111], v[68:71], v[44:47]
	v_mfma_f32_16x16x32_bf16 v[112:115], a[96:99], v[72:75], v[112:115]
	v_mfma_f32_16x16x32_bf16 v[120:123], a[100:103], v[72:75], v[120:123]
	v_mfma_f32_16x16x32_bf16 v[128:131], a[104:107], v[72:75], v[128:131]
	v_mfma_f32_16x16x32_bf16 v[136:139], a[108:111], v[72:75], v[136:139]
	v_mfma_f32_16x16x32_bf16 v[116:119], a[96:99], v[76:79], v[116:119]
	v_mfma_f32_16x16x32_bf16 v[124:127], a[100:103], v[76:79], v[124:127]
	v_mfma_f32_16x16x32_bf16 v[132:135], a[104:107], v[76:79], v[132:135]
	v_mfma_f32_16x16x32_bf16 v[140:143], a[108:111], v[76:79], v[140:143]
	s_waitcnt vmcnt(17)
	ds_read_b64_tr_b16 a[80:81], v4 offset:16384
	ds_read_b64_tr_b16 a[82:83], v4 offset:16896
	ds_read_b64_tr_b16 a[84:85], v5 offset:16384
	ds_read_b64_tr_b16 a[86:87], v5 offset:16896
	ds_read_b64_tr_b16 a[88:89], v6 offset:16384
	ds_read_b64_tr_b16 a[90:91], v6 offset:16896
	ds_read_b64_tr_b16 a[92:93], v7 offset:16384
	ds_read_b64_tr_b16 a[94:95], v7 offset:16896
	s_waitcnt lgkmcnt(0)
	s_add_u32 m0, s65, 16384
	s_mov_b32 s63, 0
	buffer_load_dwordx4 v1, s[44:47], s63 offen lds
	s_add_u32 m0, s65, 17408
	s_mov_b32 s63, 0
	buffer_load_dwordx4 v2, s[44:47], s63 offen lds
	s_add_u32 m0, s65, 18432
	s_mov_b32 s63, 196608
	buffer_load_dwordx4 v1, s[44:47], s63 offen lds
	s_add_u32 m0, s65, 19456
	s_mov_b32 s63, 196608
	buffer_load_dwordx4 v2, s[44:47], s63 offen lds
	ds_read_b128 v[64:67], v10 offset:8192
	ds_read_b128 v[68:71], v10 offset:9216
	ds_read_b128 v[72:75], v13 offset:8192
	ds_read_b128 v[76:79], v13 offset:9216
	s_waitcnt lgkmcnt(4)
	v_mfma_f32_16x16x32_bf16 v[16:19], a[80:83], v[48:51], v[16:19]
	v_mfma_f32_16x16x32_bf16 v[24:27], a[84:87], v[48:51], v[24:27]
	v_mfma_f32_16x16x32_bf16 v[32:35], a[88:91], v[48:51], v[32:35]
	v_mfma_f32_16x16x32_bf16 v[40:43], a[92:95], v[48:51], v[40:43]
	v_mfma_f32_16x16x32_bf16 v[20:23], a[80:83], v[52:55], v[20:23]
	v_mfma_f32_16x16x32_bf16 v[28:31], a[84:87], v[52:55], v[28:31]
	v_mfma_f32_16x16x32_bf16 v[36:39], a[88:91], v[52:55], v[36:39]
	v_mfma_f32_16x16x32_bf16 v[44:47], a[92:95], v[52:55], v[44:47]
	v_mfma_f32_16x16x32_bf16 v[112:115], a[80:83], v[56:59], v[112:115]
	v_mfma_f32_16x16x32_bf16 v[120:123], a[84:87], v[56:59], v[120:123]
	v_mfma_f32_16x16x32_bf16 v[128:131], a[88:91], v[56:59], v[128:131]
	v_mfma_f32_16x16x32_bf16 v[136:139], a[92:95], v[56:59], v[136:139]
	v_mfma_f32_16x16x32_bf16 v[116:119], a[80:83], v[60:63], v[116:119]
	v_mfma_f32_16x16x32_bf16 v[124:127], a[84:87], v[60:63], v[124:127]
	v_mfma_f32_16x16x32_bf16 v[132:135], a[88:91], v[60:63], v[132:135]
	v_mfma_f32_16x16x32_bf16 v[140:143], a[92:95], v[60:63], v[140:143]
	s_waitcnt vmcnt(17)
	ds_read_b64_tr_b16 a[64:65], v4 offset:0
	ds_read_b64_tr_b16 a[66:67], v4 offset:512
	ds_read_b64_tr_b16 a[68:69], v5 offset:0
	ds_read_b64_tr_b16 a[70:71], v5 offset:512
	ds_read_b64_tr_b16 a[72:73], v6 offset:0
	ds_read_b64_tr_b16 a[74:75], v6 offset:512
	ds_read_b64_tr_b16 a[76:77], v7 offset:0
	ds_read_b64_tr_b16 a[78:79], v7 offset:512
	s_waitcnt lgkmcnt(0)
	ds_read_b128 v[48:51], v10 offset:6144
	ds_read_b128 v[52:55], v10 offset:7168
	ds_read_b128 v[56:59], v13 offset:6144
	ds_read_b128 v[60:63], v13 offset:7168
	s_waitcnt lgkmcnt(4)
	v_mfma_f32_16x16x32_bf16 v[16:19], a[64:67], v[64:67], v[16:19]
	v_mfma_f32_16x16x32_bf16 v[24:27], a[68:71], v[64:67], v[24:27]
	v_mfma_f32_16x16x32_bf16 v[32:35], a[72:75], v[64:67], v[32:35]
	v_mfma_f32_16x16x32_bf16 v[40:43], a[76:79], v[64:67], v[40:43]
	v_mfma_f32_16x16x32_bf16 v[20:23], a[64:67], v[68:71], v[20:23]
	v_mfma_f32_16x16x32_bf16 v[28:31], a[68:71], v[68:71], v[28:31]
	v_mfma_f32_16x16x32_bf16 v[36:39], a[72:75], v[68:71], v[36:39]
	v_mfma_f32_16x16x32_bf16 v[44:47], a[76:79], v[68:71], v[44:47]
	v_mfma_f32_16x16x32_bf16 v[112:115], a[64:67], v[72:75], v[112:115]
	v_mfma_f32_16x16x32_bf16 v[120:123], a[68:71], v[72:75], v[120:123]
	v_mfma_f32_16x16x32_bf16 v[128:131], a[72:75], v[72:75], v[128:131]
	v_mfma_f32_16x16x32_bf16 v[136:139], a[76:79], v[72:75], v[136:139]
	v_mfma_f32_16x16x32_bf16 v[116:119], a[64:67], v[76:79], v[116:119]
	v_mfma_f32_16x16x32_bf16 v[124:127], a[68:71], v[76:79], v[124:127]
	v_mfma_f32_16x16x32_bf16 v[132:135], a[72:75], v[76:79], v[132:135]
	v_mfma_f32_16x16x32_bf16 v[140:143], a[76:79], v[76:79], v[140:143]
	s_waitcnt vmcnt(13)
	ds_read_b64_tr_b16 a[48:49], v4 offset:4096
	ds_read_b64_tr_b16 a[50:51], v4 offset:4608
	ds_read_b64_tr_b16 a[52:53], v5 offset:4096
	ds_read_b64_tr_b16 a[54:55], v5 offset:4608
	ds_read_b64_tr_b16 a[56:57], v6 offset:4096
	ds_read_b64_tr_b16 a[58:59], v6 offset:4608
	ds_read_b64_tr_b16 a[60:61], v7 offset:4096
	ds_read_b64_tr_b16 a[62:63], v7 offset:4608
	s_waitcnt lgkmcnt(0)
	ds_read_b128 v[64:67], v10 offset:4096
	ds_read_b128 v[68:71], v10 offset:5120
	ds_read_b128 v[72:75], v13 offset:4096
	ds_read_b128 v[76:79], v13 offset:5120
	s_waitcnt lgkmcnt(4)
	v_mfma_f32_16x16x32_bf16 v[16:19], a[48:51], v[48:51], v[16:19]
	v_mfma_f32_16x16x32_bf16 v[24:27], a[52:55], v[48:51], v[24:27]
	v_mfma_f32_16x16x32_bf16 v[32:35], a[56:59], v[48:51], v[32:35]
	v_mfma_f32_16x16x32_bf16 v[40:43], a[60:63], v[48:51], v[40:43]
	v_mfma_f32_16x16x32_bf16 v[20:23], a[48:51], v[52:55], v[20:23]
	v_mfma_f32_16x16x32_bf16 v[28:31], a[52:55], v[52:55], v[28:31]
	v_mfma_f32_16x16x32_bf16 v[36:39], a[56:59], v[52:55], v[36:39]
	v_mfma_f32_16x16x32_bf16 v[44:47], a[60:63], v[52:55], v[44:47]
	v_mfma_f32_16x16x32_bf16 v[112:115], a[48:51], v[56:59], v[112:115]
	v_mfma_f32_16x16x32_bf16 v[120:123], a[52:55], v[56:59], v[120:123]
	v_mfma_f32_16x16x32_bf16 v[128:131], a[56:59], v[56:59], v[128:131]
	v_mfma_f32_16x16x32_bf16 v[136:139], a[60:63], v[56:59], v[136:139]
	v_mfma_f32_16x16x32_bf16 v[116:119], a[48:51], v[60:63], v[116:119]
	v_mfma_f32_16x16x32_bf16 v[124:127], a[52:55], v[60:63], v[124:127]
	v_mfma_f32_16x16x32_bf16 v[132:135], a[56:59], v[60:63], v[132:135]
	v_mfma_f32_16x16x32_bf16 v[140:143], a[60:63], v[60:63], v[140:143]
	s_waitcnt vmcnt(9)
	ds_read_b64_tr_b16 a[32:33], v4 offset:8192
	ds_read_b64_tr_b16 a[34:35], v4 offset:8704
	ds_read_b64_tr_b16 a[36:37], v5 offset:8192
	ds_read_b64_tr_b16 a[38:39], v5 offset:8704
	ds_read_b64_tr_b16 a[40:41], v6 offset:8192
	ds_read_b64_tr_b16 a[42:43], v6 offset:8704
	ds_read_b64_tr_b16 a[44:45], v7 offset:8192
	ds_read_b64_tr_b16 a[46:47], v7 offset:8704
	s_waitcnt lgkmcnt(0)
	ds_read_b128 v[48:51], v10 offset:2048
	ds_read_b128 v[52:55], v10 offset:3072
	ds_read_b128 v[56:59], v13 offset:2048
	ds_read_b128 v[60:63], v13 offset:3072
	s_waitcnt lgkmcnt(4)
	v_mfma_f32_16x16x32_bf16 v[16:19], a[32:35], v[64:67], v[16:19]
	v_mfma_f32_16x16x32_bf16 v[24:27], a[36:39], v[64:67], v[24:27]
	v_mfma_f32_16x16x32_bf16 v[32:35], a[40:43], v[64:67], v[32:35]
	v_mfma_f32_16x16x32_bf16 v[40:43], a[44:47], v[64:67], v[40:43]
	v_mfma_f32_16x16x32_bf16 v[20:23], a[32:35], v[68:71], v[20:23]
	v_mfma_f32_16x16x32_bf16 v[28:31], a[36:39], v[68:71], v[28:31]
	v_mfma_f32_16x16x32_bf16 v[36:39], a[40:43], v[68:71], v[36:39]
	v_mfma_f32_16x16x32_bf16 v[44:47], a[44:47], v[68:71], v[44:47]
	v_mfma_f32_16x16x32_bf16 v[112:115], a[32:35], v[72:75], v[112:115]
	v_mfma_f32_16x16x32_bf16 v[120:123], a[36:39], v[72:75], v[120:123]
	v_mfma_f32_16x16x32_bf16 v[128:131], a[40:43], v[72:75], v[128:131]
	v_mfma_f32_16x16x32_bf16 v[136:139], a[44:47], v[72:75], v[136:139]
	v_mfma_f32_16x16x32_bf16 v[116:119], a[32:35], v[76:79], v[116:119]
	v_mfma_f32_16x16x32_bf16 v[124:127], a[36:39], v[76:79], v[124:127]
	v_mfma_f32_16x16x32_bf16 v[132:135], a[40:43], v[76:79], v[132:135]
	v_mfma_f32_16x16x32_bf16 v[140:143], a[44:47], v[76:79], v[140:143]
	s_waitcnt vmcnt(4)
	ds_read_b64_tr_b16 a[16:17], v4 offset:12288
	ds_read_b64_tr_b16 a[18:19], v4 offset:12800
	ds_read_b64_tr_b16 a[20:21], v5 offset:12288
	ds_read_b64_tr_b16 a[22:23], v5 offset:12800
	ds_read_b64_tr_b16 a[24:25], v6 offset:12288
	ds_read_b64_tr_b16 a[26:27], v6 offset:12800
	ds_read_b64_tr_b16 a[28:29], v7 offset:12288
	ds_read_b64_tr_b16 a[30:31], v7 offset:12800
	s_waitcnt lgkmcnt(0)
	ds_read_b128 v[64:67], v10 offset:0
	ds_read_b128 v[68:71], v10 offset:1024
	ds_read_b128 v[72:75], v13 offset:0
	ds_read_b128 v[76:79], v13 offset:1024
	s_waitcnt lgkmcnt(4)
	v_mfma_f32_16x16x32_bf16 v[16:19], a[16:19], v[48:51], v[16:19]
	v_mfma_f32_16x16x32_bf16 v[24:27], a[20:23], v[48:51], v[24:27]
	v_mfma_f32_16x16x32_bf16 v[32:35], a[24:27], v[48:51], v[32:35]
	v_mfma_f32_16x16x32_bf16 v[40:43], a[28:31], v[48:51], v[40:43]
	v_mfma_f32_16x16x32_bf16 v[20:23], a[16:19], v[52:55], v[20:23]
	v_mfma_f32_16x16x32_bf16 v[28:31], a[20:23], v[52:55], v[28:31]
	v_mfma_f32_16x16x32_bf16 v[36:39], a[24:27], v[52:55], v[36:39]
	v_mfma_f32_16x16x32_bf16 v[44:47], a[28:31], v[52:55], v[44:47]
	v_mfma_f32_16x16x32_bf16 v[112:115], a[16:19], v[56:59], v[112:115]
	v_mfma_f32_16x16x32_bf16 v[120:123], a[20:23], v[56:59], v[120:123]
	v_mfma_f32_16x16x32_bf16 v[128:131], a[24:27], v[56:59], v[128:131]
	v_mfma_f32_16x16x32_bf16 v[136:139], a[28:31], v[56:59], v[136:139]
	v_mfma_f32_16x16x32_bf16 v[116:119], a[16:19], v[60:63], v[116:119]
	v_mfma_f32_16x16x32_bf16 v[124:127], a[20:23], v[60:63], v[124:127]
	v_mfma_f32_16x16x32_bf16 v[132:135], a[24:27], v[60:63], v[132:135]
	v_mfma_f32_16x16x32_bf16 v[140:143], a[28:31], v[60:63], v[140:143]
	s_waitcnt vmcnt(8)
	v_readfirstlane_b32 s6, v150
	s_nop 0
	s_cmp_ge_u32 s6, 256
	s_cbranch_scc1 L_swok_112
	v_mov_b32 v153, 128
L_sw_111:
	buffer_load_dwordx3 v[150:152], v153, s[40:43], 0 offen sc1
	s_waitcnt vmcnt(0)
	v_readfirstlane_b32 s6, v150
	s_nop 0
	s_cmp_ge_u32 s6, 256
	s_cbranch_scc1 L_swok_112
	s_sleep 4
	s_add_u32 s34, s34, 1
	s_cmp_lt_u32 s34, 0x40000
	s_cbranch_scc1 L_sw_111
	s_endpgm
L_swok_112:
	v_readfirstlane_b32 s74, v151
	v_readfirstlane_b32 s75, v152
	s_add_u32 s80, s61, 1
	s_cmp_eq_u32 s61, 2
	s_cselect_b32 s80, s72, s80
	s_cselect_b32 s81, 1, 0
	s_cselect_b32 s83, 3, s72
	s_lshl_b32 s73, s71, 2
	s_add_u32 s73, s73, s80
	s_lshl_b32 s73, s73, 19
	s_lshr_b32 s78, s74, s71
	s_xor_b32 s78, s78, s81
	s_and_b32 s78, s78, 1
	s_lshl_b32 s78, s78, 13
	s_add_u32 s73, s73, s78
	s_add_u32 s78, s71, s83
	s_bfe_u32 s79, s78, 0x10001
	s_lshl_b32 s79, s79, 14
	s_and_b32 s78, s78, 1
	s_lshl_b32 s78, s78, 12
	s_add_u32 s78, s78, s79
	s_add_u32 s73, s73, s78
	v_lshl_add_u32 v11, v0, 4, s73
	s_lshl_b32 s73, s71, 2
	s_add_u32 s73, s73, 0
	s_lshl_b32 s73, s73, 19
	s_lshr_b32 s78, s74, s71
	s_xor_b32 s78, s78, 0
	s_and_b32 s78, s78, 1
	s_lshl_b32 s78, s78, 13
	s_add_u32 s73, s73, s78
	v_add_u32 v12, s78, v12
	s_cmp_eq_u32 s61, 2
	s_cselect_b32 s73, 0xfe00000, s73
	s_add_u32 s78, s71, s72
	s_bfe_u32 s79, s78, 0x10001
	s_lshl_b32 s79, s79, 14
	s_and_b32 s78, s78, 1
	s_lshl_b32 s78, s78, 12
	s_add_u32 s78, s78, s79
	s_add_u32 s77, s73, s78
	s_add_u32 s78, s71, 3
	s_bfe_u32 s79, s78, 0x10001
	s_lshl_b32 s79, s79, 14
	s_and_b32 s78, s78, 1
	s_lshl_b32 s78, s78, 12
	s_add_u32 s78, s78, s79
	s_add_u32 s73, s73, s78
	s_lshl_b32 s78, s61, 11
	s_add_u32 s77, s77, s78
	v_lshl_add_u32 v96, v0, 4, s77
	s_lshl_b32 s78, s72, 10
	s_add_u32 s73, s73, s78
	v_lshl_add_u32 v97, v0, 4, s73
	v_cmp_le_u32 vcc, 32, v0
	s_and_b32 s78, s74, 1
	s_lshl_b32 s78, s78, 13
	s_add_u32 s78, s78, 0x180000
	s_and_b32 s79, s74, 16
	s_lshl_b32 s79, s79, 9
	s_add_u32 s79, s79, 0x980000
	v_mov_b32 v150, s78
	v_mov_b32 v151, s79
	v_cndmask_b32 v150, v150, v151, vcc
	s_mul_i32 s73, s72, 3
	s_add_u32 s73, s73, 1
	s_cmp_eq_u32 s72, 0
	s_cselect_b32 s73, 0, s73
	s_lshr_b32 s78, s71, 3
	s_add_u32 s73, s73, s78
	s_cmp_ge_u32 s71, 24
	s_cselect_b32 s78, s72, 0
	s_add_u32 s79, s78, 9
	s_cmp_lg_u32 s78, 0
	s_cselect_b32 s73, s79, s73
	s_lshr_b32 s78, s73, 3
	s_lshl_b32 s78, s78, 14
	s_and_b32 s73, s73, 7
	s_lshl_b32 s73, s73, 10
	s_add_u32 s73, s73, s78
	s_and_b32 s78, s71, 7
	s_lshl_b32 s78, s78, 7
	s_add_u32 s73, s73, s78
	v_and_b32 v151, 31, v0
	v_lshl_add_u32 v150, v151, 2, v150
	v_add_u32 v99, s73, v150
	s_mov_b32 s69, 0xfe00000
	s_mov_b32 s76, 0
	v_mov_b32 v150, s69
	v_cmp_gt_u32 vcc, 16, v0
	s_nop 1
	v_cndmask_b32 v12, v150, v12, vcc
	v_mov_b32 v100, -1
	v_mov_b32 v101, -1
	v_mov_b32 v102, -1
	v_mov_b32 v103, -1
	buffer_store_dwordx4 v[100:103], v96, s[36:39], s76 offen offset:0 sc1
	buffer_store_dwordx4 v[100:103], v96, s[36:39], s76 offen offset:1024 sc1
	buffer_store_dwordx4 v[100:103], v97, s[36:39], s76 offen sc1
	s_add_u32 s76, s76, 32768
	buffer_store_dwordx4 v[100:103], v96, s[36:39], s76 offen offset:0 sc1
	buffer_store_dwordx4 v[100:103], v96, s[36:39], s76 offen offset:1024 sc1
	buffer_store_dwordx4 v[100:103], v97, s[36:39], s76 offen sc1
	s_add_u32 s76, s76, 32768
	s_waitcnt vmcnt(6)
	ds_read_b64_tr_b16 a[0:1], v4 offset:16384
	ds_read_b64_tr_b16 a[2:3], v4 offset:16896
	ds_read_b64_tr_b16 a[4:5], v5 offset:16384
	ds_read_b64_tr_b16 a[6:7], v5 offset:16896
	ds_read_b64_tr_b16 a[8:9], v6 offset:16384
	ds_read_b64_tr_b16 a[10:11], v6 offset:16896
	ds_read_b64_tr_b16 a[12:13], v7 offset:16384
	ds_read_b64_tr_b16 a[14:15], v7 offset:16896
	s_waitcnt lgkmcnt(0)
	s_waitcnt lgkmcnt(0)
	v_mfma_f32_16x16x32_bf16 v[16:19], a[0:3], v[64:67], v[16:19]
	v_mfma_f32_16x16x32_bf16 v[24:27], a[4:7], v[64:67], v[24:27]
	v_mfma_f32_16x16x32_bf16 v[32:35], a[8:11], v[64:67], v[32:35]
	v_mfma_f32_16x16x32_bf16 v[40:43], a[12:15], v[64:67], v[40:43]
	v_mfma_f32_16x16x32_bf16 v[20:23], a[0:3], v[68:71], v[20:23]
	v_mfma_f32_16x16x32_bf16 v[28:31], a[4:7], v[68:71], v[28:31]
	v_mfma_f32_16x16x32_bf16 v[36:39], a[8:11], v[68:71], v[36:39]
	v_mfma_f32_16x16x32_bf16 v[44:47], a[12:15], v[68:71], v[44:47]
	v_mfma_f32_16x16x32_bf16 v[112:115], a[0:3], v[72:75], v[112:115]
	v_mfma_f32_16x16x32_bf16 v[120:123], a[4:7], v[72:75], v[120:123]
	v_mfma_f32_16x16x32_bf16 v[128:131], a[8:11], v[72:75], v[128:131]
	v_mfma_f32_16x16x32_bf16 v[136:139], a[12:15], v[72:75], v[136:139]
	v_mfma_f32_16x16x32_bf16 v[116:119], a[0:3], v[76:79], v[116:119]
	v_mfma_f32_16x16x32_bf16 v[124:127], a[4:7], v[76:79], v[124:127]
	v_mfma_f32_16x16x32_bf16 v[132:135], a[8:11], v[76:79], v[132:135]
	v_mfma_f32_16x16x32_bf16 v[140:143], a[12:15], v[76:79], v[140:143]
	s_mov_b32 s69, 0
	v_cvt_pk_bf16_f32 v80, v16, v17
	v_cvt_pk_bf16_f32 v81, v18, v19
	v_cvt_pk_bf16_f32 v82, v24, v25
	v_cvt_pk_bf16_f32 v83, v26, v27
	buffer_store_dwordx4 v[80:83], v11, s[36:39], s69 offen offset:0 sc1
	v_cvt_pk_bf16_f32 v84, v20, v21
	v_cvt_pk_bf16_f32 v85, v22, v23
	v_cvt_pk_bf16_f32 v86, v28, v29
	v_cvt_pk_bf16_f32 v87, v30, v31
	buffer_store_dwordx4 v[84:87], v11, s[36:39], s69 offen offset:1024 sc1
	v_cvt_pk_bf16_f32 v88, v32, v33
	v_cvt_pk_bf16_f32 v89, v34, v35
	v_cvt_pk_bf16_f32 v90, v40, v41
	v_cvt_pk_bf16_f32 v91, v42, v43
	buffer_store_dwordx4 v[88:91], v11, s[36:39], s69 offen offset:2048 sc1
	v_cvt_pk_bf16_f32 v92, v36, v37
	v_cvt_pk_bf16_f32 v93, v38, v39
	v_cvt_pk_bf16_f32 v94, v44, v45
	v_cvt_pk_bf16_f32 v95, v46, v47
	buffer_store_dwordx4 v[92:95], v11, s[36:39], s69 offen offset:3072 sc1
	s_mov_b32 s69, 32768
	v_cvt_pk_bf16_f32 v80, v112, v113
	v_cvt_pk_bf16_f32 v81, v114, v115
	v_cvt_pk_bf16_f32 v82, v120, v121
	v_cvt_pk_bf16_f32 v83, v122, v123
	buffer_store_dwordx4 v[80:83], v11, s[36:39], s69 offen offset:0 sc1
	v_cvt_pk_bf16_f32 v84, v116, v117
	v_cvt_pk_bf16_f32 v85, v118, v119
	v_cvt_pk_bf16_f32 v86, v124, v125
	v_cvt_pk_bf16_f32 v87, v126, v127
	buffer_store_dwordx4 v[84:87], v11, s[36:39], s69 offen offset:1024 sc1
	v_cvt_pk_bf16_f32 v88, v128, v129
	v_cvt_pk_bf16_f32 v89, v130, v131
	v_cvt_pk_bf16_f32 v90, v136, v137
	v_cvt_pk_bf16_f32 v91, v138, v139
	buffer_store_dwordx4 v[88:91], v11, s[36:39], s69 offen offset:2048 sc1
	v_cvt_pk_bf16_f32 v92, v132, v133
	v_cvt_pk_bf16_f32 v93, v134, v135
	v_cvt_pk_bf16_f32 v94, v140, v141
	v_cvt_pk_bf16_f32 v95, v142, v143
	buffer_store_dwordx4 v[92:95], v11, s[36:39], s69 offen offset:3072 sc1
	s_barrier
	s_add_u32 m0, s67, 0
	s_nop 0
	buffer_load_dwordx4 v8, s[48:51], s68 offen offset:0 lds
	s_add_u32 m0, s67, 1024
	s_nop 0
	buffer_load_dwordx4 v9, s[48:51], s68 offen offset:0 lds
	s_add_u32 m0, s67, 1984
	s_nop 0
	buffer_load_dwordx4 v8, s[48:51], s68 offen offset:64 lds
	s_add_u32 m0, s67, 3008
	s_nop 0
	buffer_load_dwordx4 v9, s[48:51], s68 offen offset:64 lds
	s_add_u32 m0, s67, 3968
	s_nop 0
	buffer_load_dwordx4 v8, s[48:51], s68 offen offset:128 lds
	s_add_u32 m0, s67, 4992
	s_nop 0
	buffer_load_dwordx4 v9, s[48:51], s68 offen offset:128 lds
	s_add_u32 m0, s67, 5952
	s_nop 0
	buffer_load_dwordx4 v8, s[48:51], s68 offen offset:192 lds
	s_add_u32 m0, s67, 6976
	s_nop 0
	buffer_load_dwordx4 v9, s[48:51], s68 offen offset:192 lds
	s_add_u32 m0, s67, 7936
	s_nop 0
	buffer_load_dwordx4 v8, s[48:51], s68 offen offset:256 lds
	s_add_u32 m0, s67, 8960
	s_nop 0
	buffer_load_dwordx4 v9, s[48:51], s68 offen offset:256 lds
	s_add_u32 s67, s67, 40960
	s_add_u32 s68, s68, 40960
	s_sub_u32 s67, s67, 122880
	s_mov_b32 s69, 0xfe00000
	s_mov_b32 s66, 2
	s_mov_b32 s70, 81920
	v_mov_b32 v106, s66
	s_waitcnt vmcnt(10)
	buffer_store_dword v106, v12, s[36:39], 0 offen sc1
	s_add_u32 m0, s67, 0
	s_nop 0
	buffer_load_dwordx4 v8, s[48:51], s68 offen offset:0 lds
	s_add_u32 m0, s67, 1024
	s_nop 0
	buffer_load_dwordx4 v9, s[48:51], s68 offen offset:0 lds
	s_add_u32 m0, s67, 1984
	s_nop 0
	buffer_load_dwordx4 v8, s[48:51], s68 offen offset:64 lds
	s_add_u32 m0, s67, 3008
	s_nop 0
	buffer_load_dwordx4 v9, s[48:51], s68 offen offset:64 lds
	s_add_u32 m0, s67, 3968
	s_nop 0
	buffer_load_dwordx4 v8, s[48:51], s68 offen offset:128 lds
	s_add_u32 m0, s67, 4992
	s_nop 0
	buffer_load_dwordx4 v9, s[48:51], s68 offen offset:128 lds
	s_add_u32 m0, s67, 5952
	s_nop 0
	buffer_load_dwordx4 v8, s[48:51], s68 offen offset:192 lds
	s_add_u32 m0, s67, 6976
	s_nop 0
	buffer_load_dwordx4 v9, s[48:51], s68 offen offset:192 lds
	s_add_u32 m0, s67, 7936
	s_nop 0
	buffer_load_dwordx4 v8, s[48:51], s68 offen offset:256 lds
	s_add_u32 m0, s67, 8960
	s_nop 0
	buffer_load_dwordx4 v9, s[48:51], s68 offen offset:256 lds
	s_add_u32 s67, s67, 40960
	s_add_u32 s68, s68, 40960
	s_waitcnt vmcnt(11)
	s_branch L_projk
L_ps_106:
	s_add_u32 m0, s65, 0
	s_mov_b32 s63, 7471104
	buffer_load_dwordx4 v1, s[44:47], s63 offen lds
	s_add_u32 m0, s65, 1024
	s_mov_b32 s63, 7471104
	buffer_load_dwordx4 v2, s[44:47], s63 offen lds
	s_add_u32 m0, s65, 2048
	s_mov_b32 s63, 7667712
	buffer_load_dwordx4 v1, s[44:47], s63 offen lds
	s_add_u32 m0, s65, 3072
	s_mov_b32 s63, 7667712
	buffer_load_dwordx4 v2, s[44:47], s63 offen lds
	s_add_u32 m0, s65, 4096
	s_mov_b32 s63, 7077888
	buffer_load_dwordx4 v1, s[44:47], s63 offen lds
	s_add_u32 m0, s65, 5120
	s_mov_b32 s63, 7077888
	buffer_load_dwordx4 v2, s[44:47], s63 offen lds
	s_add_u32 m0, s65, 6144
	s_mov_b32 s63, 7274496
	buffer_load_dwordx4 v1, s[44:47], s63 offen lds
	s_add_u32 m0, s65, 7168
	s_mov_b32 s63, 7274496
	buffer_load_dwordx4 v2, s[44:47], s63 offen lds
	s_add_u32 m0, s65, 8192
	s_mov_b32 s63, 6684672
	buffer_load_dwordx4 v1, s[44:47], s63 offen lds
	s_add_u32 m0, s65, 9216
	s_mov_b32 s63, 6684672
	buffer_load_dwordx4 v2, s[44:47], s63 offen lds
	s_add_u32 m0, s65, 10240
	s_mov_b32 s63, 6881280
	buffer_load_dwordx4 v1, s[44:47], s63 offen lds
	s_add_u32 m0, s65, 11264
	s_mov_b32 s63, 6881280
	buffer_load_dwordx4 v2, s[44:47], s63 offen lds
	s_waitcnt vmcnt(12)
	s_barrier
	s_lshl_b32 s6, s5, 12
	s_add_u32 s6, s6, 96
	v_mov_b32 v150, s6
	v_mov_b32 v151, 1
	s_mov_b64 exec, 1
	buffer_atomic_add v151, v150, s[40:43], 0 offen
	s_mov_b64 exec, -1
	s_add_u32 m0, s67, 0
	s_nop 0
	buffer_load_dwordx4 v8, s[48:51], s68 offen offset:0 lds
	s_add_u32 m0, s67, 1024
	s_nop 0
	buffer_load_dwordx4 v9, s[48:51], s68 offen offset:0 lds
	s_add_u32 m0, s67, 1984
	s_nop 0
	buffer_load_dwordx4 v8, s[48:51], s68 offen offset:64 lds
	s_add_u32 m0, s67, 3008
	s_nop 0
	buffer_load_dwordx4 v9, s[48:51], s68 offen offset:64 lds
	s_add_u32 m0, s67, 3968
	s_nop 0
	buffer_load_dwordx4 v8, s[48:51], s68 offen offset:128 lds
	s_add_u32 m0, s67, 4992
	s_nop 0
	buffer_load_dwordx4 v9, s[48:51], s68 offen offset:128 lds
	s_add_u32 m0, s67, 5952
	s_nop 0
	buffer_load_dwordx4 v8, s[48:51], s68 offen offset:192 lds
	s_add_u32 m0, s67, 6976
	s_nop 0
	buffer_load_dwordx4 v9, s[48:51], s68 offen offset:192 lds
	s_add_u32 m0, s67, 7936
	s_nop 0
	buffer_load_dwordx4 v8, s[48:51], s68 offen offset:256 lds
	s_add_u32 m0, s67, 8960
	s_nop 0
	buffer_load_dwordx4 v9, s[48:51], s68 offen offset:256 lds
	s_add_u32 s67, s67, 40960
	s_add_u32 s68, s68, 40960
	s_add_u32 m0, s65, 12288
	s_mov_b32 s63, 6291456
	buffer_load_dwordx4 v1, s[44:47], s63 offen lds
	s_add_u32 m0, s65, 13312
	s_mov_b32 s63, 6291456
	buffer_load_dwordx4 v2, s[44:47], s63 offen lds
	s_add_u32 m0, s65, 14336
	s_mov_b32 s63, 6488064
	buffer_load_dwordx4 v1, s[44:47], s63 offen lds
	s_add_u32 m0, s65, 15360
	s_mov_b32 s63, 6488064
	buffer_load_dwordx4 v2, s[44:47], s63 offen lds
	s_add_u32 m0, s65, 16384
	s_mov_b32 s63, 5898240
	buffer_load_dwordx4 v1, s[44:47], s63 offen lds
	s_add_u32 m0, s65, 17408
	s_mov_b32 s63, 5898240
	buffer_load_dwordx4 v2, s[44:47], s63 offen lds
	s_add_u32 m0, s65, 18432
	s_mov_b32 s63, 6094848
	buffer_load_dwordx4 v1, s[44:47], s63 offen lds
	s_add_u32 m0, s65, 19456
	s_mov_b32 s63, 6094848
	buffer_load_dwordx4 v2, s[44:47], s63 offen lds
	v_add_u32 v13, 40960, v10
	s_waitcnt vmcnt(27)
	ds_read_b64_tr_b16 v[240:241], v4 offset:0
	ds_read_b64_tr_b16 v[242:243], v4 offset:512
	ds_read_b64_tr_b16 v[244:245], v5 offset:0
	ds_read_b64_tr_b16 v[246:247], v5 offset:512
	ds_read_b64_tr_b16 v[248:249], v6 offset:0
	ds_read_b64_tr_b16 v[250:251], v6 offset:512
	ds_read_b64_tr_b16 v[252:253], v7 offset:0
	ds_read_b64_tr_b16 v[254:255], v7 offset:512
	s_waitcnt lgkmcnt(0)
	s_add_u32 m0, s65, 0
	s_mov_b32 s63, 5505024
	buffer_load_dwordx4 v1, s[44:47], s63 offen lds
	s_add_u32 m0, s65, 1024
	s_mov_b32 s63, 5505024
	buffer_load_dwordx4 v2, s[44:47], s63 offen lds
	s_add_u32 m0, s65, 2048
	s_mov_b32 s63, 5701632
	buffer_load_dwordx4 v1, s[44:47], s63 offen lds
	s_add_u32 m0, s65, 3072
	s_mov_b32 s63, 5701632
	buffer_load_dwordx4 v2, s[44:47], s63 offen lds
	s_waitcnt vmcnt(27)
	ds_read_b64_tr_b16 v[224:225], v4 offset:4096
	ds_read_b64_tr_b16 v[226:227], v4 offset:4608
	ds_read_b64_tr_b16 v[228:229], v5 offset:4096
	ds_read_b64_tr_b16 v[230:231], v5 offset:4608
	ds_read_b64_tr_b16 v[232:233], v6 offset:4096
	ds_read_b64_tr_b16 v[234:235], v6 offset:4608
	ds_read_b64_tr_b16 v[236:237], v7 offset:4096
	ds_read_b64_tr_b16 v[238:239], v7 offset:4608
	s_waitcnt lgkmcnt(0)
	s_add_u32 m0, s67, 0
	s_nop 0
	buffer_load_dwordx4 v8, s[48:51], s68 offen offset:0 lds
	s_add_u32 m0, s67, 1024
	s_nop 0
	buffer_load_dwordx4 v9, s[48:51], s68 offen offset:0 lds
	s_add_u32 m0, s67, 1984
	s_nop 0
	buffer_load_dwordx4 v8, s[48:51], s68 offen offset:64 lds
	s_add_u32 m0, s67, 3008
	s_nop 0
	buffer_load_dwordx4 v9, s[48:51], s68 offen offset:64 lds
	s_add_u32 m0, s67, 3968
	s_nop 0
	buffer_load_dwordx4 v8, s[48:51], s68 offen offset:128 lds
	s_add_u32 m0, s67, 4992
	s_nop 0
	buffer_load_dwordx4 v9, s[48:51], s68 offen offset:128 lds
	s_add_u32 m0, s67, 5952
	s_nop 0
	buffer_load_dwordx4 v8, s[48:51], s68 offen offset:192 lds
	s_add_u32 m0, s67, 6976
	s_nop 0
	buffer_load_dwordx4 v9, s[48:51], s68 offen offset:192 lds
	s_add_u32 m0, s67, 7936
	s_nop 0
	buffer_load_dwordx4 v8, s[48:51], s68 offen offset:256 lds
	s_add_u32 m0, s67, 8960
	s_nop 0
	buffer_load_dwordx4 v9, s[48:51], s68 offen offset:256 lds
	s_add_u32 s67, s67, 40960
	s_add_u32 s68, s68, 40960
	s_add_u32 m0, s65, 4096
	s_mov_b32 s63, 5111808
	buffer_load_dwordx4 v1, s[44:47], s63 offen lds
	s_add_u32 m0, s65, 5120
	s_mov_b32 s63, 5111808
	buffer_load_dwordx4 v2, s[44:47], s63 offen lds
	s_add_u32 m0, s65, 6144
	s_mov_b32 s63, 5308416
	buffer_load_dwordx4 v1, s[44:47], s63 offen lds
	s_add_u32 m0, s65, 7168
	s_mov_b32 s63, 5308416
	buffer_load_dwordx4 v2, s[44:47], s63 offen lds
	s_waitcnt vmcnt(37)
	ds_read_b64_tr_b16 v[208:209], v4 offset:8192
	ds_read_b64_tr_b16 v[210:211], v4 offset:8704
	ds_read_b64_tr_b16 v[212:213], v5 offset:8192
	ds_read_b64_tr_b16 v[214:215], v5 offset:8704
	ds_read_b64_tr_b16 v[216:217], v6 offset:8192
	ds_read_b64_tr_b16 v[218:219], v6 offset:8704
	ds_read_b64_tr_b16 v[220:221], v7 offset:8192
	ds_read_b64_tr_b16 v[222:223], v7 offset:8704
	s_waitcnt lgkmcnt(0)
	s_add_u32 m0, s65, 8192
	s_mov_b32 s63, 4718592
	buffer_load_dwordx4 v1, s[44:47], s63 offen lds
	s_add_u32 m0, s65, 9216
	s_mov_b32 s63, 4718592
	buffer_load_dwordx4 v2, s[44:47], s63 offen lds
	s_add_u32 m0, s65, 10240
	s_mov_b32 s63, 4915200
	buffer_load_dwordx4 v1, s[44:47], s63 offen lds
	s_add_u32 m0, s65, 11264
	s_mov_b32 s63, 4915200
	buffer_load_dwordx4 v2, s[44:47], s63 offen lds
	s_waitcnt vmcnt(26)
	ds_read_b64_tr_b16 v[192:193], v4 offset:12288
	ds_read_b64_tr_b16 v[194:195], v4 offset:12800
	ds_read_b64_tr_b16 v[196:197], v5 offset:12288
	ds_read_b64_tr_b16 v[198:199], v5 offset:12800
	ds_read_b64_tr_b16 v[200:201], v6 offset:12288
	ds_read_b64_tr_b16 v[202:203], v6 offset:12800
	ds_read_b64_tr_b16 v[204:205], v7 offset:12288
	ds_read_b64_tr_b16 v[206:207], v7 offset:12800
	s_waitcnt lgkmcnt(0)
	s_add_u32 m0, s65, 12288
	s_mov_b32 s63, 4325376
	buffer_load_dwordx4 v1, s[44:47], s63 offen lds
	s_add_u32 m0, s65, 13312
	s_mov_b32 s63, 4325376
	buffer_load_dwordx4 v2, s[44:47], s63 offen lds
	s_add_u32 m0, s65, 14336
	s_mov_b32 s63, 4521984
	buffer_load_dwordx4 v1, s[44:47], s63 offen lds
	s_add_u32 m0, s65, 15360
	s_mov_b32 s63, 4521984
	buffer_load_dwordx4 v2, s[44:47], s63 offen lds
	s_waitcnt vmcnt(26)
	ds_read_b64_tr_b16 a[240:241], v4 offset:16384
	ds_read_b64_tr_b16 a[242:243], v4 offset:16896
	ds_read_b64_tr_b16 a[244:245], v5 offset:16384
	ds_read_b64_tr_b16 a[246:247], v5 offset:16896
	ds_read_b64_tr_b16 a[248:249], v6 offset:16384
	ds_read_b64_tr_b16 a[250:251], v6 offset:16896
	ds_read_b64_tr_b16 a[252:253], v7 offset:16384
	ds_read_b64_tr_b16 a[254:255], v7 offset:16896
	s_waitcnt lgkmcnt(0)
	s_add_u32 m0, s65, 16384
	s_mov_b32 s63, 3932160
	buffer_load_dwordx4 v1, s[44:47], s63 offen lds
	s_add_u32 m0, s65, 17408
	s_mov_b32 s63, 3932160
	buffer_load_dwordx4 v2, s[44:47], s63 offen lds
	s_add_u32 m0, s65, 18432
	s_mov_b32 s63, 4128768
	buffer_load_dwordx4 v1, s[44:47], s63 offen lds
	s_add_u32 m0, s65, 19456
	s_mov_b32 s63, 4128768
	buffer_load_dwordx4 v2, s[44:47], s63 offen lds
	s_waitcnt vmcnt(26)
	ds_read_b64_tr_b16 a[224:225], v4 offset:0
	ds_read_b64_tr_b16 a[226:227], v4 offset:512
	ds_read_b64_tr_b16 a[228:229], v5 offset:0
	ds_read_b64_tr_b16 a[230:231], v5 offset:512
	ds_read_b64_tr_b16 a[232:233], v6 offset:0
	ds_read_b64_tr_b16 a[234:235], v6 offset:512
	ds_read_b64_tr_b16 a[236:237], v7 offset:0
	ds_read_b64_tr_b16 a[238:239], v7 offset:512
	s_waitcnt lgkmcnt(0)
	s_add_u32 m0, s65, 0
	s_mov_b32 s63, 3538944
	buffer_load_dwordx4 v1, s[44:47], s63 offen lds
	s_add_u32 m0, s65, 1024
	s_mov_b32 s63, 3538944
	buffer_load_dwordx4 v2, s[44:47], s63 offen lds
	s_add_u32 m0, s65, 2048
	s_mov_b32 s63, 3735552
	buffer_load_dwordx4 v1, s[44:47], s63 offen lds
	s_add_u32 m0, s65, 3072
	s_mov_b32 s63, 3735552
	buffer_load_dwordx4 v2, s[44:47], s63 offen lds
	s_waitcnt vmcnt(16)
	ds_read_b64_tr_b16 a[208:209], v4 offset:4096
	ds_read_b64_tr_b16 a[210:211], v4 offset:4608
	ds_read_b64_tr_b16 a[212:213], v5 offset:4096
	ds_read_b64_tr_b16 a[214:215], v5 offset:4608
	ds_read_b64_tr_b16 a[216:217], v6 offset:4096
	ds_read_b64_tr_b16 a[218:219], v6 offset:4608
	ds_read_b64_tr_b16 a[220:221], v7 offset:4096
	ds_read_b64_tr_b16 a[222:223], v7 offset:4608
	s_waitcnt lgkmcnt(0)
	s_add_u32 m0, s65, 4096
	s_mov_b32 s63, 3145728
	buffer_load_dwordx4 v1, s[44:47], s63 offen lds
	s_add_u32 m0, s65, 5120
	s_mov_b32 s63, 3145728
	buffer_load_dwordx4 v2, s[44:47], s63 offen lds
	s_add_u32 m0, s65, 6144
	s_mov_b32 s63, 3342336
	buffer_load_dwordx4 v1, s[44:47], s63 offen lds
	s_add_u32 m0, s65, 7168
	s_mov_b32 s63, 3342336
	buffer_load_dwordx4 v2, s[44:47], s63 offen lds
	s_waitcnt vmcnt(24)
	s_barrier
	ds_read_b128 v[48:51], v10 offset:38912
	ds_read_b128 v[52:55], v10 offset:39936
	ds_read_b128 v[56:59], v13 offset:38912
	ds_read_b128 v[60:63], v13 offset:39936
	ds_read_b128 v[64:67], v10 offset:36864
	ds_read_b128 v[68:71], v10 offset:37888
	ds_read_b128 v[72:75], v13 offset:36864
	ds_read_b128 v[76:79], v13 offset:37888
	s_waitcnt lgkmcnt(4)
	v_mfma_f32_16x16x32_bf16 v[16:19], v[48:51], v[240:243], 0
	v_mfma_f32_16x16x32_bf16 v[24:27], v[48:51], v[244:247], 0
	v_mfma_f32_16x16x32_bf16 v[32:35], v[48:51], v[248:251], 0
	v_mfma_f32_16x16x32_bf16 v[40:43], v[48:51], v[252:255], 0
	v_mfma_f32_16x16x32_bf16 v[20:23], v[52:55], v[240:243], 0
	v_mfma_f32_16x16x32_bf16 v[28:31], v[52:55], v[244:247], 0
	v_mfma_f32_16x16x32_bf16 v[36:39], v[52:55], v[248:251], 0
	v_mfma_f32_16x16x32_bf16 v[44:47], v[52:55], v[252:255], 0
	v_mfma_f32_16x16x32_bf16 v[112:115], v[56:59], v[240:243], 0
	v_mfma_f32_16x16x32_bf16 v[120:123], v[56:59], v[244:247], 0
	v_mfma_f32_16x16x32_bf16 v[128:131], v[56:59], v[248:251], 0
	v_mfma_f32_16x16x32_bf16 v[136:139], v[56:59], v[252:255], 0
	v_mfma_f32_16x16x32_bf16 v[116:119], v[60:63], v[240:243], 0
	v_mfma_f32_16x16x32_bf16 v[124:127], v[60:63], v[244:247], 0
	v_mfma_f32_16x16x32_bf16 v[132:135], v[60:63], v[248:251], 0
	v_mfma_f32_16x16x32_bf16 v[140:143], v[60:63], v[252:255], 0
	ds_read_b128 v[48:51], v10 offset:34816
	ds_read_b128 v[52:55], v10 offset:35840
	ds_read_b128 v[56:59], v13 offset:34816
	ds_read_b128 v[60:63], v13 offset:35840
	s_waitcnt lgkmcnt(4)
	v_mfma_f32_16x16x32_bf16 v[16:19], v[64:67], v[224:227], v[16:19]
	v_mfma_f32_16x16x32_bf16 v[24:27], v[64:67], v[228:231], v[24:27]
	v_mfma_f32_16x16x32_bf16 v[32:35], v[64:67], v[232:235], v[32:35]
	v_mfma_f32_16x16x32_bf16 v[40:43], v[64:67], v[236:239], v[40:43]
	v_mfma_f32_16x16x32_bf16 v[20:23], v[68:71], v[224:227], v[20:23]
	v_mfma_f32_16x16x32_bf16 v[28:31], v[68:71], v[228:231], v[28:31]
	v_mfma_f32_16x16x32_bf16 v[36:39], v[68:71], v[232:235], v[36:39]
	v_mfma_f32_16x16x32_bf16 v[44:47], v[68:71], v[236:239], v[44:47]
	v_mfma_f32_16x16x32_bf16 v[112:115], v[72:75], v[224:227], v[112:115]
	v_mfma_f32_16x16x32_bf16 v[120:123], v[72:75], v[228:231], v[120:123]
	v_mfma_f32_16x16x32_bf16 v[128:131], v[72:75], v[232:235], v[128:131]
	v_mfma_f32_16x16x32_bf16 v[136:139], v[72:75], v[236:239], v[136:139]
	v_mfma_f32_16x16x32_bf16 v[116:119], v[76:79], v[224:227], v[116:119]
	v_mfma_f32_16x16x32_bf16 v[124:127], v[76:79], v[228:231], v[124:127]
	v_mfma_f32_16x16x32_bf16 v[132:135], v[76:79], v[232:235], v[132:135]
	v_mfma_f32_16x16x32_bf16 v[140:143], v[76:79], v[236:239], v[140:143]
	s_waitcnt vmcnt(16)
	ds_read_b64_tr_b16 a[192:193], v4 offset:8192
	ds_read_b64_tr_b16 a[194:195], v4 offset:8704
	ds_read_b64_tr_b16 a[196:197], v5 offset:8192
	ds_read_b64_tr_b16 a[198:199], v5 offset:8704
	ds_read_b64_tr_b16 a[200:201], v6 offset:8192
	ds_read_b64_tr_b16 a[202:203], v6 offset:8704
	ds_read_b64_tr_b16 a[204:205], v7 offset:8192
	ds_read_b64_tr_b16 a[206:207], v7 offset:8704
	s_waitcnt lgkmcnt(0)
	s_add_u32 m0, s65, 8192
	s_mov_b32 s63, 2752512
	buffer_load_dwordx4 v1, s[44:47], s63 offen lds
	s_add_u32 m0, s65, 9216
	s_mov_b32 s63, 2752512
	buffer_load_dwordx4 v2, s[44:47], s63 offen lds
	s_add_u32 m0, s65, 10240
	s_mov_b32 s63, 2949120
	buffer_load_dwordx4 v1, s[44:47], s63 offen lds
	s_add_u32 m0, s65, 11264
	s_mov_b32 s63, 2949120
	buffer_load_dwordx4 v2, s[44:47], s63 offen lds
	ds_read_b128 v[64:67], v10 offset:32768
	ds_read_b128 v[68:71], v10 offset:33792
	ds_read_b128 v[72:75], v13 offset:32768
	ds_read_b128 v[76:79], v13 offset:33792
	s_waitcnt lgkmcnt(4)
	v_mfma_f32_16x16x32_bf16 v[16:19], v[48:51], v[208:211], v[16:19]
	v_mfma_f32_16x16x32_bf16 v[24:27], v[48:51], v[212:215], v[24:27]
	v_mfma_f32_16x16x32_bf16 v[32:35], v[48:51], v[216:219], v[32:35]
	v_mfma_f32_16x16x32_bf16 v[40:43], v[48:51], v[220:223], v[40:43]
	v_mfma_f32_16x16x32_bf16 v[20:23], v[52:55], v[208:211], v[20:23]
	v_mfma_f32_16x16x32_bf16 v[28:31], v[52:55], v[212:215], v[28:31]
	v_mfma_f32_16x16x32_bf16 v[36:39], v[52:55], v[216:219], v[36:39]
	v_mfma_f32_16x16x32_bf16 v[44:47], v[52:55], v[220:223], v[44:47]
	v_mfma_f32_16x16x32_bf16 v[112:115], v[56:59], v[208:211], v[112:115]
	v_mfma_f32_16x16x32_bf16 v[120:123], v[56:59], v[212:215], v[120:123]
	v_mfma_f32_16x16x32_bf16 v[128:131], v[56:59], v[216:219], v[128:131]
	v_mfma_f32_16x16x32_bf16 v[136:139], v[56:59], v[220:223], v[136:139]
	v_mfma_f32_16x16x32_bf16 v[116:119], v[60:63], v[208:211], v[116:119]
	v_mfma_f32_16x16x32_bf16 v[124:127], v[60:63], v[212:215], v[124:127]
	v_mfma_f32_16x16x32_bf16 v[132:135], v[60:63], v[216:219], v[132:135]
	v_mfma_f32_16x16x32_bf16 v[140:143], v[60:63], v[220:223], v[140:143]
	ds_read_b128 v[48:51], v10 offset:30720
	ds_read_b128 v[52:55], v10 offset:31744
	ds_read_b128 v[56:59], v13 offset:30720
	ds_read_b128 v[60:63], v13 offset:31744
	s_waitcnt lgkmcnt(4)
	v_mfma_f32_16x16x32_bf16 v[16:19], v[64:67], v[192:195], v[16:19]
	v_mfma_f32_16x16x32_bf16 v[24:27], v[64:67], v[196:199], v[24:27]
	v_mfma_f32_16x16x32_bf16 v[32:35], v[64:67], v[200:203], v[32:35]
	v_mfma_f32_16x16x32_bf16 v[40:43], v[64:67], v[204:207], v[40:43]
	v_mfma_f32_16x16x32_bf16 v[20:23], v[68:71], v[192:195], v[20:23]
	v_mfma_f32_16x16x32_bf16 v[28:31], v[68:71], v[196:199], v[28:31]
	v_mfma_f32_16x16x32_bf16 v[36:39], v[68:71], v[200:203], v[36:39]
	v_mfma_f32_16x16x32_bf16 v[44:47], v[68:71], v[204:207], v[44:47]
	v_mfma_f32_16x16x32_bf16 v[112:115], v[72:75], v[192:195], v[112:115]
	v_mfma_f32_16x16x32_bf16 v[120:123], v[72:75], v[196:199], v[120:123]
	v_mfma_f32_16x16x32_bf16 v[128:131], v[72:75], v[200:203], v[128:131]
	v_mfma_f32_16x16x32_bf16 v[136:139], v[72:75], v[204:207], v[136:139]
	v_mfma_f32_16x16x32_bf16 v[116:119], v[76:79], v[192:195], v[116:119]
	v_mfma_f32_16x16x32_bf16 v[124:127], v[76:79], v[196:199], v[124:127]
	v_mfma_f32_16x16x32_bf16 v[132:135], v[76:79], v[200:203], v[132:135]
	v_mfma_f32_16x16x32_bf16 v[140:143], v[76:79], v[204:207], v[140:143]
	s_waitcnt vmcnt(16)
	ds_read_b64_tr_b16 a[176:177], v4 offset:12288
	ds_read_b64_tr_b16 a[178:179], v4 offset:12800
	ds_read_b64_tr_b16 a[180:181], v5 offset:12288
	ds_read_b64_tr_b16 a[182:183], v5 offset:12800
	ds_read_b64_tr_b16 a[184:185], v6 offset:12288
	ds_read_b64_tr_b16 a[186:187], v6 offset:12800
	ds_read_b64_tr_b16 a[188:189], v7 offset:12288
	ds_read_b64_tr_b16 a[190:191], v7 offset:12800
	s_waitcnt lgkmcnt(0)
	s_add_u32 m0, s65, 12288
	s_mov_b32 s63, 2359296
	buffer_load_dwordx4 v1, s[44:47], s63 offen lds
	s_add_u32 m0, s65, 13312
	s_mov_b32 s63, 2359296
	buffer_load_dwordx4 v2, s[44:47], s63 offen lds
	s_add_u32 m0, s65, 14336
	s_mov_b32 s63, 2555904
	buffer_load_dwordx4 v1, s[44:47], s63 offen lds
	s_add_u32 m0, s65, 15360
	s_mov_b32 s63, 2555904
	buffer_load_dwordx4 v2, s[44:47], s63 offen lds
	ds_read_b128 v[64:67], v10 offset:28672
	ds_read_b128 v[68:71], v10 offset:29696
	ds_read_b128 v[72:75], v13 offset:28672
	ds_read_b128 v[76:79], v13 offset:29696
	s_waitcnt lgkmcnt(4)
	v_mfma_f32_16x16x32_bf16 v[16:19], v[48:51], a[240:243], v[16:19]
	v_mfma_f32_16x16x32_bf16 v[24:27], v[48:51], a[244:247], v[24:27]
	v_mfma_f32_16x16x32_bf16 v[32:35], v[48:51], a[248:251], v[32:35]
	v_mfma_f32_16x16x32_bf16 v[40:43], v[48:51], a[252:255], v[40:43]
	v_mfma_f32_16x16x32_bf16 v[20:23], v[52:55], a[240:243], v[20:23]
	v_mfma_f32_16x16x32_bf16 v[28:31], v[52:55], a[244:247], v[28:31]
	v_mfma_f32_16x16x32_bf16 v[36:39], v[52:55], a[248:251], v[36:39]
	v_mfma_f32_16x16x32_bf16 v[44:47], v[52:55], a[252:255], v[44:47]
	v_mfma_f32_16x16x32_bf16 v[112:115], v[56:59], a[240:243], v[112:115]
	v_mfma_f32_16x16x32_bf16 v[120:123], v[56:59], a[244:247], v[120:123]
	v_mfma_f32_16x16x32_bf16 v[128:131], v[56:59], a[248:251], v[128:131]
	v_mfma_f32_16x16x32_bf16 v[136:139], v[56:59], a[252:255], v[136:139]
	v_mfma_f32_16x16x32_bf16 v[116:119], v[60:63], a[240:243], v[116:119]
	v_mfma_f32_16x16x32_bf16 v[124:127], v[60:63], a[244:247], v[124:127]
	v_mfma_f32_16x16x32_bf16 v[132:135], v[60:63], a[248:251], v[132:135]
	v_mfma_f32_16x16x32_bf16 v[140:143], v[60:63], a[252:255], v[140:143]
	ds_read_b128 v[48:51], v10 offset:26624
	ds_read_b128 v[52:55], v10 offset:27648
	ds_read_b128 v[56:59], v13 offset:26624
	ds_read_b128 v[60:63], v13 offset:27648
	s_waitcnt lgkmcnt(4)
	v_mfma_f32_16x16x32_bf16 v[16:19], v[64:67], a[224:227], v[16:19]
	v_mfma_f32_16x16x32_bf16 v[24:27], v[64:67], a[228:231], v[24:27]
	v_mfma_f32_16x16x32_bf16 v[32:35], v[64:67], a[232:235], v[32:35]
	v_mfma_f32_16x16x32_bf16 v[40:43], v[64:67], a[236:239], v[40:43]
	v_mfma_f32_16x16x32_bf16 v[20:23], v[68:71], a[224:227], v[20:23]
	v_mfma_f32_16x16x32_bf16 v[28:31], v[68:71], a[228:231], v[28:31]
	v_mfma_f32_16x16x32_bf16 v[36:39], v[68:71], a[232:235], v[36:39]
	v_mfma_f32_16x16x32_bf16 v[44:47], v[68:71], a[236:239], v[44:47]
	v_mfma_f32_16x16x32_bf16 v[112:115], v[72:75], a[224:227], v[112:115]
	v_mfma_f32_16x16x32_bf16 v[120:123], v[72:75], a[228:231], v[120:123]
	v_mfma_f32_16x16x32_bf16 v[128:131], v[72:75], a[232:235], v[128:131]
	v_mfma_f32_16x16x32_bf16 v[136:139], v[72:75], a[236:239], v[136:139]
	v_mfma_f32_16x16x32_bf16 v[116:119], v[76:79], a[224:227], v[116:119]
	v_mfma_f32_16x16x32_bf16 v[124:127], v[76:79], a[228:231], v[124:127]
	v_mfma_f32_16x16x32_bf16 v[132:135], v[76:79], a[232:235], v[132:135]
	v_mfma_f32_16x16x32_bf16 v[140:143], v[76:79], a[236:239], v[140:143]
	s_waitcnt vmcnt(16)
	ds_read_b64_tr_b16 a[160:161], v4 offset:16384
	ds_read_b64_tr_b16 a[162:163], v4 offset:16896
	ds_read_b64_tr_b16 a[164:165], v5 offset:16384
	ds_read_b64_tr_b16 a[166:167], v5 offset:16896
	ds_read_b64_tr_b16 a[168:169], v6 offset:16384
	ds_read_b64_tr_b16 a[170:171], v6 offset:16896
	ds_read_b64_tr_b16 a[172:173], v7 offset:16384
	ds_read_b64_tr_b16 a[174:175], v7 offset:16896
	s_waitcnt lgkmcnt(0)
	s_add_u32 m0, s65, 16384
	s_mov_b32 s63, 1966080
	buffer_load_dwordx4 v1, s[44:47], s63 offen lds
	s_add_u32 m0, s65, 17408
	s_mov_b32 s63, 1966080
	buffer_load_dwordx4 v2, s[44:47], s63 offen lds
	s_add_u32 m0, s65, 18432
	s_mov_b32 s63, 2162688
	buffer_load_dwordx4 v1, s[44:47], s63 offen lds
	s_add_u32 m0, s65, 19456
	s_mov_b32 s63, 2162688
	buffer_load_dwordx4 v2, s[44:47], s63 offen lds
	ds_read_b128 v[64:67], v10 offset:24576
	ds_read_b128 v[68:71], v10 offset:25600
	ds_read_b128 v[72:75], v13 offset:24576
	ds_read_b128 v[76:79], v13 offset:25600
	s_waitcnt lgkmcnt(4)
	v_mfma_f32_16x16x32_bf16 v[16:19], v[48:51], a[208:211], v[16:19]
	v_mfma_f32_16x16x32_bf16 v[24:27], v[48:51], a[212:215], v[24:27]
	v_mfma_f32_16x16x32_bf16 v[32:35], v[48:51], a[216:219], v[32:35]
	v_mfma_f32_16x16x32_bf16 v[40:43], v[48:51], a[220:223], v[40:43]
	v_mfma_f32_16x16x32_bf16 v[20:23], v[52:55], a[208:211], v[20:23]
	v_mfma_f32_16x16x32_bf16 v[28:31], v[52:55], a[212:215], v[28:31]
	v_mfma_f32_16x16x32_bf16 v[36:39], v[52:55], a[216:219], v[36:39]
	v_mfma_f32_16x16x32_bf16 v[44:47], v[52:55], a[220:223], v[44:47]
	v_mfma_f32_16x16x32_bf16 v[112:115], v[56:59], a[208:211], v[112:115]
	v_mfma_f32_16x16x32_bf16 v[120:123], v[56:59], a[212:215], v[120:123]
	v_mfma_f32_16x16x32_bf16 v[128:131], v[56:59], a[216:219], v[128:131]
	v_mfma_f32_16x16x32_bf16 v[136:139], v[56:59], a[220:223], v[136:139]
	v_mfma_f32_16x16x32_bf16 v[116:119], v[60:63], a[208:211], v[116:119]
	v_mfma_f32_16x16x32_bf16 v[124:127], v[60:63], a[212:215], v[124:127]
	v_mfma_f32_16x16x32_bf16 v[132:135], v[60:63], a[216:219], v[132:135]
	v_mfma_f32_16x16x32_bf16 v[140:143], v[60:63], a[220:223], v[140:143]
	ds_read_b128 v[48:51], v10 offset:22528
	ds_read_b128 v[52:55], v10 offset:23552
	ds_read_b128 v[56:59], v13 offset:22528
	ds_read_b128 v[60:63], v13 offset:23552
	s_waitcnt lgkmcnt(4)
	v_mfma_f32_16x16x32_bf16 v[16:19], v[64:67], a[192:195], v[16:19]
	v_mfma_f32_16x16x32_bf16 v[24:27], v[64:67], a[196:199], v[24:27]
	v_mfma_f32_16x16x32_bf16 v[32:35], v[64:67], a[200:203], v[32:35]
	v_mfma_f32_16x16x32_bf16 v[40:43], v[64:67], a[204:207], v[40:43]
	v_mfma_f32_16x16x32_bf16 v[20:23], v[68:71], a[192:195], v[20:23]
	v_mfma_f32_16x16x32_bf16 v[28:31], v[68:71], a[196:199], v[28:31]
	v_mfma_f32_16x16x32_bf16 v[36:39], v[68:71], a[200:203], v[36:39]
	v_mfma_f32_16x16x32_bf16 v[44:47], v[68:71], a[204:207], v[44:47]
	v_mfma_f32_16x16x32_bf16 v[112:115], v[72:75], a[192:195], v[112:115]
	v_mfma_f32_16x16x32_bf16 v[120:123], v[72:75], a[196:199], v[120:123]
	v_mfma_f32_16x16x32_bf16 v[128:131], v[72:75], a[200:203], v[128:131]
	v_mfma_f32_16x16x32_bf16 v[136:139], v[72:75], a[204:207], v[136:139]
	v_mfma_f32_16x16x32_bf16 v[116:119], v[76:79], a[192:195], v[116:119]
	v_mfma_f32_16x16x32_bf16 v[124:127], v[76:79], a[196:199], v[124:127]
	v_mfma_f32_16x16x32_bf16 v[132:135], v[76:79], a[200:203], v[132:135]
	v_mfma_f32_16x16x32_bf16 v[140:143], v[76:79], a[204:207], v[140:143]
	s_waitcnt vmcnt(16)
	ds_read_b64_tr_b16 a[144:145], v4 offset:0
	ds_read_b64_tr_b16 a[146:147], v4 offset:512
	ds_read_b64_tr_b16 a[148:149], v5 offset:0
	ds_read_b64_tr_b16 a[150:151], v5 offset:512
	ds_read_b64_tr_b16 a[152:153], v6 offset:0
	ds_read_b64_tr_b16 a[154:155], v6 offset:512
	ds_read_b64_tr_b16 a[156:157], v7 offset:0
	ds_read_b64_tr_b16 a[158:159], v7 offset:512
	s_waitcnt lgkmcnt(0)
	s_add_u32 m0, s65, 0
	s_mov_b32 s63, 1572864
	buffer_load_dwordx4 v1, s[44:47], s63 offen lds
	s_add_u32 m0, s65, 1024
	s_mov_b32 s63, 1572864
	buffer_load_dwordx4 v2, s[44:47], s63 offen lds
	s_add_u32 m0, s65, 2048
	s_mov_b32 s63, 1769472
	buffer_load_dwordx4 v1, s[44:47], s63 offen lds
	s_add_u32 m0, s65, 3072
	s_mov_b32 s63, 1769472
	buffer_load_dwordx4 v2, s[44:47], s63 offen lds
	ds_read_b128 v[64:67], v10 offset:20480
	ds_read_b128 v[68:71], v10 offset:21504
	ds_read_b128 v[72:75], v13 offset:20480
	ds_read_b128 v[76:79], v13 offset:21504
	s_waitcnt lgkmcnt(4)
	v_mfma_f32_16x16x32_bf16 v[16:19], v[48:51], a[176:179], v[16:19]
	v_mfma_f32_16x16x32_bf16 v[24:27], v[48:51], a[180:183], v[24:27]
	v_mfma_f32_16x16x32_bf16 v[32:35], v[48:51], a[184:187], v[32:35]
	v_mfma_f32_16x16x32_bf16 v[40:43], v[48:51], a[188:191], v[40:43]
	v_mfma_f32_16x16x32_bf16 v[20:23], v[52:55], a[176:179], v[20:23]
	v_mfma_f32_16x16x32_bf16 v[28:31], v[52:55], a[180:183], v[28:31]
	v_mfma_f32_16x16x32_bf16 v[36:39], v[52:55], a[184:187], v[36:39]
	v_mfma_f32_16x16x32_bf16 v[44:47], v[52:55], a[188:191], v[44:47]
	v_mfma_f32_16x16x32_bf16 v[112:115], v[56:59], a[176:179], v[112:115]
	v_mfma_f32_16x16x32_bf16 v[120:123], v[56:59], a[180:183], v[120:123]
	v_mfma_f32_16x16x32_bf16 v[128:131], v[56:59], a[184:187], v[128:131]
	v_mfma_f32_16x16x32_bf16 v[136:139], v[56:59], a[188:191], v[136:139]
	v_mfma_f32_16x16x32_bf16 v[116:119], v[60:63], a[176:179], v[116:119]
	v_mfma_f32_16x16x32_bf16 v[124:127], v[60:63], a[180:183], v[124:127]
	v_mfma_f32_16x16x32_bf16 v[132:135], v[60:63], a[184:187], v[132:135]
	v_mfma_f32_16x16x32_bf16 v[140:143], v[60:63], a[188:191], v[140:143]
	ds_read_b128 v[48:51], v10 offset:18432
	ds_read_b128 v[52:55], v10 offset:19456
	ds_read_b128 v[56:59], v13 offset:18432
	ds_read_b128 v[60:63], v13 offset:19456
	s_waitcnt lgkmcnt(4)
	v_mfma_f32_16x16x32_bf16 v[16:19], v[64:67], a[160:163], v[16:19]
	v_mfma_f32_16x16x32_bf16 v[24:27], v[64:67], a[164:167], v[24:27]
	v_mfma_f32_16x16x32_bf16 v[32:35], v[64:67], a[168:171], v[32:35]
	v_mfma_f32_16x16x32_bf16 v[40:43], v[64:67], a[172:175], v[40:43]
	v_mfma_f32_16x16x32_bf16 v[20:23], v[68:71], a[160:163], v[20:23]
	v_mfma_f32_16x16x32_bf16 v[28:31], v[68:71], a[164:167], v[28:31]
	v_mfma_f32_16x16x32_bf16 v[36:39], v[68:71], a[168:171], v[36:39]
	v_mfma_f32_16x16x32_bf16 v[44:47], v[68:71], a[172:175], v[44:47]
	v_mfma_f32_16x16x32_bf16 v[112:115], v[72:75], a[160:163], v[112:115]
	v_mfma_f32_16x16x32_bf16 v[120:123], v[72:75], a[164:167], v[120:123]
	v_mfma_f32_16x16x32_bf16 v[128:131], v[72:75], a[168:171], v[128:131]
	v_mfma_f32_16x16x32_bf16 v[136:139], v[72:75], a[172:175], v[136:139]
	v_mfma_f32_16x16x32_bf16 v[116:119], v[76:79], a[160:163], v[116:119]
	v_mfma_f32_16x16x32_bf16 v[124:127], v[76:79], a[164:167], v[124:127]
	v_mfma_f32_16x16x32_bf16 v[132:135], v[76:79], a[168:171], v[132:135]
	v_mfma_f32_16x16x32_bf16 v[140:143], v[76:79], a[172:175], v[140:143]
	s_waitcnt vmcnt(16)
	ds_read_b64_tr_b16 a[128:129], v4 offset:4096
	ds_read_b64_tr_b16 a[130:131], v4 offset:4608
	ds_read_b64_tr_b16 a[132:133], v5 offset:4096
	ds_read_b64_tr_b16 a[134:135], v5 offset:4608
	ds_read_b64_tr_b16 a[136:137], v6 offset:4096
	ds_read_b64_tr_b16 a[138:139], v6 offset:4608
	ds_read_b64_tr_b16 a[140:141], v7 offset:4096
	ds_read_b64_tr_b16 a[142:143], v7 offset:4608
	s_waitcnt lgkmcnt(0)
	s_add_u32 m0, s65, 4096
	s_mov_b32 s63, 1179648
	buffer_load_dwordx4 v1, s[44:47], s63 offen lds
	s_add_u32 m0, s65, 5120
	s_mov_b32 s63, 1179648
	buffer_load_dwordx4 v2, s[44:47], s63 offen lds
	s_add_u32 m0, s65, 6144
	s_mov_b32 s63, 1376256
	buffer_load_dwordx4 v1, s[44:47], s63 offen lds
	s_add_u32 m0, s65, 7168
	s_mov_b32 s63, 1376256
	buffer_load_dwordx4 v2, s[44:47], s63 offen lds
	ds_read_b128 v[64:67], v10 offset:16384
	ds_read_b128 v[68:71], v10 offset:17408
	ds_read_b128 v[72:75], v13 offset:16384
	ds_read_b128 v[76:79], v13 offset:17408
	s_waitcnt lgkmcnt(4)
	v_mfma_f32_16x16x32_bf16 v[16:19], v[48:51], a[144:147], v[16:19]
	v_mfma_f32_16x16x32_bf16 v[24:27], v[48:51], a[148:151], v[24:27]
	v_mfma_f32_16x16x32_bf16 v[32:35], v[48:51], a[152:155], v[32:35]
	v_mfma_f32_16x16x32_bf16 v[40:43], v[48:51], a[156:159], v[40:43]
	v_mfma_f32_16x16x32_bf16 v[20:23], v[52:55], a[144:147], v[20:23]
	v_mfma_f32_16x16x32_bf16 v[28:31], v[52:55], a[148:151], v[28:31]
	v_mfma_f32_16x16x32_bf16 v[36:39], v[52:55], a[152:155], v[36:39]
	v_mfma_f32_16x16x32_bf16 v[44:47], v[52:55], a[156:159], v[44:47]
	v_mfma_f32_16x16x32_bf16 v[112:115], v[56:59], a[144:147], v[112:115]
	v_mfma_f32_16x16x32_bf16 v[120:123], v[56:59], a[148:151], v[120:123]
	v_mfma_f32_16x16x32_bf16 v[128:131], v[56:59], a[152:155], v[128:131]
	v_mfma_f32_16x16x32_bf16 v[136:139], v[56:59], a[156:159], v[136:139]
	v_mfma_f32_16x16x32_bf16 v[116:119], v[60:63], a[144:147], v[116:119]
	v_mfma_f32_16x16x32_bf16 v[124:127], v[60:63], a[148:151], v[124:127]
	v_mfma_f32_16x16x32_bf16 v[132:135], v[60:63], a[152:155], v[132:135]
	v_mfma_f32_16x16x32_bf16 v[140:143], v[60:63], a[156:159], v[140:143]
	ds_read_b128 v[48:51], v10 offset:14336
	ds_read_b128 v[52:55], v10 offset:15360
	ds_read_b128 v[56:59], v13 offset:14336
	ds_read_b128 v[60:63], v13 offset:15360
	s_waitcnt lgkmcnt(4)
	v_mfma_f32_16x16x32_bf16 v[16:19], v[64:67], a[128:131], v[16:19]
	v_mfma_f32_16x16x32_bf16 v[24:27], v[64:67], a[132:135], v[24:27]
	v_mfma_f32_16x16x32_bf16 v[32:35], v[64:67], a[136:139], v[32:35]
	v_mfma_f32_16x16x32_bf16 v[40:43], v[64:67], a[140:143], v[40:43]
	v_mfma_f32_16x16x32_bf16 v[20:23], v[68:71], a[128:131], v[20:23]
	v_mfma_f32_16x16x32_bf16 v[28:31], v[68:71], a[132:135], v[28:31]
	v_mfma_f32_16x16x32_bf16 v[36:39], v[68:71], a[136:139], v[36:39]
	v_mfma_f32_16x16x32_bf16 v[44:47], v[68:71], a[140:143], v[44:47]
	v_mfma_f32_16x16x32_bf16 v[112:115], v[72:75], a[128:131], v[112:115]
	v_mfma_f32_16x16x32_bf16 v[120:123], v[72:75], a[132:135], v[120:123]
	v_mfma_f32_16x16x32_bf16 v[128:131], v[72:75], a[136:139], v[128:131]
	v_mfma_f32_16x16x32_bf16 v[136:139], v[72:75], a[140:143], v[136:139]
	v_mfma_f32_16x16x32_bf16 v[116:119], v[76:79], a[128:131], v[116:119]
	v_mfma_f32_16x16x32_bf16 v[124:127], v[76:79], a[132:135], v[124:127]
	v_mfma_f32_16x16x32_bf16 v[132:135], v[76:79], a[136:139], v[132:135]
	v_mfma_f32_16x16x32_bf16 v[140:143], v[76:79], a[140:143], v[140:143]
	s_waitcnt vmcnt(16)
	ds_read_b64_tr_b16 a[112:113], v4 offset:8192
	ds_read_b64_tr_b16 a[114:115], v4 offset:8704
	ds_read_b64_tr_b16 a[116:117], v5 offset:8192
	ds_read_b64_tr_b16 a[118:119], v5 offset:8704
	ds_read_b64_tr_b16 a[120:121], v6 offset:8192
	ds_read_b64_tr_b16 a[122:123], v6 offset:8704
	ds_read_b64_tr_b16 a[124:125], v7 offset:8192
	ds_read_b64_tr_b16 a[126:127], v7 offset:8704
	s_waitcnt lgkmcnt(0)
	s_add_u32 m0, s65, 8192
	s_mov_b32 s63, 786432
	buffer_load_dwordx4 v1, s[44:47], s63 offen lds
	s_add_u32 m0, s65, 9216
	s_mov_b32 s63, 786432
	buffer_load_dwordx4 v2, s[44:47], s63 offen lds
	s_add_u32 m0, s65, 10240
	s_mov_b32 s63, 983040
	buffer_load_dwordx4 v1, s[44:47], s63 offen lds
	s_add_u32 m0, s65, 11264
	s_mov_b32 s63, 983040
	buffer_load_dwordx4 v2, s[44:47], s63 offen lds
	v_mov_b32 v153, 128
	buffer_load_dwordx3 v[150:152], v153, s[40:43], 0 offen sc1
	ds_read_b128 v[64:67], v10 offset:12288
	ds_read_b128 v[68:71], v10 offset:13312
	ds_read_b128 v[72:75], v13 offset:12288
	ds_read_b128 v[76:79], v13 offset:13312
	s_waitcnt lgkmcnt(4)
	v_mfma_f32_16x16x32_bf16 v[16:19], v[48:51], a[112:115], v[16:19]
	v_mfma_f32_16x16x32_bf16 v[24:27], v[48:51], a[116:119], v[24:27]
	v_mfma_f32_16x16x32_bf16 v[32:35], v[48:51], a[120:123], v[32:35]
	v_mfma_f32_16x16x32_bf16 v[40:43], v[48:51], a[124:127], v[40:43]
	v_mfma_f32_16x16x32_bf16 v[20:23], v[52:55], a[112:115], v[20:23]
	v_mfma_f32_16x16x32_bf16 v[28:31], v[52:55], a[116:119], v[28:31]
	v_mfma_f32_16x16x32_bf16 v[36:39], v[52:55], a[120:123], v[36:39]
	v_mfma_f32_16x16x32_bf16 v[44:47], v[52:55], a[124:127], v[44:47]
	v_mfma_f32_16x16x32_bf16 v[112:115], v[56:59], a[112:115], v[112:115]
	v_mfma_f32_16x16x32_bf16 v[120:123], v[56:59], a[116:119], v[120:123]
	v_mfma_f32_16x16x32_bf16 v[128:131], v[56:59], a[120:123], v[128:131]
	v_mfma_f32_16x16x32_bf16 v[136:139], v[56:59], a[124:127], v[136:139]
	v_mfma_f32_16x16x32_bf16 v[116:119], v[60:63], a[112:115], v[116:119]
	v_mfma_f32_16x16x32_bf16 v[124:127], v[60:63], a[116:119], v[124:127]
	v_mfma_f32_16x16x32_bf16 v[132:135], v[60:63], a[120:123], v[132:135]
	v_mfma_f32_16x16x32_bf16 v[140:143], v[60:63], a[124:127], v[140:143]
	s_waitcnt vmcnt(17)
	ds_read_b64_tr_b16 a[96:97], v4 offset:12288
	ds_read_b64_tr_b16 a[98:99], v4 offset:12800
	ds_read_b64_tr_b16 a[100:101], v5 offset:12288
	ds_read_b64_tr_b16 a[102:103], v5 offset:12800
	ds_read_b64_tr_b16 a[104:105], v6 offset:12288
	ds_read_b64_tr_b16 a[106:107], v6 offset:12800
	ds_read_b64_tr_b16 a[108:109], v7 offset:12288
	ds_read_b64_tr_b16 a[110:111], v7 offset:12800
	s_waitcnt lgkmcnt(0)
	s_add_u32 m0, s65, 12288
	s_mov_b32 s63, 393216
	buffer_load_dwordx4 v1, s[44:47], s63 offen lds
	s_add_u32 m0, s65, 13312
	s_mov_b32 s63, 393216
	buffer_load_dwordx4 v2, s[44:47], s63 offen lds
	s_add_u32 m0, s65, 14336
	s_mov_b32 s63, 589824
	buffer_load_dwordx4 v1, s[44:47], s63 offen lds
	s_add_u32 m0, s65, 15360
	s_mov_b32 s63, 589824
	buffer_load_dwordx4 v2, s[44:47], s63 offen lds
	ds_read_b128 v[48:51], v10 offset:10240
	ds_read_b128 v[52:55], v10 offset:11264
	ds_read_b128 v[56:59], v13 offset:10240
	ds_read_b128 v[60:63], v13 offset:11264
	s_waitcnt lgkmcnt(4)
	v_mfma_f32_16x16x32_bf16 v[16:19], v[64:67], a[96:99], v[16:19]
	v_mfma_f32_16x16x32_bf16 v[24:27], v[64:67], a[100:103], v[24:27]
	v_mfma_f32_16x16x32_bf16 v[32:35], v[64:67], a[104:107], v[32:35]
	v_mfma_f32_16x16x32_bf16 v[40:43], v[64:67], a[108:111], v[40:43]
	v_mfma_f32_16x16x32_bf16 v[20:23], v[68:71], a[96:99], v[20:23]
	v_mfma_f32_16x16x32_bf16 v[28:31], v[68:71], a[100:103], v[28:31]
	v_mfma_f32_16x16x32_bf16 v[36:39], v[68:71], a[104:107], v[36:39]
	v_mfma_f32_16x16x32_bf16 v[44:47], v[68:71], a[108:111], v[44:47]
	v_mfma_f32_16x16x32_bf16 v[112:115], v[72:75], a[96:99], v[112:115]
	v_mfma_f32_16x16x32_bf16 v[120:123], v[72:75], a[100:103], v[120:123]
	v_mfma_f32_16x16x32_bf16 v[128:131], v[72:75], a[104:107], v[128:131]
	v_mfma_f32_16x16x32_bf16 v[136:139], v[72:75], a[108:111], v[136:139]
	v_mfma_f32_16x16x32_bf16 v[116:119], v[76:79], a[96:99], v[116:119]
	v_mfma_f32_16x16x32_bf16 v[124:127], v[76:79], a[100:103], v[124:127]
	v_mfma_f32_16x16x32_bf16 v[132:135], v[76:79], a[104:107], v[132:135]
	v_mfma_f32_16x16x32_bf16 v[140:143], v[76:79], a[108:111], v[140:143]
	s_waitcnt vmcnt(17)
	ds_read_b64_tr_b16 a[80:81], v4 offset:16384
	ds_read_b64_tr_b16 a[82:83], v4 offset:16896
	ds_read_b64_tr_b16 a[84:85], v5 offset:16384
	ds_read_b64_tr_b16 a[86:87], v5 offset:16896
	ds_read_b64_tr_b16 a[88:89], v6 offset:16384
	ds_read_b64_tr_b16 a[90:91], v6 offset:16896
	ds_read_b64_tr_b16 a[92:93], v7 offset:16384
	ds_read_b64_tr_b16 a[94:95], v7 offset:16896
	s_waitcnt lgkmcnt(0)
	s_add_u32 m0, s65, 16384
	s_mov_b32 s63, 0
	buffer_load_dwordx4 v1, s[44:47], s63 offen lds
	s_add_u32 m0, s65, 17408
	s_mov_b32 s63, 0
	buffer_load_dwordx4 v2, s[44:47], s63 offen lds
	s_add_u32 m0, s65, 18432
	s_mov_b32 s63, 196608
	buffer_load_dwordx4 v1, s[44:47], s63 offen lds
	s_add_u32 m0, s65, 19456
	s_mov_b32 s63, 196608
	buffer_load_dwordx4 v2, s[44:47], s63 offen lds
	ds_read_b128 v[64:67], v10 offset:8192
	ds_read_b128 v[68:71], v10 offset:9216
	ds_read_b128 v[72:75], v13 offset:8192
	ds_read_b128 v[76:79], v13 offset:9216
	s_waitcnt lgkmcnt(4)
	v_mfma_f32_16x16x32_bf16 v[16:19], v[48:51], a[80:83], v[16:19]
	v_mfma_f32_16x16x32_bf16 v[24:27], v[48:51], a[84:87], v[24:27]
	v_mfma_f32_16x16x32_bf16 v[32:35], v[48:51], a[88:91], v[32:35]
	v_mfma_f32_16x16x32_bf16 v[40:43], v[48:51], a[92:95], v[40:43]
	v_mfma_f32_16x16x32_bf16 v[20:23], v[52:55], a[80:83], v[20:23]
	v_mfma_f32_16x16x32_bf16 v[28:31], v[52:55], a[84:87], v[28:31]
	v_mfma_f32_16x16x32_bf16 v[36:39], v[52:55], a[88:91], v[36:39]
	v_mfma_f32_16x16x32_bf16 v[44:47], v[52:55], a[92:95], v[44:47]
	v_mfma_f32_16x16x32_bf16 v[112:115], v[56:59], a[80:83], v[112:115]
	v_mfma_f32_16x16x32_bf16 v[120:123], v[56:59], a[84:87], v[120:123]
	v_mfma_f32_16x16x32_bf16 v[128:131], v[56:59], a[88:91], v[128:131]
	v_mfma_f32_16x16x32_bf16 v[136:139], v[56:59], a[92:95], v[136:139]
	v_mfma_f32_16x16x32_bf16 v[116:119], v[60:63], a[80:83], v[116:119]
	v_mfma_f32_16x16x32_bf16 v[124:127], v[60:63], a[84:87], v[124:127]
	v_mfma_f32_16x16x32_bf16 v[132:135], v[60:63], a[88:91], v[132:135]
	v_mfma_f32_16x16x32_bf16 v[140:143], v[60:63], a[92:95], v[140:143]
	s_waitcnt vmcnt(17)
	ds_read_b64_tr_b16 a[64:65], v4 offset:0
	ds_read_b64_tr_b16 a[66:67], v4 offset:512
	ds_read_b64_tr_b16 a[68:69], v5 offset:0
	ds_read_b64_tr_b16 a[70:71], v5 offset:512
	ds_read_b64_tr_b16 a[72:73], v6 offset:0
	ds_read_b64_tr_b16 a[74:75], v6 offset:512
	ds_read_b64_tr_b16 a[76:77], v7 offset:0
	ds_read_b64_tr_b16 a[78:79], v7 offset:512
	s_waitcnt lgkmcnt(0)
	ds_read_b128 v[48:51], v10 offset:6144
	ds_read_b128 v[52:55], v10 offset:7168
	ds_read_b128 v[56:59], v13 offset:6144
	ds_read_b128 v[60:63], v13 offset:7168
	s_waitcnt lgkmcnt(4)
	v_mfma_f32_16x16x32_bf16 v[16:19], v[64:67], a[64:67], v[16:19]
	v_mfma_f32_16x16x32_bf16 v[24:27], v[64:67], a[68:71], v[24:27]
	v_mfma_f32_16x16x32_bf16 v[32:35], v[64:67], a[72:75], v[32:35]
	v_mfma_f32_16x16x32_bf16 v[40:43], v[64:67], a[76:79], v[40:43]
	v_mfma_f32_16x16x32_bf16 v[20:23], v[68:71], a[64:67], v[20:23]
	v_mfma_f32_16x16x32_bf16 v[28:31], v[68:71], a[68:71], v[28:31]
	v_mfma_f32_16x16x32_bf16 v[36:39], v[68:71], a[72:75], v[36:39]
	v_mfma_f32_16x16x32_bf16 v[44:47], v[68:71], a[76:79], v[44:47]
	v_mfma_f32_16x16x32_bf16 v[112:115], v[72:75], a[64:67], v[112:115]
	v_mfma_f32_16x16x32_bf16 v[120:123], v[72:75], a[68:71], v[120:123]
	v_mfma_f32_16x16x32_bf16 v[128:131], v[72:75], a[72:75], v[128:131]
	v_mfma_f32_16x16x32_bf16 v[136:139], v[72:75], a[76:79], v[136:139]
	v_mfma_f32_16x16x32_bf16 v[116:119], v[76:79], a[64:67], v[116:119]
	v_mfma_f32_16x16x32_bf16 v[124:127], v[76:79], a[68:71], v[124:127]
	v_mfma_f32_16x16x32_bf16 v[132:135], v[76:79], a[72:75], v[132:135]
	v_mfma_f32_16x16x32_bf16 v[140:143], v[76:79], a[76:79], v[140:143]
	s_waitcnt vmcnt(13)
	ds_read_b64_tr_b16 a[48:49], v4 offset:4096
	ds_read_b64_tr_b16 a[50:51], v4 offset:4608
	ds_read_b64_tr_b16 a[52:53], v5 offset:4096
	ds_read_b64_tr_b16 a[54:55], v5 offset:4608
	ds_read_b64_tr_b16 a[56:57], v6 offset:4096
	ds_read_b64_tr_b16 a[58:59], v6 offset:4608
	ds_read_b64_tr_b16 a[60:61], v7 offset:4096
	ds_read_b64_tr_b16 a[62:63], v7 offset:4608
	s_waitcnt lgkmcnt(0)
	ds_read_b128 v[64:67], v10 offset:4096
	ds_read_b128 v[68:71], v10 offset:5120
	ds_read_b128 v[72:75], v13 offset:4096
	ds_read_b128 v[76:79], v13 offset:5120
	s_waitcnt lgkmcnt(4)
	v_mfma_f32_16x16x32_bf16 v[16:19], v[48:51], a[48:51], v[16:19]
	v_mfma_f32_16x16x32_bf16 v[24:27], v[48:51], a[52:55], v[24:27]
	v_mfma_f32_16x16x32_bf16 v[32:35], v[48:51], a[56:59], v[32:35]
	v_mfma_f32_16x16x32_bf16 v[40:43], v[48:51], a[60:63], v[40:43]
	v_mfma_f32_16x16x32_bf16 v[20:23], v[52:55], a[48:51], v[20:23]
	v_mfma_f32_16x16x32_bf16 v[28:31], v[52:55], a[52:55], v[28:31]
	v_mfma_f32_16x16x32_bf16 v[36:39], v[52:55], a[56:59], v[36:39]
	v_mfma_f32_16x16x32_bf16 v[44:47], v[52:55], a[60:63], v[44:47]
	v_mfma_f32_16x16x32_bf16 v[112:115], v[56:59], a[48:51], v[112:115]
	v_mfma_f32_16x16x32_bf16 v[120:123], v[56:59], a[52:55], v[120:123]
	v_mfma_f32_16x16x32_bf16 v[128:131], v[56:59], a[56:59], v[128:131]
	v_mfma_f32_16x16x32_bf16 v[136:139], v[56:59], a[60:63], v[136:139]
	v_mfma_f32_16x16x32_bf16 v[116:119], v[60:63], a[48:51], v[116:119]
	v_mfma_f32_16x16x32_bf16 v[124:127], v[60:63], a[52:55], v[124:127]
	v_mfma_f32_16x16x32_bf16 v[132:135], v[60:63], a[56:59], v[132:135]
	v_mfma_f32_16x16x32_bf16 v[140:143], v[60:63], a[60:63], v[140:143]
	s_waitcnt vmcnt(9)
	ds_read_b64_tr_b16 a[32:33], v4 offset:8192
	ds_read_b64_tr_b16 a[34:35], v4 offset:8704
	ds_read_b64_tr_b16 a[36:37], v5 offset:8192
	ds_read_b64_tr_b16 a[38:39], v5 offset:8704
	ds_read_b64_tr_b16 a[40:41], v6 offset:8192
	ds_read_b64_tr_b16 a[42:43], v6 offset:8704
	ds_read_b64_tr_b16 a[44:45], v7 offset:8192
	ds_read_b64_tr_b16 a[46:47], v7 offset:8704
	s_waitcnt lgkmcnt(0)
	ds_read_b128 v[48:51], v10 offset:2048
	ds_read_b128 v[52:55], v10 offset:3072
	ds_read_b128 v[56:59], v13 offset:2048
	ds_read_b128 v[60:63], v13 offset:3072
	s_waitcnt lgkmcnt(4)
	v_mfma_f32_16x16x32_bf16 v[16:19], v[64:67], a[32:35], v[16:19]
	v_mfma_f32_16x16x32_bf16 v[24:27], v[64:67], a[36:39], v[24:27]
	v_mfma_f32_16x16x32_bf16 v[32:35], v[64:67], a[40:43], v[32:35]
	v_mfma_f32_16x16x32_bf16 v[40:43], v[64:67], a[44:47], v[40:43]
	v_mfma_f32_16x16x32_bf16 v[20:23], v[68:71], a[32:35], v[20:23]
	v_mfma_f32_16x16x32_bf16 v[28:31], v[68:71], a[36:39], v[28:31]
	v_mfma_f32_16x16x32_bf16 v[36:39], v[68:71], a[40:43], v[36:39]
	v_mfma_f32_16x16x32_bf16 v[44:47], v[68:71], a[44:47], v[44:47]
	v_mfma_f32_16x16x32_bf16 v[112:115], v[72:75], a[32:35], v[112:115]
	v_mfma_f32_16x16x32_bf16 v[120:123], v[72:75], a[36:39], v[120:123]
	v_mfma_f32_16x16x32_bf16 v[128:131], v[72:75], a[40:43], v[128:131]
	v_mfma_f32_16x16x32_bf16 v[136:139], v[72:75], a[44:47], v[136:139]
	v_mfma_f32_16x16x32_bf16 v[116:119], v[76:79], a[32:35], v[116:119]
	v_mfma_f32_16x16x32_bf16 v[124:127], v[76:79], a[36:39], v[124:127]
	v_mfma_f32_16x16x32_bf16 v[132:135], v[76:79], a[40:43], v[132:135]
	v_mfma_f32_16x16x32_bf16 v[140:143], v[76:79], a[44:47], v[140:143]
	s_waitcnt vmcnt(4)
	ds_read_b64_tr_b16 a[16:17], v4 offset:12288
	ds_read_b64_tr_b16 a[18:19], v4 offset:12800
	ds_read_b64_tr_b16 a[20:21], v5 offset:12288
	ds_read_b64_tr_b16 a[22:23], v5 offset:12800
	ds_read_b64_tr_b16 a[24:25], v6 offset:12288
	ds_read_b64_tr_b16 a[26:27], v6 offset:12800
	ds_read_b64_tr_b16 a[28:29], v7 offset:12288
	ds_read_b64_tr_b16 a[30:31], v7 offset:12800
	s_waitcnt lgkmcnt(0)
	ds_read_b128 v[64:67], v10 offset:0
	ds_read_b128 v[68:71], v10 offset:1024
	ds_read_b128 v[72:75], v13 offset:0
	ds_read_b128 v[76:79], v13 offset:1024
	s_waitcnt lgkmcnt(4)
	v_mfma_f32_16x16x32_bf16 v[16:19], v[48:51], a[16:19], v[16:19]
	v_mfma_f32_16x16x32_bf16 v[24:27], v[48:51], a[20:23], v[24:27]
	v_mfma_f32_16x16x32_bf16 v[32:35], v[48:51], a[24:27], v[32:35]
	v_mfma_f32_16x16x32_bf16 v[40:43], v[48:51], a[28:31], v[40:43]
	v_mfma_f32_16x16x32_bf16 v[20:23], v[52:55], a[16:19], v[20:23]
	v_mfma_f32_16x16x32_bf16 v[28:31], v[52:55], a[20:23], v[28:31]
	v_mfma_f32_16x16x32_bf16 v[36:39], v[52:55], a[24:27], v[36:39]
	v_mfma_f32_16x16x32_bf16 v[44:47], v[52:55], a[28:31], v[44:47]
	v_mfma_f32_16x16x32_bf16 v[112:115], v[56:59], a[16:19], v[112:115]
	v_mfma_f32_16x16x32_bf16 v[120:123], v[56:59], a[20:23], v[120:123]
	v_mfma_f32_16x16x32_bf16 v[128:131], v[56:59], a[24:27], v[128:131]
	v_mfma_f32_16x16x32_bf16 v[136:139], v[56:59], a[28:31], v[136:139]
	v_mfma_f32_16x16x32_bf16 v[116:119], v[60:63], a[16:19], v[116:119]
	v_mfma_f32_16x16x32_bf16 v[124:127], v[60:63], a[20:23], v[124:127]
	v_mfma_f32_16x16x32_bf16 v[132:135], v[60:63], a[24:27], v[132:135]
	v_mfma_f32_16x16x32_bf16 v[140:143], v[60:63], a[28:31], v[140:143]
	s_waitcnt vmcnt(8)
	v_readfirstlane_b32 s6, v150
	s_nop 0
	s_cmp_ge_u32 s6, 256
	s_cbranch_scc1 L_swok_114
	v_mov_b32 v153, 128
L_sw_113:
	buffer_load_dwordx3 v[150:152], v153, s[40:43], 0 offen sc1
	s_waitcnt vmcnt(0)
	v_readfirstlane_b32 s6, v150
	s_nop 0
	s_cmp_ge_u32 s6, 256
	s_cbranch_scc1 L_swok_114
	s_sleep 4
	s_add_u32 s34, s34, 1
	s_cmp_lt_u32 s34, 0x40000
	s_cbranch_scc1 L_sw_113
	s_endpgm
L_swok_114:
	v_readfirstlane_b32 s74, v151
	v_readfirstlane_b32 s75, v152
	s_add_u32 s80, s61, 1
	s_cmp_eq_u32 s61, 2
	s_cselect_b32 s80, s72, s80
	s_cselect_b32 s81, 1, 0
	s_cselect_b32 s83, 3, s72
	s_lshl_b32 s73, s71, 2
	s_add_u32 s73, s73, s80
	s_lshl_b32 s73, s73, 19
	s_lshr_b32 s78, s74, s71
	s_xor_b32 s78, s78, s81
	s_and_b32 s78, s78, 1
	s_lshl_b32 s78, s78, 13
	s_add_u32 s73, s73, s78
	s_add_u32 s78, s71, s83
	s_bfe_u32 s79, s78, 0x10001
	s_lshl_b32 s79, s79, 14
	s_and_b32 s78, s78, 1
	s_lshl_b32 s78, s78, 12
	s_add_u32 s78, s78, s79
	s_add_u32 s73, s73, s78
	v_lshl_add_u32 v11, v0, 4, s73
	s_lshl_b32 s73, s71, 2
	s_add_u32 s73, s73, 0
	s_lshl_b32 s73, s73, 19
	s_lshr_b32 s78, s74, s71
	s_xor_b32 s78, s78, 0
	s_and_b32 s78, s78, 1
	s_lshl_b32 s78, s78, 13
	s_add_u32 s73, s73, s78
	v_add_u32 v12, s78, v12
	s_cmp_eq_u32 s61, 2
	s_cselect_b32 s73, 0xfe00000, s73
	s_add_u32 s78, s71, s72
	s_bfe_u32 s79, s78, 0x10001
	s_lshl_b32 s79, s79, 14
	s_and_b32 s78, s78, 1
	s_lshl_b32 s78, s78, 12
	s_add_u32 s78, s78, s79
	s_add_u32 s77, s73, s78
	s_add_u32 s78, s71, 3
	s_bfe_u32 s79, s78, 0x10001
	s_lshl_b32 s79, s79, 14
	s_and_b32 s78, s78, 1
	s_lshl_b32 s78, s78, 12
	s_add_u32 s78, s78, s79
	s_add_u32 s73, s73, s78
	s_lshl_b32 s78, s61, 11
	s_add_u32 s77, s77, s78
	v_lshl_add_u32 v96, v0, 4, s77
	s_lshl_b32 s78, s72, 10
	s_add_u32 s73, s73, s78
	v_lshl_add_u32 v97, v0, 4, s73
	v_cmp_le_u32 vcc, 32, v0
	s_and_b32 s78, s74, 1
	s_lshl_b32 s78, s78, 13
	s_add_u32 s78, s78, 0x180000
	s_and_b32 s79, s74, 16
	s_lshl_b32 s79, s79, 9
	s_add_u32 s79, s79, 0x980000
	v_mov_b32 v150, s78
	v_mov_b32 v151, s79
	v_cndmask_b32 v150, v150, v151, vcc
	s_mul_i32 s73, s72, 3
	s_add_u32 s73, s73, 1
	s_cmp_eq_u32 s72, 0
	s_cselect_b32 s73, 0, s73
	s_lshr_b32 s78, s71, 3
	s_add_u32 s73, s73, s78
	s_cmp_ge_u32 s71, 24
	s_cselect_b32 s78, s72, 0
	s_add_u32 s79, s78, 9
	s_cmp_lg_u32 s78, 0
	s_cselect_b32 s73, s79, s73
	s_lshr_b32 s78, s73, 3
	s_lshl_b32 s78, s78, 14
	s_and_b32 s73, s73, 7
	s_lshl_b32 s73, s73, 10
	s_add_u32 s73, s73, s78
	s_and_b32 s78, s71, 7
	s_lshl_b32 s78, s78, 7
	s_add_u32 s73, s73, s78
	v_and_b32 v151, 31, v0
	v_lshl_add_u32 v150, v151, 2, v150
	v_add_u32 v99, s73, v150
	s_mov_b32 s69, 0xfe00000
	s_mov_b32 s76, 0
	v_mov_b32 v150, s69
	v_cmp_gt_u32 vcc, 16, v0
	s_nop 1
	v_cndmask_b32 v12, v150, v12, vcc
	v_mov_b32 v100, -1
	v_mov_b32 v101, -1
	v_mov_b32 v102, -1
	v_mov_b32 v103, -1
	buffer_store_dwordx4 v[100:103], v96, s[36:39], s76 offen offset:0 sc1
	buffer_store_dwordx4 v[100:103], v96, s[36:39], s76 offen offset:1024 sc1
	buffer_store_dword v100, v99, s[36:39], s76 offen sc1
	s_add_u32 s76, s76, 32768
	buffer_store_dwordx4 v[100:103], v96, s[36:39], s76 offen offset:0 sc1
	buffer_store_dwordx4 v[100:103], v96, s[36:39], s76 offen offset:1024 sc1
	buffer_store_dword v100, v99, s[36:39], s76 offen sc1
	s_add_u32 s76, s76, 32768
	s_waitcnt vmcnt(6)
	ds_read_b64_tr_b16 a[0:1], v4 offset:16384
	ds_read_b64_tr_b16 a[2:3], v4 offset:16896
	ds_read_b64_tr_b16 a[4:5], v5 offset:16384
	ds_read_b64_tr_b16 a[6:7], v5 offset:16896
	ds_read_b64_tr_b16 a[8:9], v6 offset:16384
	ds_read_b64_tr_b16 a[10:11], v6 offset:16896
	ds_read_b64_tr_b16 a[12:13], v7 offset:16384
	ds_read_b64_tr_b16 a[14:15], v7 offset:16896
	s_waitcnt lgkmcnt(0)
	s_waitcnt lgkmcnt(0)
	v_mfma_f32_16x16x32_bf16 v[16:19], v[64:67], a[0:3], v[16:19]
	v_mfma_f32_16x16x32_bf16 v[24:27], v[64:67], a[4:7], v[24:27]
	v_mfma_f32_16x16x32_bf16 v[32:35], v[64:67], a[8:11], v[32:35]
	v_mfma_f32_16x16x32_bf16 v[40:43], v[64:67], a[12:15], v[40:43]
	v_mfma_f32_16x16x32_bf16 v[20:23], v[68:71], a[0:3], v[20:23]
	v_mfma_f32_16x16x32_bf16 v[28:31], v[68:71], a[4:7], v[28:31]
	v_mfma_f32_16x16x32_bf16 v[36:39], v[68:71], a[8:11], v[36:39]
	v_mfma_f32_16x16x32_bf16 v[44:47], v[68:71], a[12:15], v[44:47]
	v_mfma_f32_16x16x32_bf16 v[112:115], v[72:75], a[0:3], v[112:115]
	v_mfma_f32_16x16x32_bf16 v[120:123], v[72:75], a[4:7], v[120:123]
	v_mfma_f32_16x16x32_bf16 v[128:131], v[72:75], a[8:11], v[128:131]
	v_mfma_f32_16x16x32_bf16 v[136:139], v[72:75], a[12:15], v[136:139]
	v_mfma_f32_16x16x32_bf16 v[116:119], v[76:79], a[0:3], v[116:119]
	v_mfma_f32_16x16x32_bf16 v[124:127], v[76:79], a[4:7], v[124:127]
	v_mfma_f32_16x16x32_bf16 v[132:135], v[76:79], a[8:11], v[132:135]
	v_mfma_f32_16x16x32_bf16 v[140:143], v[76:79], a[12:15], v[140:143]
	s_mov_b32 s69, 0
	v_cvt_pk_bf16_f32 v80, v16, v17
	v_cvt_pk_bf16_f32 v81, v18, v19
	v_cvt_pk_bf16_f32 v82, v20, v21
	v_cvt_pk_bf16_f32 v83, v22, v23
	buffer_store_dwordx4 v[80:83], v11, s[36:39], s69 offen offset:0 sc1
	v_cvt_pk_bf16_f32 v84, v24, v25
	v_cvt_pk_bf16_f32 v85, v26, v27
	v_cvt_pk_bf16_f32 v86, v28, v29
	v_cvt_pk_bf16_f32 v87, v30, v31
	buffer_store_dwordx4 v[84:87], v11, s[36:39], s69 offen offset:1024 sc1
	v_cvt_pk_bf16_f32 v88, v32, v33
	v_cvt_pk_bf16_f32 v89, v34, v35
	v_cvt_pk_bf16_f32 v90, v36, v37
	v_cvt_pk_bf16_f32 v91, v38, v39
	buffer_store_dwordx4 v[88:91], v11, s[36:39], s69 offen offset:2048 sc1
	v_cvt_pk_bf16_f32 v92, v40, v41
	v_cvt_pk_bf16_f32 v93, v42, v43
	v_cvt_pk_bf16_f32 v94, v44, v45
	v_cvt_pk_bf16_f32 v95, v46, v47
	buffer_store_dwordx4 v[92:95], v11, s[36:39], s69 offen offset:3072 sc1
	s_mov_b32 s69, 32768
	v_cvt_pk_bf16_f32 v80, v112, v113
	v_cvt_pk_bf16_f32 v81, v114, v115
	v_cvt_pk_bf16_f32 v82, v116, v117
	v_cvt_pk_bf16_f32 v83, v118, v119
	buffer_store_dwordx4 v[80:83], v11, s[36:39], s69 offen offset:0 sc1
	v_cvt_pk_bf16_f32 v84, v120, v121
	v_cvt_pk_bf16_f32 v85, v122, v123
	v_cvt_pk_bf16_f32 v86, v124, v125
	v_cvt_pk_bf16_f32 v87, v126, v127
	buffer_store_dwordx4 v[84:87], v11, s[36:39], s69 offen offset:1024 sc1
	v_cvt_pk_bf16_f32 v88, v128, v129
	v_cvt_pk_bf16_f32 v89, v130, v131
	v_cvt_pk_bf16_f32 v90, v132, v133
	v_cvt_pk_bf16_f32 v91, v134, v135
	buffer_store_dwordx4 v[88:91], v11, s[36:39], s69 offen offset:2048 sc1
	v_cvt_pk_bf16_f32 v92, v136, v137
	v_cvt_pk_bf16_f32 v93, v138, v139
	v_cvt_pk_bf16_f32 v94, v140, v141
	v_cvt_pk_bf16_f32 v95, v142, v143
	buffer_store_dwordx4 v[92:95], v11, s[36:39], s69 offen offset:3072 sc1
	s_barrier
	s_add_u32 m0, s67, 0
	s_nop 0
	buffer_load_dwordx4 v8, s[48:51], s68 offen offset:0 lds
	s_add_u32 m0, s67, 1024
	s_nop 0
	buffer_load_dwordx4 v9, s[48:51], s68 offen offset:0 lds
	s_add_u32 m0, s67, 1984
	s_nop 0
	buffer_load_dwordx4 v8, s[48:51], s68 offen offset:64 lds
	s_add_u32 m0, s67, 3008
	s_nop 0
	buffer_load_dwordx4 v9, s[48:51], s68 offen offset:64 lds
	s_add_u32 m0, s67, 3968
	s_nop 0
	buffer_load_dwordx4 v8, s[48:51], s68 offen offset:128 lds
	s_add_u32 m0, s67, 4992
	s_nop 0
	buffer_load_dwordx4 v9, s[48:51], s68 offen offset:128 lds
	s_add_u32 m0, s67, 5952
	s_nop 0
	buffer_load_dwordx4 v8, s[48:51], s68 offen offset:192 lds
	s_add_u32 m0, s67, 6976
	s_nop 0
	buffer_load_dwordx4 v9, s[48:51], s68 offen offset:192 lds
	s_add_u32 m0, s67, 7936
	s_nop 0
	buffer_load_dwordx4 v8, s[48:51], s68 offen offset:256 lds
	s_add_u32 m0, s67, 8960
	s_nop 0
	buffer_load_dwordx4 v9, s[48:51], s68 offen offset:256 lds
	s_add_u32 s67, s67, 40960
	s_add_u32 s68, s68, 40960
	s_sub_u32 s67, s67, 122880
	s_mov_b32 s69, 0xfe00000
	s_mov_b32 s66, 2
	s_mov_b32 s70, 81920
	v_mov_b32 v106, s66
	s_waitcnt vmcnt(10)
	buffer_store_dword v106, v12, s[36:39], 0 offen sc1
	s_add_u32 m0, s67, 0
	s_nop 0
	buffer_load_dwordx4 v8, s[48:51], s68 offen offset:0 lds
	s_add_u32 m0, s67, 1024
	s_nop 0
	buffer_load_dwordx4 v9, s[48:51], s68 offen offset:0 lds
	s_add_u32 m0, s67, 1984
	s_nop 0
	buffer_load_dwordx4 v8, s[48:51], s68 offen offset:64 lds
	s_add_u32 m0, s67, 3008
	s_nop 0
	buffer_load_dwordx4 v9, s[48:51], s68 offen offset:64 lds
	s_add_u32 m0, s67, 3968
	s_nop 0
	buffer_load_dwordx4 v8, s[48:51], s68 offen offset:128 lds
	s_add_u32 m0, s67, 4992
	s_nop 0
	buffer_load_dwordx4 v9, s[48:51], s68 offen offset:128 lds
	s_add_u32 m0, s67, 5952
	s_nop 0
	buffer_load_dwordx4 v8, s[48:51], s68 offen offset:192 lds
	s_add_u32 m0, s67, 6976
	s_nop 0
	buffer_load_dwordx4 v9, s[48:51], s68 offen offset:192 lds
	s_add_u32 m0, s67, 7936
	s_nop 0
	buffer_load_dwordx4 v8, s[48:51], s68 offen offset:256 lds
	s_add_u32 m0, s67, 8960
	s_nop 0
	buffer_load_dwordx4 v9, s[48:51], s68 offen offset:256 lds
	s_add_u32 s67, s67, 40960
	s_add_u32 s68, s68, 40960
	s_waitcnt vmcnt(11)
	s_branch L_projv
.p2align 6
L_projk:
	s_barrier
	v_add_u32 v13, s70, v10
	ds_read_b128 v[48:51], v13 offset:0
	ds_read_b128 v[52:55], v13 offset:1024
	ds_read_b128 v[56:59], v13 offset:2048
	ds_read_b128 v[60:63], v13 offset:3072
L_p_115:
	ds_read_b128 v[64:67], v13 offset:4096
	ds_read_b128 v[68:71], v13 offset:5120
	s_waitcnt lgkmcnt(4)
	v_mfma_f32_16x16x32_bf16 v[16:19], a[0:3], v[48:51], 0
	s_add_u32 s70, s70, 40960
	s_cmp_eq_u32 s70, 122880
	v_mfma_f32_16x16x32_bf16 v[24:27], a[4:7], v[48:51], 0
	s_cselect_b32 s70, 0, s70
	s_sub_u32 s82, s66, 12
	v_mfma_f32_16x16x32_bf16 v[32:35], a[8:11], v[48:51], 0
	v_cmp_gt_i32 vcc, s82, v105
	v_mfma_f32_16x16x32_bf16 v[40:43], a[12:15], v[48:51], 0
	v_mfma_f32_16x16x32_bf16 v[20:23], a[0:3], v[52:55], 0
	s_cbranch_vccnz L_pw_117
L_pg_116:
	v_mfma_f32_16x16x32_bf16 v[28:31], a[4:7], v[52:55], 0
	buffer_load_dword v105, v104, s[36:39], 0 offen sc1
	v_mfma_f32_16x16x32_bf16 v[36:39], a[8:11], v[52:55], 0
	v_mfma_f32_16x16x32_bf16 v[44:47], a[12:15], v[52:55], 0
	ds_read_b128 v[72:75], v13 offset:6144
	ds_read_b128 v[76:79], v13 offset:7168
	s_waitcnt lgkmcnt(4)
	v_mfma_f32_16x16x32_bf16 v[16:19], a[16:19], v[56:59], v[16:19]
	v_cvt_pk_bf16_f32 v80, v112, v113
	v_mfma_f32_16x16x32_bf16 v[24:27], a[20:23], v[56:59], v[24:27]
	v_cvt_pk_bf16_f32 v81, v114, v115
	v_mfma_f32_16x16x32_bf16 v[32:35], a[24:27], v[56:59], v[32:35]
	v_cvt_pk_bf16_f32 v82, v120, v121
	v_mfma_f32_16x16x32_bf16 v[40:43], a[28:31], v[56:59], v[40:43]
	v_cvt_pk_bf16_f32 v83, v122, v123
	v_mfma_f32_16x16x32_bf16 v[20:23], a[16:19], v[60:63], v[20:23]
	v_mfma_f32_16x16x32_bf16 v[28:31], a[20:23], v[60:63], v[28:31]
	buffer_store_dwordx4 v[80:83], v11, s[36:39], s69 offen offset:0 sc1
	v_mfma_f32_16x16x32_bf16 v[36:39], a[24:27], v[60:63], v[36:39]
	v_mfma_f32_16x16x32_bf16 v[44:47], a[28:31], v[60:63], v[44:47]
	ds_read_b128 v[48:51], v13 offset:8192
	ds_read_b128 v[52:55], v13 offset:9216
	s_waitcnt lgkmcnt(4)
	v_mfma_f32_16x16x32_bf16 v[16:19], a[32:35], v[64:67], v[16:19]
	v_cvt_pk_bf16_f32 v84, v116, v117
	v_mfma_f32_16x16x32_bf16 v[24:27], a[36:39], v[64:67], v[24:27]
	v_cvt_pk_bf16_f32 v85, v118, v119
	v_mfma_f32_16x16x32_bf16 v[32:35], a[40:43], v[64:67], v[32:35]
	v_cvt_pk_bf16_f32 v86, v124, v125
	v_mfma_f32_16x16x32_bf16 v[40:43], a[44:47], v[64:67], v[40:43]
	v_cvt_pk_bf16_f32 v87, v126, v127
	v_mfma_f32_16x16x32_bf16 v[20:23], a[32:35], v[68:71], v[20:23]
	v_mfma_f32_16x16x32_bf16 v[28:31], a[36:39], v[68:71], v[28:31]
	buffer_store_dwordx4 v[84:87], v11, s[36:39], s69 offen offset:1024 sc1
	v_mfma_f32_16x16x32_bf16 v[36:39], a[40:43], v[68:71], v[36:39]
	v_mfma_f32_16x16x32_bf16 v[44:47], a[44:47], v[68:71], v[44:47]
	ds_read_b128 v[56:59], v13 offset:10240
	ds_read_b128 v[60:63], v13 offset:11264
	s_waitcnt lgkmcnt(4)
	v_mfma_f32_16x16x32_bf16 v[16:19], a[48:51], v[72:75], v[16:19]
	v_cvt_pk_bf16_f32 v88, v128, v129
	v_mfma_f32_16x16x32_bf16 v[24:27], a[52:55], v[72:75], v[24:27]
	v_cvt_pk_bf16_f32 v89, v130, v131
	v_mfma_f32_16x16x32_bf16 v[32:35], a[56:59], v[72:75], v[32:35]
	v_cvt_pk_bf16_f32 v90, v136, v137
	v_mfma_f32_16x16x32_bf16 v[40:43], a[60:63], v[72:75], v[40:43]
	v_cvt_pk_bf16_f32 v91, v138, v139
	v_mfma_f32_16x16x32_bf16 v[20:23], a[48:51], v[76:79], v[20:23]
	v_mfma_f32_16x16x32_bf16 v[28:31], a[52:55], v[76:79], v[28:31]
	buffer_store_dwordx4 v[88:91], v11, s[36:39], s69 offen offset:2048 sc1
	v_mfma_f32_16x16x32_bf16 v[36:39], a[56:59], v[76:79], v[36:39]
	v_mfma_f32_16x16x32_bf16 v[44:47], a[60:63], v[76:79], v[44:47]
	ds_read_b128 v[64:67], v13 offset:12288
	ds_read_b128 v[68:71], v13 offset:13312
	s_waitcnt lgkmcnt(4)
	v_mfma_f32_16x16x32_bf16 v[16:19], a[64:67], v[48:51], v[16:19]
	v_cvt_pk_bf16_f32 v92, v132, v133
	v_mfma_f32_16x16x32_bf16 v[24:27], a[68:71], v[48:51], v[24:27]
	v_cvt_pk_bf16_f32 v93, v134, v135
	v_mfma_f32_16x16x32_bf16 v[32:35], a[72:75], v[48:51], v[32:35]
	v_cvt_pk_bf16_f32 v94, v140, v141
	v_mfma_f32_16x16x32_bf16 v[40:43], a[76:79], v[48:51], v[40:43]
	v_cvt_pk_bf16_f32 v95, v142, v143
	v_mfma_f32_16x16x32_bf16 v[20:23], a[64:67], v[52:55], v[20:23]
	v_mfma_f32_16x16x32_bf16 v[28:31], a[68:71], v[52:55], v[28:31]
	buffer_store_dwordx4 v[92:95], v11, s[36:39], s69 offen offset:3072 sc1
	v_mfma_f32_16x16x32_bf16 v[36:39], a[72:75], v[52:55], v[36:39]
	v_mfma_f32_16x16x32_bf16 v[44:47], a[76:79], v[52:55], v[44:47]
	ds_read_b128 v[72:75], v13 offset:14336
	ds_read_b128 v[76:79], v13 offset:15360
	s_waitcnt lgkmcnt(4)
	v_mfma_f32_16x16x32_bf16 v[16:19], a[80:83], v[56:59], v[16:19]
	v_mfma_f32_16x16x32_bf16 v[24:27], a[84:87], v[56:59], v[24:27]
	v_mfma_f32_16x16x32_bf16 v[32:35], a[88:91], v[56:59], v[32:35]
	s_add_u32 m0, s67, 0
	v_mfma_f32_16x16x32_bf16 v[40:43], a[92:95], v[56:59], v[40:43]
	buffer_load_dwordx4 v8, s[48:51], s68 offen offset:0 lds
	v_mfma_f32_16x16x32_bf16 v[20:23], a[80:83], v[60:63], v[20:23]
	v_mfma_f32_16x16x32_bf16 v[28:31], a[84:87], v[60:63], v[28:31]
	v_mfma_f32_16x16x32_bf16 v[36:39], a[88:91], v[60:63], v[36:39]
	v_mfma_f32_16x16x32_bf16 v[44:47], a[92:95], v[60:63], v[44:47]
	ds_read_b128 v[48:51], v13 offset:16384
	ds_read_b128 v[52:55], v13 offset:17408
	s_waitcnt lgkmcnt(4)
	v_mfma_f32_16x16x32_bf16 v[16:19], a[96:99], v[64:67], v[16:19]
	v_mfma_f32_16x16x32_bf16 v[24:27], a[100:103], v[64:67], v[24:27]
	v_mfma_f32_16x16x32_bf16 v[32:35], a[104:107], v[64:67], v[32:35]
	s_add_u32 m0, s67, 1024
	v_mfma_f32_16x16x32_bf16 v[40:43], a[108:111], v[64:67], v[40:43]
	buffer_load_dwordx4 v9, s[48:51], s68 offen offset:0 lds
	v_mfma_f32_16x16x32_bf16 v[20:23], a[96:99], v[68:71], v[20:23]
	v_mfma_f32_16x16x32_bf16 v[28:31], a[100:103], v[68:71], v[28:31]
	v_mfma_f32_16x16x32_bf16 v[36:39], a[104:107], v[68:71], v[36:39]
	v_mfma_f32_16x16x32_bf16 v[44:47], a[108:111], v[68:71], v[44:47]
	ds_read_b128 v[56:59], v13 offset:18432
	ds_read_b128 v[60:63], v13 offset:19456
	s_waitcnt lgkmcnt(4)
	v_mfma_f32_16x16x32_bf16 v[16:19], a[112:115], v[72:75], v[16:19]
	v_mfma_f32_16x16x32_bf16 v[24:27], a[116:119], v[72:75], v[24:27]
	v_mfma_f32_16x16x32_bf16 v[32:35], a[120:123], v[72:75], v[32:35]
	s_add_u32 m0, s67, 1984
	v_mfma_f32_16x16x32_bf16 v[40:43], a[124:127], v[72:75], v[40:43]
	buffer_load_dwordx4 v8, s[48:51], s68 offen offset:64 lds
	v_mfma_f32_16x16x32_bf16 v[20:23], a[112:115], v[76:79], v[20:23]
	v_mfma_f32_16x16x32_bf16 v[28:31], a[116:119], v[76:79], v[28:31]
	v_mfma_f32_16x16x32_bf16 v[36:39], a[120:123], v[76:79], v[36:39]
	v_mfma_f32_16x16x32_bf16 v[44:47], a[124:127], v[76:79], v[44:47]
	ds_read_b128 v[64:67], v13 offset:20480
	ds_read_b128 v[68:71], v13 offset:21504
	s_waitcnt lgkmcnt(4)
	v_mfma_f32_16x16x32_bf16 v[16:19], a[128:131], v[48:51], v[16:19]
	v_mfma_f32_16x16x32_bf16 v[24:27], a[132:135], v[48:51], v[24:27]
	v_mfma_f32_16x16x32_bf16 v[32:35], a[136:139], v[48:51], v[32:35]
	s_add_u32 m0, s67, 3008
	v_mfma_f32_16x16x32_bf16 v[40:43], a[140:143], v[48:51], v[40:43]
	buffer_load_dwordx4 v9, s[48:51], s68 offen offset:64 lds
	v_mfma_f32_16x16x32_bf16 v[20:23], a[128:131], v[52:55], v[20:23]
	v_mfma_f32_16x16x32_bf16 v[28:31], a[132:135], v[52:55], v[28:31]
	v_mfma_f32_16x16x32_bf16 v[36:39], a[136:139], v[52:55], v[36:39]
	v_mfma_f32_16x16x32_bf16 v[44:47], a[140:143], v[52:55], v[44:47]
	ds_read_b128 v[72:75], v13 offset:22528
	ds_read_b128 v[76:79], v13 offset:23552
	s_waitcnt lgkmcnt(4)
	v_mfma_f32_16x16x32_bf16 v[16:19], a[144:147], v[56:59], v[16:19]
	v_mfma_f32_16x16x32_bf16 v[24:27], a[148:151], v[56:59], v[24:27]
	v_mfma_f32_16x16x32_bf16 v[32:35], a[152:155], v[56:59], v[32:35]
	s_add_u32 m0, s67, 3968
	v_mfma_f32_16x16x32_bf16 v[40:43], a[156:159], v[56:59], v[40:43]
	buffer_load_dwordx4 v8, s[48:51], s68 offen offset:128 lds
	v_mfma_f32_16x16x32_bf16 v[20:23], a[144:147], v[60:63], v[20:23]
	v_mfma_f32_16x16x32_bf16 v[28:31], a[148:151], v[60:63], v[28:31]
	v_mfma_f32_16x16x32_bf16 v[36:39], a[152:155], v[60:63], v[36:39]
	v_mfma_f32_16x16x32_bf16 v[44:47], a[156:159], v[60:63], v[44:47]
	ds_read_b128 v[48:51], v13 offset:24576
	ds_read_b128 v[52:55], v13 offset:25600
	s_waitcnt lgkmcnt(4)
	v_mfma_f32_16x16x32_bf16 v[16:19], a[160:163], v[64:67], v[16:19]
	v_mfma_f32_16x16x32_bf16 v[24:27], a[164:167], v[64:67], v[24:27]
	v_mfma_f32_16x16x32_bf16 v[32:35], a[168:171], v[64:67], v[32:35]
	s_add_u32 m0, s67, 4992
	v_mfma_f32_16x16x32_bf16 v[40:43], a[172:175], v[64:67], v[40:43]
	buffer_load_dwordx4 v9, s[48:51], s68 offen offset:128 lds
	v_mfma_f32_16x16x32_bf16 v[20:23], a[160:163], v[68:71], v[20:23]
	v_mfma_f32_16x16x32_bf16 v[28:31], a[164:167], v[68:71], v[28:31]
	v_mfma_f32_16x16x32_bf16 v[36:39], a[168:171], v[68:71], v[36:39]
	v_mfma_f32_16x16x32_bf16 v[44:47], a[172:175], v[68:71], v[44:47]
	ds_read_b128 v[56:59], v13 offset:26624
	ds_read_b128 v[60:63], v13 offset:27648
	s_waitcnt lgkmcnt(4)
	v_mfma_f32_16x16x32_bf16 v[16:19], a[176:179], v[72:75], v[16:19]
	v_mfma_f32_16x16x32_bf16 v[24:27], a[180:183], v[72:75], v[24:27]
	v_mfma_f32_16x16x32_bf16 v[32:35], a[184:187], v[72:75], v[32:35]
	s_add_u32 m0, s67, 5952
	v_mfma_f32_16x16x32_bf16 v[40:43], a[188:191], v[72:75], v[40:43]
	buffer_load_dwordx4 v8, s[48:51], s68 offen offset:192 lds
	v_mfma_f32_16x16x32_bf16 v[20:23], a[176:179], v[76:79], v[20:23]
	v_mfma_f32_16x16x32_bf16 v[28:31], a[180:183], v[76:79], v[28:31]
	v_mfma_f32_16x16x32_bf16 v[36:39], a[184:187], v[76:79], v[36:39]
	s_cmp_le_u32 s66, 6
	s_cbranch_scc1 L_pf_119
L_pe_118:
	v_mfma_f32_16x16x32_bf16 v[44:47], a[188:191], v[76:79], v[44:47]
	ds_read_b128 v[64:67], v13 offset:28672
	ds_read_b128 v[68:71], v13 offset:29696
	s_waitcnt lgkmcnt(4)
	v_mfma_f32_16x16x32_bf16 v[16:19], a[192:195], v[48:51], v[16:19]
	v_mfma_f32_16x16x32_bf16 v[24:27], a[196:199], v[48:51], v[24:27]
	v_mfma_f32_16x16x32_bf16 v[32:35], a[200:203], v[48:51], v[32:35]
	s_add_u32 m0, s67, 6976
	v_mfma_f32_16x16x32_bf16 v[40:43], a[204:207], v[48:51], v[40:43]
	buffer_load_dwordx4 v9, s[48:51], s68 offen offset:192 lds
	v_mfma_f32_16x16x32_bf16 v[20:23], a[192:195], v[52:55], v[20:23]
	v_mfma_f32_16x16x32_bf16 v[28:31], a[196:199], v[52:55], v[28:31]
	v_mfma_f32_16x16x32_bf16 v[36:39], a[200:203], v[52:55], v[36:39]
	v_mfma_f32_16x16x32_bf16 v[44:47], a[204:207], v[52:55], v[44:47]
	ds_read_b128 v[72:75], v13 offset:30720
	ds_read_b128 v[76:79], v13 offset:31744
	s_waitcnt lgkmcnt(4)
	v_mfma_f32_16x16x32_bf16 v[16:19], a[208:211], v[56:59], v[16:19]
	v_mfma_f32_16x16x32_bf16 v[24:27], a[212:215], v[56:59], v[24:27]
	v_mfma_f32_16x16x32_bf16 v[32:35], a[216:219], v[56:59], v[32:35]
	s_add_u32 m0, s67, 7936
	v_mfma_f32_16x16x32_bf16 v[40:43], a[220:223], v[56:59], v[40:43]
	buffer_load_dwordx4 v8, s[48:51], s68 offen offset:256 lds
	v_mfma_f32_16x16x32_bf16 v[20:23], a[208:211], v[60:63], v[20:23]
	v_mfma_f32_16x16x32_bf16 v[28:31], a[212:215], v[60:63], v[28:31]
	v_mfma_f32_16x16x32_bf16 v[36:39], a[216:219], v[60:63], v[36:39]
	v_mfma_f32_16x16x32_bf16 v[44:47], a[220:223], v[60:63], v[44:47]
	ds_read_b128 v[48:51], v13 offset:32768
	ds_read_b128 v[52:55], v13 offset:33792
	s_waitcnt lgkmcnt(4)
	v_mfma_f32_16x16x32_bf16 v[16:19], a[224:227], v[64:67], v[16:19]
	v_mfma_f32_16x16x32_bf16 v[24:27], a[228:231], v[64:67], v[24:27]
	v_mfma_f32_16x16x32_bf16 v[32:35], a[232:235], v[64:67], v[32:35]
	s_add_u32 m0, s67, 8960
	v_mfma_f32_16x16x32_bf16 v[40:43], a[236:239], v[64:67], v[40:43]
	buffer_load_dwordx4 v9, s[48:51], s68 offen offset:256 lds
	v_mfma_f32_16x16x32_bf16 v[20:23], a[224:227], v[68:71], v[20:23]
	v_mfma_f32_16x16x32_bf16 v[28:31], a[228:231], v[68:71], v[28:31]
	v_mfma_f32_16x16x32_bf16 v[36:39], a[232:235], v[68:71], v[36:39]
	v_mfma_f32_16x16x32_bf16 v[44:47], a[236:239], v[68:71], v[44:47]
	ds_read_b128 v[56:59], v13 offset:34816
	ds_read_b128 v[60:63], v13 offset:35840
	s_waitcnt lgkmcnt(4)
	v_mfma_f32_16x16x32_bf16 v[16:19], a[240:243], v[72:75], v[16:19]
	v_mfma_f32_16x16x32_bf16 v[24:27], a[244:247], v[72:75], v[24:27]
	buffer_store_dwordx4 v[100:103], v96, s[36:39], s76 offen offset:0 sc1
	v_mfma_f32_16x16x32_bf16 v[32:35], a[248:251], v[72:75], v[32:35]
	v_mfma_f32_16x16x32_bf16 v[40:43], a[252:255], v[72:75], v[40:43]
	v_mfma_f32_16x16x32_bf16 v[20:23], a[240:243], v[76:79], v[20:23]
	v_mfma_f32_16x16x32_bf16 v[28:31], a[244:247], v[76:79], v[28:31]
	buffer_store_dwordx4 v[100:103], v96, s[36:39], s76 offen offset:1024 sc1
	v_mfma_f32_16x16x32_bf16 v[36:39], a[248:251], v[76:79], v[36:39]
	v_mfma_f32_16x16x32_bf16 v[44:47], a[252:255], v[76:79], v[44:47]
	ds_read_b128 v[64:67], v13 offset:36864
	ds_read_b128 v[68:71], v13 offset:37888
	s_waitcnt lgkmcnt(4)
	v_mfma_f32_16x16x32_bf16 v[16:19], v[192:195], v[48:51], v[16:19]
	v_mfma_f32_16x16x32_bf16 v[24:27], v[196:199], v[48:51], v[24:27]
	buffer_store_dwordx4 v[100:103], v97, s[36:39], s76 offen sc1
	v_mfma_f32_16x16x32_bf16 v[32:35], v[200:203], v[48:51], v[32:35]
	v_mfma_f32_16x16x32_bf16 v[40:43], v[204:207], v[48:51], v[40:43]
	v_mfma_f32_16x16x32_bf16 v[20:23], v[192:195], v[52:55], v[20:23]
	v_mfma_f32_16x16x32_bf16 v[28:31], v[196:199], v[52:55], v[28:31]
	v_mfma_f32_16x16x32_bf16 v[36:39], v[200:203], v[52:55], v[36:39]
	v_mfma_f32_16x16x32_bf16 v[44:47], v[204:207], v[52:55], v[44:47]
	ds_read_b128 v[72:75], v13 offset:38912
	ds_read_b128 v[76:79], v13 offset:39936
	s_waitcnt lgkmcnt(4)
	v_mfma_f32_16x16x32_bf16 v[16:19], v[208:211], v[56:59], v[16:19]
	v_mfma_f32_16x16x32_bf16 v[24:27], v[212:215], v[56:59], v[24:27]
	v_mfma_f32_16x16x32_bf16 v[32:35], v[216:219], v[56:59], v[32:35]
	v_mfma_f32_16x16x32_bf16 v[40:43], v[220:223], v[56:59], v[40:43]
	v_mfma_f32_16x16x32_bf16 v[20:23], v[208:211], v[60:63], v[20:23]
	v_mfma_f32_16x16x32_bf16 v[28:31], v[212:215], v[60:63], v[28:31]
	v_mfma_f32_16x16x32_bf16 v[36:39], v[216:219], v[60:63], v[36:39]
	v_mfma_f32_16x16x32_bf16 v[44:47], v[220:223], v[60:63], v[44:47]
	v_mov_b32 v106, s66
	s_waitcnt vmcnt(13) lgkmcnt(0)
	buffer_store_dword v106, v12, s[36:39], 0 offen sc1
	s_barrier
	v_add_u32 v13, s70, v10
	ds_read_b128 v[48:51], v13 offset:0
	ds_read_b128 v[52:55], v13 offset:1024
	v_mfma_f32_16x16x32_bf16 v[16:19], v[224:227], v[64:67], v[16:19]
	v_mfma_f32_16x16x32_bf16 v[24:27], v[228:231], v[64:67], v[24:27]
	v_mfma_f32_16x16x32_bf16 v[32:35], v[232:235], v[64:67], v[32:35]
	v_mfma_f32_16x16x32_bf16 v[40:43], v[236:239], v[64:67], v[40:43]
	v_mfma_f32_16x16x32_bf16 v[20:23], v[224:227], v[68:71], v[20:23]
	v_mfma_f32_16x16x32_bf16 v[28:31], v[228:231], v[68:71], v[28:31]
	v_mfma_f32_16x16x32_bf16 v[36:39], v[232:235], v[68:71], v[36:39]
	v_mfma_f32_16x16x32_bf16 v[44:47], v[236:239], v[68:71], v[44:47]
	ds_read_b128 v[56:59], v13 offset:2048
	ds_read_b128 v[60:63], v13 offset:3072
	v_mfma_f32_16x16x32_bf16 v[16:19], v[240:243], v[72:75], v[16:19]
	s_add_u32 s66, s66, 1
	s_add_u32 s68, s68, 40960
	v_mfma_f32_16x16x32_bf16 v[24:27], v[244:247], v[72:75], v[24:27]
	s_add_u32 s67, s67, 40960
	s_sub_u32 s63, s67, 122880
	v_mfma_f32_16x16x32_bf16 v[32:35], v[248:251], v[72:75], v[32:35]
	s_cmp_ge_u32 s67, 122880
	s_cselect_b32 s67, s63, s67
	v_mfma_f32_16x16x32_bf16 v[40:43], v[252:255], v[72:75], v[40:43]
	s_mov_b32 s69, s76
	s_add_u32 s76, s76, 32768
	v_mfma_f32_16x16x32_bf16 v[20:23], v[240:243], v[76:79], v[20:23]
	s_and_b32 s76, s76, 0x7ffff
	s_cmp_lt_u32 s66, 64
	v_mfma_f32_16x16x32_bf16 v[28:31], v[244:247], v[76:79], v[28:31]
	v_mfma_f32_16x16x32_bf16 v[36:39], v[248:251], v[76:79], v[36:39]
	v_mfma_f32_16x16x32_bf16 v[44:47], v[252:255], v[76:79], v[44:47]
	ds_read_b128 v[64:67], v13 offset:4096
	ds_read_b128 v[68:71], v13 offset:5120
	s_waitcnt lgkmcnt(4)
	v_mfma_f32_16x16x32_bf16 v[112:115], a[0:3], v[48:51], 0
	s_add_u32 s70, s70, 40960
	s_cmp_eq_u32 s70, 122880
	v_mfma_f32_16x16x32_bf16 v[120:123], a[4:7], v[48:51], 0
	s_cselect_b32 s70, 0, s70
	s_sub_u32 s82, s66, 12
	v_mfma_f32_16x16x32_bf16 v[128:131], a[8:11], v[48:51], 0
	v_cmp_gt_i32 vcc, s82, v105
	v_mfma_f32_16x16x32_bf16 v[136:139], a[12:15], v[48:51], 0
	v_mfma_f32_16x16x32_bf16 v[116:119], a[0:3], v[52:55], 0
	s_cbranch_vccnz L_pw_121
L_pg_120:
	v_mfma_f32_16x16x32_bf16 v[124:127], a[4:7], v[52:55], 0
	buffer_load_dword v105, v104, s[36:39], 0 offen sc1
	v_mfma_f32_16x16x32_bf16 v[132:135], a[8:11], v[52:55], 0
	v_mfma_f32_16x16x32_bf16 v[140:143], a[12:15], v[52:55], 0
	ds_read_b128 v[72:75], v13 offset:6144
	ds_read_b128 v[76:79], v13 offset:7168
	s_waitcnt lgkmcnt(4)
	v_mfma_f32_16x16x32_bf16 v[112:115], a[16:19], v[56:59], v[112:115]
	v_cvt_pk_bf16_f32 v80, v16, v17
	v_mfma_f32_16x16x32_bf16 v[120:123], a[20:23], v[56:59], v[120:123]
	v_cvt_pk_bf16_f32 v81, v18, v19
	v_mfma_f32_16x16x32_bf16 v[128:131], a[24:27], v[56:59], v[128:131]
	v_cvt_pk_bf16_f32 v82, v24, v25
	v_mfma_f32_16x16x32_bf16 v[136:139], a[28:31], v[56:59], v[136:139]
	v_cvt_pk_bf16_f32 v83, v26, v27
	v_mfma_f32_16x16x32_bf16 v[116:119], a[16:19], v[60:63], v[116:119]
	v_mfma_f32_16x16x32_bf16 v[124:127], a[20:23], v[60:63], v[124:127]
	buffer_store_dwordx4 v[80:83], v11, s[36:39], s69 offen offset:0 sc1
	v_mfma_f32_16x16x32_bf16 v[132:135], a[24:27], v[60:63], v[132:135]
	v_mfma_f32_16x16x32_bf16 v[140:143], a[28:31], v[60:63], v[140:143]
	ds_read_b128 v[48:51], v13 offset:8192
	ds_read_b128 v[52:55], v13 offset:9216
	s_waitcnt lgkmcnt(4)
	v_mfma_f32_16x16x32_bf16 v[112:115], a[32:35], v[64:67], v[112:115]
	v_cvt_pk_bf16_f32 v84, v20, v21
	v_mfma_f32_16x16x32_bf16 v[120:123], a[36:39], v[64:67], v[120:123]
	v_cvt_pk_bf16_f32 v85, v22, v23
	v_mfma_f32_16x16x32_bf16 v[128:131], a[40:43], v[64:67], v[128:131]
	v_cvt_pk_bf16_f32 v86, v28, v29
	v_mfma_f32_16x16x32_bf16 v[136:139], a[44:47], v[64:67], v[136:139]
	v_cvt_pk_bf16_f32 v87, v30, v31
	v_mfma_f32_16x16x32_bf16 v[116:119], a[32:35], v[68:71], v[116:119]
	v_mfma_f32_16x16x32_bf16 v[124:127], a[36:39], v[68:71], v[124:127]
	buffer_store_dwordx4 v[84:87], v11, s[36:39], s69 offen offset:1024 sc1
	v_mfma_f32_16x16x32_bf16 v[132:135], a[40:43], v[68:71], v[132:135]
	v_mfma_f32_16x16x32_bf16 v[140:143], a[44:47], v[68:71], v[140:143]
	ds_read_b128 v[56:59], v13 offset:10240
	ds_read_b128 v[60:63], v13 offset:11264
	s_waitcnt lgkmcnt(4)
	v_mfma_f32_16x16x32_bf16 v[112:115], a[48:51], v[72:75], v[112:115]
	v_cvt_pk_bf16_f32 v88, v32, v33
	v_mfma_f32_16x16x32_bf16 v[120:123], a[52:55], v[72:75], v[120:123]
	v_cvt_pk_bf16_f32 v89, v34, v35
	v_mfma_f32_16x16x32_bf16 v[128:131], a[56:59], v[72:75], v[128:131]
	v_cvt_pk_bf16_f32 v90, v40, v41
	v_mfma_f32_16x16x32_bf16 v[136:139], a[60:63], v[72:75], v[136:139]
	v_cvt_pk_bf16_f32 v91, v42, v43
	v_mfma_f32_16x16x32_bf16 v[116:119], a[48:51], v[76:79], v[116:119]
	v_mfma_f32_16x16x32_bf16 v[124:127], a[52:55], v[76:79], v[124:127]
	buffer_store_dwordx4 v[88:91], v11, s[36:39], s69 offen offset:2048 sc1
	v_mfma_f32_16x16x32_bf16 v[132:135], a[56:59], v[76:79], v[132:135]
	v_mfma_f32_16x16x32_bf16 v[140:143], a[60:63], v[76:79], v[140:143]
	ds_read_b128 v[64:67], v13 offset:12288
	ds_read_b128 v[68:71], v13 offset:13312
	s_waitcnt lgkmcnt(4)
	v_mfma_f32_16x16x32_bf16 v[112:115], a[64:67], v[48:51], v[112:115]
	v_cvt_pk_bf16_f32 v92, v36, v37
	v_mfma_f32_16x16x32_bf16 v[120:123], a[68:71], v[48:51], v[120:123]
	v_cvt_pk_bf16_f32 v93, v38, v39
	v_mfma_f32_16x16x32_bf16 v[128:131], a[72:75], v[48:51], v[128:131]
	v_cvt_pk_bf16_f32 v94, v44, v45
	v_mfma_f32_16x16x32_bf16 v[136:139], a[76:79], v[48:51], v[136:139]
	v_cvt_pk_bf16_f32 v95, v46, v47
	v_mfma_f32_16x16x32_bf16 v[116:119], a[64:67], v[52:55], v[116:119]
	v_mfma_f32_16x16x32_bf16 v[124:127], a[68:71], v[52:55], v[124:127]
	buffer_store_dwordx4 v[92:95], v11, s[36:39], s69 offen offset:3072 sc1
	v_mfma_f32_16x16x32_bf16 v[132:135], a[72:75], v[52:55], v[132:135]
	v_mfma_f32_16x16x32_bf16 v[140:143], a[76:79], v[52:55], v[140:143]
	ds_read_b128 v[72:75], v13 offset:14336
	ds_read_b128 v[76:79], v13 offset:15360
	s_waitcnt lgkmcnt(4)
	v_mfma_f32_16x16x32_bf16 v[112:115], a[80:83], v[56:59], v[112:115]
	v_mfma_f32_16x16x32_bf16 v[120:123], a[84:87], v[56:59], v[120:123]
	v_mfma_f32_16x16x32_bf16 v[128:131], a[88:91], v[56:59], v[128:131]
	s_add_u32 m0, s67, 0
	v_mfma_f32_16x16x32_bf16 v[136:139], a[92:95], v[56:59], v[136:139]
	buffer_load_dwordx4 v8, s[48:51], s68 offen offset:0 lds
	v_mfma_f32_16x16x32_bf16 v[116:119], a[80:83], v[60:63], v[116:119]
	v_mfma_f32_16x16x32_bf16 v[124:127], a[84:87], v[60:63], v[124:127]
	v_mfma_f32_16x16x32_bf16 v[132:135], a[88:91], v[60:63], v[132:135]
	v_mfma_f32_16x16x32_bf16 v[140:143], a[92:95], v[60:63], v[140:143]
	ds_read_b128 v[48:51], v13 offset:16384
	ds_read_b128 v[52:55], v13 offset:17408
	s_waitcnt lgkmcnt(4)
	v_mfma_f32_16x16x32_bf16 v[112:115], a[96:99], v[64:67], v[112:115]
	v_mfma_f32_16x16x32_bf16 v[120:123], a[100:103], v[64:67], v[120:123]
	v_mfma_f32_16x16x32_bf16 v[128:131], a[104:107], v[64:67], v[128:131]
	s_add_u32 m0, s67, 1024
	v_mfma_f32_16x16x32_bf16 v[136:139], a[108:111], v[64:67], v[136:139]
	buffer_load_dwordx4 v9, s[48:51], s68 offen offset:0 lds
	v_mfma_f32_16x16x32_bf16 v[116:119], a[96:99], v[68:71], v[116:119]
	v_mfma_f32_16x16x32_bf16 v[124:127], a[100:103], v[68:71], v[124:127]
	v_mfma_f32_16x16x32_bf16 v[132:135], a[104:107], v[68:71], v[132:135]
	v_mfma_f32_16x16x32_bf16 v[140:143], a[108:111], v[68:71], v[140:143]
	ds_read_b128 v[56:59], v13 offset:18432
	ds_read_b128 v[60:63], v13 offset:19456
	s_waitcnt lgkmcnt(4)
	v_mfma_f32_16x16x32_bf16 v[112:115], a[112:115], v[72:75], v[112:115]
	v_mfma_f32_16x16x32_bf16 v[120:123], a[116:119], v[72:75], v[120:123]
	v_mfma_f32_16x16x32_bf16 v[128:131], a[120:123], v[72:75], v[128:131]
	s_add_u32 m0, s67, 1984
	v_mfma_f32_16x16x32_bf16 v[136:139], a[124:127], v[72:75], v[136:139]
	buffer_load_dwordx4 v8, s[48:51], s68 offen offset:64 lds
	v_mfma_f32_16x16x32_bf16 v[116:119], a[112:115], v[76:79], v[116:119]
	v_mfma_f32_16x16x32_bf16 v[124:127], a[116:119], v[76:79], v[124:127]
	v_mfma_f32_16x16x32_bf16 v[132:135], a[120:123], v[76:79], v[132:135]
	v_mfma_f32_16x16x32_bf16 v[140:143], a[124:127], v[76:79], v[140:143]
	ds_read_b128 v[64:67], v13 offset:20480
	ds_read_b128 v[68:71], v13 offset:21504
	s_waitcnt lgkmcnt(4)
	v_mfma_f32_16x16x32_bf16 v[112:115], a[128:131], v[48:51], v[112:115]
	v_mfma_f32_16x16x32_bf16 v[120:123], a[132:135], v[48:51], v[120:123]
	v_mfma_f32_16x16x32_bf16 v[128:131], a[136:139], v[48:51], v[128:131]
	s_add_u32 m0, s67, 3008
	v_mfma_f32_16x16x32_bf16 v[136:139], a[140:143], v[48:51], v[136:139]
	buffer_load_dwordx4 v9, s[48:51], s68 offen offset:64 lds
	v_mfma_f32_16x16x32_bf16 v[116:119], a[128:131], v[52:55], v[116:119]
	v_mfma_f32_16x16x32_bf16 v[124:127], a[132:135], v[52:55], v[124:127]
	v_mfma_f32_16x16x32_bf16 v[132:135], a[136:139], v[52:55], v[132:135]
	v_mfma_f32_16x16x32_bf16 v[140:143], a[140:143], v[52:55], v[140:143]
	ds_read_b128 v[72:75], v13 offset:22528
	ds_read_b128 v[76:79], v13 offset:23552
	s_waitcnt lgkmcnt(4)
	v_mfma_f32_16x16x32_bf16 v[112:115], a[144:147], v[56:59], v[112:115]
	v_mfma_f32_16x16x32_bf16 v[120:123], a[148:151], v[56:59], v[120:123]
	v_mfma_f32_16x16x32_bf16 v[128:131], a[152:155], v[56:59], v[128:131]
	s_add_u32 m0, s67, 3968
	v_mfma_f32_16x16x32_bf16 v[136:139], a[156:159], v[56:59], v[136:139]
	buffer_load_dwordx4 v8, s[48:51], s68 offen offset:128 lds
	v_mfma_f32_16x16x32_bf16 v[116:119], a[144:147], v[60:63], v[116:119]
	v_mfma_f32_16x16x32_bf16 v[124:127], a[148:151], v[60:63], v[124:127]
	v_mfma_f32_16x16x32_bf16 v[132:135], a[152:155], v[60:63], v[132:135]
	v_mfma_f32_16x16x32_bf16 v[140:143], a[156:159], v[60:63], v[140:143]
	ds_read_b128 v[48:51], v13 offset:24576
	ds_read_b128 v[52:55], v13 offset:25600
	s_waitcnt lgkmcnt(4)
	v_mfma_f32_16x16x32_bf16 v[112:115], a[160:163], v[64:67], v[112:115]
	v_mfma_f32_16x16x32_bf16 v[120:123], a[164:167], v[64:67], v[120:123]
	v_mfma_f32_16x16x32_bf16 v[128:131], a[168:171], v[64:67], v[128:131]
	s_add_u32 m0, s67, 4992
	v_mfma_f32_16x16x32_bf16 v[136:139], a[172:175], v[64:67], v[136:139]
	buffer_load_dwordx4 v9, s[48:51], s68 offen offset:128 lds
	v_mfma_f32_16x16x32_bf16 v[116:119], a[160:163], v[68:71], v[116:119]
	v_mfma_f32_16x16x32_bf16 v[124:127], a[164:167], v[68:71], v[124:127]
	v_mfma_f32_16x16x32_bf16 v[132:135], a[168:171], v[68:71], v[132:135]
	v_mfma_f32_16x16x32_bf16 v[140:143], a[172:175], v[68:71], v[140:143]
	ds_read_b128 v[56:59], v13 offset:26624
	ds_read_b128 v[60:63], v13 offset:27648
	s_waitcnt lgkmcnt(4)
	v_mfma_f32_16x16x32_bf16 v[112:115], a[176:179], v[72:75], v[112:115]
	v_mfma_f32_16x16x32_bf16 v[120:123], a[180:183], v[72:75], v[120:123]
	v_mfma_f32_16x16x32_bf16 v[128:131], a[184:187], v[72:75], v[128:131]
	s_add_u32 m0, s67, 5952
	v_mfma_f32_16x16x32_bf16 v[136:139], a[188:191], v[72:75], v[136:139]
	buffer_load_dwordx4 v8, s[48:51], s68 offen offset:192 lds
	v_mfma_f32_16x16x32_bf16 v[116:119], a[176:179], v[76:79], v[116:119]
	v_mfma_f32_16x16x32_bf16 v[124:127], a[180:183], v[76:79], v[124:127]
	v_mfma_f32_16x16x32_bf16 v[132:135], a[184:187], v[76:79], v[132:135]
	s_cmp_le_u32 s66, 6
	s_cbranch_scc1 L_pf_123
L_pe_122:
	v_mfma_f32_16x16x32_bf16 v[140:143], a[188:191], v[76:79], v[140:143]
	ds_read_b128 v[64:67], v13 offset:28672
	ds_read_b128 v[68:71], v13 offset:29696
	s_waitcnt lgkmcnt(4)
	v_mfma_f32_16x16x32_bf16 v[112:115], a[192:195], v[48:51], v[112:115]
	v_mfma_f32_16x16x32_bf16 v[120:123], a[196:199], v[48:51], v[120:123]
	v_mfma_f32_16x16x32_bf16 v[128:131], a[200:203], v[48:51], v[128:131]
	s_add_u32 m0, s67, 6976
	v_mfma_f32_16x16x32_bf16 v[136:139], a[204:207], v[48:51], v[136:139]
	buffer_load_dwordx4 v9, s[48:51], s68 offen offset:192 lds
	v_mfma_f32_16x16x32_bf16 v[116:119], a[192:195], v[52:55], v[116:119]
	v_mfma_f32_16x16x32_bf16 v[124:127], a[196:199], v[52:55], v[124:127]
	v_mfma_f32_16x16x32_bf16 v[132:135], a[200:203], v[52:55], v[132:135]
	v_mfma_f32_16x16x32_bf16 v[140:143], a[204:207], v[52:55], v[140:143]
	ds_read_b128 v[72:75], v13 offset:30720
	ds_read_b128 v[76:79], v13 offset:31744
	s_waitcnt lgkmcnt(4)
	v_mfma_f32_16x16x32_bf16 v[112:115], a[208:211], v[56:59], v[112:115]
	v_mfma_f32_16x16x32_bf16 v[120:123], a[212:215], v[56:59], v[120:123]
	v_mfma_f32_16x16x32_bf16 v[128:131], a[216:219], v[56:59], v[128:131]
	s_add_u32 m0, s67, 7936
	v_mfma_f32_16x16x32_bf16 v[136:139], a[220:223], v[56:59], v[136:139]
	buffer_load_dwordx4 v8, s[48:51], s68 offen offset:256 lds
	v_mfma_f32_16x16x32_bf16 v[116:119], a[208:211], v[60:63], v[116:119]
	v_mfma_f32_16x16x32_bf16 v[124:127], a[212:215], v[60:63], v[124:127]
	v_mfma_f32_16x16x32_bf16 v[132:135], a[216:219], v[60:63], v[132:135]
	v_mfma_f32_16x16x32_bf16 v[140:143], a[220:223], v[60:63], v[140:143]
	ds_read_b128 v[48:51], v13 offset:32768
	ds_read_b128 v[52:55], v13 offset:33792
	s_waitcnt lgkmcnt(4)
	v_mfma_f32_16x16x32_bf16 v[112:115], a[224:227], v[64:67], v[112:115]
	v_mfma_f32_16x16x32_bf16 v[120:123], a[228:231], v[64:67], v[120:123]
	v_mfma_f32_16x16x32_bf16 v[128:131], a[232:235], v[64:67], v[128:131]
	s_add_u32 m0, s67, 8960
	v_mfma_f32_16x16x32_bf16 v[136:139], a[236:239], v[64:67], v[136:139]
	buffer_load_dwordx4 v9, s[48:51], s68 offen offset:256 lds
	v_mfma_f32_16x16x32_bf16 v[116:119], a[224:227], v[68:71], v[116:119]
	v_mfma_f32_16x16x32_bf16 v[124:127], a[228:231], v[68:71], v[124:127]
	v_mfma_f32_16x16x32_bf16 v[132:135], a[232:235], v[68:71], v[132:135]
	v_mfma_f32_16x16x32_bf16 v[140:143], a[236:239], v[68:71], v[140:143]
	ds_read_b128 v[56:59], v13 offset:34816
	ds_read_b128 v[60:63], v13 offset:35840
	s_waitcnt lgkmcnt(4)
	v_mfma_f32_16x16x32_bf16 v[112:115], a[240:243], v[72:75], v[112:115]
	v_mfma_f32_16x16x32_bf16 v[120:123], a[244:247], v[72:75], v[120:123]
	buffer_store_dwordx4 v[100:103], v96, s[36:39], s76 offen offset:0 sc1
	v_mfma_f32_16x16x32_bf16 v[128:131], a[248:251], v[72:75], v[128:131]
	v_mfma_f32_16x16x32_bf16 v[136:139], a[252:255], v[72:75], v[136:139]
	v_mfma_f32_16x16x32_bf16 v[116:119], a[240:243], v[76:79], v[116:119]
	v_mfma_f32_16x16x32_bf16 v[124:127], a[244:247], v[76:79], v[124:127]
	buffer_store_dwordx4 v[100:103], v96, s[36:39], s76 offen offset:1024 sc1
	v_mfma_f32_16x16x32_bf16 v[132:135], a[248:251], v[76:79], v[132:135]
	v_mfma_f32_16x16x32_bf16 v[140:143], a[252:255], v[76:79], v[140:143]
	ds_read_b128 v[64:67], v13 offset:36864
	ds_read_b128 v[68:71], v13 offset:37888
	s_waitcnt lgkmcnt(4)
	v_mfma_f32_16x16x32_bf16 v[112:115], v[192:195], v[48:51], v[112:115]
	v_mfma_f32_16x16x32_bf16 v[120:123], v[196:199], v[48:51], v[120:123]
	buffer_store_dwordx4 v[100:103], v97, s[36:39], s76 offen sc1
	v_mfma_f32_16x16x32_bf16 v[128:131], v[200:203], v[48:51], v[128:131]
	v_mfma_f32_16x16x32_bf16 v[136:139], v[204:207], v[48:51], v[136:139]
	v_mfma_f32_16x16x32_bf16 v[116:119], v[192:195], v[52:55], v[116:119]
	v_mfma_f32_16x16x32_bf16 v[124:127], v[196:199], v[52:55], v[124:127]
	v_mfma_f32_16x16x32_bf16 v[132:135], v[200:203], v[52:55], v[132:135]
	v_mfma_f32_16x16x32_bf16 v[140:143], v[204:207], v[52:55], v[140:143]
	ds_read_b128 v[72:75], v13 offset:38912
	ds_read_b128 v[76:79], v13 offset:39936
	s_waitcnt lgkmcnt(4)
	v_mfma_f32_16x16x32_bf16 v[112:115], v[208:211], v[56:59], v[112:115]
	v_mfma_f32_16x16x32_bf16 v[120:123], v[212:215], v[56:59], v[120:123]
	v_mfma_f32_16x16x32_bf16 v[128:131], v[216:219], v[56:59], v[128:131]
	v_mfma_f32_16x16x32_bf16 v[136:139], v[220:223], v[56:59], v[136:139]
	v_mfma_f32_16x16x32_bf16 v[116:119], v[208:211], v[60:63], v[116:119]
	v_mfma_f32_16x16x32_bf16 v[124:127], v[212:215], v[60:63], v[124:127]
	v_mfma_f32_16x16x32_bf16 v[132:135], v[216:219], v[60:63], v[132:135]
	v_mfma_f32_16x16x32_bf16 v[140:143], v[220:223], v[60:63], v[140:143]
	v_mov_b32 v106, s66
	s_waitcnt vmcnt(13) lgkmcnt(0)
	buffer_store_dword v106, v12, s[36:39], 0 offen sc1
	s_barrier
	v_add_u32 v13, s70, v10
	ds_read_b128 v[48:51], v13 offset:0
	ds_read_b128 v[52:55], v13 offset:1024
	v_mfma_f32_16x16x32_bf16 v[112:115], v[224:227], v[64:67], v[112:115]
	v_mfma_f32_16x16x32_bf16 v[120:123], v[228:231], v[64:67], v[120:123]
	v_mfma_f32_16x16x32_bf16 v[128:131], v[232:235], v[64:67], v[128:131]
	v_mfma_f32_16x16x32_bf16 v[136:139], v[236:239], v[64:67], v[136:139]
	v_mfma_f32_16x16x32_bf16 v[116:119], v[224:227], v[68:71], v[116:119]
	v_mfma_f32_16x16x32_bf16 v[124:127], v[228:231], v[68:71], v[124:127]
	v_mfma_f32_16x16x32_bf16 v[132:135], v[232:235], v[68:71], v[132:135]
	v_mfma_f32_16x16x32_bf16 v[140:143], v[236:239], v[68:71], v[140:143]
	ds_read_b128 v[56:59], v13 offset:2048
	ds_read_b128 v[60:63], v13 offset:3072
	v_mfma_f32_16x16x32_bf16 v[112:115], v[240:243], v[72:75], v[112:115]
	s_add_u32 s66, s66, 1
	s_add_u32 s68, s68, 40960
	v_mfma_f32_16x16x32_bf16 v[120:123], v[244:247], v[72:75], v[120:123]
	s_add_u32 s67, s67, 40960
	s_sub_u32 s63, s67, 122880
	v_mfma_f32_16x16x32_bf16 v[128:131], v[248:251], v[72:75], v[128:131]
	s_cmp_ge_u32 s67, 122880
	s_cselect_b32 s67, s63, s67
	v_mfma_f32_16x16x32_bf16 v[136:139], v[252:255], v[72:75], v[136:139]
	s_mov_b32 s69, s76
	s_add_u32 s76, s76, 32768
	v_mfma_f32_16x16x32_bf16 v[116:119], v[240:243], v[76:79], v[116:119]
	s_and_b32 s76, s76, 0x7ffff
	s_cmp_lt_u32 s66, 64
	v_mfma_f32_16x16x32_bf16 v[124:127], v[244:247], v[76:79], v[124:127]
	v_mfma_f32_16x16x32_bf16 v[132:135], v[248:251], v[76:79], v[132:135]
	v_mfma_f32_16x16x32_bf16 v[140:143], v[252:255], v[76:79], v[140:143]
	s_cbranch_scc1 L_p_115
	v_cvt_pk_bf16_f32 v80, v112, v113
	v_cvt_pk_bf16_f32 v81, v114, v115
	v_cvt_pk_bf16_f32 v82, v120, v121
	v_cvt_pk_bf16_f32 v83, v122, v123
	buffer_store_dwordx4 v[80:83], v11, s[36:39], s69 offen offset:0 sc1
	v_cvt_pk_bf16_f32 v84, v116, v117
	v_cvt_pk_bf16_f32 v85, v118, v119
	v_cvt_pk_bf16_f32 v86, v124, v125
	v_cvt_pk_bf16_f32 v87, v126, v127
	buffer_store_dwordx4 v[84:87], v11, s[36:39], s69 offen offset:1024 sc1
	v_cvt_pk_bf16_f32 v88, v128, v129
	v_cvt_pk_bf16_f32 v89, v130, v131
	v_cvt_pk_bf16_f32 v90, v136, v137
	v_cvt_pk_bf16_f32 v91, v138, v139
	buffer_store_dwordx4 v[88:91], v11, s[36:39], s69 offen offset:2048 sc1
	v_cvt_pk_bf16_f32 v92, v132, v133
	v_cvt_pk_bf16_f32 v93, v134, v135
	v_cvt_pk_bf16_f32 v94, v140, v141
	v_cvt_pk_bf16_f32 v95, v142, v143
	buffer_store_dwordx4 v[92:95], v11, s[36:39], s69 offen offset:3072 sc1
	v_mov_b32 v106, s66
	s_waitcnt vmcnt(0)
	buffer_store_dword v106, v12, s[36:39], 0 offen sc1
	s_endpgm
L_pw_117:
	buffer_load_dword v105, v104, s[36:39], 0 offen sc1
	s_waitcnt vmcnt(0)
	v_cmp_gt_i32 vcc, s82, v105
	s_cbranch_vccz L_pg_116
	s_sleep 2
	s_add_u32 s34, s34, 1
	s_cmp_lt_u32 s34, 0x40000
	s_cbranch_scc1 L_pw_117
	s_endpgm
L_pf_119:
	v_mov_b32 v106, s66
	s_waitcnt vmcnt(7)
	buffer_store_dword v106, v12, s[36:39], 0 offen sc1
	s_branch L_pe_118
L_pw_121:
	buffer_load_dword v105, v104, s[36:39], 0 offen sc1
	s_waitcnt vmcnt(0)
	v_cmp_gt_i32 vcc, s82, v105
	s_cbranch_vccz L_pg_120
	s_sleep 2
	s_add_u32 s34, s34, 1
	s_cmp_lt_u32 s34, 0x40000
	s_cbranch_scc1 L_pw_121
	s_endpgm
L_pf_123:
	v_mov_b32 v106, s66
	s_waitcnt vmcnt(7)
	buffer_store_dword v106, v12, s[36:39], 0 offen sc1
	s_branch L_pe_122
.p2align 6
L_projv:
	s_barrier
	v_add_u32 v13, s70, v10
	ds_read_b128 v[48:51], v13 offset:0
	ds_read_b128 v[52:55], v13 offset:1024
	ds_read_b128 v[56:59], v13 offset:2048
	ds_read_b128 v[60:63], v13 offset:3072
L_p_124:
	ds_read_b128 v[64:67], v13 offset:4096
	ds_read_b128 v[68:71], v13 offset:5120
	s_waitcnt lgkmcnt(4)
	v_mfma_f32_16x16x32_bf16 v[16:19], v[48:51], a[0:3], 0
	s_add_u32 s70, s70, 40960
	s_cmp_eq_u32 s70, 122880
	v_mfma_f32_16x16x32_bf16 v[24:27], v[48:51], a[4:7], 0
	s_cselect_b32 s70, 0, s70
	s_sub_u32 s82, s66, 12
	v_mfma_f32_16x16x32_bf16 v[32:35], v[48:51], a[8:11], 0
	v_cmp_gt_i32 vcc, s82, v105
	v_mfma_f32_16x16x32_bf16 v[40:43], v[48:51], a[12:15], 0
	v_mfma_f32_16x16x32_bf16 v[20:23], v[52:55], a[0:3], 0
	s_cbranch_vccnz L_pw_126
L_pg_125:
	v_mfma_f32_16x16x32_bf16 v[28:31], v[52:55], a[4:7], 0
	buffer_load_dword v105, v104, s[36:39], 0 offen sc1
	v_mfma_f32_16x16x32_bf16 v[36:39], v[52:55], a[8:11], 0
	v_mfma_f32_16x16x32_bf16 v[44:47], v[52:55], a[12:15], 0
	ds_read_b128 v[72:75], v13 offset:6144
	ds_read_b128 v[76:79], v13 offset:7168
	s_waitcnt lgkmcnt(4)
	v_mfma_f32_16x16x32_bf16 v[16:19], v[56:59], a[16:19], v[16:19]
	v_cvt_pk_bf16_f32 v80, v112, v113
	v_mfma_f32_16x16x32_bf16 v[24:27], v[56:59], a[20:23], v[24:27]
	v_cvt_pk_bf16_f32 v81, v114, v115
	v_mfma_f32_16x16x32_bf16 v[32:35], v[56:59], a[24:27], v[32:35]
	v_cvt_pk_bf16_f32 v82, v116, v117
	v_mfma_f32_16x16x32_bf16 v[40:43], v[56:59], a[28:31], v[40:43]
	v_cvt_pk_bf16_f32 v83, v118, v119
	v_mfma_f32_16x16x32_bf16 v[20:23], v[60:63], a[16:19], v[20:23]
	v_mfma_f32_16x16x32_bf16 v[28:31], v[60:63], a[20:23], v[28:31]
	buffer_store_dwordx4 v[80:83], v11, s[36:39], s69 offen offset:0 sc1
	v_mfma_f32_16x16x32_bf16 v[36:39], v[60:63], a[24:27], v[36:39]
	v_mfma_f32_16x16x32_bf16 v[44:47], v[60:63], a[28:31], v[44:47]
	ds_read_b128 v[48:51], v13 offset:8192
	ds_read_b128 v[52:55], v13 offset:9216
	s_waitcnt lgkmcnt(4)
	v_mfma_f32_16x16x32_bf16 v[16:19], v[64:67], a[32:35], v[16:19]
	v_cvt_pk_bf16_f32 v84, v120, v121
	v_mfma_f32_16x16x32_bf16 v[24:27], v[64:67], a[36:39], v[24:27]
	v_cvt_pk_bf16_f32 v85, v122, v123
	v_mfma_f32_16x16x32_bf16 v[32:35], v[64:67], a[40:43], v[32:35]
	v_cvt_pk_bf16_f32 v86, v124, v125
	v_mfma_f32_16x16x32_bf16 v[40:43], v[64:67], a[44:47], v[40:43]
	v_cvt_pk_bf16_f32 v87, v126, v127
	v_mfma_f32_16x16x32_bf16 v[20:23], v[68:71], a[32:35], v[20:23]
	v_mfma_f32_16x16x32_bf16 v[28:31], v[68:71], a[36:39], v[28:31]
	buffer_store_dwordx4 v[84:87], v11, s[36:39], s69 offen offset:1024 sc1
	v_mfma_f32_16x16x32_bf16 v[36:39], v[68:71], a[40:43], v[36:39]
	v_mfma_f32_16x16x32_bf16 v[44:47], v[68:71], a[44:47], v[44:47]
	ds_read_b128 v[56:59], v13 offset:10240
	ds_read_b128 v[60:63], v13 offset:11264
	s_waitcnt lgkmcnt(4)
	v_mfma_f32_16x16x32_bf16 v[16:19], v[72:75], a[48:51], v[16:19]
	v_cvt_pk_bf16_f32 v88, v128, v129
	v_mfma_f32_16x16x32_bf16 v[24:27], v[72:75], a[52:55], v[24:27]
	v_cvt_pk_bf16_f32 v89, v130, v131
	v_mfma_f32_16x16x32_bf16 v[32:35], v[72:75], a[56:59], v[32:35]
	v_cvt_pk_bf16_f32 v90, v132, v133
	v_mfma_f32_16x16x32_bf16 v[40:43], v[72:75], a[60:63], v[40:43]
	v_cvt_pk_bf16_f32 v91, v134, v135
	v_mfma_f32_16x16x32_bf16 v[20:23], v[76:79], a[48:51], v[20:23]
	v_mfma_f32_16x16x32_bf16 v[28:31], v[76:79], a[52:55], v[28:31]
	buffer_store_dwordx4 v[88:91], v11, s[36:39], s69 offen offset:2048 sc1
	v_mfma_f32_16x16x32_bf16 v[36:39], v[76:79], a[56:59], v[36:39]
	v_mfma_f32_16x16x32_bf16 v[44:47], v[76:79], a[60:63], v[44:47]
	ds_read_b128 v[64:67], v13 offset:12288
	ds_read_b128 v[68:71], v13 offset:13312
	s_waitcnt lgkmcnt(4)
	v_mfma_f32_16x16x32_bf16 v[16:19], v[48:51], a[64:67], v[16:19]
	v_cvt_pk_bf16_f32 v92, v136, v137
	v_mfma_f32_16x16x32_bf16 v[24:27], v[48:51], a[68:71], v[24:27]
	v_cvt_pk_bf16_f32 v93, v138, v139
	v_mfma_f32_16x16x32_bf16 v[32:35], v[48:51], a[72:75], v[32:35]
	v_cvt_pk_bf16_f32 v94, v140, v141
	v_mfma_f32_16x16x32_bf16 v[40:43], v[48:51], a[76:79], v[40:43]
	v_cvt_pk_bf16_f32 v95, v142, v143
	v_mfma_f32_16x16x32_bf16 v[20:23], v[52:55], a[64:67], v[20:23]
	v_mfma_f32_16x16x32_bf16 v[28:31], v[52:55], a[68:71], v[28:31]
	buffer_store_dwordx4 v[92:95], v11, s[36:39], s69 offen offset:3072 sc1
	v_mfma_f32_16x16x32_bf16 v[36:39], v[52:55], a[72:75], v[36:39]
	v_mfma_f32_16x16x32_bf16 v[44:47], v[52:55], a[76:79], v[44:47]
	ds_read_b128 v[72:75], v13 offset:14336
	ds_read_b128 v[76:79], v13 offset:15360
	s_waitcnt lgkmcnt(4)
	v_mfma_f32_16x16x32_bf16 v[16:19], v[56:59], a[80:83], v[16:19]
	v_mfma_f32_16x16x32_bf16 v[24:27], v[56:59], a[84:87], v[24:27]
	v_mfma_f32_16x16x32_bf16 v[32:35], v[56:59], a[88:91], v[32:35]
	s_add_u32 m0, s67, 0
	v_mfma_f32_16x16x32_bf16 v[40:43], v[56:59], a[92:95], v[40:43]
	buffer_load_dwordx4 v8, s[48:51], s68 offen offset:0 lds
	v_mfma_f32_16x16x32_bf16 v[20:23], v[60:63], a[80:83], v[20:23]
	v_mfma_f32_16x16x32_bf16 v[28:31], v[60:63], a[84:87], v[28:31]
	v_mfma_f32_16x16x32_bf16 v[36:39], v[60:63], a[88:91], v[36:39]
	v_mfma_f32_16x16x32_bf16 v[44:47], v[60:63], a[92:95], v[44:47]
	ds_read_b128 v[48:51], v13 offset:16384
	ds_read_b128 v[52:55], v13 offset:17408
	s_waitcnt lgkmcnt(4)
	v_mfma_f32_16x16x32_bf16 v[16:19], v[64:67], a[96:99], v[16:19]
	v_mfma_f32_16x16x32_bf16 v[24:27], v[64:67], a[100:103], v[24:27]
	v_mfma_f32_16x16x32_bf16 v[32:35], v[64:67], a[104:107], v[32:35]
	s_add_u32 m0, s67, 1024
	v_mfma_f32_16x16x32_bf16 v[40:43], v[64:67], a[108:111], v[40:43]
	buffer_load_dwordx4 v9, s[48:51], s68 offen offset:0 lds
	v_mfma_f32_16x16x32_bf16 v[20:23], v[68:71], a[96:99], v[20:23]
	v_mfma_f32_16x16x32_bf16 v[28:31], v[68:71], a[100:103], v[28:31]
	v_mfma_f32_16x16x32_bf16 v[36:39], v[68:71], a[104:107], v[36:39]
	v_mfma_f32_16x16x32_bf16 v[44:47], v[68:71], a[108:111], v[44:47]
	ds_read_b128 v[56:59], v13 offset:18432
	ds_read_b128 v[60:63], v13 offset:19456
	s_waitcnt lgkmcnt(4)
	v_mfma_f32_16x16x32_bf16 v[16:19], v[72:75], a[112:115], v[16:19]
	v_mfma_f32_16x16x32_bf16 v[24:27], v[72:75], a[116:119], v[24:27]
	v_mfma_f32_16x16x32_bf16 v[32:35], v[72:75], a[120:123], v[32:35]
	s_add_u32 m0, s67, 1984
	v_mfma_f32_16x16x32_bf16 v[40:43], v[72:75], a[124:127], v[40:43]
	buffer_load_dwordx4 v8, s[48:51], s68 offen offset:64 lds
	v_mfma_f32_16x16x32_bf16 v[20:23], v[76:79], a[112:115], v[20:23]
	v_mfma_f32_16x16x32_bf16 v[28:31], v[76:79], a[116:119], v[28:31]
	v_mfma_f32_16x16x32_bf16 v[36:39], v[76:79], a[120:123], v[36:39]
	v_mfma_f32_16x16x32_bf16 v[44:47], v[76:79], a[124:127], v[44:47]
	ds_read_b128 v[64:67], v13 offset:20480
	ds_read_b128 v[68:71], v13 offset:21504
	s_waitcnt lgkmcnt(4)
	v_mfma_f32_16x16x32_bf16 v[16:19], v[48:51], a[128:131], v[16:19]
	v_mfma_f32_16x16x32_bf16 v[24:27], v[48:51], a[132:135], v[24:27]
	v_mfma_f32_16x16x32_bf16 v[32:35], v[48:51], a[136:139], v[32:35]
	s_add_u32 m0, s67, 3008
	v_mfma_f32_16x16x32_bf16 v[40:43], v[48:51], a[140:143], v[40:43]
	buffer_load_dwordx4 v9, s[48:51], s68 offen offset:64 lds
	v_mfma_f32_16x16x32_bf16 v[20:23], v[52:55], a[128:131], v[20:23]
	v_mfma_f32_16x16x32_bf16 v[28:31], v[52:55], a[132:135], v[28:31]
	v_mfma_f32_16x16x32_bf16 v[36:39], v[52:55], a[136:139], v[36:39]
	v_mfma_f32_16x16x32_bf16 v[44:47], v[52:55], a[140:143], v[44:47]
	ds_read_b128 v[72:75], v13 offset:22528
	ds_read_b128 v[76:79], v13 offset:23552
	s_waitcnt lgkmcnt(4)
	v_mfma_f32_16x16x32_bf16 v[16:19], v[56:59], a[144:147], v[16:19]
	v_mfma_f32_16x16x32_bf16 v[24:27], v[56:59], a[148:151], v[24:27]
	v_mfma_f32_16x16x32_bf16 v[32:35], v[56:59], a[152:155], v[32:35]
	s_add_u32 m0, s67, 3968
	v_mfma_f32_16x16x32_bf16 v[40:43], v[56:59], a[156:159], v[40:43]
	buffer_load_dwordx4 v8, s[48:51], s68 offen offset:128 lds
	v_mfma_f32_16x16x32_bf16 v[20:23], v[60:63], a[144:147], v[20:23]
	v_mfma_f32_16x16x32_bf16 v[28:31], v[60:63], a[148:151], v[28:31]
	v_mfma_f32_16x16x32_bf16 v[36:39], v[60:63], a[152:155], v[36:39]
	v_mfma_f32_16x16x32_bf16 v[44:47], v[60:63], a[156:159], v[44:47]
	ds_read_b128 v[48:51], v13 offset:24576
	ds_read_b128 v[52:55], v13 offset:25600
	s_waitcnt lgkmcnt(4)
	v_mfma_f32_16x16x32_bf16 v[16:19], v[64:67], a[160:163], v[16:19]
	v_mfma_f32_16x16x32_bf16 v[24:27], v[64:67], a[164:167], v[24:27]
	v_mfma_f32_16x16x32_bf16 v[32:35], v[64:67], a[168:171], v[32:35]
	s_add_u32 m0, s67, 4992
	v_mfma_f32_16x16x32_bf16 v[40:43], v[64:67], a[172:175], v[40:43]
	buffer_load_dwordx4 v9, s[48:51], s68 offen offset:128 lds
	v_mfma_f32_16x16x32_bf16 v[20:23], v[68:71], a[160:163], v[20:23]
	v_mfma_f32_16x16x32_bf16 v[28:31], v[68:71], a[164:167], v[28:31]
	v_mfma_f32_16x16x32_bf16 v[36:39], v[68:71], a[168:171], v[36:39]
	v_mfma_f32_16x16x32_bf16 v[44:47], v[68:71], a[172:175], v[44:47]
	ds_read_b128 v[56:59], v13 offset:26624
	ds_read_b128 v[60:63], v13 offset:27648
	s_waitcnt lgkmcnt(4)
	v_mfma_f32_16x16x32_bf16 v[16:19], v[72:75], a[176:179], v[16:19]
	v_mfma_f32_16x16x32_bf16 v[24:27], v[72:75], a[180:183], v[24:27]
	v_mfma_f32_16x16x32_bf16 v[32:35], v[72:75], a[184:187], v[32:35]
	s_add_u32 m0, s67, 5952
	v_mfma_f32_16x16x32_bf16 v[40:43], v[72:75], a[188:191], v[40:43]
	buffer_load_dwordx4 v8, s[48:51], s68 offen offset:192 lds
	v_mfma_f32_16x16x32_bf16 v[20:23], v[76:79], a[176:179], v[20:23]
	v_mfma_f32_16x16x32_bf16 v[28:31], v[76:79], a[180:183], v[28:31]
	v_mfma_f32_16x16x32_bf16 v[36:39], v[76:79], a[184:187], v[36:39]
	s_cmp_le_u32 s66, 6
	s_cbranch_scc1 L_pf_128
L_pe_127:
	v_mfma_f32_16x16x32_bf16 v[44:47], v[76:79], a[188:191], v[44:47]
	ds_read_b128 v[64:67], v13 offset:28672
	ds_read_b128 v[68:71], v13 offset:29696
	s_waitcnt lgkmcnt(4)
	v_mfma_f32_16x16x32_bf16 v[16:19], v[48:51], a[192:195], v[16:19]
	v_mfma_f32_16x16x32_bf16 v[24:27], v[48:51], a[196:199], v[24:27]
	v_mfma_f32_16x16x32_bf16 v[32:35], v[48:51], a[200:203], v[32:35]
	s_add_u32 m0, s67, 6976
	v_mfma_f32_16x16x32_bf16 v[40:43], v[48:51], a[204:207], v[40:43]
	buffer_load_dwordx4 v9, s[48:51], s68 offen offset:192 lds
	v_mfma_f32_16x16x32_bf16 v[20:23], v[52:55], a[192:195], v[20:23]
	v_mfma_f32_16x16x32_bf16 v[28:31], v[52:55], a[196:199], v[28:31]
	v_mfma_f32_16x16x32_bf16 v[36:39], v[52:55], a[200:203], v[36:39]
	v_mfma_f32_16x16x32_bf16 v[44:47], v[52:55], a[204:207], v[44:47]
	ds_read_b128 v[72:75], v13 offset:30720
	ds_read_b128 v[76:79], v13 offset:31744
	s_waitcnt lgkmcnt(4)
	v_mfma_f32_16x16x32_bf16 v[16:19], v[56:59], a[208:211], v[16:19]
	v_mfma_f32_16x16x32_bf16 v[24:27], v[56:59], a[212:215], v[24:27]
	v_mfma_f32_16x16x32_bf16 v[32:35], v[56:59], a[216:219], v[32:35]
	s_add_u32 m0, s67, 7936
	v_mfma_f32_16x16x32_bf16 v[40:43], v[56:59], a[220:223], v[40:43]
	buffer_load_dwordx4 v8, s[48:51], s68 offen offset:256 lds
	v_mfma_f32_16x16x32_bf16 v[20:23], v[60:63], a[208:211], v[20:23]
	v_mfma_f32_16x16x32_bf16 v[28:31], v[60:63], a[212:215], v[28:31]
	v_mfma_f32_16x16x32_bf16 v[36:39], v[60:63], a[216:219], v[36:39]
	v_mfma_f32_16x16x32_bf16 v[44:47], v[60:63], a[220:223], v[44:47]
	ds_read_b128 v[48:51], v13 offset:32768
	ds_read_b128 v[52:55], v13 offset:33792
	s_waitcnt lgkmcnt(4)
	v_mfma_f32_16x16x32_bf16 v[16:19], v[64:67], a[224:227], v[16:19]
	v_mfma_f32_16x16x32_bf16 v[24:27], v[64:67], a[228:231], v[24:27]
	v_mfma_f32_16x16x32_bf16 v[32:35], v[64:67], a[232:235], v[32:35]
	s_add_u32 m0, s67, 8960
	v_mfma_f32_16x16x32_bf16 v[40:43], v[64:67], a[236:239], v[40:43]
	buffer_load_dwordx4 v9, s[48:51], s68 offen offset:256 lds
	v_mfma_f32_16x16x32_bf16 v[20:23], v[68:71], a[224:227], v[20:23]
	v_mfma_f32_16x16x32_bf16 v[28:31], v[68:71], a[228:231], v[28:31]
	v_mfma_f32_16x16x32_bf16 v[36:39], v[68:71], a[232:235], v[36:39]
	v_mfma_f32_16x16x32_bf16 v[44:47], v[68:71], a[236:239], v[44:47]
	ds_read_b128 v[56:59], v13 offset:34816
	ds_read_b128 v[60:63], v13 offset:35840
	s_waitcnt lgkmcnt(4)
	v_mfma_f32_16x16x32_bf16 v[16:19], v[72:75], a[240:243], v[16:19]
	v_mfma_f32_16x16x32_bf16 v[24:27], v[72:75], a[244:247], v[24:27]
	buffer_store_dwordx4 v[100:103], v96, s[36:39], s76 offen offset:0 sc1
	v_mfma_f32_16x16x32_bf16 v[32:35], v[72:75], a[248:251], v[32:35]
	v_mfma_f32_16x16x32_bf16 v[40:43], v[72:75], a[252:255], v[40:43]
	v_mfma_f32_16x16x32_bf16 v[20:23], v[76:79], a[240:243], v[20:23]
	v_mfma_f32_16x16x32_bf16 v[28:31], v[76:79], a[244:247], v[28:31]
	buffer_store_dwordx4 v[100:103], v96, s[36:39], s76 offen offset:1024 sc1
	v_mfma_f32_16x16x32_bf16 v[36:39], v[76:79], a[248:251], v[36:39]
	v_mfma_f32_16x16x32_bf16 v[44:47], v[76:79], a[252:255], v[44:47]
	ds_read_b128 v[64:67], v13 offset:36864
	ds_read_b128 v[68:71], v13 offset:37888
	s_waitcnt lgkmcnt(4)
	v_mfma_f32_16x16x32_bf16 v[16:19], v[48:51], v[192:195], v[16:19]
	v_mfma_f32_16x16x32_bf16 v[24:27], v[48:51], v[196:199], v[24:27]
	buffer_store_dword v100, v99, s[36:39], s76 offen sc1
	v_mfma_f32_16x16x32_bf16 v[32:35], v[48:51], v[200:203], v[32:35]
	v_mfma_f32_16x16x32_bf16 v[40:43], v[48:51], v[204:207], v[40:43]
	v_mfma_f32_16x16x32_bf16 v[20:23], v[52:55], v[192:195], v[20:23]
	v_mfma_f32_16x16x32_bf16 v[28:31], v[52:55], v[196:199], v[28:31]
	v_mfma_f32_16x16x32_bf16 v[36:39], v[52:55], v[200:203], v[36:39]
	v_mfma_f32_16x16x32_bf16 v[44:47], v[52:55], v[204:207], v[44:47]
	ds_read_b128 v[72:75], v13 offset:38912
	ds_read_b128 v[76:79], v13 offset:39936
	s_waitcnt lgkmcnt(4)
	v_mfma_f32_16x16x32_bf16 v[16:19], v[56:59], v[208:211], v[16:19]
	v_mfma_f32_16x16x32_bf16 v[24:27], v[56:59], v[212:215], v[24:27]
	v_mfma_f32_16x16x32_bf16 v[32:35], v[56:59], v[216:219], v[32:35]
	v_mfma_f32_16x16x32_bf16 v[40:43], v[56:59], v[220:223], v[40:43]
	v_mfma_f32_16x16x32_bf16 v[20:23], v[60:63], v[208:211], v[20:23]
	v_mfma_f32_16x16x32_bf16 v[28:31], v[60:63], v[212:215], v[28:31]
	v_mfma_f32_16x16x32_bf16 v[36:39], v[60:63], v[216:219], v[36:39]
	v_mfma_f32_16x16x32_bf16 v[44:47], v[60:63], v[220:223], v[44:47]
	v_mov_b32 v106, s66
	s_waitcnt vmcnt(13) lgkmcnt(0)
	buffer_store_dword v106, v12, s[36:39], 0 offen sc1
	s_barrier
	v_add_u32 v13, s70, v10
	ds_read_b128 v[48:51], v13 offset:0
	ds_read_b128 v[52:55], v13 offset:1024
	v_mfma_f32_16x16x32_bf16 v[16:19], v[64:67], v[224:227], v[16:19]
	v_mfma_f32_16x16x32_bf16 v[24:27], v[64:67], v[228:231], v[24:27]
	v_mfma_f32_16x16x32_bf16 v[32:35], v[64:67], v[232:235], v[32:35]
	v_mfma_f32_16x16x32_bf16 v[40:43], v[64:67], v[236:239], v[40:43]
	v_mfma_f32_16x16x32_bf16 v[20:23], v[68:71], v[224:227], v[20:23]
	v_mfma_f32_16x16x32_bf16 v[28:31], v[68:71], v[228:231], v[28:31]
	v_mfma_f32_16x16x32_bf16 v[36:39], v[68:71], v[232:235], v[36:39]
	v_mfma_f32_16x16x32_bf16 v[44:47], v[68:71], v[236:239], v[44:47]
	ds_read_b128 v[56:59], v13 offset:2048
	ds_read_b128 v[60:63], v13 offset:3072
	v_mfma_f32_16x16x32_bf16 v[16:19], v[72:75], v[240:243], v[16:19]
	s_add_u32 s66, s66, 1
	s_add_u32 s68, s68, 40960
	v_mfma_f32_16x16x32_bf16 v[24:27], v[72:75], v[244:247], v[24:27]
	s_add_u32 s67, s67, 40960
	s_sub_u32 s63, s67, 122880
	v_mfma_f32_16x16x32_bf16 v[32:35], v[72:75], v[248:251], v[32:35]
	s_cmp_ge_u32 s67, 122880
	s_cselect_b32 s67, s63, s67
	v_mfma_f32_16x16x32_bf16 v[40:43], v[72:75], v[252:255], v[40:43]
	s_mov_b32 s69, s76
	s_add_u32 s76, s76, 32768
	v_mfma_f32_16x16x32_bf16 v[20:23], v[76:79], v[240:243], v[20:23]
	s_and_b32 s76, s76, 0x7ffff
	s_cmp_lt_u32 s66, 64
	v_mfma_f32_16x16x32_bf16 v[28:31], v[76:79], v[244:247], v[28:31]
	v_mfma_f32_16x16x32_bf16 v[36:39], v[76:79], v[248:251], v[36:39]
	v_mfma_f32_16x16x32_bf16 v[44:47], v[76:79], v[252:255], v[44:47]
	ds_read_b128 v[64:67], v13 offset:4096
	ds_read_b128 v[68:71], v13 offset:5120
	s_waitcnt lgkmcnt(4)
	v_mfma_f32_16x16x32_bf16 v[112:115], v[48:51], a[0:3], 0
	s_add_u32 s70, s70, 40960
	s_cmp_eq_u32 s70, 122880
	v_mfma_f32_16x16x32_bf16 v[120:123], v[48:51], a[4:7], 0
	s_cselect_b32 s70, 0, s70
	s_sub_u32 s82, s66, 12
	v_mfma_f32_16x16x32_bf16 v[128:131], v[48:51], a[8:11], 0
	v_cmp_gt_i32 vcc, s82, v105
	v_mfma_f32_16x16x32_bf16 v[136:139], v[48:51], a[12:15], 0
	v_mfma_f32_16x16x32_bf16 v[116:119], v[52:55], a[0:3], 0
	s_cbranch_vccnz L_pw_130
L_pg_129:
	v_mfma_f32_16x16x32_bf16 v[124:127], v[52:55], a[4:7], 0
	buffer_load_dword v105, v104, s[36:39], 0 offen sc1
	v_mfma_f32_16x16x32_bf16 v[132:135], v[52:55], a[8:11], 0
	v_mfma_f32_16x16x32_bf16 v[140:143], v[52:55], a[12:15], 0
	ds_read_b128 v[72:75], v13 offset:6144
	ds_read_b128 v[76:79], v13 offset:7168
	s_waitcnt lgkmcnt(4)
	v_mfma_f32_16x16x32_bf16 v[112:115], v[56:59], a[16:19], v[112:115]
	v_cvt_pk_bf16_f32 v80, v16, v17
	v_mfma_f32_16x16x32_bf16 v[120:123], v[56:59], a[20:23], v[120:123]
	v_cvt_pk_bf16_f32 v81, v18, v19
	v_mfma_f32_16x16x32_bf16 v[128:131], v[56:59], a[24:27], v[128:131]
	v_cvt_pk_bf16_f32 v82, v20, v21
	v_mfma_f32_16x16x32_bf16 v[136:139], v[56:59], a[28:31], v[136:139]
	v_cvt_pk_bf16_f32 v83, v22, v23
	v_mfma_f32_16x16x32_bf16 v[116:119], v[60:63], a[16:19], v[116:119]
	v_mfma_f32_16x16x32_bf16 v[124:127], v[60:63], a[20:23], v[124:127]
	buffer_store_dwordx4 v[80:83], v11, s[36:39], s69 offen offset:0 sc1
	v_mfma_f32_16x16x32_bf16 v[132:135], v[60:63], a[24:27], v[132:135]
	v_mfma_f32_16x16x32_bf16 v[140:143], v[60:63], a[28:31], v[140:143]
	ds_read_b128 v[48:51], v13 offset:8192
	ds_read_b128 v[52:55], v13 offset:9216
	s_waitcnt lgkmcnt(4)
	v_mfma_f32_16x16x32_bf16 v[112:115], v[64:67], a[32:35], v[112:115]
	v_cvt_pk_bf16_f32 v84, v24, v25
	v_mfma_f32_16x16x32_bf16 v[120:123], v[64:67], a[36:39], v[120:123]
	v_cvt_pk_bf16_f32 v85, v26, v27
	v_mfma_f32_16x16x32_bf16 v[128:131], v[64:67], a[40:43], v[128:131]
	v_cvt_pk_bf16_f32 v86, v28, v29
	v_mfma_f32_16x16x32_bf16 v[136:139], v[64:67], a[44:47], v[136:139]
	v_cvt_pk_bf16_f32 v87, v30, v31
	v_mfma_f32_16x16x32_bf16 v[116:119], v[68:71], a[32:35], v[116:119]
	v_mfma_f32_16x16x32_bf16 v[124:127], v[68:71], a[36:39], v[124:127]
	buffer_store_dwordx4 v[84:87], v11, s[36:39], s69 offen offset:1024 sc1
	v_mfma_f32_16x16x32_bf16 v[132:135], v[68:71], a[40:43], v[132:135]
	v_mfma_f32_16x16x32_bf16 v[140:143], v[68:71], a[44:47], v[140:143]
	ds_read_b128 v[56:59], v13 offset:10240
	ds_read_b128 v[60:63], v13 offset:11264
	s_waitcnt lgkmcnt(4)
	v_mfma_f32_16x16x32_bf16 v[112:115], v[72:75], a[48:51], v[112:115]
	v_cvt_pk_bf16_f32 v88, v32, v33
	v_mfma_f32_16x16x32_bf16 v[120:123], v[72:75], a[52:55], v[120:123]
	v_cvt_pk_bf16_f32 v89, v34, v35
	v_mfma_f32_16x16x32_bf16 v[128:131], v[72:75], a[56:59], v[128:131]
	v_cvt_pk_bf16_f32 v90, v36, v37
	v_mfma_f32_16x16x32_bf16 v[136:139], v[72:75], a[60:63], v[136:139]
	v_cvt_pk_bf16_f32 v91, v38, v39
	v_mfma_f32_16x16x32_bf16 v[116:119], v[76:79], a[48:51], v[116:119]
	v_mfma_f32_16x16x32_bf16 v[124:127], v[76:79], a[52:55], v[124:127]
	buffer_store_dwordx4 v[88:91], v11, s[36:39], s69 offen offset:2048 sc1
	v_mfma_f32_16x16x32_bf16 v[132:135], v[76:79], a[56:59], v[132:135]
	v_mfma_f32_16x16x32_bf16 v[140:143], v[76:79], a[60:63], v[140:143]
	ds_read_b128 v[64:67], v13 offset:12288
	ds_read_b128 v[68:71], v13 offset:13312
	s_waitcnt lgkmcnt(4)
	v_mfma_f32_16x16x32_bf16 v[112:115], v[48:51], a[64:67], v[112:115]
	v_cvt_pk_bf16_f32 v92, v40, v41
	v_mfma_f32_16x16x32_bf16 v[120:123], v[48:51], a[68:71], v[120:123]
	v_cvt_pk_bf16_f32 v93, v42, v43
	v_mfma_f32_16x16x32_bf16 v[128:131], v[48:51], a[72:75], v[128:131]
	v_cvt_pk_bf16_f32 v94, v44, v45
	v_mfma_f32_16x16x32_bf16 v[136:139], v[48:51], a[76:79], v[136:139]
	v_cvt_pk_bf16_f32 v95, v46, v47
	v_mfma_f32_16x16x32_bf16 v[116:119], v[52:55], a[64:67], v[116:119]
	v_mfma_f32_16x16x32_bf16 v[124:127], v[52:55], a[68:71], v[124:127]
	buffer_store_dwordx4 v[92:95], v11, s[36:39], s69 offen offset:3072 sc1
	v_mfma_f32_16x16x32_bf16 v[132:135], v[52:55], a[72:75], v[132:135]
	v_mfma_f32_16x16x32_bf16 v[140:143], v[52:55], a[76:79], v[140:143]
	ds_read_b128 v[72:75], v13 offset:14336
	ds_read_b128 v[76:79], v13 offset:15360
	s_waitcnt lgkmcnt(4)
	v_mfma_f32_16x16x32_bf16 v[112:115], v[56:59], a[80:83], v[112:115]
	v_mfma_f32_16x16x32_bf16 v[120:123], v[56:59], a[84:87], v[120:123]
	v_mfma_f32_16x16x32_bf16 v[128:131], v[56:59], a[88:91], v[128:131]
	s_add_u32 m0, s67, 0
	v_mfma_f32_16x16x32_bf16 v[136:139], v[56:59], a[92:95], v[136:139]
	buffer_load_dwordx4 v8, s[48:51], s68 offen offset:0 lds
	v_mfma_f32_16x16x32_bf16 v[116:119], v[60:63], a[80:83], v[116:119]
	v_mfma_f32_16x16x32_bf16 v[124:127], v[60:63], a[84:87], v[124:127]
	v_mfma_f32_16x16x32_bf16 v[132:135], v[60:63], a[88:91], v[132:135]
	v_mfma_f32_16x16x32_bf16 v[140:143], v[60:63], a[92:95], v[140:143]
	ds_read_b128 v[48:51], v13 offset:16384
	ds_read_b128 v[52:55], v13 offset:17408
	s_waitcnt lgkmcnt(4)
	v_mfma_f32_16x16x32_bf16 v[112:115], v[64:67], a[96:99], v[112:115]
	v_mfma_f32_16x16x32_bf16 v[120:123], v[64:67], a[100:103], v[120:123]
	v_mfma_f32_16x16x32_bf16 v[128:131], v[64:67], a[104:107], v[128:131]
	s_add_u32 m0, s67, 1024
	v_mfma_f32_16x16x32_bf16 v[136:139], v[64:67], a[108:111], v[136:139]
	buffer_load_dwordx4 v9, s[48:51], s68 offen offset:0 lds
	v_mfma_f32_16x16x32_bf16 v[116:119], v[68:71], a[96:99], v[116:119]
	v_mfma_f32_16x16x32_bf16 v[124:127], v[68:71], a[100:103], v[124:127]
	v_mfma_f32_16x16x32_bf16 v[132:135], v[68:71], a[104:107], v[132:135]
	v_mfma_f32_16x16x32_bf16 v[140:143], v[68:71], a[108:111], v[140:143]
	ds_read_b128 v[56:59], v13 offset:18432
	ds_read_b128 v[60:63], v13 offset:19456
	s_waitcnt lgkmcnt(4)
	v_mfma_f32_16x16x32_bf16 v[112:115], v[72:75], a[112:115], v[112:115]
	v_mfma_f32_16x16x32_bf16 v[120:123], v[72:75], a[116:119], v[120:123]
	v_mfma_f32_16x16x32_bf16 v[128:131], v[72:75], a[120:123], v[128:131]
	s_add_u32 m0, s67, 1984
	v_mfma_f32_16x16x32_bf16 v[136:139], v[72:75], a[124:127], v[136:139]
	buffer_load_dwordx4 v8, s[48:51], s68 offen offset:64 lds
	v_mfma_f32_16x16x32_bf16 v[116:119], v[76:79], a[112:115], v[116:119]
	v_mfma_f32_16x16x32_bf16 v[124:127], v[76:79], a[116:119], v[124:127]
	v_mfma_f32_16x16x32_bf16 v[132:135], v[76:79], a[120:123], v[132:135]
	v_mfma_f32_16x16x32_bf16 v[140:143], v[76:79], a[124:127], v[140:143]
	ds_read_b128 v[64:67], v13 offset:20480
	ds_read_b128 v[68:71], v13 offset:21504
	s_waitcnt lgkmcnt(4)
	v_mfma_f32_16x16x32_bf16 v[112:115], v[48:51], a[128:131], v[112:115]
	v_mfma_f32_16x16x32_bf16 v[120:123], v[48:51], a[132:135], v[120:123]
	v_mfma_f32_16x16x32_bf16 v[128:131], v[48:51], a[136:139], v[128:131]
	s_add_u32 m0, s67, 3008
	v_mfma_f32_16x16x32_bf16 v[136:139], v[48:51], a[140:143], v[136:139]
	buffer_load_dwordx4 v9, s[48:51], s68 offen offset:64 lds
	v_mfma_f32_16x16x32_bf16 v[116:119], v[52:55], a[128:131], v[116:119]
	v_mfma_f32_16x16x32_bf16 v[124:127], v[52:55], a[132:135], v[124:127]
	v_mfma_f32_16x16x32_bf16 v[132:135], v[52:55], a[136:139], v[132:135]
	v_mfma_f32_16x16x32_bf16 v[140:143], v[52:55], a[140:143], v[140:143]
	ds_read_b128 v[72:75], v13 offset:22528
	ds_read_b128 v[76:79], v13 offset:23552
	s_waitcnt lgkmcnt(4)
	v_mfma_f32_16x16x32_bf16 v[112:115], v[56:59], a[144:147], v[112:115]
	v_mfma_f32_16x16x32_bf16 v[120:123], v[56:59], a[148:151], v[120:123]
	v_mfma_f32_16x16x32_bf16 v[128:131], v[56:59], a[152:155], v[128:131]
	s_add_u32 m0, s67, 3968
	v_mfma_f32_16x16x32_bf16 v[136:139], v[56:59], a[156:159], v[136:139]
	buffer_load_dwordx4 v8, s[48:51], s68 offen offset:128 lds
	v_mfma_f32_16x16x32_bf16 v[116:119], v[60:63], a[144:147], v[116:119]
	v_mfma_f32_16x16x32_bf16 v[124:127], v[60:63], a[148:151], v[124:127]
	v_mfma_f32_16x16x32_bf16 v[132:135], v[60:63], a[152:155], v[132:135]
	v_mfma_f32_16x16x32_bf16 v[140:143], v[60:63], a[156:159], v[140:143]
	ds_read_b128 v[48:51], v13 offset:24576
	ds_read_b128 v[52:55], v13 offset:25600
	s_waitcnt lgkmcnt(4)
	v_mfma_f32_16x16x32_bf16 v[112:115], v[64:67], a[160:163], v[112:115]
	v_mfma_f32_16x16x32_bf16 v[120:123], v[64:67], a[164:167], v[120:123]
	v_mfma_f32_16x16x32_bf16 v[128:131], v[64:67], a[168:171], v[128:131]
	s_add_u32 m0, s67, 4992
	v_mfma_f32_16x16x32_bf16 v[136:139], v[64:67], a[172:175], v[136:139]
	buffer_load_dwordx4 v9, s[48:51], s68 offen offset:128 lds
	v_mfma_f32_16x16x32_bf16 v[116:119], v[68:71], a[160:163], v[116:119]
	v_mfma_f32_16x16x32_bf16 v[124:127], v[68:71], a[164:167], v[124:127]
	v_mfma_f32_16x16x32_bf16 v[132:135], v[68:71], a[168:171], v[132:135]
	v_mfma_f32_16x16x32_bf16 v[140:143], v[68:71], a[172:175], v[140:143]
	ds_read_b128 v[56:59], v13 offset:26624
	ds_read_b128 v[60:63], v13 offset:27648
	s_waitcnt lgkmcnt(4)
	v_mfma_f32_16x16x32_bf16 v[112:115], v[72:75], a[176:179], v[112:115]
	v_mfma_f32_16x16x32_bf16 v[120:123], v[72:75], a[180:183], v[120:123]
	v_mfma_f32_16x16x32_bf16 v[128:131], v[72:75], a[184:187], v[128:131]
	s_add_u32 m0, s67, 5952
	v_mfma_f32_16x16x32_bf16 v[136:139], v[72:75], a[188:191], v[136:139]
	buffer_load_dwordx4 v8, s[48:51], s68 offen offset:192 lds
	v_mfma_f32_16x16x32_bf16 v[116:119], v[76:79], a[176:179], v[116:119]
	v_mfma_f32_16x16x32_bf16 v[124:127], v[76:79], a[180:183], v[124:127]
	v_mfma_f32_16x16x32_bf16 v[132:135], v[76:79], a[184:187], v[132:135]
	s_cmp_le_u32 s66, 6
	s_cbranch_scc1 L_pf_132
L_pe_131:
	v_mfma_f32_16x16x32_bf16 v[140:143], v[76:79], a[188:191], v[140:143]
	ds_read_b128 v[64:67], v13 offset:28672
	ds_read_b128 v[68:71], v13 offset:29696
	s_waitcnt lgkmcnt(4)
	v_mfma_f32_16x16x32_bf16 v[112:115], v[48:51], a[192:195], v[112:115]
	v_mfma_f32_16x16x32_bf16 v[120:123], v[48:51], a[196:199], v[120:123]
	v_mfma_f32_16x16x32_bf16 v[128:131], v[48:51], a[200:203], v[128:131]
	s_add_u32 m0, s67, 6976
	v_mfma_f32_16x16x32_bf16 v[136:139], v[48:51], a[204:207], v[136:139]
	buffer_load_dwordx4 v9, s[48:51], s68 offen offset:192 lds
	v_mfma_f32_16x16x32_bf16 v[116:119], v[52:55], a[192:195], v[116:119]
	v_mfma_f32_16x16x32_bf16 v[124:127], v[52:55], a[196:199], v[124:127]
	v_mfma_f32_16x16x32_bf16 v[132:135], v[52:55], a[200:203], v[132:135]
	v_mfma_f32_16x16x32_bf16 v[140:143], v[52:55], a[204:207], v[140:143]
	ds_read_b128 v[72:75], v13 offset:30720
	ds_read_b128 v[76:79], v13 offset:31744
	s_waitcnt lgkmcnt(4)
	v_mfma_f32_16x16x32_bf16 v[112:115], v[56:59], a[208:211], v[112:115]
	v_mfma_f32_16x16x32_bf16 v[120:123], v[56:59], a[212:215], v[120:123]
	v_mfma_f32_16x16x32_bf16 v[128:131], v[56:59], a[216:219], v[128:131]
	s_add_u32 m0, s67, 7936
	v_mfma_f32_16x16x32_bf16 v[136:139], v[56:59], a[220:223], v[136:139]
	buffer_load_dwordx4 v8, s[48:51], s68 offen offset:256 lds
	v_mfma_f32_16x16x32_bf16 v[116:119], v[60:63], a[208:211], v[116:119]
	v_mfma_f32_16x16x32_bf16 v[124:127], v[60:63], a[212:215], v[124:127]
	v_mfma_f32_16x16x32_bf16 v[132:135], v[60:63], a[216:219], v[132:135]
	v_mfma_f32_16x16x32_bf16 v[140:143], v[60:63], a[220:223], v[140:143]
	ds_read_b128 v[48:51], v13 offset:32768
	ds_read_b128 v[52:55], v13 offset:33792
	s_waitcnt lgkmcnt(4)
	v_mfma_f32_16x16x32_bf16 v[112:115], v[64:67], a[224:227], v[112:115]
	v_mfma_f32_16x16x32_bf16 v[120:123], v[64:67], a[228:231], v[120:123]
	v_mfma_f32_16x16x32_bf16 v[128:131], v[64:67], a[232:235], v[128:131]
	s_add_u32 m0, s67, 8960
	v_mfma_f32_16x16x32_bf16 v[136:139], v[64:67], a[236:239], v[136:139]
	buffer_load_dwordx4 v9, s[48:51], s68 offen offset:256 lds
	v_mfma_f32_16x16x32_bf16 v[116:119], v[68:71], a[224:227], v[116:119]
	v_mfma_f32_16x16x32_bf16 v[124:127], v[68:71], a[228:231], v[124:127]
	v_mfma_f32_16x16x32_bf16 v[132:135], v[68:71], a[232:235], v[132:135]
	v_mfma_f32_16x16x32_bf16 v[140:143], v[68:71], a[236:239], v[140:143]
	ds_read_b128 v[56:59], v13 offset:34816
	ds_read_b128 v[60:63], v13 offset:35840
	s_waitcnt lgkmcnt(4)
	v_mfma_f32_16x16x32_bf16 v[112:115], v[72:75], a[240:243], v[112:115]
	v_mfma_f32_16x16x32_bf16 v[120:123], v[72:75], a[244:247], v[120:123]
	buffer_store_dwordx4 v[100:103], v96, s[36:39], s76 offen offset:0 sc1
	v_mfma_f32_16x16x32_bf16 v[128:131], v[72:75], a[248:251], v[128:131]
	v_mfma_f32_16x16x32_bf16 v[136:139], v[72:75], a[252:255], v[136:139]
	v_mfma_f32_16x16x32_bf16 v[116:119], v[76:79], a[240:243], v[116:119]
	v_mfma_f32_16x16x32_bf16 v[124:127], v[76:79], a[244:247], v[124:127]
	buffer_store_dwordx4 v[100:103], v96, s[36:39], s76 offen offset:1024 sc1
	v_mfma_f32_16x16x32_bf16 v[132:135], v[76:79], a[248:251], v[132:135]
	v_mfma_f32_16x16x32_bf16 v[140:143], v[76:79], a[252:255], v[140:143]
	ds_read_b128 v[64:67], v13 offset:36864
	ds_read_b128 v[68:71], v13 offset:37888
	s_waitcnt lgkmcnt(4)
	v_mfma_f32_16x16x32_bf16 v[112:115], v[48:51], v[192:195], v[112:115]
	v_mfma_f32_16x16x32_bf16 v[120:123], v[48:51], v[196:199], v[120:123]
	buffer_store_dword v100, v99, s[36:39], s76 offen sc1
	v_mfma_f32_16x16x32_bf16 v[128:131], v[48:51], v[200:203], v[128:131]
	v_mfma_f32_16x16x32_bf16 v[136:139], v[48:51], v[204:207], v[136:139]
	v_mfma_f32_16x16x32_bf16 v[116:119], v[52:55], v[192:195], v[116:119]
	v_mfma_f32_16x16x32_bf16 v[124:127], v[52:55], v[196:199], v[124:127]
	v_mfma_f32_16x16x32_bf16 v[132:135], v[52:55], v[200:203], v[132:135]
	v_mfma_f32_16x16x32_bf16 v[140:143], v[52:55], v[204:207], v[140:143]
	ds_read_b128 v[72:75], v13 offset:38912
	ds_read_b128 v[76:79], v13 offset:39936
	s_waitcnt lgkmcnt(4)
	v_mfma_f32_16x16x32_bf16 v[112:115], v[56:59], v[208:211], v[112:115]
	v_mfma_f32_16x16x32_bf16 v[120:123], v[56:59], v[212:215], v[120:123]
	v_mfma_f32_16x16x32_bf16 v[128:131], v[56:59], v[216:219], v[128:131]
	v_mfma_f32_16x16x32_bf16 v[136:139], v[56:59], v[220:223], v[136:139]
	v_mfma_f32_16x16x32_bf16 v[116:119], v[60:63], v[208:211], v[116:119]
	v_mfma_f32_16x16x32_bf16 v[124:127], v[60:63], v[212:215], v[124:127]
	v_mfma_f32_16x16x32_bf16 v[132:135], v[60:63], v[216:219], v[132:135]
	v_mfma_f32_16x16x32_bf16 v[140:143], v[60:63], v[220:223], v[140:143]
	v_mov_b32 v106, s66
	s_waitcnt vmcnt(13) lgkmcnt(0)
	buffer_store_dword v106, v12, s[36:39], 0 offen sc1
	s_barrier
	v_add_u32 v13, s70, v10
	ds_read_b128 v[48:51], v13 offset:0
	ds_read_b128 v[52:55], v13 offset:1024
	v_mfma_f32_16x16x32_bf16 v[112:115], v[64:67], v[224:227], v[112:115]
	v_mfma_f32_16x16x32_bf16 v[120:123], v[64:67], v[228:231], v[120:123]
	v_mfma_f32_16x16x32_bf16 v[128:131], v[64:67], v[232:235], v[128:131]
	v_mfma_f32_16x16x32_bf16 v[136:139], v[64:67], v[236:239], v[136:139]
	v_mfma_f32_16x16x32_bf16 v[116:119], v[68:71], v[224:227], v[116:119]
	v_mfma_f32_16x16x32_bf16 v[124:127], v[68:71], v[228:231], v[124:127]
	v_mfma_f32_16x16x32_bf16 v[132:135], v[68:71], v[232:235], v[132:135]
	v_mfma_f32_16x16x32_bf16 v[140:143], v[68:71], v[236:239], v[140:143]
	ds_read_b128 v[56:59], v13 offset:2048
	ds_read_b128 v[60:63], v13 offset:3072
	v_mfma_f32_16x16x32_bf16 v[112:115], v[72:75], v[240:243], v[112:115]
	s_add_u32 s66, s66, 1
	s_add_u32 s68, s68, 40960
	v_mfma_f32_16x16x32_bf16 v[120:123], v[72:75], v[244:247], v[120:123]
	s_add_u32 s67, s67, 40960
	s_sub_u32 s63, s67, 122880
	v_mfma_f32_16x16x32_bf16 v[128:131], v[72:75], v[248:251], v[128:131]
	s_cmp_ge_u32 s67, 122880
	s_cselect_b32 s67, s63, s67
	v_mfma_f32_16x16x32_bf16 v[136:139], v[72:75], v[252:255], v[136:139]
	s_mov_b32 s69, s76
	s_add_u32 s76, s76, 32768
	v_mfma_f32_16x16x32_bf16 v[116:119], v[76:79], v[240:243], v[116:119]
	s_and_b32 s76, s76, 0x7ffff
	s_cmp_lt_u32 s66, 64
	v_mfma_f32_16x16x32_bf16 v[124:127], v[76:79], v[244:247], v[124:127]
	v_mfma_f32_16x16x32_bf16 v[132:135], v[76:79], v[248:251], v[132:135]
	v_mfma_f32_16x16x32_bf16 v[140:143], v[76:79], v[252:255], v[140:143]
	s_cbranch_scc1 L_p_124
	v_cvt_pk_bf16_f32 v80, v112, v113
	v_cvt_pk_bf16_f32 v81, v114, v115
	v_cvt_pk_bf16_f32 v82, v116, v117
	v_cvt_pk_bf16_f32 v83, v118, v119
	buffer_store_dwordx4 v[80:83], v11, s[36:39], s69 offen offset:0 sc1
	v_cvt_pk_bf16_f32 v84, v120, v121
	v_cvt_pk_bf16_f32 v85, v122, v123
	v_cvt_pk_bf16_f32 v86, v124, v125
	v_cvt_pk_bf16_f32 v87, v126, v127
	buffer_store_dwordx4 v[84:87], v11, s[36:39], s69 offen offset:1024 sc1
	v_cvt_pk_bf16_f32 v88, v128, v129
	v_cvt_pk_bf16_f32 v89, v130, v131
	v_cvt_pk_bf16_f32 v90, v132, v133
	v_cvt_pk_bf16_f32 v91, v134, v135
	buffer_store_dwordx4 v[88:91], v11, s[36:39], s69 offen offset:2048 sc1
	v_cvt_pk_bf16_f32 v92, v136, v137
	v_cvt_pk_bf16_f32 v93, v138, v139
	v_cvt_pk_bf16_f32 v94, v140, v141
	v_cvt_pk_bf16_f32 v95, v142, v143
	buffer_store_dwordx4 v[92:95], v11, s[36:39], s69 offen offset:3072 sc1
	v_mov_b32 v106, s66
	s_waitcnt vmcnt(0)
	buffer_store_dword v106, v12, s[36:39], 0 offen sc1
	s_endpgm
L_pw_126:
	buffer_load_dword v105, v104, s[36:39], 0 offen sc1
	s_waitcnt vmcnt(0)
	v_cmp_gt_i32 vcc, s82, v105
	s_cbranch_vccz L_pg_125
	s_sleep 2
	s_add_u32 s34, s34, 1
	s_cmp_lt_u32 s34, 0x40000
	s_cbranch_scc1 L_pw_126
	s_endpgm
L_pf_128:
	v_mov_b32 v106, s66
	s_waitcnt vmcnt(7)
	buffer_store_dword v106, v12, s[36:39], 0 offen sc1
	s_branch L_pe_127
L_pw_130:
	buffer_load_dword v105, v104, s[36:39], 0 offen sc1
	s_waitcnt vmcnt(0)
	v_cmp_gt_i32 vcc, s82, v105
	s_cbranch_vccz L_pg_129
	s_sleep 2
	s_add_u32 s34, s34, 1
	s_cmp_lt_u32 s34, 0x40000
	s_cbranch_scc1 L_pw_130
	s_endpgm
L_pf_132:
	v_mov_b32 v106, s66
	s_waitcnt vmcnt(7)
	buffer_store_dword v106, v12, s[36:39], 0 offen sc1
	s_branch L_pe_131
L_attn:
	s_lshl_b32 s66, s60, 2
	s_add_u32 s66, s66, s5
	s_lshr_b32 s61, s66, 1
	s_and_b32 s62, s66, 1
	s_lshl_b32 s6, s66, 7
	s_add_u32 s6, s6, 0x4090000
	v_lshl_add_u32 v5, v0, 2, s6
	v_mov_b32 v10, 0
	s_mov_b64 exec, 0xffff
	buffer_store_dword v10, v5, s[36:39], 0 offen sc1
	s_mov_b64 exec, -1
	s_waitcnt vmcnt(0)
	s_barrier
	s_lshl_b32 s6, s5, 12
	s_add_u32 s6, s6, 96
	v_mov_b32 v10, s6
	v_mov_b32 v11, 1
	s_mov_b64 exec, 1
	buffer_atomic_add v11, v10, s[40:43], 0 offen
	s_mov_b64 exec, -1
	s_cmp_lg_u32 s66, 0
	s_cbranch_scc1 L_anw_133
	v_lshlrev_b32 v11, 2, v0
	s_mov_b64 exec, 7
L_wa_134:
	v_mov_b32 v10, 0
	buffer_atomic_or v10, v11, s[40:43], 0 offen offset:96 sc0
	s_waitcnt vmcnt(0)
	v_readfirstlane_b32 s6, v10
	s_nop 0
	s_cmp_ge_u32 s6, 256
	s_cbranch_scc1 L_wao_135
	s_add_u32 s34, s34, 1
	s_cmp_lt_u32 s34, 0x40000
	s_cbranch_scc1 L_wa_134
	s_endpgm
L_wao_135:
	v_readlane_b32 s6, v10, 1
	v_readlane_b32 s7, v10, 2
	s_mov_b64 exec, 1
	v_mov_b32 v11, s6
	v_mov_b32 v12, s7
	v_mov_b32 v13, 128
	buffer_store_dwordx3 v[10:12], v13, s[40:43], 0 offen sc1
	s_waitcnt vmcnt(0)
	s_mov_b64 exec, -1
L_anw_133:
	s_barrier
	v_mov_b32 v13, 128
L_sw_136:
	buffer_load_dwordx3 v[10:12], v13, s[40:43], 0 offen sc1
	s_waitcnt vmcnt(0)
	v_readfirstlane_b32 s6, v10
	s_nop 0
	s_cmp_ge_u32 s6, 256
	s_cbranch_scc1 L_swok_137
	s_sleep 4
	s_add_u32 s34, s34, 1
	s_cmp_lt_u32 s34, 0x40000
	s_cbranch_scc1 L_sw_136
	s_endpgm
L_swok_137:
	s_mov_b32 s44, s8
	s_and_b32 s45, s9, 0xffff
	s_mov_b32 s46, 0x280000
	s_mov_b32 s47, 0x20000
	s_lshl_b32 s6, s60, 2
	s_add_u32 s6, s6, s5
	s_mul_i32 s6, s6, 40960
	v_lshlrev_b32 v10, 7, v0
	buffer_load_dword v11, v10, s[44:47], s6 offen
	s_add_u32 s6, s6, 8192
	buffer_load_dword v11, v10, s[44:47], s6 offen
	s_add_u32 s6, s6, 8192
	buffer_load_dword v11, v10, s[44:47], s6 offen
	s_add_u32 s6, s6, 8192
	buffer_load_dword v11, v10, s[44:47], s6 offen
	s_add_u32 s6, s6, 8192
	buffer_load_dword v11, v10, s[44:47], s6 offen
	s_add_u32 s6, s6, 8192
	s_waitcnt vmcnt(0)
	s_lshl_b32 s6, s62, 15
	v_lshl_add_u32 v1, v0, 4, s6
	v_mov_b32 v2, v1
	v_lshl_add_u32 v9, v0, 2, s6
	v_and_b32 v10, 15, v0
	v_lshrrev_b32 v11, 4, v0
	s_lshl_b32 s6, s5, 13
	v_lshlrev_b32 v6, 5, v10
	v_lshl_add_u32 v6, v11, 3, v6
	v_add_u32 v6, s6, v6
	v_lshlrev_b32 v7, 3, v0
	v_add_u32 v7, s6, v7
	v_lshlrev_b32 v11, 2, v11
	v_mov_b32 v8, 0xd04e79ff
	s_mov_b32 s68, 0x3dd53b95
	v_add_u32 v12, 0, v11
	v_cmp_le_u32 s[76:77], v12, v10
	v_add_u32 v12, 1, v11
	v_cmp_le_u32 s[78:79], v12, v10
	v_add_u32 v12, 2, v11
	v_cmp_le_u32 s[80:81], v12, v10
	v_add_u32 v12, 3, v11
	v_cmp_le_u32 s[82:83], v12, v10
	v_mov_b32 v21, 0
	v_mov_b32 v27, 0
	v_mov_b32 v33, 0
	v_mov_b32 v39, 0
	v_mov_b32 v45, 0
	v_mov_b32 v51, 0
	v_mov_b32 v57, 0
	v_mov_b32 v63, 0
	v_mov_b32 v69, 0
	v_mov_b32 v75, 0
	v_mov_b32 v81, 0
	v_mov_b32 v87, 0
	v_mov_b32 v92, 0
	v_mov_b32 v93, 0
	v_mov_b32 v153, 0
	v_mov_b32 v157, 0
	v_mov_b32 v162, 0
	v_mov_b32 v163, 0
	v_mov_b32 v13, 128
L_sw_138:
	buffer_load_dwordx3 v[10:12], v13, s[40:43], 0 offen sc1
	s_waitcnt vmcnt(0)
	v_readfirstlane_b32 s6, v10
	s_nop 0
	s_cmp_ge_u32 s6, 256
	s_cbranch_scc1 L_swok_139
	s_sleep 4
	s_add_u32 s34, s34, 1
	s_cmp_lt_u32 s34, 0x40000
	s_cbranch_scc1 L_sw_138
	s_endpgm
L_swok_139:
	v_readfirstlane_b32 s84, v11
	v_readfirstlane_b32 s85, v12
	s_lshl_b32 s64, s61, 2
	s_add_u32 s64, s64, 1
	s_lshl_b32 s64, s64, 19
	s_lshr_b32 s66, s84, s61
	s_xor_b32 s66, s66, 0
	s_and_b32 s66, s66, 1
	s_lshl_b32 s66, s66, 13
	s_add_u32 s64, s64, s66
	s_add_u32 s66, s61, 0
	s_bfe_u32 s67, s66, 0x10001
	s_lshl_b32 s67, s67, 14
	s_and_b32 s66, s66, 1
	s_lshl_b32 s66, s66, 12
	s_add_u32 s66, s66, s67
	s_add_u32 s8, s64, s66
	s_add_u32 s66, s61, 1
	s_bfe_u32 s67, s66, 0x10001
	s_lshl_b32 s67, s67, 14
	s_and_b32 s66, s66, 1
	s_lshl_b32 s66, s66, 12
	s_add_u32 s66, s66, s67
	s_add_u32 s9, s64, s66
	s_add_u32 s66, s61, 2
	s_bfe_u32 s67, s66, 0x10001
	s_lshl_b32 s67, s67, 14
	s_and_b32 s66, s66, 1
	s_lshl_b32 s66, s66, 12
	s_add_u32 s66, s66, s67
	s_add_u32 s10, s64, s66
	s_lshl_b32 s64, s61, 2
	s_add_u32 s64, s64, 2
	s_lshl_b32 s64, s64, 19
	s_lshr_b32 s66, s84, s61
	s_xor_b32 s66, s66, 0
	s_and_b32 s66, s66, 1
	s_lshl_b32 s66, s66, 13
	s_add_u32 s64, s64, s66
	s_add_u32 s66, s61, 0
	s_bfe_u32 s67, s66, 0x10001
	s_lshl_b32 s67, s67, 14
	s_and_b32 s66, s66, 1
	s_lshl_b32 s66, s66, 12
	s_add_u32 s66, s66, s67
	s_add_u32 s14, s64, s66
	s_add_u32 s66, s61, 1
	s_bfe_u32 s67, s66, 0x10001
	s_lshl_b32 s67, s67, 14
	s_and_b32 s66, s66, 1
	s_lshl_b32 s66, s66, 12
	s_add_u32 s66, s66, s67
	s_add_u32 s15, s64, s66
	s_add_u32 s66, s61, 2
	s_bfe_u32 s67, s66, 0x10001
	s_lshl_b32 s67, s67, 14
	s_and_b32 s66, s66, 1
	s_lshl_b32 s66, s66, 12
	s_add_u32 s66, s66, s67
	s_add_u32 s16, s64, s66
	s_lshl_b32 s64, s61, 2
	s_add_u32 s64, s64, 0
	s_lshl_b32 s64, s64, 19
	s_lshr_b32 s66, s84, s61
	s_xor_b32 s66, s66, 1
	s_and_b32 s66, s66, 1
	s_lshl_b32 s66, s66, 13
	s_add_u32 s64, s64, s66
	s_add_u32 s66, s61, 0
	s_bfe_u32 s67, s66, 0x10001
	s_lshl_b32 s67, s67, 14
	s_and_b32 s66, s66, 1
	s_lshl_b32 s66, s66, 12
	s_add_u32 s66, s66, s67
	s_add_u32 s17, s64, s66
	s_add_u32 s66, s61, 1
	s_bfe_u32 s67, s66, 0x10001
	s_lshl_b32 s67, s67, 14
	s_and_b32 s66, s66, 1
	s_lshl_b32 s66, s66, 12
	s_add_u32 s66, s66, s67
	s_add_u32 s18, s64, s66
	s_add_u32 s66, s61, 2
	s_bfe_u32 s67, s66, 0x10001
	s_lshl_b32 s67, s67, 14
	s_and_b32 s66, s66, 1
	s_lshl_b32 s66, s66, 12
	s_add_u32 s66, s66, s67
	s_add_u32 s19, s64, s66
	s_add_u32 s66, s61, 3
	s_bfe_u32 s67, s66, 0x10001
	s_lshl_b32 s67, s67, 14
	s_and_b32 s66, s66, 1
	s_lshl_b32 s66, s66, 12
	s_add_u32 s66, s66, s67
	s_add_u32 s11, s64, s66
	s_add_u32 s12, s11, 0x80000
	s_add_u32 s13, s11, 0x100000
	s_lshl_b32 s64, s61, 2
	s_add_u32 s64, s64, 0
	s_lshl_b32 s64, s64, 19
	s_lshr_b32 s66, s84, s61
	s_xor_b32 s66, s66, 0
	s_and_b32 s66, s66, 1
	s_lshl_b32 s66, s66, 13
	s_add_u32 s64, s64, s66
	s_add_u32 s66, s61, 3
	s_bfe_u32 s67, s66, 0x10001
	s_lshl_b32 s67, s67, 14
	s_and_b32 s66, s66, 1
	s_lshl_b32 s66, s66, 12
	s_add_u32 s66, s66, s67
	s_add_u32 s73, s64, s66
	s_bfe_u32 s66, s61, 0x10004
	s_mul_i32 s66, s66, 3072
	s_add_u32 s64, s64, s66
	s_add_u32 s66, s61, 0
	s_bfe_u32 s67, s66, 0x10001
	s_lshl_b32 s67, s67, 14
	s_and_b32 s66, s66, 1
	s_lshl_b32 s66, s66, 12
	s_add_u32 s66, s66, s67
	s_add_u32 s70, s64, s66
	s_add_u32 s66, s61, 1
	s_bfe_u32 s67, s66, 0x10001
	s_lshl_b32 s67, s67, 14
	s_and_b32 s66, s66, 1
	s_lshl_b32 s66, s66, 12
	s_add_u32 s66, s66, s67
	s_add_u32 s71, s64, s66
	s_add_u32 s66, s61, 2
	s_bfe_u32 s67, s66, 0x10001
	s_lshl_b32 s67, s67, 14
	s_and_b32 s66, s66, 1
	s_lshl_b32 s66, s66, 12
	s_add_u32 s66, s66, s67
	s_add_u32 s72, s64, s66
	s_add_u32 s6, s73, 1575936
	v_lshl_add_u32 v4, v0, 8, s6
	s_add_u32 s6, s73, 1605632
	v_min_u32 v10, 8, v0
	v_lshl_add_u32 v3, v10, 7, s6
	s_mov_b32 s69, s62
	v_mov_b32 v15, v1
L_apw_140:
	buffer_load_dword v14, v3, s[36:39], 0 offen sc1
	s_waitcnt vmcnt(0)
	v_cmp_ge_u32 vcc, s69, v14
	s_cbranch_vccz L_apo_141
	s_sleep 8
	s_add_u32 s34, s34, 1
	s_cmp_lt_u32 s34, 0x40000
	s_cbranch_scc1 L_apw_140
	s_endpgm
L_apo_141:
	buffer_load_dwordx4 a[48:51], v15, s[36:39], s8 offen offset:0 sc1
	buffer_load_dwordx4 a[52:55], v15, s[36:39], s8 offen offset:1024 sc1
	buffer_load_dwordx4 a[56:59], v15, s[36:39], s8 offen offset:2048 sc1
	buffer_load_dwordx4 a[60:63], v15, s[36:39], s8 offen offset:3072 sc1
	buffer_load_dwordx4 a[64:67], v15, s[36:39], s9 offen offset:0 sc1
	buffer_load_dwordx4 a[68:71], v15, s[36:39], s9 offen offset:1024 sc1
	buffer_load_dwordx4 a[72:75], v15, s[36:39], s9 offen offset:2048 sc1
	buffer_load_dwordx4 a[76:79], v15, s[36:39], s9 offen offset:3072 sc1
	buffer_load_dwordx4 a[80:83], v15, s[36:39], s10 offen offset:0 sc1
	buffer_load_dwordx4 a[84:87], v15, s[36:39], s10 offen offset:1024 sc1
	buffer_load_dwordx4 a[88:91], v15, s[36:39], s10 offen offset:2048 sc1
	buffer_load_dwordx4 a[92:95], v15, s[36:39], s10 offen offset:3072 sc1
	buffer_load_dwordx4 a[0:3], v15, s[36:39], s11 offen offset:0 sc1
	buffer_load_dwordx4 a[4:7], v15, s[36:39], s11 offen offset:1024 sc1
	buffer_load_dwordx4 a[8:11], v15, s[36:39], s11 offen offset:2048 sc1
	buffer_load_dwordx4 a[12:15], v15, s[36:39], s11 offen offset:3072 sc1
	buffer_load_dwordx4 a[16:19], v15, s[36:39], s12 offen offset:0 sc1
	buffer_load_dwordx4 a[20:23], v15, s[36:39], s12 offen offset:1024 sc1
	buffer_load_dwordx4 a[24:27], v15, s[36:39], s12 offen offset:2048 sc1
	buffer_load_dwordx4 a[28:31], v15, s[36:39], s12 offen offset:3072 sc1
	buffer_load_dwordx4 a[32:35], v15, s[36:39], s13 offen offset:0 sc1
	buffer_load_dwordx4 a[36:39], v15, s[36:39], s13 offen offset:1024 sc1
	buffer_load_dwordx4 a[40:43], v15, s[36:39], s13 offen offset:2048 sc1
	buffer_load_dwordx4 a[44:47], v15, s[36:39], s13 offen offset:3072 sc1
	buffer_load_dwordx4 v[22:25], v15, s[36:39], s14 offen offset:0 sc1
	buffer_load_dwordx4 v[28:31], v15, s[36:39], s14 offen offset:1024 sc1
	buffer_load_dwordx4 v[34:37], v15, s[36:39], s14 offen offset:2048 sc1
	buffer_load_dwordx4 v[40:43], v15, s[36:39], s14 offen offset:3072 sc1
	buffer_load_dwordx4 v[46:49], v15, s[36:39], s15 offen offset:0 sc1
	buffer_load_dwordx4 v[52:55], v15, s[36:39], s15 offen offset:1024 sc1
	buffer_load_dwordx4 v[58:61], v15, s[36:39], s15 offen offset:2048 sc1
	buffer_load_dwordx4 v[64:67], v15, s[36:39], s15 offen offset:3072 sc1
	buffer_load_dwordx4 v[70:73], v15, s[36:39], s16 offen offset:0 sc1
	buffer_load_dwordx4 v[76:79], v15, s[36:39], s16 offen offset:1024 sc1
	buffer_load_dwordx4 v[82:85], v15, s[36:39], s16 offen offset:2048 sc1
	buffer_load_dwordx4 v[88:91], v15, s[36:39], s16 offen offset:3072 sc1
	s_waitcnt vmcnt(12)
L_at_142:
	v_mfma_f32_16x16x32_bf16 v[132:135], a[48:51], a[0:3], 0
	v_mfma_f32_16x16x32_bf16 v[136:139], a[48:51], a[4:7], 0
	v_mfma_f32_16x16x32_bf16 v[140:143], a[52:55], a[4:7], 0
	v_mfma_f32_16x16x32_bf16 v[132:135], a[56:59], a[8:11], v[132:135]
	v_mfma_f32_16x16x32_bf16 v[136:139], a[56:59], a[12:15], v[136:139]
	v_mfma_f32_16x16x32_bf16 v[140:143], a[60:63], a[12:15], v[140:143]
	v_mfma_f32_16x16x32_bf16 v[132:135], a[64:67], a[16:19], v[132:135]
	v_mfma_f32_16x16x32_bf16 v[136:139], a[64:67], a[20:23], v[136:139]
	v_mfma_f32_16x16x32_bf16 v[140:143], a[68:71], a[20:23], v[140:143]
	v_mfma_f32_16x16x32_bf16 v[132:135], a[72:75], a[24:27], v[132:135]
	v_mfma_f32_16x16x32_bf16 v[136:139], a[72:75], a[28:31], v[136:139]
	v_mfma_f32_16x16x32_bf16 v[140:143], a[76:79], a[28:31], v[140:143]
	v_mfma_f32_16x16x32_bf16 v[132:135], a[80:83], a[32:35], v[132:135]
	v_mfma_f32_16x16x32_bf16 v[136:139], a[80:83], a[36:39], v[136:139]
	v_mfma_f32_16x16x32_bf16 v[140:143], a[84:87], a[36:39], v[140:143]
	v_mfma_f32_16x16x32_bf16 v[132:135], a[88:91], a[40:43], v[132:135]
	v_mfma_f32_16x16x32_bf16 v[136:139], a[88:91], a[44:47], v[136:139]
	v_mfma_f32_16x16x32_bf16 v[140:143], a[92:95], a[44:47], v[140:143]
	v_add_u32 v1, 65536, v1
	v_and_b32 v1, 0x7ffff, v1
	s_add_u32 s69, s62, 2
	s_cmp_ge_u32 s69, 64
	s_cselect_b32 s6, 0xfe00000, 0
	s_min_u32 s69, s69, 63
	v_add_u32 v15, s6, v1
	v_cmp_ge_u32 vcc, s69, v14
	s_cbranch_vccz L_apo_146
L_apw_145:
	buffer_load_dword v14, v3, s[36:39], 0 offen sc1
	s_waitcnt vmcnt(0)
	v_cmp_ge_u32 vcc, s69, v14
	s_cbranch_vccz L_apo_146
	s_sleep 8
	s_add_u32 s34, s34, 1
	s_cmp_lt_u32 s34, 0x40000
	s_cbranch_scc1 L_apw_145
	s_endpgm
L_apo_146:
	buffer_load_dwordx4 a[48:51], v15, s[36:39], s8 offen offset:0 sc1
	buffer_load_dwordx4 a[52:55], v15, s[36:39], s8 offen offset:1024 sc1
	buffer_load_dwordx4 a[56:59], v15, s[36:39], s8 offen offset:2048 sc1
	buffer_load_dwordx4 a[60:63], v15, s[36:39], s8 offen offset:3072 sc1
	buffer_load_dwordx4 a[64:67], v15, s[36:39], s9 offen offset:0 sc1
	buffer_load_dwordx4 a[68:71], v15, s[36:39], s9 offen offset:1024 sc1
	buffer_load_dwordx4 a[72:75], v15, s[36:39], s9 offen offset:2048 sc1
	buffer_load_dwordx4 a[76:79], v15, s[36:39], s9 offen offset:3072 sc1
	buffer_load_dwordx4 a[80:83], v15, s[36:39], s10 offen offset:0 sc1
	buffer_load_dwordx4 a[84:87], v15, s[36:39], s10 offen offset:1024 sc1
	buffer_load_dwordx4 a[88:91], v15, s[36:39], s10 offen offset:2048 sc1
	buffer_load_dwordx4 a[92:95], v15, s[36:39], s10 offen offset:3072 sc1
	s_cmp_eq_u32 s62, 63
	s_cselect_b32 s7, 0, 0x80
L_acw_143:
	v_mov_b32 v10, 0
	s_mov_b64 exec, 7
	buffer_atomic_or v10, v4, s[36:39], s7 offen sc0
	s_waitcnt vmcnt(0)
	v_cmp_ge_u32 vcc, s62, v10
	s_mov_b64 exec, -1
	s_cbranch_vccz L_aco_144
	s_sleep 0
	s_add_u32 s34, s34, 1
	s_cmp_lt_u32 s34, 0x40000
	s_cbranch_scc1 L_acw_143
	s_endpgm
L_aco_144:
	buffer_load_dword v96, v9, s[36:39], s73 offen offset:0 sc1
	buffer_load_dword v97, v9, s[36:39], s73 offen offset:256 sc1
	buffer_load_dword v98, v9, s[36:39], s73 offen offset:512 sc1
	buffer_load_dword v99, v9, s[36:39], s73 offen offset:768 sc1
	buffer_load_dword v100, v9, s[36:39], s73 offen offset:1024 sc1
	buffer_load_dword v101, v9, s[36:39], s73 offen offset:1280 sc1
	buffer_load_dword v102, v9, s[36:39], s73 offen offset:1536 sc1
	buffer_load_dword v103, v9, s[36:39], s73 offen offset:1792 sc1
	buffer_load_dword v104, v9, s[36:39], s73 offen offset:2048 sc1
	buffer_load_dword v105, v9, s[36:39], s73 offen offset:2304 sc1
	buffer_load_dword v106, v9, s[36:39], s73 offen offset:2560 sc1
	buffer_load_dword v107, v9, s[36:39], s73 offen offset:2816 sc1
	buffer_load_dword v20, v9, s[36:39], s70 offen offset:0 sc1
	buffer_load_dword v26, v9, s[36:39], s70 offen offset:256 sc1
	buffer_load_dword v32, v9, s[36:39], s70 offen offset:512 sc1
	buffer_load_dword v38, v9, s[36:39], s70 offen offset:768 sc1
	buffer_load_dword v44, v9, s[36:39], s71 offen offset:0 sc1
	buffer_load_dword v50, v9, s[36:39], s71 offen offset:256 sc1
	buffer_load_dword v56, v9, s[36:39], s71 offen offset:512 sc1
	buffer_load_dword v62, v9, s[36:39], s71 offen offset:768 sc1
	buffer_load_dword v68, v9, s[36:39], s72 offen offset:0 sc1
	buffer_load_dword v74, v9, s[36:39], s72 offen offset:256 sc1
	buffer_load_dword v80, v9, s[36:39], s72 offen offset:512 sc1
	buffer_load_dword v86, v9, s[36:39], s72 offen offset:768 sc1
	s_cmp_eq_u32 s62, 63
	s_cbranch_scc1 L_adc_147
L_adb_148:
	v_cndmask_b32 v132, v8, v132, s[76:77]
	v_cndmask_b32 v140, v8, v140, s[76:77]
	v_cndmask_b32 v133, v8, v133, s[78:79]
	v_cndmask_b32 v141, v8, v141, s[78:79]
	v_cndmask_b32 v134, v8, v134, s[80:81]
	v_cndmask_b32 v142, v8, v142, s[80:81]
	v_cndmask_b32 v135, v8, v135, s[82:83]
	v_cndmask_b32 v143, v8, v143, s[82:83]
	s_waitcnt vmcnt(12)
	ds_write_b32 v6, v96 offset:0
	ds_write_b32 v6, v97 offset:512
	ds_write_b32 v6, v98 offset:1024
	ds_write_b32 v6, v99 offset:1536
	ds_write_b32 v6, v100 offset:2048
	ds_write_b32 v6, v101 offset:2560
	ds_write_b32 v6, v102 offset:3072
	ds_write_b32 v6, v103 offset:3584
	ds_write_b32 v6, v104 offset:4096
	ds_write_b32 v6, v105 offset:4608
	ds_write_b32 v6, v106 offset:5120
	ds_write_b32 v6, v107 offset:5632
	ds_read_b64_tr_b16 v[108:109], v7 offset:0
	ds_read_b64_tr_b16 v[110:111], v7 offset:512
	ds_read_b64_tr_b16 v[112:113], v7 offset:1024
	ds_read_b64_tr_b16 v[114:115], v7 offset:1536
	ds_read_b64_tr_b16 v[116:117], v7 offset:2048
	ds_read_b64_tr_b16 v[118:119], v7 offset:2560
	ds_read_b64_tr_b16 v[120:121], v7 offset:3072
	ds_read_b64_tr_b16 v[122:123], v7 offset:3584
	ds_read_b64_tr_b16 v[124:125], v7 offset:4096
	ds_read_b64_tr_b16 v[126:127], v7 offset:4608
	ds_read_b64_tr_b16 v[128:129], v7 offset:5120
	ds_read_b64_tr_b16 v[130:131], v7 offset:5632
	s_waitcnt lgkmcnt(10)
	v_mfma_f32_16x16x32_bf16 v[144:147], v[108:111], a[0:3], 0
	v_mfma_f32_16x16x32_bf16 v[148:151], v[108:111], a[4:7], 0
	s_waitcnt lgkmcnt(8)
	v_mfma_f32_16x16x32_bf16 v[144:147], v[112:115], a[8:11], v[144:147]
	v_mfma_f32_16x16x32_bf16 v[148:151], v[112:115], a[12:15], v[148:151]
	s_waitcnt lgkmcnt(6)
	v_mfma_f32_16x16x32_bf16 v[144:147], v[116:119], a[16:19], v[144:147]
	v_mfma_f32_16x16x32_bf16 v[148:151], v[116:119], a[20:23], v[148:151]
	s_waitcnt lgkmcnt(4)
	v_mfma_f32_16x16x32_bf16 v[144:147], v[120:123], a[24:27], v[144:147]
	v_mfma_f32_16x16x32_bf16 v[148:151], v[120:123], a[28:31], v[148:151]
	s_waitcnt lgkmcnt(2)
	v_mfma_f32_16x16x32_bf16 v[144:147], v[124:127], a[32:35], v[144:147]
	v_mfma_f32_16x16x32_bf16 v[148:151], v[124:127], a[36:39], v[148:151]
	s_waitcnt lgkmcnt(0)
	v_mfma_f32_16x16x32_bf16 v[144:147], v[128:131], a[40:43], v[144:147]
	v_mfma_f32_16x16x32_bf16 v[148:151], v[128:131], a[44:47], v[148:151]
	s_cmp_lt_u32 s62, 62
	s_cbranch_scc1 L_anq_149
	s_waitcnt vmcnt(0)
	s_nop 4
	s_branch L_ajq_150
L_anq_149:
	buffer_load_dwordx4 a[0:3], v15, s[36:39], s11 offen offset:0 sc1
	buffer_load_dwordx4 a[4:7], v15, s[36:39], s11 offen offset:1024 sc1
	buffer_load_dwordx4 a[8:11], v15, s[36:39], s11 offen offset:2048 sc1
	buffer_load_dwordx4 a[12:15], v15, s[36:39], s11 offen offset:3072 sc1
	buffer_load_dwordx4 a[16:19], v15, s[36:39], s12 offen offset:0 sc1
	buffer_load_dwordx4 a[20:23], v15, s[36:39], s12 offen offset:1024 sc1
	buffer_load_dwordx4 a[24:27], v15, s[36:39], s12 offen offset:2048 sc1
	buffer_load_dwordx4 a[28:31], v15, s[36:39], s12 offen offset:3072 sc1
	buffer_load_dwordx4 a[32:35], v15, s[36:39], s13 offen offset:0 sc1
	buffer_load_dwordx4 a[36:39], v15, s[36:39], s13 offen offset:1024 sc1
	buffer_load_dwordx4 a[40:43], v15, s[36:39], s13 offen offset:2048 sc1
	buffer_load_dwordx4 a[44:47], v15, s[36:39], s13 offen offset:3072 sc1
L_ajq_150:
	v_max_f32 v10, v132, v133
	v_max3_f32 v10, v10, v134, v135
	v_max3_f32 v10, v10, v144, v145
	v_mov_b32 v11, v10
	s_nop 1
	v_permlane16_swap_b32 v10, v11
	v_max_f32 v10, v10, v11
	v_mov_b32 v11, v10
	s_nop 1
	v_permlane32_swap_b32 v10, v11
	v_max_f32 v10, v10, v11
	v_mul_f32 v10, s68, v10
	v_fma_f32 v132, v132, s68, -v10
	v_fma_f32 v133, v133, s68, -v10
	v_fma_f32 v134, v134, s68, -v10
	v_fma_f32 v135, v135, s68, -v10
	v_fma_f32 v144, v144, s68, -v10
	v_fma_f32 v145, v145, s68, -v10
	v_exp_f32 v132, v132
	v_exp_f32 v133, v133
	v_exp_f32 v134, v134
	v_exp_f32 v135, v135
	v_exp_f32 v144, v144
	v_exp_f32 v145, v145
	v_add_f32 v10, v132, v133
	v_add_f32 v10, v10, v134
	v_add_f32 v10, v10, v135
	v_add_f32 v10, v10, v144
	v_add_f32 v10, v10, v145
	v_mov_b32 v11, v10
	s_nop 1
	v_permlane16_swap_b32 v10, v11
	v_add_f32 v10, v10, v11
	v_mov_b32 v11, v10
	s_nop 1
	v_permlane32_swap_b32 v10, v11
	v_add_f32 v10, v10, v11
	v_rcp_f32 v10, v10
	s_nop 0
	v_mul_f32 v132, v132, v10
	v_mul_f32 v133, v133, v10
	v_mul_f32 v134, v134, v10
	v_mul_f32 v135, v135, v10
	v_mul_f32 v144, v144, v10
	v_mul_f32 v145, v145, v10
	v_cvt_pk_bf16_f32 v152, v144, v145
	v_cvt_pk_bf16_f32 v154, v132, v133
	v_cvt_pk_bf16_f32 v155, v134, v135
	v_max_f32 v12, v136, v137
	v_max3_f32 v12, v12, v138, v139
	v_max3_f32 v12, v12, v140, v141
	v_max3_f32 v12, v12, v142, v143
	v_max3_f32 v12, v12, v148, v149
	v_mov_b32 v13, v12
	s_nop 1
	v_permlane16_swap_b32 v12, v13
	v_max_f32 v12, v12, v13
	v_mov_b32 v13, v12
	s_nop 1
	v_permlane32_swap_b32 v12, v13
	v_max_f32 v12, v12, v13
	v_mul_f32 v12, s68, v12
	v_fma_f32 v136, v136, s68, -v12
	v_fma_f32 v137, v137, s68, -v12
	v_fma_f32 v138, v138, s68, -v12
	v_fma_f32 v139, v139, s68, -v12
	v_fma_f32 v140, v140, s68, -v12
	v_fma_f32 v141, v141, s68, -v12
	v_fma_f32 v142, v142, s68, -v12
	v_fma_f32 v143, v143, s68, -v12
	v_fma_f32 v148, v148, s68, -v12
	v_fma_f32 v149, v149, s68, -v12
	v_exp_f32 v136, v136
	v_exp_f32 v137, v137
	v_exp_f32 v138, v138
	v_exp_f32 v139, v139
	v_exp_f32 v140, v140
	v_exp_f32 v141, v141
	v_exp_f32 v142, v142
	v_exp_f32 v143, v143
	v_exp_f32 v148, v148
	v_exp_f32 v149, v149
	v_add_f32 v12, v136, v137
	v_add_f32 v12, v12, v138
	v_add_f32 v12, v12, v139
	v_add_f32 v12, v12, v140
	v_add_f32 v12, v12, v141
	v_add_f32 v12, v12, v142
	v_add_f32 v12, v12, v143
	v_add_f32 v12, v12, v148
	v_add_f32 v12, v12, v149
	v_mov_b32 v13, v12
	s_nop 1
	v_permlane16_swap_b32 v12, v13
	v_add_f32 v12, v12, v13
	v_mov_b32 v13, v12
	s_nop 1
	v_permlane32_swap_b32 v12, v13
	v_add_f32 v12, v12, v13
	v_rcp_f32 v12, v12
	s_nop 0
	v_mul_f32 v136, v136, v12
	v_mul_f32 v137, v137, v12
	v_mul_f32 v138, v138, v12
	v_mul_f32 v139, v139, v12
	v_mul_f32 v140, v140, v12
	v_mul_f32 v141, v141, v12
	v_mul_f32 v142, v142, v12
	v_mul_f32 v143, v143, v12
	v_mul_f32 v148, v148, v12
	v_mul_f32 v149, v149, v12
	v_cvt_pk_bf16_f32 v156, v148, v149
	v_cvt_pk_bf16_f32 v158, v136, v137
	v_cvt_pk_bf16_f32 v159, v138, v139
	v_cvt_pk_bf16_f32 v160, v140, v141
	v_cvt_pk_bf16_f32 v161, v142, v143
	s_waitcnt vmcnt(12)
	v_mfma_f32_16x16x32_bf16 v[172:175], v[20:23], v[156:159], 0
	v_mfma_f32_16x16x32_bf16 v[164:167], v[20:23], v[152:155], 0
	v_mfma_f32_16x16x32_bf16 v[172:175], v[24:27], v[160:163], v[172:175]
	v_mfma_f32_16x16x32_bf16 v[176:179], v[26:29], v[156:159], 0
	v_mfma_f32_16x16x32_bf16 v[168:171], v[26:29], v[152:155], 0
	v_mfma_f32_16x16x32_bf16 v[176:179], v[30:33], v[160:163], v[176:179]
	v_mfma_f32_16x16x32_bf16 v[188:191], v[32:35], v[156:159], 0
	v_mfma_f32_16x16x32_bf16 v[180:183], v[32:35], v[152:155], 0
	v_mfma_f32_16x16x32_bf16 v[188:191], v[36:39], v[160:163], v[188:191]
	v_mfma_f32_16x16x32_bf16 v[192:195], v[38:41], v[156:159], 0
	v_mfma_f32_16x16x32_bf16 v[184:187], v[38:41], v[152:155], 0
	v_mfma_f32_16x16x32_bf16 v[192:195], v[42:45], v[160:163], v[192:195]
	v_mfma_f32_16x16x32_bf16 v[204:207], v[44:47], v[156:159], 0
	v_cvt_pk_bf16_f32 v212, v164, v165
	v_cvt_pk_bf16_f32 v213, v166, v167
	v_mfma_f32_16x16x32_bf16 v[196:199], v[44:47], v[152:155], 0
	v_cvt_pk_bf16_f32 v214, v168, v169
	v_cvt_pk_bf16_f32 v215, v170, v171
	v_mfma_f32_16x16x32_bf16 v[204:207], v[48:51], v[160:163], v[204:207]
	buffer_store_dwordx4 v[212:215], v2, s[36:39], s17 offen offset:0 sc1
	v_cvt_pk_bf16_f32 v216, v172, v173
	v_mfma_f32_16x16x32_bf16 v[208:211], v[50:53], v[156:159], 0
	v_cvt_pk_bf16_f32 v217, v174, v175
	v_cvt_pk_bf16_f32 v218, v176, v177
	v_mfma_f32_16x16x32_bf16 v[200:203], v[50:53], v[152:155], 0
	v_cvt_pk_bf16_f32 v219, v178, v179
	buffer_store_dwordx4 v[216:219], v2, s[36:39], s17 offen offset:1024 sc1
	v_mfma_f32_16x16x32_bf16 v[208:211], v[54:57], v[160:163], v[208:211]
	v_mfma_f32_16x16x32_bf16 v[172:175], v[56:59], v[156:159], 0
	v_cvt_pk_bf16_f32 v220, v180, v181
	v_cvt_pk_bf16_f32 v221, v182, v183
	v_mfma_f32_16x16x32_bf16 v[164:167], v[56:59], v[152:155], 0
	v_cvt_pk_bf16_f32 v222, v184, v185
	v_cvt_pk_bf16_f32 v223, v186, v187
	v_mfma_f32_16x16x32_bf16 v[172:175], v[60:63], v[160:163], v[172:175]
	buffer_store_dwordx4 v[220:223], v2, s[36:39], s17 offen offset:2048 sc1
	v_cvt_pk_bf16_f32 v224, v188, v189
	v_mfma_f32_16x16x32_bf16 v[176:179], v[62:65], v[156:159], 0
	v_cvt_pk_bf16_f32 v225, v190, v191
	v_cvt_pk_bf16_f32 v226, v192, v193
	v_mfma_f32_16x16x32_bf16 v[168:171], v[62:65], v[152:155], 0
	v_cvt_pk_bf16_f32 v227, v194, v195
	buffer_store_dwordx4 v[224:227], v2, s[36:39], s17 offen offset:3072 sc1
	v_mfma_f32_16x16x32_bf16 v[176:179], v[66:69], v[160:163], v[176:179]
	v_mfma_f32_16x16x32_bf16 v[188:191], v[68:71], v[156:159], 0
	v_cvt_pk_bf16_f32 v212, v196, v197
	v_cvt_pk_bf16_f32 v213, v198, v199
	v_mfma_f32_16x16x32_bf16 v[180:183], v[68:71], v[152:155], 0
	v_cvt_pk_bf16_f32 v214, v200, v201
	v_cvt_pk_bf16_f32 v215, v202, v203
	v_mfma_f32_16x16x32_bf16 v[188:191], v[72:75], v[160:163], v[188:191]
	buffer_store_dwordx4 v[212:215], v2, s[36:39], s18 offen offset:0 sc1
	v_cvt_pk_bf16_f32 v216, v204, v205
	v_mfma_f32_16x16x32_bf16 v[192:195], v[74:77], v[156:159], 0
	v_cvt_pk_bf16_f32 v217, v206, v207
	v_cvt_pk_bf16_f32 v218, v208, v209
	v_mfma_f32_16x16x32_bf16 v[184:187], v[74:77], v[152:155], 0
	v_cvt_pk_bf16_f32 v219, v210, v211
	buffer_store_dwordx4 v[216:219], v2, s[36:39], s18 offen offset:1024 sc1
	v_mfma_f32_16x16x32_bf16 v[192:195], v[78:81], v[160:163], v[192:195]
	v_mfma_f32_16x16x32_bf16 v[204:207], v[80:83], v[156:159], 0
	v_cvt_pk_bf16_f32 v220, v164, v165
	v_cvt_pk_bf16_f32 v221, v166, v167
	v_mfma_f32_16x16x32_bf16 v[196:199], v[80:83], v[152:155], 0
	v_cvt_pk_bf16_f32 v222, v168, v169
	v_cvt_pk_bf16_f32 v223, v170, v171
	v_mfma_f32_16x16x32_bf16 v[204:207], v[84:87], v[160:163], v[204:207]
	buffer_store_dwordx4 v[220:223], v2, s[36:39], s18 offen offset:2048 sc1
	v_cvt_pk_bf16_f32 v224, v172, v173
	v_mfma_f32_16x16x32_bf16 v[208:211], v[86:89], v[156:159], 0
	v_cvt_pk_bf16_f32 v225, v174, v175
	v_cvt_pk_bf16_f32 v226, v176, v177
	v_mfma_f32_16x16x32_bf16 v[200:203], v[86:89], v[152:155], 0
	v_cvt_pk_bf16_f32 v227, v178, v179
	buffer_store_dwordx4 v[224:227], v2, s[36:39], s18 offen offset:3072 sc1
	v_mfma_f32_16x16x32_bf16 v[208:211], v[90:93], v[160:163], v[208:211]
	v_cvt_pk_bf16_f32 v212, v180, v181
	v_cvt_pk_bf16_f32 v213, v182, v183
	v_cvt_pk_bf16_f32 v214, v184, v185
	v_cvt_pk_bf16_f32 v215, v186, v187
	buffer_store_dwordx4 v[212:215], v2, s[36:39], s19 offen offset:0 sc1
	v_cvt_pk_bf16_f32 v216, v188, v189
	v_cvt_pk_bf16_f32 v217, v190, v191
	v_cvt_pk_bf16_f32 v218, v192, v193
	v_cvt_pk_bf16_f32 v219, v194, v195
	buffer_store_dwordx4 v[216:219], v2, s[36:39], s19 offen offset:1024 sc1
	v_cvt_pk_bf16_f32 v220, v196, v197
	v_cvt_pk_bf16_f32 v221, v198, v199
	v_cvt_pk_bf16_f32 v222, v200, v201
	v_cvt_pk_bf16_f32 v223, v202, v203
	buffer_store_dwordx4 v[220:223], v2, s[36:39], s19 offen offset:2048 sc1
	v_cvt_pk_bf16_f32 v224, v204, v205
	v_cvt_pk_bf16_f32 v225, v206, v207
	v_cvt_pk_bf16_f32 v226, v208, v209
	v_cvt_pk_bf16_f32 v227, v210, v211
	buffer_store_dwordx4 v[224:227], v2, s[36:39], s19 offen offset:3072 sc1
	s_cmp_ge_u32 s62, 62
	s_cbranch_scc1 L_al_151
	buffer_load_dword v14, v3, s[36:39], 0 offen sc1
	buffer_load_dwordx4 v[22:25], v15, s[36:39], s14 offen offset:0 sc1
	buffer_load_dwordx4 v[28:31], v15, s[36:39], s14 offen offset:1024 sc1
	buffer_load_dwordx4 v[34:37], v15, s[36:39], s14 offen offset:2048 sc1
	buffer_load_dwordx4 v[40:43], v15, s[36:39], s14 offen offset:3072 sc1
	buffer_load_dwordx4 v[46:49], v15, s[36:39], s15 offen offset:0 sc1
	buffer_load_dwordx4 v[52:55], v15, s[36:39], s15 offen offset:1024 sc1
	buffer_load_dwordx4 v[58:61], v15, s[36:39], s15 offen offset:2048 sc1
	buffer_load_dwordx4 v[64:67], v15, s[36:39], s15 offen offset:3072 sc1
	buffer_load_dwordx4 v[70:73], v15, s[36:39], s16 offen offset:0 sc1
	buffer_load_dwordx4 v[76:79], v15, s[36:39], s16 offen offset:1024 sc1
	buffer_load_dwordx4 v[82:85], v15, s[36:39], s16 offen offset:2048 sc1
	buffer_load_dwordx4 v[88:91], v15, s[36:39], s16 offen offset:3072 sc1
	s_add_u32 s6, s62, 1
	v_mov_b32 v10, s6
	s_add_u32 s62, s62, 2
	v_add_u32 v9, 65536, v9
	v_add_u32 v2, 65536, v2
	v_and_b32 v9, 0x7ffff, v9
	s_waitcnt vmcnt(12)
	s_mov_b64 exec, 0xffff
	buffer_store_dword v10, v5, s[36:39], 0 offen sc1
	s_mov_b64 exec, -1
	s_branch L_at_142
L_al_151:
	s_add_u32 s6, s62, 1
	v_mov_b32 v10, s6
	s_waitcnt vmcnt(0)
	s_mov_b64 exec, 0xffff
	buffer_store_dword v10, v5, s[36:39], 0 offen sc1
	s_endpgm
L_adc_147:
	s_waitcnt vmcnt(12)
	v_max_u32 v10, v96, v97
	v_max3_u32 v10, v10, v98, v99
	v_max3_u32 v10, v10, v100, v101
	v_max3_u32 v10, v10, v102, v103
	v_max3_u32 v10, v10, v104, v105
	v_max3_u32 v10, v10, v106, v107
	s_waitcnt vmcnt(0)
	v_max3_u32 v10, v10, v20, v26
	v_max3_u32 v10, v10, v32, v38
	v_max3_u32 v10, v10, v44, v50
	v_max3_u32 v10, v10, v56, v62
	v_max3_u32 v10, v10, v68, v74
	v_max3_u32 v10, v10, v80, v86
	v_cmp_eq_u32 vcc, -1, v10
	s_cbranch_vccz L_adb_148
	s_add_u32 s34, s34, 1
	s_cmp_lt_u32 s34, 0x40000
	s_cbranch_scc1 L_aco_144
	s_endpgm
L_op:
	s_mov_b32 s44, s18
	s_and_b32 s45, s19, 0xffff
	s_mov_b32 s46, 0x780000
	s_mov_b32 s47, 0x20000
	s_mov_b32 s48, s28
	s_and_b32 s49, s29, 0xffff
	s_mov_b32 s50, 0x500000
	s_mov_b32 s51, 0x20000
	v_lshlrev_b32 v9, 4, v0
	s_mul_i32 s6, s60, 20
	s_add_u32 s6, s6, s61
	s_and_b32 s7, s5, 1
	s_lshl_b32 s7, s7, 11
	s_add_u32 s7, s7, 0x40a0000
	s_lshl_b32 s68, s6, 13
	s_add_u32 s68, s68, s7
	s_xor_b32 s69, s68, 0x2000
	v_mov_b32 v12, -1
	v_mov_b32 v13, -1
	v_mov_b32 v14, -1
	v_mov_b32 v15, -1
	buffer_store_dwordx4 v[12:15], v9, s[36:39], s68 offen
	buffer_store_dwordx4 v[12:15], v9, s[36:39], s68 offen offset:1024
	s_waitcnt vmcnt(0)
	s_barrier
	s_lshl_b32 s6, s5, 12
	s_add_u32 s6, s6, 96
	v_mov_b32 v12, s6
	v_mov_b32 v13, 1
	s_mov_b64 exec, 1
	buffer_atomic_add v13, v12, s[40:43], 0 offen
	s_mov_b64 exec, -1
	s_and_b32 s6, s61, 1
	s_lshl_b32 s72, s6, 2
	s_add_u32 s72, s72, s5
	s_lshl_b32 s72, s72, 2
	s_lshl_b32 s7, s60, 10
	v_add_u32 v6, s7, v9
	v_and_b32 v20, 15, v0
	v_lshrrev_b32 v21, 4, v0
	s_lshl_b32 s73, s6, 1
	s_xor_b32 s73, s73, s5
	s_lshl_b32 s73, s73, 2
	v_add_u32 v21, s73, v21
	v_lshlrev_b32 v22, 4, v21
	v_lshl_add_u32 v17, v20, 8, v22
	s_lshl_b32 s63, s60, 4
	v_add_u32 v22, s63, v21
	v_mul_u32_u24 v22, 2560, v22
	v_lshl_add_u32 v22, v20, 3, v22
	s_lshr_b32 s63, s61, 1
	s_lshl_b32 s63, s63, 7
	v_add_u32 v11, s63, v22
	s_mul_i32 s7, s72, 245760
	s_add_u32 s7, s7, s63
	v_lshrrev_b32 v22, 3, v0
	v_mul_u32_u24 v23, 1280, v22
	v_and_b32 v22, 6, v22
	v_and_b32 v24, 7, v0
	v_xor_b32 v22, v22, v24
	v_lshl_add_u32 v23, v22, 4, v23
	v_add_u32 v1, s7, v23
	s_mul_i32 s64, s5, 40960
	v_lshrrev_b32 v22, 2, v0
	v_lshlrev_b32 v23, 7, v22
	v_and_b32 v24, 3, v0
	v_lshl_add_u32 v23, v24, 3, v23
	v_add_u32 v23, s64, v23
	v_bfe_u32 v22, v0, 3, 2
	v_xor_b32 v24, 0, v22
	v_lshl_add_u32 v2, v24, 5, v23
	v_xor_b32 v24, 1, v22
	v_lshl_add_u32 v3, v24, 5, v23
	v_xor_b32 v24, 2, v22
	v_lshl_add_u32 v4, v24, 5, v23
	v_xor_b32 v24, 3, v22
	v_lshl_add_u32 v5, v24, 5, v23
	v_min_u32 v22, 3, v0
	s_lshl_b32 s6, s72, 8
	s_add_u32 s6, s6, 0x4090000
	v_lshl_add_u32 v8, v22, 8, s6
	s_mul_i32 s6, s5, 4352
	v_and_b32 v22, 48, v0
	v_add3_u32 v16, s6, v9, v22
	v_lshl_add_u32 v17, v20, 4, v17
	s_mov_b32 s62, 0
	s_mov_b32 s70, 0
	v_mov_b32 v15, 128
L_sw_152:
	buffer_load_dwordx3 v[12:14], v15, s[40:43], 0 offen sc1
	s_waitcnt vmcnt(0)
	v_readfirstlane_b32 s6, v12
	s_nop 0
	s_cmp_ge_u32 s6, 256
	s_cbranch_scc1 L_swok_153
	s_sleep 4
	s_add_u32 s34, s34, 1
	s_cmp_lt_u32 s34, 0x40000
	s_cbranch_scc1 L_sw_152
	s_endpgm
L_swok_153:
	v_readfirstlane_b32 s74, v13
	v_readfirstlane_b32 s75, v14
	s_add_u32 s73, s72, 0
	s_lshl_b32 s65, s73, 2
	s_add_u32 s65, s65, 0
	s_lshl_b32 s65, s65, 19
	s_lshr_b32 s6, s74, s73
	s_xor_b32 s6, s6, 1
	s_and_b32 s6, s6, 1
	s_lshl_b32 s6, s6, 13
	s_add_u32 s65, s65, s6
	s_add_u32 s6, s73, 0
	s_bfe_u32 s7, s6, 0x10001
	s_lshl_b32 s7, s7, 14
	s_and_b32 s6, s6, 1
	s_lshl_b32 s6, s6, 12
	s_add_u32 s6, s6, s7
	s_add_u32 s76, s65, s6
	s_add_u32 s6, s73, 1
	s_bfe_u32 s7, s6, 0x10001
	s_lshl_b32 s7, s7, 14
	s_and_b32 s6, s6, 1
	s_lshl_b32 s6, s6, 12
	s_add_u32 s6, s6, s7
	s_add_u32 s77, s65, s6
	s_add_u32 s6, s73, 2
	s_bfe_u32 s7, s6, 0x10001
	s_lshl_b32 s7, s7, 14
	s_and_b32 s6, s6, 1
	s_lshl_b32 s6, s6, 12
	s_add_u32 s6, s6, s7
	s_add_u32 s78, s65, s6
	s_add_u32 s73, s72, 1
	s_lshl_b32 s65, s73, 2
	s_add_u32 s65, s65, 0
	s_lshl_b32 s65, s65, 19
	s_lshr_b32 s6, s74, s73
	s_xor_b32 s6, s6, 1
	s_and_b32 s6, s6, 1
	s_lshl_b32 s6, s6, 13
	s_add_u32 s65, s65, s6
	s_add_u32 s6, s73, 0
	s_bfe_u32 s7, s6, 0x10001
	s_lshl_b32 s7, s7, 14
	s_and_b32 s6, s6, 1
	s_lshl_b32 s6, s6, 12
	s_add_u32 s6, s6, s7
	s_add_u32 s79, s65, s6
	s_add_u32 s6, s73, 1
	s_bfe_u32 s7, s6, 0x10001
	s_lshl_b32 s7, s7, 14
	s_and_b32 s6, s6, 1
	s_lshl_b32 s6, s6, 12
	s_add_u32 s6, s6, s7
	s_add_u32 s80, s65, s6
	s_add_u32 s6, s73, 2
	s_bfe_u32 s7, s6, 0x10001
	s_lshl_b32 s7, s7, 14
	s_and_b32 s6, s6, 1
	s_lshl_b32 s6, s6, 12
	s_add_u32 s6, s6, s7
	s_add_u32 s81, s65, s6
	s_add_u32 s73, s72, 2
	s_lshl_b32 s65, s73, 2
	s_add_u32 s65, s65, 0
	s_lshl_b32 s65, s65, 19
	s_lshr_b32 s6, s74, s73
	s_xor_b32 s6, s6, 1
	s_and_b32 s6, s6, 1
	s_lshl_b32 s6, s6, 13
	s_add_u32 s65, s65, s6
	s_add_u32 s6, s73, 0
	s_bfe_u32 s7, s6, 0x10001
	s_lshl_b32 s7, s7, 14
	s_and_b32 s6, s6, 1
	s_lshl_b32 s6, s6, 12
	s_add_u32 s6, s6, s7
	s_add_u32 s82, s65, s6
	s_add_u32 s6, s73, 1
	s_bfe_u32 s7, s6, 0x10001
	s_lshl_b32 s7, s7, 14
	s_and_b32 s6, s6, 1
	s_lshl_b32 s6, s6, 12
	s_add_u32 s6, s6, s7
	s_add_u32 s83, s65, s6
	s_add_u32 s6, s73, 2
	s_bfe_u32 s7, s6, 0x10001
	s_lshl_b32 s7, s7, 14
	s_and_b32 s6, s6, 1
	s_lshl_b32 s6, s6, 12
	s_add_u32 s6, s6, s7
	s_add_u32 s84, s65, s6
	s_add_u32 s73, s72, 3
	s_lshl_b32 s65, s73, 2
	s_add_u32 s65, s65, 0
	s_lshl_b32 s65, s65, 19
	s_lshr_b32 s6, s74, s73
	s_xor_b32 s6, s6, 1
	s_and_b32 s6, s6, 1
	s_lshl_b32 s6, s6, 13
	s_add_u32 s65, s65, s6
	s_add_u32 s6, s73, 0
	s_bfe_u32 s7, s6, 0x10001
	s_lshl_b32 s7, s7, 14
	s_and_b32 s6, s6, 1
	s_lshl_b32 s6, s6, 12
	s_add_u32 s6, s6, s7
	s_add_u32 s85, s65, s6
	s_add_u32 s6, s73, 1
	s_bfe_u32 s7, s6, 0x10001
	s_lshl_b32 s7, s7, 14
	s_and_b32 s6, s6, 1
	s_lshl_b32 s6, s6, 12
	s_add_u32 s6, s6, s7
	s_add_u32 s86, s65, s6
	s_add_u32 s6, s73, 2
	s_bfe_u32 s7, s6, 0x10001
	s_lshl_b32 s7, s7, 14
	s_and_b32 s6, s6, 1
	s_lshl_b32 s6, s6, 12
	s_add_u32 s6, s6, s7
	s_add_u32 s87, s65, s6
	v_and_b32 v13, 1, v13
	v_lshlrev_b32 v13, 13, v13
	v_add_u32 v13, 0x18d000, v13
L_ls_154:
	buffer_load_dword v12, v13, s[36:39], 0 offen sc1
	s_waitcnt vmcnt(0)
	v_cmp_gt_u32 vcc, 3, v12
	s_cbranch_vccz L_lso_155
	s_sleep 8
	s_add_u32 s34, s34, 1
	s_cmp_lt_u32 s34, 0x40000
	s_cbranch_scc1 L_ls_154
	s_endpgm
L_lso_155:
	s_mov_b32 s63, 0
	s_add_u32 m0, s64, 0
	s_nop 0
	buffer_load_dwordx4 v1, s[44:47], s63 offen nt lds
	s_mov_b32 s63, 10240
	s_add_u32 m0, s64, 1024
	s_nop 0
	buffer_load_dwordx4 v1, s[44:47], s63 offen nt lds
	s_mov_b32 s63, 20480
	s_add_u32 m0, s64, 2048
	s_nop 0
	buffer_load_dwordx4 v1, s[44:47], s63 offen nt lds
	s_mov_b32 s63, 30720
	s_add_u32 m0, s64, 3072
	s_nop 0
	buffer_load_dwordx4 v1, s[44:47], s63 offen nt lds
	s_mov_b32 s63, 40960
	s_add_u32 m0, s64, 4096
	s_nop 0
	buffer_load_dwordx4 v1, s[44:47], s63 offen nt lds
	s_mov_b32 s63, 51200
	s_add_u32 m0, s64, 5120
	s_nop 0
	buffer_load_dwordx4 v1, s[44:47], s63 offen nt lds
	s_mov_b32 s63, 61440
	s_add_u32 m0, s64, 6144
	s_nop 0
	buffer_load_dwordx4 v1, s[44:47], s63 offen nt lds
	s_mov_b32 s63, 71680
	s_add_u32 m0, s64, 7168
	s_nop 0
	buffer_load_dwordx4 v1, s[44:47], s63 offen nt lds
	s_waitcnt vmcnt(4)
	ds_read_b64_tr_b16 a[0:1], v2 offset:0
	ds_read_b64_tr_b16 a[2:3], v2 offset:2048
	ds_read_b64_tr_b16 a[4:5], v3 offset:0
	ds_read_b64_tr_b16 a[6:7], v3 offset:2048
	ds_read_b64_tr_b16 a[8:9], v4 offset:0
	ds_read_b64_tr_b16 a[10:11], v4 offset:2048
	ds_read_b64_tr_b16 a[12:13], v5 offset:0
	ds_read_b64_tr_b16 a[14:15], v5 offset:2048
	s_waitcnt lgkmcnt(0)
	s_mov_b32 s63, 81920
	s_add_u32 m0, s64, 8192
	s_nop 0
	buffer_load_dwordx4 v1, s[44:47], s63 offen nt lds
	s_mov_b32 s63, 92160
	s_add_u32 m0, s64, 9216
	s_nop 0
	buffer_load_dwordx4 v1, s[44:47], s63 offen nt lds
	s_mov_b32 s63, 102400
	s_add_u32 m0, s64, 10240
	s_nop 0
	buffer_load_dwordx4 v1, s[44:47], s63 offen nt lds
	s_mov_b32 s63, 112640
	s_add_u32 m0, s64, 11264
	s_nop 0
	buffer_load_dwordx4 v1, s[44:47], s63 offen nt lds
	s_waitcnt vmcnt(4)
	ds_read_b64_tr_b16 a[16:17], v2 offset:4096
	ds_read_b64_tr_b16 a[18:19], v2 offset:6144
	ds_read_b64_tr_b16 a[20:21], v3 offset:4096
	ds_read_b64_tr_b16 a[22:23], v3 offset:6144
	ds_read_b64_tr_b16 a[24:25], v4 offset:4096
	ds_read_b64_tr_b16 a[26:27], v4 offset:6144
	ds_read_b64_tr_b16 a[28:29], v5 offset:4096
	ds_read_b64_tr_b16 a[30:31], v5 offset:6144
	s_waitcnt lgkmcnt(0)
	s_mov_b32 s63, 122880
	s_add_u32 m0, s64, 12288
	s_nop 0
	buffer_load_dwordx4 v1, s[44:47], s63 offen nt lds
	s_mov_b32 s63, 133120
	s_add_u32 m0, s64, 13312
	s_nop 0
	buffer_load_dwordx4 v1, s[44:47], s63 offen nt lds
	s_mov_b32 s63, 143360
	s_add_u32 m0, s64, 14336
	s_nop 0
	buffer_load_dwordx4 v1, s[44:47], s63 offen nt lds
	s_mov_b32 s63, 153600
	s_add_u32 m0, s64, 15360
	s_nop 0
	buffer_load_dwordx4 v1, s[44:47], s63 offen nt lds
	s_waitcnt vmcnt(4)
	ds_read_b64_tr_b16 a[32:33], v2 offset:8192
	ds_read_b64_tr_b16 a[34:35], v2 offset:10240
	ds_read_b64_tr_b16 a[36:37], v3 offset:8192
	ds_read_b64_tr_b16 a[38:39], v3 offset:10240
	ds_read_b64_tr_b16 a[40:41], v4 offset:8192
	ds_read_b64_tr_b16 a[42:43], v4 offset:10240
	ds_read_b64_tr_b16 a[44:45], v5 offset:8192
	ds_read_b64_tr_b16 a[46:47], v5 offset:10240
	s_waitcnt lgkmcnt(0)
	s_mov_b32 s63, 163840
	s_add_u32 m0, s64, 16384
	s_nop 0
	buffer_load_dwordx4 v1, s[44:47], s63 offen nt lds
	s_mov_b32 s63, 174080
	s_add_u32 m0, s64, 17408
	s_nop 0
	buffer_load_dwordx4 v1, s[44:47], s63 offen nt lds
	s_mov_b32 s63, 184320
	s_add_u32 m0, s64, 18432
	s_nop 0
	buffer_load_dwordx4 v1, s[44:47], s63 offen nt lds
	s_mov_b32 s63, 194560
	s_add_u32 m0, s64, 19456
	s_nop 0
	buffer_load_dwordx4 v1, s[44:47], s63 offen nt lds
	s_waitcnt vmcnt(4)
	ds_read_b64_tr_b16 a[48:49], v2 offset:12288
	ds_read_b64_tr_b16 a[50:51], v2 offset:14336
	ds_read_b64_tr_b16 a[52:53], v3 offset:12288
	ds_read_b64_tr_b16 a[54:55], v3 offset:14336
	ds_read_b64_tr_b16 a[56:57], v4 offset:12288
	ds_read_b64_tr_b16 a[58:59], v4 offset:14336
	ds_read_b64_tr_b16 a[60:61], v5 offset:12288
	ds_read_b64_tr_b16 a[62:63], v5 offset:14336
	s_waitcnt lgkmcnt(0)
	s_mov_b32 s63, 204800
	s_add_u32 m0, s64, 20480
	s_nop 0
	buffer_load_dwordx4 v1, s[44:47], s63 offen nt lds
	s_mov_b32 s63, 215040
	s_add_u32 m0, s64, 21504
	s_nop 0
	buffer_load_dwordx4 v1, s[44:47], s63 offen nt lds
	s_mov_b32 s63, 225280
	s_add_u32 m0, s64, 22528
	s_nop 0
	buffer_load_dwordx4 v1, s[44:47], s63 offen nt lds
	s_mov_b32 s63, 235520
	s_add_u32 m0, s64, 23552
	s_nop 0
	buffer_load_dwordx4 v1, s[44:47], s63 offen nt lds
	s_waitcnt vmcnt(4)
	ds_read_b64_tr_b16 a[64:65], v2 offset:16384
	ds_read_b64_tr_b16 a[66:67], v2 offset:18432
	ds_read_b64_tr_b16 a[68:69], v3 offset:16384
	ds_read_b64_tr_b16 a[70:71], v3 offset:18432
	ds_read_b64_tr_b16 a[72:73], v4 offset:16384
	ds_read_b64_tr_b16 a[74:75], v4 offset:18432
	ds_read_b64_tr_b16 a[76:77], v5 offset:16384
	ds_read_b64_tr_b16 a[78:79], v5 offset:18432
	s_waitcnt lgkmcnt(0)
	s_mov_b32 s63, 245760
	s_add_u32 m0, s64, 24576
	s_nop 0
	buffer_load_dwordx4 v1, s[44:47], s63 offen nt lds
	s_mov_b32 s63, 256000
	s_add_u32 m0, s64, 25600
	s_nop 0
	buffer_load_dwordx4 v1, s[44:47], s63 offen nt lds
	s_mov_b32 s63, 266240
	s_add_u32 m0, s64, 26624
	s_nop 0
	buffer_load_dwordx4 v1, s[44:47], s63 offen nt lds
	s_mov_b32 s63, 276480
	s_add_u32 m0, s64, 27648
	s_nop 0
	buffer_load_dwordx4 v1, s[44:47], s63 offen nt lds
	s_waitcnt vmcnt(4)
	ds_read_b64_tr_b16 a[80:81], v2 offset:20480
	ds_read_b64_tr_b16 a[82:83], v2 offset:22528
	ds_read_b64_tr_b16 a[84:85], v3 offset:20480
	ds_read_b64_tr_b16 a[86:87], v3 offset:22528
	ds_read_b64_tr_b16 a[88:89], v4 offset:20480
	ds_read_b64_tr_b16 a[90:91], v4 offset:22528
	ds_read_b64_tr_b16 a[92:93], v5 offset:20480
	ds_read_b64_tr_b16 a[94:95], v5 offset:22528
	s_waitcnt lgkmcnt(0)
	s_mov_b32 s63, 286720
	s_add_u32 m0, s64, 28672
	s_nop 0
	buffer_load_dwordx4 v1, s[44:47], s63 offen nt lds
	s_mov_b32 s63, 296960
	s_add_u32 m0, s64, 29696
	s_nop 0
	buffer_load_dwordx4 v1, s[44:47], s63 offen nt lds
	s_mov_b32 s63, 307200
	s_add_u32 m0, s64, 30720
	s_nop 0
	buffer_load_dwordx4 v1, s[44:47], s63 offen nt lds
	s_mov_b32 s63, 317440
	s_add_u32 m0, s64, 31744
	s_nop 0
	buffer_load_dwordx4 v1, s[44:47], s63 offen nt lds
	s_waitcnt vmcnt(4)
	ds_read_b64_tr_b16 a[96:97], v2 offset:24576
	ds_read_b64_tr_b16 a[98:99], v2 offset:26624
	ds_read_b64_tr_b16 a[100:101], v3 offset:24576
	ds_read_b64_tr_b16 a[102:103], v3 offset:26624
	ds_read_b64_tr_b16 a[104:105], v4 offset:24576
	ds_read_b64_tr_b16 a[106:107], v4 offset:26624
	ds_read_b64_tr_b16 a[108:109], v5 offset:24576
	ds_read_b64_tr_b16 a[110:111], v5 offset:26624
	s_waitcnt lgkmcnt(0)
	s_mov_b32 s63, 327680
	s_add_u32 m0, s64, 32768
	s_nop 0
	buffer_load_dwordx4 v1, s[44:47], s63 offen nt lds
	s_mov_b32 s63, 337920
	s_add_u32 m0, s64, 33792
	s_nop 0
	buffer_load_dwordx4 v1, s[44:47], s63 offen nt lds
	s_mov_b32 s63, 348160
	s_add_u32 m0, s64, 34816
	s_nop 0
	buffer_load_dwordx4 v1, s[44:47], s63 offen nt lds
	s_mov_b32 s63, 358400
	s_add_u32 m0, s64, 35840
	s_nop 0
	buffer_load_dwordx4 v1, s[44:47], s63 offen nt lds
	s_waitcnt vmcnt(4)
	ds_read_b64_tr_b16 a[112:113], v2 offset:28672
	ds_read_b64_tr_b16 a[114:115], v2 offset:30720
	ds_read_b64_tr_b16 a[116:117], v3 offset:28672
	ds_read_b64_tr_b16 a[118:119], v3 offset:30720
	ds_read_b64_tr_b16 a[120:121], v4 offset:28672
	ds_read_b64_tr_b16 a[122:123], v4 offset:30720
	ds_read_b64_tr_b16 a[124:125], v5 offset:28672
	ds_read_b64_tr_b16 a[126:127], v5 offset:30720
	s_waitcnt lgkmcnt(0)
	s_mov_b32 s63, 368640
	s_add_u32 m0, s64, 36864
	s_nop 0
	buffer_load_dwordx4 v1, s[44:47], s63 offen nt lds
	s_mov_b32 s63, 378880
	s_add_u32 m0, s64, 37888
	s_nop 0
	buffer_load_dwordx4 v1, s[44:47], s63 offen nt lds
	s_mov_b32 s63, 389120
	s_add_u32 m0, s64, 38912
	s_nop 0
	buffer_load_dwordx4 v1, s[44:47], s63 offen nt lds
	s_mov_b32 s63, 399360
	s_add_u32 m0, s64, 39936
	s_nop 0
	buffer_load_dwordx4 v1, s[44:47], s63 offen nt lds
	s_waitcnt vmcnt(4)
	ds_read_b64_tr_b16 a[128:129], v2 offset:32768
	ds_read_b64_tr_b16 a[130:131], v2 offset:34816
	ds_read_b64_tr_b16 a[132:133], v3 offset:32768
	ds_read_b64_tr_b16 a[134:135], v3 offset:34816
	ds_read_b64_tr_b16 a[136:137], v4 offset:32768
	ds_read_b64_tr_b16 a[138:139], v4 offset:34816
	ds_read_b64_tr_b16 a[140:141], v5 offset:32768
	ds_read_b64_tr_b16 a[142:143], v5 offset:34816
	s_waitcnt lgkmcnt(0)
	s_mov_b32 s63, 409600
	s_add_u32 m0, s64, 0
	s_nop 0
	buffer_load_dwordx4 v1, s[44:47], s63 offen nt lds
	s_mov_b32 s63, 419840
	s_add_u32 m0, s64, 1024
	s_nop 0
	buffer_load_dwordx4 v1, s[44:47], s63 offen nt lds
	s_mov_b32 s63, 430080
	s_add_u32 m0, s64, 2048
	s_nop 0
	buffer_load_dwordx4 v1, s[44:47], s63 offen nt lds
	s_mov_b32 s63, 440320
	s_add_u32 m0, s64, 3072
	s_nop 0
	buffer_load_dwordx4 v1, s[44:47], s63 offen nt lds
	s_waitcnt vmcnt(4)
	ds_read_b64_tr_b16 a[144:145], v2 offset:36864
	ds_read_b64_tr_b16 a[146:147], v2 offset:38912
	ds_read_b64_tr_b16 a[148:149], v3 offset:36864
	ds_read_b64_tr_b16 a[150:151], v3 offset:38912
	ds_read_b64_tr_b16 a[152:153], v4 offset:36864
	ds_read_b64_tr_b16 a[154:155], v4 offset:38912
	ds_read_b64_tr_b16 a[156:157], v5 offset:36864
	ds_read_b64_tr_b16 a[158:159], v5 offset:38912
	s_waitcnt lgkmcnt(0)
	s_mov_b32 s63, 450560
	s_add_u32 m0, s64, 4096
	s_nop 0
	buffer_load_dwordx4 v1, s[44:47], s63 offen nt lds
	s_mov_b32 s63, 460800
	s_add_u32 m0, s64, 5120
	s_nop 0
	buffer_load_dwordx4 v1, s[44:47], s63 offen nt lds
	s_mov_b32 s63, 471040
	s_add_u32 m0, s64, 6144
	s_nop 0
	buffer_load_dwordx4 v1, s[44:47], s63 offen nt lds
	s_mov_b32 s63, 481280
	s_add_u32 m0, s64, 7168
	s_nop 0
	buffer_load_dwordx4 v1, s[44:47], s63 offen nt lds
	s_waitcnt vmcnt(4)
	ds_read_b64_tr_b16 a[160:161], v2 offset:0
	ds_read_b64_tr_b16 a[162:163], v2 offset:2048
	ds_read_b64_tr_b16 a[164:165], v3 offset:0
	ds_read_b64_tr_b16 a[166:167], v3 offset:2048
	ds_read_b64_tr_b16 a[168:169], v4 offset:0
	ds_read_b64_tr_b16 a[170:171], v4 offset:2048
	ds_read_b64_tr_b16 a[172:173], v5 offset:0
	ds_read_b64_tr_b16 a[174:175], v5 offset:2048
	s_waitcnt lgkmcnt(0)
	s_mov_b32 s63, 491520
	s_add_u32 m0, s64, 8192
	s_nop 0
	buffer_load_dwordx4 v1, s[44:47], s63 offen nt lds
	s_mov_b32 s63, 501760
	s_add_u32 m0, s64, 9216
	s_nop 0
	buffer_load_dwordx4 v1, s[44:47], s63 offen nt lds
	s_mov_b32 s63, 512000
	s_add_u32 m0, s64, 10240
	s_nop 0
	buffer_load_dwordx4 v1, s[44:47], s63 offen nt lds
	s_mov_b32 s63, 522240
	s_add_u32 m0, s64, 11264
	s_nop 0
	buffer_load_dwordx4 v1, s[44:47], s63 offen nt lds
	s_waitcnt vmcnt(4)
	ds_read_b64_tr_b16 a[176:177], v2 offset:4096
	ds_read_b64_tr_b16 a[178:179], v2 offset:6144
	ds_read_b64_tr_b16 a[180:181], v3 offset:4096
	ds_read_b64_tr_b16 a[182:183], v3 offset:6144
	ds_read_b64_tr_b16 a[184:185], v4 offset:4096
	ds_read_b64_tr_b16 a[186:187], v4 offset:6144
	ds_read_b64_tr_b16 a[188:189], v5 offset:4096
	ds_read_b64_tr_b16 a[190:191], v5 offset:6144
	s_waitcnt lgkmcnt(0)
	s_mov_b32 s63, 532480
	s_add_u32 m0, s64, 12288
	s_nop 0
	buffer_load_dwordx4 v1, s[44:47], s63 offen nt lds
	s_mov_b32 s63, 542720
	s_add_u32 m0, s64, 13312
	s_nop 0
	buffer_load_dwordx4 v1, s[44:47], s63 offen nt lds
	s_mov_b32 s63, 552960
	s_add_u32 m0, s64, 14336
	s_nop 0
	buffer_load_dwordx4 v1, s[44:47], s63 offen nt lds
	s_mov_b32 s63, 563200
	s_add_u32 m0, s64, 15360
	s_nop 0
	buffer_load_dwordx4 v1, s[44:47], s63 offen nt lds
	s_waitcnt vmcnt(4)
	ds_read_b64_tr_b16 a[192:193], v2 offset:8192
	ds_read_b64_tr_b16 a[194:195], v2 offset:10240
	ds_read_b64_tr_b16 a[196:197], v3 offset:8192
	ds_read_b64_tr_b16 a[198:199], v3 offset:10240
	ds_read_b64_tr_b16 a[200:201], v4 offset:8192
	ds_read_b64_tr_b16 a[202:203], v4 offset:10240
	ds_read_b64_tr_b16 a[204:205], v5 offset:8192
	ds_read_b64_tr_b16 a[206:207], v5 offset:10240
	s_waitcnt lgkmcnt(0)
	s_mov_b32 s63, 573440
	s_add_u32 m0, s64, 16384
	s_nop 0
	buffer_load_dwordx4 v1, s[44:47], s63 offen nt lds
	s_mov_b32 s63, 583680
	s_add_u32 m0, s64, 17408
	s_nop 0
	buffer_load_dwordx4 v1, s[44:47], s63 offen nt lds
	s_mov_b32 s63, 593920
	s_add_u32 m0, s64, 18432
	s_nop 0
	buffer_load_dwordx4 v1, s[44:47], s63 offen nt lds
	s_mov_b32 s63, 604160
	s_add_u32 m0, s64, 19456
	s_nop 0
	buffer_load_dwordx4 v1, s[44:47], s63 offen nt lds
	s_waitcnt vmcnt(4)
	ds_read_b64_tr_b16 a[208:209], v2 offset:12288
	ds_read_b64_tr_b16 a[210:211], v2 offset:14336
	ds_read_b64_tr_b16 a[212:213], v3 offset:12288
	ds_read_b64_tr_b16 a[214:215], v3 offset:14336
	ds_read_b64_tr_b16 a[216:217], v4 offset:12288
	ds_read_b64_tr_b16 a[218:219], v4 offset:14336
	ds_read_b64_tr_b16 a[220:221], v5 offset:12288
	ds_read_b64_tr_b16 a[222:223], v5 offset:14336
	s_waitcnt lgkmcnt(0)
	s_mov_b32 s63, 614400
	s_add_u32 m0, s64, 20480
	s_nop 0
	buffer_load_dwordx4 v1, s[44:47], s63 offen nt lds
	s_mov_b32 s63, 624640
	s_add_u32 m0, s64, 21504
	s_nop 0
	buffer_load_dwordx4 v1, s[44:47], s63 offen nt lds
	s_mov_b32 s63, 634880
	s_add_u32 m0, s64, 22528
	s_nop 0
	buffer_load_dwordx4 v1, s[44:47], s63 offen nt lds
	s_mov_b32 s63, 645120
	s_add_u32 m0, s64, 23552
	s_nop 0
	buffer_load_dwordx4 v1, s[44:47], s63 offen nt lds
	s_waitcnt vmcnt(4)
	ds_read_b64_tr_b16 a[224:225], v2 offset:16384
	ds_read_b64_tr_b16 a[226:227], v2 offset:18432
	ds_read_b64_tr_b16 a[228:229], v3 offset:16384
	ds_read_b64_tr_b16 a[230:231], v3 offset:18432
	ds_read_b64_tr_b16 a[232:233], v4 offset:16384
	ds_read_b64_tr_b16 a[234:235], v4 offset:18432
	ds_read_b64_tr_b16 a[236:237], v5 offset:16384
	ds_read_b64_tr_b16 a[238:239], v5 offset:18432
	s_waitcnt lgkmcnt(0)
	s_mov_b32 s63, 655360
	s_add_u32 m0, s64, 24576
	s_nop 0
	buffer_load_dwordx4 v1, s[44:47], s63 offen nt lds
	s_mov_b32 s63, 665600
	s_add_u32 m0, s64, 25600
	s_nop 0
	buffer_load_dwordx4 v1, s[44:47], s63 offen nt lds
	s_mov_b32 s63, 675840
	s_add_u32 m0, s64, 26624
	s_nop 0
	buffer_load_dwordx4 v1, s[44:47], s63 offen nt lds
	s_mov_b32 s63, 686080
	s_add_u32 m0, s64, 27648
	s_nop 0
	buffer_load_dwordx4 v1, s[44:47], s63 offen nt lds
	s_waitcnt vmcnt(4)
	ds_read_b64_tr_b16 a[240:241], v2 offset:20480
	ds_read_b64_tr_b16 a[242:243], v2 offset:22528
	ds_read_b64_tr_b16 a[244:245], v3 offset:20480
	ds_read_b64_tr_b16 a[246:247], v3 offset:22528
	ds_read_b64_tr_b16 a[248:249], v4 offset:20480
	ds_read_b64_tr_b16 a[250:251], v4 offset:22528
	ds_read_b64_tr_b16 a[252:253], v5 offset:20480
	ds_read_b64_tr_b16 a[254:255], v5 offset:22528
	s_waitcnt lgkmcnt(0)
	s_mov_b32 s63, 696320
	s_add_u32 m0, s64, 28672
	s_nop 0
	buffer_load_dwordx4 v1, s[44:47], s63 offen nt lds
	s_mov_b32 s63, 706560
	s_add_u32 m0, s64, 29696
	s_nop 0
	buffer_load_dwordx4 v1, s[44:47], s63 offen nt lds
	s_mov_b32 s63, 716800
	s_add_u32 m0, s64, 30720
	s_nop 0
	buffer_load_dwordx4 v1, s[44:47], s63 offen nt lds
	s_mov_b32 s63, 727040
	s_add_u32 m0, s64, 31744
	s_nop 0
	buffer_load_dwordx4 v1, s[44:47], s63 offen nt lds
	s_waitcnt vmcnt(4)
	ds_read_b64_tr_b16 v[128:129], v2 offset:24576
	ds_read_b64_tr_b16 v[130:131], v2 offset:26624
	ds_read_b64_tr_b16 v[132:133], v3 offset:24576
	ds_read_b64_tr_b16 v[134:135], v3 offset:26624
	ds_read_b64_tr_b16 v[136:137], v4 offset:24576
	ds_read_b64_tr_b16 v[138:139], v4 offset:26624
	ds_read_b64_tr_b16 v[140:141], v5 offset:24576
	ds_read_b64_tr_b16 v[142:143], v5 offset:26624
	s_waitcnt lgkmcnt(0)
	s_mov_b32 s63, 737280
	s_add_u32 m0, s64, 32768
	s_nop 0
	buffer_load_dwordx4 v1, s[44:47], s63 offen nt lds
	s_mov_b32 s63, 747520
	s_add_u32 m0, s64, 33792
	s_nop 0
	buffer_load_dwordx4 v1, s[44:47], s63 offen nt lds
	s_mov_b32 s63, 757760
	s_add_u32 m0, s64, 34816
	s_nop 0
	buffer_load_dwordx4 v1, s[44:47], s63 offen nt lds
	s_mov_b32 s63, 768000
	s_add_u32 m0, s64, 35840
	s_nop 0
	buffer_load_dwordx4 v1, s[44:47], s63 offen nt lds
	s_waitcnt vmcnt(4)
	ds_read_b64_tr_b16 v[144:145], v2 offset:28672
	ds_read_b64_tr_b16 v[146:147], v2 offset:30720
	ds_read_b64_tr_b16 v[148:149], v3 offset:28672
	ds_read_b64_tr_b16 v[150:151], v3 offset:30720
	ds_read_b64_tr_b16 v[152:153], v4 offset:28672
	ds_read_b64_tr_b16 v[154:155], v4 offset:30720
	ds_read_b64_tr_b16 v[156:157], v5 offset:28672
	ds_read_b64_tr_b16 v[158:159], v5 offset:30720
	s_waitcnt lgkmcnt(0)
	s_mov_b32 s63, 778240
	s_add_u32 m0, s64, 36864
	s_nop 0
	buffer_load_dwordx4 v1, s[44:47], s63 offen nt lds
	s_mov_b32 s63, 788480
	s_add_u32 m0, s64, 37888
	s_nop 0
	buffer_load_dwordx4 v1, s[44:47], s63 offen nt lds
	s_mov_b32 s63, 798720
	s_add_u32 m0, s64, 38912
	s_nop 0
	buffer_load_dwordx4 v1, s[44:47], s63 offen nt lds
	s_mov_b32 s63, 808960
	s_add_u32 m0, s64, 39936
	s_nop 0
	buffer_load_dwordx4 v1, s[44:47], s63 offen nt lds
	s_waitcnt vmcnt(4)
	ds_read_b64_tr_b16 v[160:161], v2 offset:32768
	ds_read_b64_tr_b16 v[162:163], v2 offset:34816
	ds_read_b64_tr_b16 v[164:165], v3 offset:32768
	ds_read_b64_tr_b16 v[166:167], v3 offset:34816
	ds_read_b64_tr_b16 v[168:169], v4 offset:32768
	ds_read_b64_tr_b16 v[170:171], v4 offset:34816
	ds_read_b64_tr_b16 v[172:173], v5 offset:32768
	ds_read_b64_tr_b16 v[174:175], v5 offset:34816
	s_waitcnt lgkmcnt(0)
	s_mov_b32 s63, 819200
	s_add_u32 m0, s64, 0
	s_nop 0
	buffer_load_dwordx4 v1, s[44:47], s63 offen nt lds
	s_mov_b32 s63, 829440
	s_add_u32 m0, s64, 1024
	s_nop 0
	buffer_load_dwordx4 v1, s[44:47], s63 offen nt lds
	s_mov_b32 s63, 839680
	s_add_u32 m0, s64, 2048
	s_nop 0
	buffer_load_dwordx4 v1, s[44:47], s63 offen nt lds
	s_mov_b32 s63, 849920
	s_add_u32 m0, s64, 3072
	s_nop 0
	buffer_load_dwordx4 v1, s[44:47], s63 offen nt lds
	s_waitcnt vmcnt(4)
	ds_read_b64_tr_b16 v[176:177], v2 offset:36864
	ds_read_b64_tr_b16 v[178:179], v2 offset:38912
	ds_read_b64_tr_b16 v[180:181], v3 offset:36864
	ds_read_b64_tr_b16 v[182:183], v3 offset:38912
	ds_read_b64_tr_b16 v[184:185], v4 offset:36864
	ds_read_b64_tr_b16 v[186:187], v4 offset:38912
	ds_read_b64_tr_b16 v[188:189], v5 offset:36864
	ds_read_b64_tr_b16 v[190:191], v5 offset:38912
	s_waitcnt lgkmcnt(0)
	s_mov_b32 s63, 860160
	s_add_u32 m0, s64, 4096
	s_nop 0
	buffer_load_dwordx4 v1, s[44:47], s63 offen nt lds
	s_mov_b32 s63, 870400
	s_add_u32 m0, s64, 5120
	s_nop 0
	buffer_load_dwordx4 v1, s[44:47], s63 offen nt lds
	s_mov_b32 s63, 880640
	s_add_u32 m0, s64, 6144
	s_nop 0
	buffer_load_dwordx4 v1, s[44:47], s63 offen nt lds
	s_mov_b32 s63, 890880
	s_add_u32 m0, s64, 7168
	s_nop 0
	buffer_load_dwordx4 v1, s[44:47], s63 offen nt lds
	s_waitcnt vmcnt(4)
	ds_read_b64_tr_b16 v[192:193], v2 offset:0
	ds_read_b64_tr_b16 v[194:195], v2 offset:2048
	ds_read_b64_tr_b16 v[196:197], v3 offset:0
	ds_read_b64_tr_b16 v[198:199], v3 offset:2048
	ds_read_b64_tr_b16 v[200:201], v4 offset:0
	ds_read_b64_tr_b16 v[202:203], v4 offset:2048
	ds_read_b64_tr_b16 v[204:205], v5 offset:0
	ds_read_b64_tr_b16 v[206:207], v5 offset:2048
	s_waitcnt lgkmcnt(0)
	s_mov_b32 s63, 901120
	s_add_u32 m0, s64, 8192
	s_nop 0
	buffer_load_dwordx4 v1, s[44:47], s63 offen nt lds
	s_mov_b32 s63, 911360
	s_add_u32 m0, s64, 9216
	s_nop 0
	buffer_load_dwordx4 v1, s[44:47], s63 offen nt lds
	s_mov_b32 s63, 921600
	s_add_u32 m0, s64, 10240
	s_nop 0
	buffer_load_dwordx4 v1, s[44:47], s63 offen nt lds
	s_mov_b32 s63, 931840
	s_add_u32 m0, s64, 11264
	s_nop 0
	buffer_load_dwordx4 v1, s[44:47], s63 offen nt lds
	s_waitcnt vmcnt(4)
	ds_read_b64_tr_b16 v[208:209], v2 offset:4096
	ds_read_b64_tr_b16 v[210:211], v2 offset:6144
	ds_read_b64_tr_b16 v[212:213], v3 offset:4096
	ds_read_b64_tr_b16 v[214:215], v3 offset:6144
	ds_read_b64_tr_b16 v[216:217], v4 offset:4096
	ds_read_b64_tr_b16 v[218:219], v4 offset:6144
	ds_read_b64_tr_b16 v[220:221], v5 offset:4096
	ds_read_b64_tr_b16 v[222:223], v5 offset:6144
	s_waitcnt lgkmcnt(0)
	s_mov_b32 s63, 942080
	s_add_u32 m0, s64, 12288
	s_nop 0
	buffer_load_dwordx4 v1, s[44:47], s63 offen nt lds
	s_mov_b32 s63, 952320
	s_add_u32 m0, s64, 13312
	s_nop 0
	buffer_load_dwordx4 v1, s[44:47], s63 offen nt lds
	s_mov_b32 s63, 962560
	s_add_u32 m0, s64, 14336
	s_nop 0
	buffer_load_dwordx4 v1, s[44:47], s63 offen nt lds
	s_mov_b32 s63, 972800
	s_add_u32 m0, s64, 15360
	s_nop 0
	buffer_load_dwordx4 v1, s[44:47], s63 offen nt lds
	s_waitcnt vmcnt(4)
	ds_read_b64_tr_b16 v[224:225], v2 offset:8192
	ds_read_b64_tr_b16 v[226:227], v2 offset:10240
	ds_read_b64_tr_b16 v[228:229], v3 offset:8192
	ds_read_b64_tr_b16 v[230:231], v3 offset:10240
	ds_read_b64_tr_b16 v[232:233], v4 offset:8192
	ds_read_b64_tr_b16 v[234:235], v4 offset:10240
	ds_read_b64_tr_b16 v[236:237], v5 offset:8192
	ds_read_b64_tr_b16 v[238:239], v5 offset:10240
	s_waitcnt vmcnt(0)
	ds_read_b64_tr_b16 v[240:241], v2 offset:12288
	ds_read_b64_tr_b16 v[242:243], v2 offset:14336
	ds_read_b64_tr_b16 v[244:245], v3 offset:12288
	ds_read_b64_tr_b16 v[246:247], v3 offset:14336
	ds_read_b64_tr_b16 v[248:249], v4 offset:12288
	ds_read_b64_tr_b16 v[250:251], v4 offset:14336
	ds_read_b64_tr_b16 v[252:253], v5 offset:12288
	ds_read_b64_tr_b16 v[254:255], v5 offset:14336
	s_waitcnt lgkmcnt(0)
	s_barrier
	s_mov_b32 s71, 0
	s_mov_b32 s67, 0
	v_mov_b32 v10, v9
L_o_156:
	buffer_load_dwordx4 v[12:15], v10, s[36:39], s69 offen sc1
	buffer_load_dword v19, v8, s[36:39], 0 offen sc1
	s_cmp_eq_u32 s71, 0
	s_cbranch_scc1 L_onp_163
	s_waitcnt vmcnt(1)
	v_and_b32 v20, 1, v12
	v_cmp_ne_u32 vcc, s67, v20
	s_cbranch_vccnz L_omo_164
	v_pk_add_f32 v[12:13], v[24:25], v[12:13]
	v_pk_add_f32 v[14:15], v[26:27], v[14:15]
	v_cvt_pk_bf16_f32 v20, v12, v13
	v_cvt_pk_bf16_f32 v21, v14, v15
	buffer_store_dwordx2 v[20:21], v11, s[48:51], s70 offen nt
	s_add_u32 s70, s70, 81920
	s_mov_b32 s71, 0
L_onp_163:
	s_cmp_ge_u32 s62, 64
	s_cbranch_scc1 L_of_162
L_omo_164:
	s_waitcnt vmcnt(0)
	v_cmp_ge_u32 vcc, s62, v19
	s_cbranch_vccz L_ook_157
	s_add_u32 s34, s34, 1
	s_cmp_lt_u32 s34, 0x40000
	s_cbranch_scc1 L_o_156
	s_endpgm
L_ook_157:
	buffer_load_dwordx4 v[48:51], v6, s[36:39], s76 offen offset:0 sc1
	buffer_load_dwordx4 v[52:55], v6, s[36:39], s76 offen offset:2048 sc1
	buffer_load_dwordx4 v[56:59], v6, s[36:39], s77 offen offset:0 sc1
	buffer_load_dwordx4 v[60:63], v6, s[36:39], s77 offen offset:2048 sc1
	buffer_load_dwordx4 v[64:67], v6, s[36:39], s78 offen offset:0 sc1
	buffer_load_dwordx4 v[68:71], v6, s[36:39], s78 offen offset:2048 sc1
	buffer_load_dwordx4 v[72:75], v6, s[36:39], s79 offen offset:0 sc1
	buffer_load_dwordx4 v[76:79], v6, s[36:39], s79 offen offset:2048 sc1
	buffer_load_dwordx4 v[80:83], v6, s[36:39], s80 offen offset:0 sc1
	buffer_load_dwordx4 v[84:87], v6, s[36:39], s80 offen offset:2048 sc1
	buffer_load_dwordx4 v[88:91], v6, s[36:39], s81 offen offset:0 sc1
L_or_160:
	v_xor_b32 v8, 0x80, v8
	buffer_load_dwordx4 v[92:95], v6, s[36:39], s81 offen offset:2048 sc1
	s_waitcnt vmcnt(11)
	v_mfma_f32_16x16x32_bf16 v[32:35], a[0:3], v[48:51], 0
	v_mfma_f32_16x16x32_bf16 v[36:39], a[4:7], v[48:51], 0
	v_mfma_f32_16x16x32_bf16 v[40:43], a[8:11], v[48:51], 0
	v_mfma_f32_16x16x32_bf16 v[44:47], a[12:15], v[48:51], 0
	buffer_load_dword v19, v8, s[36:39], 0 offen sc1
	buffer_load_dwordx4 v[48:51], v6, s[36:39], s82 offen offset:0 sc1
	s_waitcnt vmcnt(12)
	v_mfma_f32_16x16x32_bf16 v[32:35], a[16:19], v[52:55], v[32:35]
	v_mfma_f32_16x16x32_bf16 v[36:39], a[20:23], v[52:55], v[36:39]
	v_mfma_f32_16x16x32_bf16 v[40:43], a[24:27], v[52:55], v[40:43]
	v_mfma_f32_16x16x32_bf16 v[44:47], a[28:31], v[52:55], v[44:47]
	buffer_load_dwordx4 v[12:15], v10, s[36:39], s69 offen sc1
	buffer_load_dwordx4 v[52:55], v6, s[36:39], s82 offen offset:2048 sc1
	s_waitcnt vmcnt(13)
	v_mfma_f32_16x16x32_bf16 v[32:35], a[32:35], v[56:59], v[32:35]
	v_mfma_f32_16x16x32_bf16 v[36:39], a[36:39], v[56:59], v[36:39]
	v_mfma_f32_16x16x32_bf16 v[40:43], a[40:43], v[56:59], v[40:43]
	v_mfma_f32_16x16x32_bf16 v[44:47], a[44:47], v[56:59], v[44:47]
	buffer_load_dwordx4 v[56:59], v6, s[36:39], s83 offen offset:0 sc1
	s_waitcnt vmcnt(13)
	v_mfma_f32_16x16x32_bf16 v[32:35], a[48:51], v[60:63], v[32:35]
	v_mfma_f32_16x16x32_bf16 v[36:39], a[52:55], v[60:63], v[36:39]
	v_mfma_f32_16x16x32_bf16 v[40:43], a[56:59], v[60:63], v[40:43]
	v_mfma_f32_16x16x32_bf16 v[44:47], a[60:63], v[60:63], v[44:47]
	buffer_load_dwordx4 v[60:63], v6, s[36:39], s83 offen offset:2048 sc1
	s_waitcnt vmcnt(13)
	v_mfma_f32_16x16x32_bf16 v[32:35], a[64:67], v[64:67], v[32:35]
	v_mfma_f32_16x16x32_bf16 v[36:39], a[68:71], v[64:67], v[36:39]
	v_mfma_f32_16x16x32_bf16 v[40:43], a[72:75], v[64:67], v[40:43]
	v_mfma_f32_16x16x32_bf16 v[44:47], a[76:79], v[64:67], v[44:47]
	buffer_load_dwordx4 v[64:67], v6, s[36:39], s84 offen offset:0 sc1
	s_waitcnt vmcnt(13)
	v_mfma_f32_16x16x32_bf16 v[32:35], a[80:83], v[68:71], v[32:35]
	v_mfma_f32_16x16x32_bf16 v[36:39], a[84:87], v[68:71], v[36:39]
	v_mfma_f32_16x16x32_bf16 v[40:43], a[88:91], v[68:71], v[40:43]
	v_mfma_f32_16x16x32_bf16 v[44:47], a[92:95], v[68:71], v[44:47]
	buffer_load_dwordx4 v[68:71], v6, s[36:39], s84 offen offset:2048 sc1
	s_waitcnt vmcnt(13)
	v_mfma_f32_16x16x32_bf16 v[32:35], a[96:99], v[72:75], v[32:35]
	v_mfma_f32_16x16x32_bf16 v[36:39], a[100:103], v[72:75], v[36:39]
	v_mfma_f32_16x16x32_bf16 v[40:43], a[104:107], v[72:75], v[40:43]
	v_mfma_f32_16x16x32_bf16 v[44:47], a[108:111], v[72:75], v[44:47]
	buffer_load_dwordx4 v[72:75], v6, s[36:39], s85 offen offset:0 sc1
	s_waitcnt vmcnt(13)
	v_mfma_f32_16x16x32_bf16 v[32:35], a[112:115], v[76:79], v[32:35]
	v_mfma_f32_16x16x32_bf16 v[36:39], a[116:119], v[76:79], v[36:39]
	v_mfma_f32_16x16x32_bf16 v[40:43], a[120:123], v[76:79], v[40:43]
	v_mfma_f32_16x16x32_bf16 v[44:47], a[124:127], v[76:79], v[44:47]
	buffer_load_dwordx4 v[76:79], v6, s[36:39], s85 offen offset:2048 sc1
	s_waitcnt vmcnt(13)
	v_mfma_f32_16x16x32_bf16 v[32:35], a[128:131], v[80:83], v[32:35]
	v_mfma_f32_16x16x32_bf16 v[36:39], a[132:135], v[80:83], v[36:39]
	v_mfma_f32_16x16x32_bf16 v[40:43], a[136:139], v[80:83], v[40:43]
	v_mfma_f32_16x16x32_bf16 v[44:47], a[140:143], v[80:83], v[44:47]
	buffer_load_dwordx4 v[80:83], v6, s[36:39], s86 offen offset:0 sc1
	s_waitcnt vmcnt(13)
	v_mfma_f32_16x16x32_bf16 v[32:35], a[144:147], v[84:87], v[32:35]
	v_mfma_f32_16x16x32_bf16 v[36:39], a[148:151], v[84:87], v[36:39]
	v_mfma_f32_16x16x32_bf16 v[40:43], a[152:155], v[84:87], v[40:43]
	v_mfma_f32_16x16x32_bf16 v[44:47], a[156:159], v[84:87], v[44:47]
	buffer_load_dwordx4 v[84:87], v6, s[36:39], s86 offen offset:2048 sc1
	s_waitcnt vmcnt(13)
	v_mfma_f32_16x16x32_bf16 v[32:35], a[160:163], v[88:91], v[32:35]
	v_mfma_f32_16x16x32_bf16 v[36:39], a[164:167], v[88:91], v[36:39]
	v_mfma_f32_16x16x32_bf16 v[40:43], a[168:171], v[88:91], v[40:43]
	v_mfma_f32_16x16x32_bf16 v[44:47], a[172:175], v[88:91], v[44:47]
	buffer_load_dwordx4 v[88:91], v6, s[36:39], s87 offen offset:0 sc1
	s_waitcnt vmcnt(13)
	v_mfma_f32_16x16x32_bf16 v[32:35], a[176:179], v[92:95], v[32:35]
	v_mfma_f32_16x16x32_bf16 v[36:39], a[180:183], v[92:95], v[36:39]
	v_mfma_f32_16x16x32_bf16 v[40:43], a[184:187], v[92:95], v[40:43]
	v_mfma_f32_16x16x32_bf16 v[44:47], a[188:191], v[92:95], v[44:47]
	buffer_load_dwordx4 v[92:95], v6, s[36:39], s87 offen offset:2048 sc1
	s_waitcnt vmcnt(12)
	v_mfma_f32_16x16x32_bf16 v[32:35], a[192:195], v[48:51], v[32:35]
	v_mfma_f32_16x16x32_bf16 v[36:39], a[196:199], v[48:51], v[36:39]
	v_mfma_f32_16x16x32_bf16 v[40:43], a[200:203], v[48:51], v[40:43]
	v_mfma_f32_16x16x32_bf16 v[44:47], a[204:207], v[48:51], v[44:47]
	s_waitcnt vmcnt(13)
	s_add_u32 s6, s62, 1
	v_cmp_ge_u32 vcc, s6, v19
	s_nop 0
	s_cmp_eq_u64 vcc, 0
	s_cselect_b32 s66, 0, 0xfe00000
	s_add_u32 s6, s66, 32768
	v_add_u32 v7, s6, v6
	buffer_load_dwordx4 v[48:51], v7, s[36:39], s76 offen offset:0 sc1
	s_waitcnt vmcnt(11)
	v_mfma_f32_16x16x32_bf16 v[32:35], a[208:211], v[52:55], v[32:35]
	v_mfma_f32_16x16x32_bf16 v[36:39], a[212:215], v[52:55], v[36:39]
	v_mfma_f32_16x16x32_bf16 v[40:43], a[216:219], v[52:55], v[40:43]
	v_mfma_f32_16x16x32_bf16 v[44:47], a[220:223], v[52:55], v[44:47]
	buffer_load_dwordx4 v[52:55], v7, s[36:39], s76 offen offset:2048 sc1
	s_waitcnt vmcnt(11)
	v_mfma_f32_16x16x32_bf16 v[32:35], a[224:227], v[56:59], v[32:35]
	v_mfma_f32_16x16x32_bf16 v[36:39], a[228:231], v[56:59], v[36:39]
	v_mfma_f32_16x16x32_bf16 v[40:43], a[232:235], v[56:59], v[40:43]
	v_mfma_f32_16x16x32_bf16 v[44:47], a[236:239], v[56:59], v[44:47]
	s_waitcnt vmcnt(13)
	s_cmp_lg_u32 s71, 0
	s_cbranch_scc1 L_ox_158
L_oxo_159:
	buffer_load_dwordx4 v[56:59], v7, s[36:39], s77 offen offset:0 sc1
	s_waitcnt vmcnt(11)
	v_mfma_f32_16x16x32_bf16 v[32:35], a[240:243], v[60:63], v[32:35]
	v_mfma_f32_16x16x32_bf16 v[36:39], a[244:247], v[60:63], v[36:39]
	v_mfma_f32_16x16x32_bf16 v[40:43], a[248:251], v[60:63], v[40:43]
	v_mfma_f32_16x16x32_bf16 v[44:47], a[252:255], v[60:63], v[44:47]
	buffer_load_dwordx4 v[60:63], v7, s[36:39], s77 offen offset:2048 sc1
	s_waitcnt vmcnt(11)
	v_mfma_f32_16x16x32_bf16 v[32:35], v[128:131], v[64:67], v[32:35]
	v_mfma_f32_16x16x32_bf16 v[36:39], v[132:135], v[64:67], v[36:39]
	v_mfma_f32_16x16x32_bf16 v[40:43], v[136:139], v[64:67], v[40:43]
	v_mfma_f32_16x16x32_bf16 v[44:47], v[140:143], v[64:67], v[44:47]
	buffer_load_dwordx4 v[64:67], v7, s[36:39], s78 offen offset:0 sc1
	s_waitcnt vmcnt(11)
	v_mfma_f32_16x16x32_bf16 v[32:35], v[144:147], v[68:71], v[32:35]
	v_mfma_f32_16x16x32_bf16 v[36:39], v[148:151], v[68:71], v[36:39]
	v_mfma_f32_16x16x32_bf16 v[40:43], v[152:155], v[68:71], v[40:43]
	v_mfma_f32_16x16x32_bf16 v[44:47], v[156:159], v[68:71], v[44:47]
	buffer_load_dwordx4 v[68:71], v7, s[36:39], s78 offen offset:2048 sc1
	s_waitcnt vmcnt(11)
	v_mfma_f32_16x16x32_bf16 v[32:35], v[160:163], v[72:75], v[32:35]
	v_mfma_f32_16x16x32_bf16 v[36:39], v[164:167], v[72:75], v[36:39]
	v_mfma_f32_16x16x32_bf16 v[40:43], v[168:171], v[72:75], v[40:43]
	v_mfma_f32_16x16x32_bf16 v[44:47], v[172:175], v[72:75], v[44:47]
	buffer_load_dwordx4 v[72:75], v7, s[36:39], s79 offen offset:0 sc1
	s_waitcnt vmcnt(11)
	v_mfma_f32_16x16x32_bf16 v[32:35], v[176:179], v[76:79], v[32:35]
	v_mfma_f32_16x16x32_bf16 v[36:39], v[180:183], v[76:79], v[36:39]
	v_mfma_f32_16x16x32_bf16 v[40:43], v[184:187], v[76:79], v[40:43]
	v_mfma_f32_16x16x32_bf16 v[44:47], v[188:191], v[76:79], v[44:47]
	buffer_load_dwordx4 v[76:79], v7, s[36:39], s79 offen offset:2048 sc1
	s_waitcnt vmcnt(11)
	v_mfma_f32_16x16x32_bf16 v[32:35], v[192:195], v[80:83], v[32:35]
	v_mfma_f32_16x16x32_bf16 v[36:39], v[196:199], v[80:83], v[36:39]
	v_mfma_f32_16x16x32_bf16 v[40:43], v[200:203], v[80:83], v[40:43]
	v_mfma_f32_16x16x32_bf16 v[44:47], v[204:207], v[80:83], v[44:47]
	buffer_load_dwordx4 v[80:83], v7, s[36:39], s80 offen offset:0 sc1
	s_waitcnt vmcnt(11)
	v_mfma_f32_16x16x32_bf16 v[32:35], v[208:211], v[84:87], v[32:35]
	v_mfma_f32_16x16x32_bf16 v[36:39], v[212:215], v[84:87], v[36:39]
	v_mfma_f32_16x16x32_bf16 v[40:43], v[216:219], v[84:87], v[40:43]
	v_mfma_f32_16x16x32_bf16 v[44:47], v[220:223], v[84:87], v[44:47]
	buffer_load_dword v19, v8, s[36:39], 0 offen sc1
	buffer_load_dwordx4 v[84:87], v7, s[36:39], s80 offen offset:2048 sc1
	s_waitcnt vmcnt(12)
	v_mfma_f32_16x16x32_bf16 v[32:35], v[224:227], v[88:91], v[32:35]
	v_mfma_f32_16x16x32_bf16 v[36:39], v[228:231], v[88:91], v[36:39]
	v_mfma_f32_16x16x32_bf16 v[40:43], v[232:235], v[88:91], v[40:43]
	v_mfma_f32_16x16x32_bf16 v[44:47], v[236:239], v[88:91], v[44:47]
	buffer_load_dwordx4 v[88:91], v7, s[36:39], s81 offen offset:0 sc1
	s_waitcnt vmcnt(12)
	v_mfma_f32_16x16x32_bf16 v[32:35], v[240:243], v[92:95], v[32:35]
	v_mfma_f32_16x16x32_bf16 v[36:39], v[244:247], v[92:95], v[36:39]
	v_mfma_f32_16x16x32_bf16 v[40:43], v[248:251], v[92:95], v[40:43]
	v_mfma_f32_16x16x32_bf16 v[44:47], v[252:255], v[92:95], v[44:47]
	s_bfe_u32 s67, s62, 0x10001
	s_and_b32 s6, s62, 1
	s_lshl_b32 s6, s6, 10
	v_add_u32 v10, s6, v9
	s_add_u32 s62, s62, 1
	ds_write_b128 v16, v[32:35] offset:0
	ds_write_b128 v16, v[36:39] offset:1088
	ds_write_b128 v16, v[40:43] offset:2176
	ds_write_b128 v16, v[44:47] offset:3264
	v_add_u32 v6, 32768, v6
	s_waitcnt lgkmcnt(0)
	s_barrier
	ds_read_b128 v[32:35], v17 offset:0
	ds_read_b128 v[36:39], v17 offset:4352
	ds_read_b128 v[40:43], v17 offset:8704
	ds_read_b128 v[44:47], v17 offset:13056
	v_xor_b32 v16, 0x8000, v16
	v_xor_b32 v17, 0x8000, v17
	s_waitcnt lgkmcnt(0)
	v_pk_add_f32 v[32:33], v[32:33], v[36:37]
	v_pk_add_f32 v[34:35], v[34:35], v[38:39]
	v_pk_add_f32 v[40:41], v[40:41], v[44:45]
	v_pk_add_f32 v[42:43], v[42:43], v[46:47]
	v_pk_add_f32 v[24:25], v[32:33], v[40:41]
	v_pk_add_f32 v[26:27], v[34:35], v[42:43]
	s_cmp_lt_u32 s5, 2
	s_cselect_b32 s71, 1, 0
	s_cbranch_scc1 L_on_165
	v_and_or_b32 v24, v24, -2, s67
	buffer_store_dwordx4 v[24:27], v10, s[36:39], s68 offen
L_on_165:
	s_cmp_eq_u32 s66, 0
	s_cbranch_scc1 L_or_160
	s_waitcnt vmcnt(2)
	v_cmp_ge_u32 vcc, s62, v19
	s_cbranch_vccz L_ook_157
	s_branch L_o_156
L_of_162:
	s_mul_i32 s73, s60, 20
	s_add_u32 s73, s73, s61
	s_endpgm
L_ox_158:
	v_and_b32 v20, 1, v12
	v_cmp_ne_u32 vcc, s67, v20
	s_cbranch_vccnz L_oxa_166
	v_pk_add_f32 v[12:13], v[24:25], v[12:13]
	v_pk_add_f32 v[14:15], v[26:27], v[14:15]
	v_cvt_pk_bf16_f32 v20, v12, v13
	v_cvt_pk_bf16_f32 v21, v14, v15
	buffer_store_dwordx2 v[20:21], v11, s[48:51], s70 offen nt
	s_add_u32 s70, s70, 81920
	s_mov_b32 s71, 0
	s_branch L_oxo_159
L_oxa_166:
	buffer_load_dwordx4 v[12:15], v10, s[36:39], s69 offen sc1
	s_waitcnt vmcnt(0)
	s_add_u32 s34, s34, 1
	s_cmp_lt_u32 s34, 0x40000
	s_cbranch_scc1 L_ox_158
	s_endpgm
L_b:
	s_barrier
	s_lshl_b32 s6, s5, 12
	s_add_u32 s6, s6, 96
	v_mov_b32 v12, s6
	v_mov_b32 v13, 1
	s_mov_b64 exec, 1
	buffer_atomic_add v13, v12, s[40:43], 0 offen
	s_mov_b64 exec, -1
	s_mov_b32 s44, s22
	s_and_b32 s45, s23, 0xffff
	s_mov_b32 s46, 0x280000
	s_mov_b32 s47, 0x20000
	s_mov_b32 s48, s24
	s_and_b32 s49, s25, 0xffff
	s_mov_b32 s50, 0x258000
	s_mov_b32 s51, 0x20000
	s_mov_b32 s52, s26
	s_and_b32 s53, s27, 0xffff
	s_mov_b32 s54, 0xc8000
	s_mov_b32 s55, 0x20000
	s_mov_b32 s56, s28
	s_and_b32 s57, s29, 0xffff
	s_mov_b32 s58, 0x500000
	s_mov_b32 s59, 0x20000
	v_mov_b32 v15, 128
L_sw_168:
	buffer_load_dwordx3 v[12:14], v15, s[40:43], 0 offen sc1
	s_waitcnt vmcnt(0)
	v_readfirstlane_b32 s6, v12
	s_nop 0
	s_cmp_ge_u32 s6, 256
	s_cbranch_scc1 L_swok_169
	s_sleep 4
	s_add_u32 s34, s34, 1
	s_cmp_lt_u32 s34, 0x40000
	s_cbranch_scc1 L_sw_168
	s_endpgm
L_swok_169:
	v_and_b32 v13, 1, v13
	v_lshlrev_b32 v13, 13, v13
	v_add_u32 v13, 0x18d000, v13
L_ls_170:
	buffer_load_dword v12, v13, s[36:39], 0 offen sc1
	s_waitcnt vmcnt(0)
	v_cmp_gt_u32 vcc, 1, v12
	s_cbranch_vccz L_lso_171
	s_sleep 8
	s_add_u32 s34, s34, 1
	s_cmp_lt_u32 s34, 0x40000
	s_cbranch_scc1 L_ls_170
	s_endpgm
L_lso_171:
	s_lshl_b32 s6, s60, 2
	s_add_u32 s6, s6, s5
	s_mul_i32 s6, s6, 24576
	v_lshlrev_b32 v20, 7, v0
	buffer_load_dword v21, v20, s[48:51], s6 offen
	s_add_u32 s6, s6, 8192
	buffer_load_dword v21, v20, s[48:51], s6 offen
	s_add_u32 s6, s6, 8192
	buffer_load_dword v21, v20, s[48:51], s6 offen
	s_add_u32 s6, s6, 8192
	s_lshl_b32 s6, s60, 2
	s_add_u32 s6, s6, s5
	s_mul_i32 s6, s6, 8192
	v_lshlrev_b32 v20, 7, v0
	buffer_load_dword v21, v20, s[52:55], s6 offen
	s_add_u32 s6, s6, 8192
	s_waitcnt vmcnt(0)
	s_lshl_b32 s6, s5, 8
	s_add_u32 s6, s6, 0
	v_add_u32 v20, s6, v0
	v_mul_u32_u24 v21, 6554, v20
	v_lshrrev_b32 v21, 16, v21
	v_mul_u32_u24 v22, 10, v21
	v_sub_u32 v22, v20, v22
	v_lshrrev_b32 v23, 5, v21
	v_and_b32 v24, 0x13, v21
	v_and_b32 v25, 4, v21
	v_lshl_add_u32 v24, v25, 1, v24
	v_and_b32 v25, 8, v21
	v_lshrrev_b32 v25, 1, v25
	v_add_u32 v24, v24, v25
	v_mul_u32_u24 v24, 3840, v24
	v_lshl_add_u32 v24, v22, 4, v24
	v_mul_u32_u24 v25, 1280, v23
	v_add_u32 v24, v24, v25
	v_mov_b32 v25, 0x40000000
	v_cmp_gt_u32 vcc, 3, v23
	s_nop 1
	v_cndmask_b32 v1, v25, v24, vcc
	s_lshl_b32 s6, s5, 8
	s_add_u32 s6, s6, 64
	v_add_u32 v20, s6, v0
	v_mul_u32_u24 v21, 6554, v20
	v_lshrrev_b32 v21, 16, v21
	v_mul_u32_u24 v22, 10, v21
	v_sub_u32 v22, v20, v22
	v_lshrrev_b32 v23, 5, v21
	v_and_b32 v24, 0x13, v21
	v_and_b32 v25, 4, v21
	v_lshl_add_u32 v24, v25, 1, v24
	v_and_b32 v25, 8, v21
	v_lshrrev_b32 v25, 1, v25
	v_add_u32 v24, v24, v25
	v_mul_u32_u24 v24, 3840, v24
	v_lshl_add_u32 v24, v22, 4, v24
	v_mul_u32_u24 v25, 1280, v23
	v_add_u32 v24, v24, v25
	v_mov_b32 v25, 0x40000000
	v_cmp_gt_u32 vcc, 3, v23
	s_nop 1
	v_cndmask_b32 v2, v25, v24, vcc
	s_lshl_b32 s6, s5, 8
	s_add_u32 s6, s6, 128
	v_add_u32 v20, s6, v0
	v_mul_u32_u24 v21, 6554, v20
	v_lshrrev_b32 v21, 16, v21
	v_mul_u32_u24 v22, 10, v21
	v_sub_u32 v22, v20, v22
	v_lshrrev_b32 v23, 5, v21
	v_and_b32 v24, 0x13, v21
	v_and_b32 v25, 4, v21
	v_lshl_add_u32 v24, v25, 1, v24
	v_and_b32 v25, 8, v21
	v_lshrrev_b32 v25, 1, v25
	v_add_u32 v24, v24, v25
	v_mul_u32_u24 v24, 3840, v24
	v_lshl_add_u32 v24, v22, 4, v24
	v_mul_u32_u24 v25, 1280, v23
	v_add_u32 v24, v24, v25
	v_mov_b32 v25, 0x40000000
	v_cmp_gt_u32 vcc, 3, v23
	s_nop 1
	v_cndmask_b32 v3, v25, v24, vcc
	s_lshl_b32 s6, s5, 8
	s_add_u32 s6, s6, 192
	v_add_u32 v20, s6, v0
	v_mul_u32_u24 v21, 6554, v20
	v_lshrrev_b32 v21, 16, v21
	v_mul_u32_u24 v22, 10, v21
	v_sub_u32 v22, v20, v22
	v_lshrrev_b32 v23, 5, v21
	v_and_b32 v24, 0x13, v21
	v_and_b32 v25, 4, v21
	v_lshl_add_u32 v24, v25, 1, v24
	v_and_b32 v25, 8, v21
	v_lshrrev_b32 v25, 1, v25
	v_add_u32 v24, v24, v25
	v_mul_u32_u24 v24, 3840, v24
	v_lshl_add_u32 v24, v22, 4, v24
	v_mul_u32_u24 v25, 1280, v23
	v_add_u32 v24, v24, v25
	v_mov_b32 v25, 0x40000000
	v_cmp_gt_u32 vcc, 3, v23
	s_nop 1
	v_cndmask_b32 v4, v25, v24, vcc
	s_lshl_b32 s64, s5, 12
	s_mov_b32 s63, 0
	v_and_b32 v20, 15, v0
	v_lshrrev_b32 v21, 4, v0
	s_lshl_b32 s6, s60, 2
	s_add_u32 s6, s6, s5
	s_lshl_b32 s6, s6, 4
	v_add_u32 v8, s6, v20
	v_mul_u32_u24 v22, 1280, v8
	v_lshl_add_u32 v22, v21, 4, v22
	v_max_u32 v23, 16, v8
	v_subrev_u32 v23, 16, v23
	v_mul_u32_u24 v23, 1280, v23
	v_lshl_add_u32 v23, v21, 4, v23
	buffer_load_dwordx4 a[0:3], v22, s[44:47], 0 offen offset:0 nt
	buffer_load_dwordx4 a[80:83], v23, s[44:47], 0 offen offset:0 nt
	buffer_load_dwordx4 a[4:7], v22, s[44:47], 0 offen offset:64 nt
	buffer_load_dwordx4 a[84:87], v23, s[44:47], 0 offen offset:64 nt
	buffer_load_dwordx4 a[8:11], v22, s[44:47], 0 offen offset:128 nt
	buffer_load_dwordx4 a[88:91], v23, s[44:47], 0 offen offset:128 nt
	buffer_load_dwordx4 a[12:15], v22, s[44:47], 0 offen offset:192 nt
	buffer_load_dwordx4 a[92:95], v23, s[44:47], 0 offen offset:192 nt
	buffer_load_dwordx4 a[16:19], v22, s[44:47], 0 offen offset:256 nt
	buffer_load_dwordx4 a[96:99], v23, s[44:47], 0 offen offset:256 nt
	buffer_load_dwordx4 a[20:23], v22, s[44:47], 0 offen offset:320 nt
	buffer_load_dwordx4 a[100:103], v23, s[44:47], 0 offen offset:320 nt
	buffer_load_dwordx4 a[24:27], v22, s[44:47], 0 offen offset:384 nt
	buffer_load_dwordx4 a[104:107], v23, s[44:47], 0 offen offset:384 nt
	buffer_load_dwordx4 a[28:31], v22, s[44:47], 0 offen offset:448 nt
	buffer_load_dwordx4 a[108:111], v23, s[44:47], 0 offen offset:448 nt
	buffer_load_dwordx4 a[32:35], v22, s[44:47], 0 offen offset:512 nt
	buffer_load_dwordx4 a[112:115], v23, s[44:47], 0 offen offset:512 nt
	buffer_load_dwordx4 a[36:39], v22, s[44:47], 0 offen offset:576 nt
	buffer_load_dwordx4 a[116:119], v23, s[44:47], 0 offen offset:576 nt
	buffer_load_dwordx4 a[40:43], v22, s[44:47], 0 offen offset:640 nt
	buffer_load_dwordx4 a[120:123], v23, s[44:47], 0 offen offset:640 nt
	buffer_load_dwordx4 a[44:47], v22, s[44:47], 0 offen offset:704 nt
	buffer_load_dwordx4 a[124:127], v23, s[44:47], 0 offen offset:704 nt
	buffer_load_dwordx4 a[48:51], v22, s[44:47], 0 offen offset:768 nt
	buffer_load_dwordx4 a[128:131], v23, s[44:47], 0 offen offset:768 nt
	buffer_load_dwordx4 a[52:55], v22, s[44:47], 0 offen offset:832 nt
	buffer_load_dwordx4 a[132:135], v23, s[44:47], 0 offen offset:832 nt
	buffer_load_dwordx4 a[56:59], v22, s[44:47], 0 offen offset:896 nt
	buffer_load_dwordx4 a[136:139], v23, s[44:47], 0 offen offset:896 nt
	buffer_load_dwordx4 a[60:63], v22, s[44:47], 0 offen offset:960 nt
	buffer_load_dwordx4 a[140:143], v23, s[44:47], 0 offen offset:960 nt
	buffer_load_dwordx4 a[64:67], v22, s[44:47], 0 offen offset:1024 nt
	buffer_load_dwordx4 a[144:147], v23, s[44:47], 0 offen offset:1024 nt
	buffer_load_dwordx4 a[68:71], v22, s[44:47], 0 offen offset:1088 nt
	buffer_load_dwordx4 a[148:151], v23, s[44:47], 0 offen offset:1088 nt
	buffer_load_dwordx4 a[72:75], v22, s[44:47], 0 offen offset:1152 nt
	buffer_load_dwordx4 a[152:155], v23, s[44:47], 0 offen offset:1152 nt
	buffer_load_dwordx4 a[76:79], v22, s[44:47], 0 offen offset:1216 nt
	buffer_load_dwordx4 a[156:159], v23, s[44:47], 0 offen offset:1216 nt
	v_mul_u32_u24 v22, 2560, v8
	v_lshl_add_u32 v22, v21, 3, v22
	v_add_u32 v10, 1280, v22
	v_bfe_u32 v22, v0, 2, 3
	v_lshrrev_b32 v23, 5, v0
	v_lshl_add_u32 v22, v23, 4, v22
	v_mul_u32_u24 v22, 160, v22
	v_and_b32 v23, 3, v0
	v_mul_u32_u24 v23, 40, v23
	v_add_u32 v28, v22, v23
	v_add_u32 v29, 65536, v28
	v_add_u32 v30, 131072, v28
	v_mov_b32 v9, 0xcf8547b1
	s_mov_b32 s65, 0x3ea52b5c
	s_mov_b32 s62, 0
	s_waitcnt vmcnt(0)
	s_add_u32 m0, s64, 0
	s_nop 0
	buffer_load_dwordx4 v1, s[48:51], s63 offen lds
	s_add_u32 m0, s64, 1024
	s_nop 0
	buffer_load_dwordx4 v2, s[48:51], s63 offen lds
	s_add_u32 m0, s64, 2048
	s_nop 0
	buffer_load_dwordx4 v3, s[48:51], s63 offen lds
	s_add_u32 m0, s64, 3072
	s_nop 0
	buffer_load_dwordx4 v4, s[48:51], s63 offen lds
	s_add_u32 s63, s63, 122880
	s_add_u32 m0, s64, 16384
	s_nop 0
	buffer_load_dwordx4 v1, s[48:51], s63 offen lds
	s_add_u32 m0, s64, 17408
	s_nop 0
	buffer_load_dwordx4 v2, s[48:51], s63 offen lds
	s_add_u32 m0, s64, 18432
	s_nop 0
	buffer_load_dwordx4 v3, s[48:51], s63 offen lds
	s_add_u32 m0, s64, 19456
	s_nop 0
	buffer_load_dwordx4 v4, s[48:51], s63 offen lds
	s_add_u32 s63, s63, 122880
	s_add_u32 m0, s64, 32768
	s_nop 0
	buffer_load_dwordx4 v1, s[48:51], s63 offen lds
	s_add_u32 m0, s64, 33792
	s_nop 0
	buffer_load_dwordx4 v2, s[48:51], s63 offen lds
	s_add_u32 m0, s64, 34816
	s_nop 0
	buffer_load_dwordx4 v3, s[48:51], s63 offen lds
	s_add_u32 m0, s64, 35840
	s_nop 0
	buffer_load_dwordx4 v4, s[48:51], s63 offen lds
	s_add_u32 s63, s63, 122880
	s_add_u32 m0, s64, 49152
	s_nop 0
	buffer_load_dwordx4 v1, s[48:51], s63 offen lds
	s_add_u32 m0, s64, 50176
	s_nop 0
	buffer_load_dwordx4 v2, s[48:51], s63 offen lds
	s_add_u32 m0, s64, 51200
	s_nop 0
	buffer_load_dwordx4 v3, s[48:51], s63 offen lds
	s_add_u32 m0, s64, 52224
	s_nop 0
	buffer_load_dwordx4 v4, s[48:51], s63 offen lds
	s_add_u32 s63, s63, 122880
	s_add_u32 m0, s64, 65536
	s_nop 0
	buffer_load_dwordx4 v1, s[48:51], s63 offen lds
	s_add_u32 m0, s64, 66560
	s_nop 0
	buffer_load_dwordx4 v2, s[48:51], s63 offen lds
	s_add_u32 m0, s64, 67584
	s_nop 0
	buffer_load_dwordx4 v3, s[48:51], s63 offen lds
	s_add_u32 m0, s64, 68608
	s_nop 0
	buffer_load_dwordx4 v4, s[48:51], s63 offen lds
	s_add_u32 s63, s63, 122880
	s_add_u32 m0, s64, 81920
	s_nop 0
	buffer_load_dwordx4 v1, s[48:51], s63 offen lds
	s_add_u32 m0, s64, 82944
	s_nop 0
	buffer_load_dwordx4 v2, s[48:51], s63 offen lds
	s_add_u32 m0, s64, 83968
	s_nop 0
	buffer_load_dwordx4 v3, s[48:51], s63 offen lds
	s_add_u32 m0, s64, 84992
	s_nop 0
	buffer_load_dwordx4 v4, s[48:51], s63 offen lds
	s_add_u32 s63, s63, 122880
	s_add_u32 m0, s64, 98304
	s_nop 0
	buffer_load_dwordx4 v1, s[48:51], s63 offen lds
	s_add_u32 m0, s64, 99328
	s_nop 0
	buffer_load_dwordx4 v2, s[48:51], s63 offen lds
	s_add_u32 m0, s64, 100352
	s_nop 0
	buffer_load_dwordx4 v3, s[48:51], s63 offen lds
	s_add_u32 m0, s64, 101376
	s_nop 0
	buffer_load_dwordx4 v4, s[48:51], s63 offen lds
	s_add_u32 s63, s63, 122880
	s_add_u32 m0, s64, 114688
	s_nop 0
	buffer_load_dwordx4 v1, s[48:51], s63 offen lds
	s_add_u32 m0, s64, 115712
	s_nop 0
	buffer_load_dwordx4 v2, s[48:51], s63 offen lds
	s_add_u32 m0, s64, 116736
	s_nop 0
	buffer_load_dwordx4 v3, s[48:51], s63 offen lds
	s_add_u32 m0, s64, 117760
	s_nop 0
	buffer_load_dwordx4 v4, s[48:51], s63 offen lds
	s_add_u32 s63, s63, 122880
	s_add_u32 m0, s64, 131072
	s_nop 0
	buffer_load_dwordx4 v1, s[48:51], s63 offen lds
	s_add_u32 m0, s64, 132096
	s_nop 0
	buffer_load_dwordx4 v2, s[48:51], s63 offen lds
	s_add_u32 m0, s64, 133120
	s_nop 0
	buffer_load_dwordx4 v3, s[48:51], s63 offen lds
	s_add_u32 m0, s64, 134144
	s_nop 0
	buffer_load_dwordx4 v4, s[48:51], s63 offen lds
	s_add_u32 s63, s63, 122880
L_bg_172:
	s_waitcnt vmcnt(32)
	s_barrier
	ds_read_b64_tr_b16 v[132:133], v28 offset:5120
	ds_read_b64_tr_b16 v[134:135], v28 offset:6400
	ds_read_b64_tr_b16 v[136:137], v28 offset:10240
	ds_read_b64_tr_b16 v[138:139], v28 offset:11520
	ds_read_b64_tr_b16 v[140:141], v28 offset:0
	ds_read_b64_tr_b16 v[142:143], v28 offset:1280
	ds_read_b64_tr_b16 v[144:145], v28 offset:5128
	ds_read_b64_tr_b16 v[146:147], v28 offset:6408
	ds_read_b64_tr_b16 v[148:149], v28 offset:10248
	ds_read_b64_tr_b16 v[150:151], v28 offset:11528
	ds_read_b64_tr_b16 v[152:153], v28 offset:8
	ds_read_b64_tr_b16 v[154:155], v28 offset:1288
	s_waitcnt lgkmcnt(10)
	v_mfma_f32_16x16x32_bf16 v[52:55], v[132:135], a[0:3], 0
	v_mfma_f32_16x16x32_bf16 v[72:75], v[132:135], a[80:83], 0
	s_add_u32 m0, s64, 147456
	s_nop 0
	buffer_load_dwordx4 v1, s[48:51], s63 offen lds
	ds_read_b64_tr_b16 v[132:133], v28 offset:5136
	ds_read_b64_tr_b16 v[134:135], v28 offset:6416
	s_waitcnt lgkmcnt(10)
	v_mfma_f32_16x16x32_bf16 v[92:95], v[136:139], a[0:3], 0
	v_mfma_f32_16x16x32_bf16 v[112:115], v[136:139], a[80:83], 0
	ds_read_b64_tr_b16 v[136:137], v28 offset:10256
	ds_read_b64_tr_b16 v[138:139], v28 offset:11536
	s_waitcnt lgkmcnt(10)
	v_mfma_f32_16x16x32_bf16 v[32:35], v[140:143], a[0:3], 0
	ds_read_b64_tr_b16 v[140:141], v28 offset:16
	ds_read_b64_tr_b16 v[142:143], v28 offset:1296
	s_waitcnt lgkmcnt(10)
	v_mfma_f32_16x16x32_bf16 v[56:59], v[144:147], a[0:3], 0
	v_mfma_f32_16x16x32_bf16 v[76:79], v[144:147], a[80:83], 0
	ds_read_b64_tr_b16 v[144:145], v28 offset:5144
	ds_read_b64_tr_b16 v[146:147], v28 offset:6424
	s_waitcnt lgkmcnt(10)
	v_mfma_f32_16x16x32_bf16 v[96:99], v[148:151], a[0:3], 0
	v_mfma_f32_16x16x32_bf16 v[116:119], v[148:151], a[80:83], 0
	s_add_u32 m0, s64, 148480
	s_nop 0
	buffer_load_dwordx4 v2, s[48:51], s63 offen lds
	ds_read_b64_tr_b16 v[148:149], v28 offset:10264
	ds_read_b64_tr_b16 v[150:151], v28 offset:11544
	s_waitcnt lgkmcnt(10)
	v_mfma_f32_16x16x32_bf16 v[36:39], v[152:155], a[0:3], 0
	ds_read_b64_tr_b16 v[152:153], v28 offset:24
	ds_read_b64_tr_b16 v[154:155], v28 offset:1304
	s_waitcnt lgkmcnt(10)
	v_mfma_f32_16x16x32_bf16 v[60:63], v[132:135], a[0:3], 0
	v_mfma_f32_16x16x32_bf16 v[80:83], v[132:135], a[80:83], 0
	ds_read_b64_tr_b16 v[132:133], v28 offset:5152
	ds_read_b64_tr_b16 v[134:135], v28 offset:6432
	s_waitcnt lgkmcnt(10)
	v_mfma_f32_16x16x32_bf16 v[100:103], v[136:139], a[0:3], 0
	v_mfma_f32_16x16x32_bf16 v[120:123], v[136:139], a[80:83], 0
	ds_read_b64_tr_b16 v[136:137], v28 offset:10272
	ds_read_b64_tr_b16 v[138:139], v28 offset:11552
	s_waitcnt lgkmcnt(10)
	v_mfma_f32_16x16x32_bf16 v[40:43], v[140:143], a[0:3], 0
	s_add_u32 m0, s64, 149504
	s_nop 0
	buffer_load_dwordx4 v3, s[48:51], s63 offen lds
	ds_read_b64_tr_b16 v[140:141], v28 offset:32
	ds_read_b64_tr_b16 v[142:143], v28 offset:1312
	s_waitcnt lgkmcnt(10)
	v_mfma_f32_16x16x32_bf16 v[64:67], v[144:147], a[0:3], 0
	v_mfma_f32_16x16x32_bf16 v[84:87], v[144:147], a[80:83], 0
	s_waitcnt lgkmcnt(8)
	v_mfma_f32_16x16x32_bf16 v[104:107], v[148:151], a[0:3], 0
	v_mfma_f32_16x16x32_bf16 v[124:127], v[148:151], a[80:83], 0
	s_waitcnt lgkmcnt(6)
	v_mfma_f32_16x16x32_bf16 v[44:47], v[152:155], a[0:3], 0
	s_waitcnt lgkmcnt(4)
	v_mfma_f32_16x16x32_bf16 v[68:71], v[132:135], a[0:3], 0
	v_mfma_f32_16x16x32_bf16 v[88:91], v[132:135], a[80:83], 0
	s_add_u32 m0, s64, 150528
	s_nop 0
	buffer_load_dwordx4 v4, s[48:51], s63 offen lds
	s_waitcnt lgkmcnt(2)
	v_mfma_f32_16x16x32_bf16 v[108:111], v[136:139], a[0:3], 0
	v_mfma_f32_16x16x32_bf16 v[128:131], v[136:139], a[80:83], 0
	s_add_u32 s63, s63, 122880
	s_waitcnt lgkmcnt(0)
	v_mfma_f32_16x16x32_bf16 v[48:51], v[140:143], a[0:3], 0
	s_waitcnt vmcnt(32)
	s_barrier
	ds_read_b64_tr_b16 v[132:133], v28 offset:21504
	ds_read_b64_tr_b16 v[134:135], v28 offset:22784
	ds_read_b64_tr_b16 v[136:137], v28 offset:26624
	ds_read_b64_tr_b16 v[138:139], v28 offset:27904
	ds_read_b64_tr_b16 v[140:141], v28 offset:16384
	ds_read_b64_tr_b16 v[142:143], v28 offset:17664
	ds_read_b64_tr_b16 v[144:145], v28 offset:21512
	ds_read_b64_tr_b16 v[146:147], v28 offset:22792
	ds_read_b64_tr_b16 v[148:149], v28 offset:26632
	ds_read_b64_tr_b16 v[150:151], v28 offset:27912
	ds_read_b64_tr_b16 v[152:153], v28 offset:16392
	ds_read_b64_tr_b16 v[154:155], v28 offset:17672
	s_waitcnt lgkmcnt(10)
	v_mfma_f32_16x16x32_bf16 v[52:55], v[132:135], a[4:7], v[52:55]
	v_mfma_f32_16x16x32_bf16 v[72:75], v[132:135], a[84:87], v[72:75]
	s_add_u32 m0, s64, 0
	s_nop 0
	buffer_load_dwordx4 v1, s[48:51], s63 offen lds
	ds_read_b64_tr_b16 v[132:133], v28 offset:21520
	ds_read_b64_tr_b16 v[134:135], v28 offset:22800
	s_waitcnt lgkmcnt(10)
	v_mfma_f32_16x16x32_bf16 v[92:95], v[136:139], a[4:7], v[92:95]
	v_mfma_f32_16x16x32_bf16 v[112:115], v[136:139], a[84:87], v[112:115]
	ds_read_b64_tr_b16 v[136:137], v28 offset:26640
	ds_read_b64_tr_b16 v[138:139], v28 offset:27920
	s_waitcnt lgkmcnt(10)
	v_mfma_f32_16x16x32_bf16 v[32:35], v[140:143], a[4:7], v[32:35]
	ds_read_b64_tr_b16 v[140:141], v28 offset:16400
	ds_read_b64_tr_b16 v[142:143], v28 offset:17680
	s_waitcnt lgkmcnt(10)
	v_mfma_f32_16x16x32_bf16 v[56:59], v[144:147], a[4:7], v[56:59]
	v_mfma_f32_16x16x32_bf16 v[76:79], v[144:147], a[84:87], v[76:79]
	ds_read_b64_tr_b16 v[144:145], v28 offset:21528
	ds_read_b64_tr_b16 v[146:147], v28 offset:22808
	s_waitcnt lgkmcnt(10)
	v_mfma_f32_16x16x32_bf16 v[96:99], v[148:151], a[4:7], v[96:99]
	v_mfma_f32_16x16x32_bf16 v[116:119], v[148:151], a[84:87], v[116:119]
	s_add_u32 m0, s64, 1024
	s_nop 0
	buffer_load_dwordx4 v2, s[48:51], s63 offen lds
	ds_read_b64_tr_b16 v[148:149], v28 offset:26648
	ds_read_b64_tr_b16 v[150:151], v28 offset:27928
	s_waitcnt lgkmcnt(10)
	v_mfma_f32_16x16x32_bf16 v[36:39], v[152:155], a[4:7], v[36:39]
	ds_read_b64_tr_b16 v[152:153], v28 offset:16408
	ds_read_b64_tr_b16 v[154:155], v28 offset:17688
	s_waitcnt lgkmcnt(10)
	v_mfma_f32_16x16x32_bf16 v[60:63], v[132:135], a[4:7], v[60:63]
	v_mfma_f32_16x16x32_bf16 v[80:83], v[132:135], a[84:87], v[80:83]
	ds_read_b64_tr_b16 v[132:133], v28 offset:21536
	ds_read_b64_tr_b16 v[134:135], v28 offset:22816
	s_waitcnt lgkmcnt(10)
	v_mfma_f32_16x16x32_bf16 v[100:103], v[136:139], a[4:7], v[100:103]
	v_mfma_f32_16x16x32_bf16 v[120:123], v[136:139], a[84:87], v[120:123]
	ds_read_b64_tr_b16 v[136:137], v28 offset:26656
	ds_read_b64_tr_b16 v[138:139], v28 offset:27936
	s_waitcnt lgkmcnt(10)
	v_mfma_f32_16x16x32_bf16 v[40:43], v[140:143], a[4:7], v[40:43]
	s_add_u32 m0, s64, 2048
	s_nop 0
	buffer_load_dwordx4 v3, s[48:51], s63 offen lds
	ds_read_b64_tr_b16 v[140:141], v28 offset:16416
	ds_read_b64_tr_b16 v[142:143], v28 offset:17696
	s_waitcnt lgkmcnt(10)
	v_mfma_f32_16x16x32_bf16 v[64:67], v[144:147], a[4:7], v[64:67]
	v_mfma_f32_16x16x32_bf16 v[84:87], v[144:147], a[84:87], v[84:87]
	s_waitcnt lgkmcnt(8)
	v_mfma_f32_16x16x32_bf16 v[104:107], v[148:151], a[4:7], v[104:107]
	v_mfma_f32_16x16x32_bf16 v[124:127], v[148:151], a[84:87], v[124:127]
	s_waitcnt lgkmcnt(6)
	v_mfma_f32_16x16x32_bf16 v[44:47], v[152:155], a[4:7], v[44:47]
	s_waitcnt lgkmcnt(4)
	v_mfma_f32_16x16x32_bf16 v[68:71], v[132:135], a[4:7], v[68:71]
	v_mfma_f32_16x16x32_bf16 v[88:91], v[132:135], a[84:87], v[88:91]
	s_add_u32 m0, s64, 3072
	s_nop 0
	buffer_load_dwordx4 v4, s[48:51], s63 offen lds
	s_waitcnt lgkmcnt(2)
	v_mfma_f32_16x16x32_bf16 v[108:111], v[136:139], a[4:7], v[108:111]
	v_mfma_f32_16x16x32_bf16 v[128:131], v[136:139], a[84:87], v[128:131]
	s_add_u32 s63, s63, 122880
	s_waitcnt lgkmcnt(0)
	v_mfma_f32_16x16x32_bf16 v[48:51], v[140:143], a[4:7], v[48:51]
	s_waitcnt vmcnt(32)
	s_barrier
	ds_read_b64_tr_b16 v[132:133], v28 offset:37888
	ds_read_b64_tr_b16 v[134:135], v28 offset:39168
	ds_read_b64_tr_b16 v[136:137], v28 offset:43008
	ds_read_b64_tr_b16 v[138:139], v28 offset:44288
	ds_read_b64_tr_b16 v[140:141], v28 offset:32768
	ds_read_b64_tr_b16 v[142:143], v28 offset:34048
	ds_read_b64_tr_b16 v[144:145], v28 offset:37896
	ds_read_b64_tr_b16 v[146:147], v28 offset:39176
	ds_read_b64_tr_b16 v[148:149], v28 offset:43016
	ds_read_b64_tr_b16 v[150:151], v28 offset:44296
	ds_read_b64_tr_b16 v[152:153], v28 offset:32776
	ds_read_b64_tr_b16 v[154:155], v28 offset:34056
	s_waitcnt lgkmcnt(10)
	v_mfma_f32_16x16x32_bf16 v[52:55], v[132:135], a[8:11], v[52:55]
	v_mfma_f32_16x16x32_bf16 v[72:75], v[132:135], a[88:91], v[72:75]
	s_add_u32 m0, s64, 16384
	s_nop 0
	buffer_load_dwordx4 v1, s[48:51], s63 offen lds
	ds_read_b64_tr_b16 v[132:133], v28 offset:37904
	ds_read_b64_tr_b16 v[134:135], v28 offset:39184
	s_waitcnt lgkmcnt(10)
	v_mfma_f32_16x16x32_bf16 v[92:95], v[136:139], a[8:11], v[92:95]
	v_mfma_f32_16x16x32_bf16 v[112:115], v[136:139], a[88:91], v[112:115]
	ds_read_b64_tr_b16 v[136:137], v28 offset:43024
	ds_read_b64_tr_b16 v[138:139], v28 offset:44304
	s_waitcnt lgkmcnt(10)
	v_mfma_f32_16x16x32_bf16 v[32:35], v[140:143], a[8:11], v[32:35]
	ds_read_b64_tr_b16 v[140:141], v28 offset:32784
	ds_read_b64_tr_b16 v[142:143], v28 offset:34064
	s_waitcnt lgkmcnt(10)
	v_mfma_f32_16x16x32_bf16 v[56:59], v[144:147], a[8:11], v[56:59]
	v_mfma_f32_16x16x32_bf16 v[76:79], v[144:147], a[88:91], v[76:79]
	ds_read_b64_tr_b16 v[144:145], v28 offset:37912
	ds_read_b64_tr_b16 v[146:147], v28 offset:39192
	s_waitcnt lgkmcnt(10)
	v_mfma_f32_16x16x32_bf16 v[96:99], v[148:151], a[8:11], v[96:99]
	v_mfma_f32_16x16x32_bf16 v[116:119], v[148:151], a[88:91], v[116:119]
	s_add_u32 m0, s64, 17408
	s_nop 0
	buffer_load_dwordx4 v2, s[48:51], s63 offen lds
	ds_read_b64_tr_b16 v[148:149], v28 offset:43032
	ds_read_b64_tr_b16 v[150:151], v28 offset:44312
	s_waitcnt lgkmcnt(10)
	v_mfma_f32_16x16x32_bf16 v[36:39], v[152:155], a[8:11], v[36:39]
	ds_read_b64_tr_b16 v[152:153], v28 offset:32792
	ds_read_b64_tr_b16 v[154:155], v28 offset:34072
	s_waitcnt lgkmcnt(10)
	v_mfma_f32_16x16x32_bf16 v[60:63], v[132:135], a[8:11], v[60:63]
	v_mfma_f32_16x16x32_bf16 v[80:83], v[132:135], a[88:91], v[80:83]
	ds_read_b64_tr_b16 v[132:133], v28 offset:37920
	ds_read_b64_tr_b16 v[134:135], v28 offset:39200
	s_waitcnt lgkmcnt(10)
	v_mfma_f32_16x16x32_bf16 v[100:103], v[136:139], a[8:11], v[100:103]
	v_mfma_f32_16x16x32_bf16 v[120:123], v[136:139], a[88:91], v[120:123]
	ds_read_b64_tr_b16 v[136:137], v28 offset:43040
	ds_read_b64_tr_b16 v[138:139], v28 offset:44320
	s_waitcnt lgkmcnt(10)
	v_mfma_f32_16x16x32_bf16 v[40:43], v[140:143], a[8:11], v[40:43]
	s_add_u32 m0, s64, 18432
	s_nop 0
	buffer_load_dwordx4 v3, s[48:51], s63 offen lds
	ds_read_b64_tr_b16 v[140:141], v28 offset:32800
	ds_read_b64_tr_b16 v[142:143], v28 offset:34080
	s_waitcnt lgkmcnt(10)
	v_mfma_f32_16x16x32_bf16 v[64:67], v[144:147], a[8:11], v[64:67]
	v_mfma_f32_16x16x32_bf16 v[84:87], v[144:147], a[88:91], v[84:87]
	s_waitcnt lgkmcnt(8)
	v_mfma_f32_16x16x32_bf16 v[104:107], v[148:151], a[8:11], v[104:107]
	v_mfma_f32_16x16x32_bf16 v[124:127], v[148:151], a[88:91], v[124:127]
	s_waitcnt lgkmcnt(6)
	v_mfma_f32_16x16x32_bf16 v[44:47], v[152:155], a[8:11], v[44:47]
	s_waitcnt lgkmcnt(4)
	v_mfma_f32_16x16x32_bf16 v[68:71], v[132:135], a[8:11], v[68:71]
	v_mfma_f32_16x16x32_bf16 v[88:91], v[132:135], a[88:91], v[88:91]
	s_add_u32 m0, s64, 19456
	s_nop 0
	buffer_load_dwordx4 v4, s[48:51], s63 offen lds
	s_waitcnt lgkmcnt(2)
	v_mfma_f32_16x16x32_bf16 v[108:111], v[136:139], a[8:11], v[108:111]
	v_mfma_f32_16x16x32_bf16 v[128:131], v[136:139], a[88:91], v[128:131]
	s_add_u32 s63, s63, 122880
	s_waitcnt lgkmcnt(0)
	v_mfma_f32_16x16x32_bf16 v[48:51], v[140:143], a[8:11], v[48:51]
	s_waitcnt vmcnt(32)
	s_barrier
	ds_read_b64_tr_b16 v[132:133], v28 offset:54272
	ds_read_b64_tr_b16 v[134:135], v28 offset:55552
	ds_read_b64_tr_b16 v[136:137], v28 offset:59392
	ds_read_b64_tr_b16 v[138:139], v28 offset:60672
	ds_read_b64_tr_b16 v[140:141], v28 offset:49152
	ds_read_b64_tr_b16 v[142:143], v28 offset:50432
	ds_read_b64_tr_b16 v[144:145], v28 offset:54280
	ds_read_b64_tr_b16 v[146:147], v28 offset:55560
	ds_read_b64_tr_b16 v[148:149], v28 offset:59400
	ds_read_b64_tr_b16 v[150:151], v28 offset:60680
	ds_read_b64_tr_b16 v[152:153], v28 offset:49160
	ds_read_b64_tr_b16 v[154:155], v28 offset:50440
	s_waitcnt lgkmcnt(10)
	v_mfma_f32_16x16x32_bf16 v[52:55], v[132:135], a[12:15], v[52:55]
	v_mfma_f32_16x16x32_bf16 v[72:75], v[132:135], a[92:95], v[72:75]
	s_add_u32 m0, s64, 32768
	s_nop 0
	buffer_load_dwordx4 v1, s[48:51], s63 offen lds
	ds_read_b64_tr_b16 v[132:133], v28 offset:54288
	ds_read_b64_tr_b16 v[134:135], v28 offset:55568
	s_waitcnt lgkmcnt(10)
	v_mfma_f32_16x16x32_bf16 v[92:95], v[136:139], a[12:15], v[92:95]
	v_mfma_f32_16x16x32_bf16 v[112:115], v[136:139], a[92:95], v[112:115]
	ds_read_b64_tr_b16 v[136:137], v28 offset:59408
	ds_read_b64_tr_b16 v[138:139], v28 offset:60688
	s_waitcnt lgkmcnt(10)
	v_mfma_f32_16x16x32_bf16 v[32:35], v[140:143], a[12:15], v[32:35]
	ds_read_b64_tr_b16 v[140:141], v28 offset:49168
	ds_read_b64_tr_b16 v[142:143], v28 offset:50448
	s_waitcnt lgkmcnt(10)
	v_mfma_f32_16x16x32_bf16 v[56:59], v[144:147], a[12:15], v[56:59]
	v_mfma_f32_16x16x32_bf16 v[76:79], v[144:147], a[92:95], v[76:79]
	ds_read_b64_tr_b16 v[144:145], v28 offset:54296
	ds_read_b64_tr_b16 v[146:147], v28 offset:55576
	s_waitcnt lgkmcnt(10)
	v_mfma_f32_16x16x32_bf16 v[96:99], v[148:151], a[12:15], v[96:99]
	v_mfma_f32_16x16x32_bf16 v[116:119], v[148:151], a[92:95], v[116:119]
	s_add_u32 m0, s64, 33792
	s_nop 0
	buffer_load_dwordx4 v2, s[48:51], s63 offen lds
	ds_read_b64_tr_b16 v[148:149], v28 offset:59416
	ds_read_b64_tr_b16 v[150:151], v28 offset:60696
	s_waitcnt lgkmcnt(10)
	v_mfma_f32_16x16x32_bf16 v[36:39], v[152:155], a[12:15], v[36:39]
	ds_read_b64_tr_b16 v[152:153], v28 offset:49176
	ds_read_b64_tr_b16 v[154:155], v28 offset:50456
	s_waitcnt lgkmcnt(10)
	v_mfma_f32_16x16x32_bf16 v[60:63], v[132:135], a[12:15], v[60:63]
	v_mfma_f32_16x16x32_bf16 v[80:83], v[132:135], a[92:95], v[80:83]
	ds_read_b64_tr_b16 v[132:133], v28 offset:54304
	ds_read_b64_tr_b16 v[134:135], v28 offset:55584
	s_waitcnt lgkmcnt(10)
	v_mfma_f32_16x16x32_bf16 v[100:103], v[136:139], a[12:15], v[100:103]
	v_mfma_f32_16x16x32_bf16 v[120:123], v[136:139], a[92:95], v[120:123]
	ds_read_b64_tr_b16 v[136:137], v28 offset:59424
	ds_read_b64_tr_b16 v[138:139], v28 offset:60704
	s_waitcnt lgkmcnt(10)
	v_mfma_f32_16x16x32_bf16 v[40:43], v[140:143], a[12:15], v[40:43]
	s_add_u32 m0, s64, 34816
	s_nop 0
	buffer_load_dwordx4 v3, s[48:51], s63 offen lds
	ds_read_b64_tr_b16 v[140:141], v28 offset:49184
	ds_read_b64_tr_b16 v[142:143], v28 offset:50464
	s_waitcnt lgkmcnt(10)
	v_mfma_f32_16x16x32_bf16 v[64:67], v[144:147], a[12:15], v[64:67]
	v_mfma_f32_16x16x32_bf16 v[84:87], v[144:147], a[92:95], v[84:87]
	s_waitcnt lgkmcnt(8)
	v_mfma_f32_16x16x32_bf16 v[104:107], v[148:151], a[12:15], v[104:107]
	v_mfma_f32_16x16x32_bf16 v[124:127], v[148:151], a[92:95], v[124:127]
	s_waitcnt lgkmcnt(6)
	v_mfma_f32_16x16x32_bf16 v[44:47], v[152:155], a[12:15], v[44:47]
	s_waitcnt lgkmcnt(4)
	v_mfma_f32_16x16x32_bf16 v[68:71], v[132:135], a[12:15], v[68:71]
	v_mfma_f32_16x16x32_bf16 v[88:91], v[132:135], a[92:95], v[88:91]
	s_add_u32 m0, s64, 35840
	s_nop 0
	buffer_load_dwordx4 v4, s[48:51], s63 offen lds
	s_waitcnt lgkmcnt(2)
	v_mfma_f32_16x16x32_bf16 v[108:111], v[136:139], a[12:15], v[108:111]
	v_mfma_f32_16x16x32_bf16 v[128:131], v[136:139], a[92:95], v[128:131]
	s_add_u32 s63, s63, 122880
	s_waitcnt lgkmcnt(0)
	v_mfma_f32_16x16x32_bf16 v[48:51], v[140:143], a[12:15], v[48:51]
	s_waitcnt vmcnt(32)
	s_barrier
	ds_read_b64_tr_b16 v[132:133], v29 offset:5120
	ds_read_b64_tr_b16 v[134:135], v29 offset:6400
	ds_read_b64_tr_b16 v[136:137], v29 offset:10240
	ds_read_b64_tr_b16 v[138:139], v29 offset:11520
	ds_read_b64_tr_b16 v[140:141], v29 offset:0
	ds_read_b64_tr_b16 v[142:143], v29 offset:1280
	ds_read_b64_tr_b16 v[144:145], v29 offset:5128
	ds_read_b64_tr_b16 v[146:147], v29 offset:6408
	ds_read_b64_tr_b16 v[148:149], v29 offset:10248
	ds_read_b64_tr_b16 v[150:151], v29 offset:11528
	ds_read_b64_tr_b16 v[152:153], v29 offset:8
	ds_read_b64_tr_b16 v[154:155], v29 offset:1288
	s_waitcnt lgkmcnt(10)
	v_mfma_f32_16x16x32_bf16 v[52:55], v[132:135], a[16:19], v[52:55]
	v_mfma_f32_16x16x32_bf16 v[72:75], v[132:135], a[96:99], v[72:75]
	s_add_u32 m0, s64, 49152
	s_nop 0
	buffer_load_dwordx4 v1, s[48:51], s63 offen lds
	ds_read_b64_tr_b16 v[132:133], v29 offset:5136
	ds_read_b64_tr_b16 v[134:135], v29 offset:6416
	s_waitcnt lgkmcnt(10)
	v_mfma_f32_16x16x32_bf16 v[92:95], v[136:139], a[16:19], v[92:95]
	v_mfma_f32_16x16x32_bf16 v[112:115], v[136:139], a[96:99], v[112:115]
	ds_read_b64_tr_b16 v[136:137], v29 offset:10256
	ds_read_b64_tr_b16 v[138:139], v29 offset:11536
	s_waitcnt lgkmcnt(10)
	v_mfma_f32_16x16x32_bf16 v[32:35], v[140:143], a[16:19], v[32:35]
	ds_read_b64_tr_b16 v[140:141], v29 offset:16
	ds_read_b64_tr_b16 v[142:143], v29 offset:1296
	s_waitcnt lgkmcnt(10)
	v_mfma_f32_16x16x32_bf16 v[56:59], v[144:147], a[16:19], v[56:59]
	v_mfma_f32_16x16x32_bf16 v[76:79], v[144:147], a[96:99], v[76:79]
	ds_read_b64_tr_b16 v[144:145], v29 offset:5144
	ds_read_b64_tr_b16 v[146:147], v29 offset:6424
	s_waitcnt lgkmcnt(10)
	v_mfma_f32_16x16x32_bf16 v[96:99], v[148:151], a[16:19], v[96:99]
	v_mfma_f32_16x16x32_bf16 v[116:119], v[148:151], a[96:99], v[116:119]
	s_add_u32 m0, s64, 50176
	s_nop 0
	buffer_load_dwordx4 v2, s[48:51], s63 offen lds
	ds_read_b64_tr_b16 v[148:149], v29 offset:10264
	ds_read_b64_tr_b16 v[150:151], v29 offset:11544
	s_waitcnt lgkmcnt(10)
	v_mfma_f32_16x16x32_bf16 v[36:39], v[152:155], a[16:19], v[36:39]
	ds_read_b64_tr_b16 v[152:153], v29 offset:24
	ds_read_b64_tr_b16 v[154:155], v29 offset:1304
	s_waitcnt lgkmcnt(10)
	v_mfma_f32_16x16x32_bf16 v[60:63], v[132:135], a[16:19], v[60:63]
	v_mfma_f32_16x16x32_bf16 v[80:83], v[132:135], a[96:99], v[80:83]
	ds_read_b64_tr_b16 v[132:133], v29 offset:5152
	ds_read_b64_tr_b16 v[134:135], v29 offset:6432
	s_waitcnt lgkmcnt(10)
	v_mfma_f32_16x16x32_bf16 v[100:103], v[136:139], a[16:19], v[100:103]
	v_mfma_f32_16x16x32_bf16 v[120:123], v[136:139], a[96:99], v[120:123]
	ds_read_b64_tr_b16 v[136:137], v29 offset:10272
	ds_read_b64_tr_b16 v[138:139], v29 offset:11552
	s_waitcnt lgkmcnt(10)
	v_mfma_f32_16x16x32_bf16 v[40:43], v[140:143], a[16:19], v[40:43]
	s_add_u32 m0, s64, 51200
	s_nop 0
	buffer_load_dwordx4 v3, s[48:51], s63 offen lds
	ds_read_b64_tr_b16 v[140:141], v29 offset:32
	ds_read_b64_tr_b16 v[142:143], v29 offset:1312
	s_waitcnt lgkmcnt(10)
	v_mfma_f32_16x16x32_bf16 v[64:67], v[144:147], a[16:19], v[64:67]
	v_mfma_f32_16x16x32_bf16 v[84:87], v[144:147], a[96:99], v[84:87]
	s_waitcnt lgkmcnt(8)
	v_mfma_f32_16x16x32_bf16 v[104:107], v[148:151], a[16:19], v[104:107]
	v_mfma_f32_16x16x32_bf16 v[124:127], v[148:151], a[96:99], v[124:127]
	s_waitcnt lgkmcnt(6)
	v_mfma_f32_16x16x32_bf16 v[44:47], v[152:155], a[16:19], v[44:47]
	s_waitcnt lgkmcnt(4)
	v_mfma_f32_16x16x32_bf16 v[68:71], v[132:135], a[16:19], v[68:71]
	v_mfma_f32_16x16x32_bf16 v[88:91], v[132:135], a[96:99], v[88:91]
	s_add_u32 m0, s64, 52224
	s_nop 0
	buffer_load_dwordx4 v4, s[48:51], s63 offen lds
	s_waitcnt lgkmcnt(2)
	v_mfma_f32_16x16x32_bf16 v[108:111], v[136:139], a[16:19], v[108:111]
	v_mfma_f32_16x16x32_bf16 v[128:131], v[136:139], a[96:99], v[128:131]
	s_add_u32 s63, s63, 122880
	s_waitcnt lgkmcnt(0)
	v_mfma_f32_16x16x32_bf16 v[48:51], v[140:143], a[16:19], v[48:51]
	s_waitcnt vmcnt(32)
	s_barrier
	ds_read_b64_tr_b16 v[132:133], v29 offset:21504
	ds_read_b64_tr_b16 v[134:135], v29 offset:22784
	ds_read_b64_tr_b16 v[136:137], v29 offset:26624
	ds_read_b64_tr_b16 v[138:139], v29 offset:27904
	ds_read_b64_tr_b16 v[140:141], v29 offset:16384
	ds_read_b64_tr_b16 v[142:143], v29 offset:17664
	ds_read_b64_tr_b16 v[144:145], v29 offset:21512
	ds_read_b64_tr_b16 v[146:147], v29 offset:22792
	ds_read_b64_tr_b16 v[148:149], v29 offset:26632
	ds_read_b64_tr_b16 v[150:151], v29 offset:27912
	ds_read_b64_tr_b16 v[152:153], v29 offset:16392
	ds_read_b64_tr_b16 v[154:155], v29 offset:17672
	s_waitcnt lgkmcnt(10)
	v_mfma_f32_16x16x32_bf16 v[52:55], v[132:135], a[20:23], v[52:55]
	v_mfma_f32_16x16x32_bf16 v[72:75], v[132:135], a[100:103], v[72:75]
	s_add_u32 m0, s64, 65536
	s_nop 0
	buffer_load_dwordx4 v1, s[48:51], s63 offen lds
	ds_read_b64_tr_b16 v[132:133], v29 offset:21520
	ds_read_b64_tr_b16 v[134:135], v29 offset:22800
	s_waitcnt lgkmcnt(10)
	v_mfma_f32_16x16x32_bf16 v[92:95], v[136:139], a[20:23], v[92:95]
	v_mfma_f32_16x16x32_bf16 v[112:115], v[136:139], a[100:103], v[112:115]
	ds_read_b64_tr_b16 v[136:137], v29 offset:26640
	ds_read_b64_tr_b16 v[138:139], v29 offset:27920
	s_waitcnt lgkmcnt(10)
	v_mfma_f32_16x16x32_bf16 v[32:35], v[140:143], a[20:23], v[32:35]
	ds_read_b64_tr_b16 v[140:141], v29 offset:16400
	ds_read_b64_tr_b16 v[142:143], v29 offset:17680
	s_waitcnt lgkmcnt(10)
	v_mfma_f32_16x16x32_bf16 v[56:59], v[144:147], a[20:23], v[56:59]
	v_mfma_f32_16x16x32_bf16 v[76:79], v[144:147], a[100:103], v[76:79]
	ds_read_b64_tr_b16 v[144:145], v29 offset:21528
	ds_read_b64_tr_b16 v[146:147], v29 offset:22808
	s_waitcnt lgkmcnt(10)
	v_mfma_f32_16x16x32_bf16 v[96:99], v[148:151], a[20:23], v[96:99]
	v_mfma_f32_16x16x32_bf16 v[116:119], v[148:151], a[100:103], v[116:119]
	s_add_u32 m0, s64, 66560
	s_nop 0
	buffer_load_dwordx4 v2, s[48:51], s63 offen lds
	ds_read_b64_tr_b16 v[148:149], v29 offset:26648
	ds_read_b64_tr_b16 v[150:151], v29 offset:27928
	s_waitcnt lgkmcnt(10)
	v_mfma_f32_16x16x32_bf16 v[36:39], v[152:155], a[20:23], v[36:39]
	ds_read_b64_tr_b16 v[152:153], v29 offset:16408
	ds_read_b64_tr_b16 v[154:155], v29 offset:17688
	s_waitcnt lgkmcnt(10)
	v_mfma_f32_16x16x32_bf16 v[60:63], v[132:135], a[20:23], v[60:63]
	v_mfma_f32_16x16x32_bf16 v[80:83], v[132:135], a[100:103], v[80:83]
	ds_read_b64_tr_b16 v[132:133], v29 offset:21536
	ds_read_b64_tr_b16 v[134:135], v29 offset:22816
	s_waitcnt lgkmcnt(10)
	v_mfma_f32_16x16x32_bf16 v[100:103], v[136:139], a[20:23], v[100:103]
	v_mfma_f32_16x16x32_bf16 v[120:123], v[136:139], a[100:103], v[120:123]
	ds_read_b64_tr_b16 v[136:137], v29 offset:26656
	ds_read_b64_tr_b16 v[138:139], v29 offset:27936
	s_waitcnt lgkmcnt(10)
	v_mfma_f32_16x16x32_bf16 v[40:43], v[140:143], a[20:23], v[40:43]
	s_add_u32 m0, s64, 67584
	s_nop 0
	buffer_load_dwordx4 v3, s[48:51], s63 offen lds
	ds_read_b64_tr_b16 v[140:141], v29 offset:16416
	ds_read_b64_tr_b16 v[142:143], v29 offset:17696
	s_waitcnt lgkmcnt(10)
	v_mfma_f32_16x16x32_bf16 v[64:67], v[144:147], a[20:23], v[64:67]
	v_mfma_f32_16x16x32_bf16 v[84:87], v[144:147], a[100:103], v[84:87]
	s_waitcnt lgkmcnt(8)
	v_mfma_f32_16x16x32_bf16 v[104:107], v[148:151], a[20:23], v[104:107]
	v_mfma_f32_16x16x32_bf16 v[124:127], v[148:151], a[100:103], v[124:127]
	s_waitcnt lgkmcnt(6)
	v_mfma_f32_16x16x32_bf16 v[44:47], v[152:155], a[20:23], v[44:47]
	s_waitcnt lgkmcnt(4)
	v_mfma_f32_16x16x32_bf16 v[68:71], v[132:135], a[20:23], v[68:71]
	v_mfma_f32_16x16x32_bf16 v[88:91], v[132:135], a[100:103], v[88:91]
	s_add_u32 m0, s64, 68608
	s_nop 0
	buffer_load_dwordx4 v4, s[48:51], s63 offen lds
	s_waitcnt lgkmcnt(2)
	v_mfma_f32_16x16x32_bf16 v[108:111], v[136:139], a[20:23], v[108:111]
	v_mfma_f32_16x16x32_bf16 v[128:131], v[136:139], a[100:103], v[128:131]
	s_add_u32 s63, s63, 122880
	s_waitcnt lgkmcnt(0)
	v_mfma_f32_16x16x32_bf16 v[48:51], v[140:143], a[20:23], v[48:51]
	s_waitcnt vmcnt(32)
	s_barrier
	ds_read_b64_tr_b16 v[132:133], v29 offset:37888
	ds_read_b64_tr_b16 v[134:135], v29 offset:39168
	ds_read_b64_tr_b16 v[136:137], v29 offset:43008
	ds_read_b64_tr_b16 v[138:139], v29 offset:44288
	ds_read_b64_tr_b16 v[140:141], v29 offset:32768
	ds_read_b64_tr_b16 v[142:143], v29 offset:34048
	ds_read_b64_tr_b16 v[144:145], v29 offset:37896
	ds_read_b64_tr_b16 v[146:147], v29 offset:39176
	ds_read_b64_tr_b16 v[148:149], v29 offset:43016
	ds_read_b64_tr_b16 v[150:151], v29 offset:44296
	ds_read_b64_tr_b16 v[152:153], v29 offset:32776
	ds_read_b64_tr_b16 v[154:155], v29 offset:34056
	s_waitcnt lgkmcnt(10)
	v_mfma_f32_16x16x32_bf16 v[52:55], v[132:135], a[24:27], v[52:55]
	v_mfma_f32_16x16x32_bf16 v[72:75], v[132:135], a[104:107], v[72:75]
	s_add_u32 m0, s64, 81920
	s_nop 0
	buffer_load_dwordx4 v1, s[48:51], s63 offen lds
	ds_read_b64_tr_b16 v[132:133], v29 offset:37904
	ds_read_b64_tr_b16 v[134:135], v29 offset:39184
	s_waitcnt lgkmcnt(10)
	v_mfma_f32_16x16x32_bf16 v[92:95], v[136:139], a[24:27], v[92:95]
	v_mfma_f32_16x16x32_bf16 v[112:115], v[136:139], a[104:107], v[112:115]
	ds_read_b64_tr_b16 v[136:137], v29 offset:43024
	ds_read_b64_tr_b16 v[138:139], v29 offset:44304
	s_waitcnt lgkmcnt(10)
	v_mfma_f32_16x16x32_bf16 v[32:35], v[140:143], a[24:27], v[32:35]
	ds_read_b64_tr_b16 v[140:141], v29 offset:32784
	ds_read_b64_tr_b16 v[142:143], v29 offset:34064
	s_waitcnt lgkmcnt(10)
	v_mfma_f32_16x16x32_bf16 v[56:59], v[144:147], a[24:27], v[56:59]
	v_mfma_f32_16x16x32_bf16 v[76:79], v[144:147], a[104:107], v[76:79]
	ds_read_b64_tr_b16 v[144:145], v29 offset:37912
	ds_read_b64_tr_b16 v[146:147], v29 offset:39192
	s_waitcnt lgkmcnt(10)
	v_mfma_f32_16x16x32_bf16 v[96:99], v[148:151], a[24:27], v[96:99]
	v_mfma_f32_16x16x32_bf16 v[116:119], v[148:151], a[104:107], v[116:119]
	s_add_u32 m0, s64, 82944
	s_nop 0
	buffer_load_dwordx4 v2, s[48:51], s63 offen lds
	ds_read_b64_tr_b16 v[148:149], v29 offset:43032
	ds_read_b64_tr_b16 v[150:151], v29 offset:44312
	s_waitcnt lgkmcnt(10)
	v_mfma_f32_16x16x32_bf16 v[36:39], v[152:155], a[24:27], v[36:39]
	ds_read_b64_tr_b16 v[152:153], v29 offset:32792
	ds_read_b64_tr_b16 v[154:155], v29 offset:34072
	s_waitcnt lgkmcnt(10)
	v_mfma_f32_16x16x32_bf16 v[60:63], v[132:135], a[24:27], v[60:63]
	v_mfma_f32_16x16x32_bf16 v[80:83], v[132:135], a[104:107], v[80:83]
	ds_read_b64_tr_b16 v[132:133], v29 offset:37920
	ds_read_b64_tr_b16 v[134:135], v29 offset:39200
	s_waitcnt lgkmcnt(10)
	v_mfma_f32_16x16x32_bf16 v[100:103], v[136:139], a[24:27], v[100:103]
	v_mfma_f32_16x16x32_bf16 v[120:123], v[136:139], a[104:107], v[120:123]
	ds_read_b64_tr_b16 v[136:137], v29 offset:43040
	ds_read_b64_tr_b16 v[138:139], v29 offset:44320
	s_waitcnt lgkmcnt(10)
	v_mfma_f32_16x16x32_bf16 v[40:43], v[140:143], a[24:27], v[40:43]
	s_add_u32 m0, s64, 83968
	s_nop 0
	buffer_load_dwordx4 v3, s[48:51], s63 offen lds
	ds_read_b64_tr_b16 v[140:141], v29 offset:32800
	ds_read_b64_tr_b16 v[142:143], v29 offset:34080
	s_waitcnt lgkmcnt(10)
	v_mfma_f32_16x16x32_bf16 v[64:67], v[144:147], a[24:27], v[64:67]
	v_mfma_f32_16x16x32_bf16 v[84:87], v[144:147], a[104:107], v[84:87]
	s_waitcnt lgkmcnt(8)
	v_mfma_f32_16x16x32_bf16 v[104:107], v[148:151], a[24:27], v[104:107]
	v_mfma_f32_16x16x32_bf16 v[124:127], v[148:151], a[104:107], v[124:127]
	s_waitcnt lgkmcnt(6)
	v_mfma_f32_16x16x32_bf16 v[44:47], v[152:155], a[24:27], v[44:47]
	s_waitcnt lgkmcnt(4)
	v_mfma_f32_16x16x32_bf16 v[68:71], v[132:135], a[24:27], v[68:71]
	v_mfma_f32_16x16x32_bf16 v[88:91], v[132:135], a[104:107], v[88:91]
	s_add_u32 m0, s64, 84992
	s_nop 0
	buffer_load_dwordx4 v4, s[48:51], s63 offen lds
	s_waitcnt lgkmcnt(2)
	v_mfma_f32_16x16x32_bf16 v[108:111], v[136:139], a[24:27], v[108:111]
	v_mfma_f32_16x16x32_bf16 v[128:131], v[136:139], a[104:107], v[128:131]
	s_add_u32 s63, s63, 122880
	s_waitcnt lgkmcnt(0)
	v_mfma_f32_16x16x32_bf16 v[48:51], v[140:143], a[24:27], v[48:51]
	s_waitcnt vmcnt(32)
	s_barrier
	ds_read_b64_tr_b16 v[132:133], v29 offset:54272
	ds_read_b64_tr_b16 v[134:135], v29 offset:55552
	ds_read_b64_tr_b16 v[136:137], v29 offset:59392
	ds_read_b64_tr_b16 v[138:139], v29 offset:60672
	ds_read_b64_tr_b16 v[140:141], v29 offset:49152
	ds_read_b64_tr_b16 v[142:143], v29 offset:50432
	ds_read_b64_tr_b16 v[144:145], v29 offset:54280
	ds_read_b64_tr_b16 v[146:147], v29 offset:55560
	ds_read_b64_tr_b16 v[148:149], v29 offset:59400
	ds_read_b64_tr_b16 v[150:151], v29 offset:60680
	ds_read_b64_tr_b16 v[152:153], v29 offset:49160
	ds_read_b64_tr_b16 v[154:155], v29 offset:50440
	s_waitcnt lgkmcnt(10)
	v_mfma_f32_16x16x32_bf16 v[52:55], v[132:135], a[28:31], v[52:55]
	v_mfma_f32_16x16x32_bf16 v[72:75], v[132:135], a[108:111], v[72:75]
	s_add_u32 m0, s64, 98304
	s_nop 0
	buffer_load_dwordx4 v1, s[48:51], s63 offen lds
	ds_read_b64_tr_b16 v[132:133], v29 offset:54288
	ds_read_b64_tr_b16 v[134:135], v29 offset:55568
	s_waitcnt lgkmcnt(10)
	v_mfma_f32_16x16x32_bf16 v[92:95], v[136:139], a[28:31], v[92:95]
	v_mfma_f32_16x16x32_bf16 v[112:115], v[136:139], a[108:111], v[112:115]
	ds_read_b64_tr_b16 v[136:137], v29 offset:59408
	ds_read_b64_tr_b16 v[138:139], v29 offset:60688
	s_waitcnt lgkmcnt(10)
	v_mfma_f32_16x16x32_bf16 v[32:35], v[140:143], a[28:31], v[32:35]
	ds_read_b64_tr_b16 v[140:141], v29 offset:49168
	ds_read_b64_tr_b16 v[142:143], v29 offset:50448
	s_waitcnt lgkmcnt(10)
	v_mfma_f32_16x16x32_bf16 v[56:59], v[144:147], a[28:31], v[56:59]
	v_mfma_f32_16x16x32_bf16 v[76:79], v[144:147], a[108:111], v[76:79]
	ds_read_b64_tr_b16 v[144:145], v29 offset:54296
	ds_read_b64_tr_b16 v[146:147], v29 offset:55576
	s_waitcnt lgkmcnt(10)
	v_mfma_f32_16x16x32_bf16 v[96:99], v[148:151], a[28:31], v[96:99]
	v_mfma_f32_16x16x32_bf16 v[116:119], v[148:151], a[108:111], v[116:119]
	s_add_u32 m0, s64, 99328
	s_nop 0
	buffer_load_dwordx4 v2, s[48:51], s63 offen lds
	ds_read_b64_tr_b16 v[148:149], v29 offset:59416
	ds_read_b64_tr_b16 v[150:151], v29 offset:60696
	s_waitcnt lgkmcnt(10)
	v_mfma_f32_16x16x32_bf16 v[36:39], v[152:155], a[28:31], v[36:39]
	ds_read_b64_tr_b16 v[152:153], v29 offset:49176
	ds_read_b64_tr_b16 v[154:155], v29 offset:50456
	s_waitcnt lgkmcnt(10)
	v_mfma_f32_16x16x32_bf16 v[60:63], v[132:135], a[28:31], v[60:63]
	v_mfma_f32_16x16x32_bf16 v[80:83], v[132:135], a[108:111], v[80:83]
	ds_read_b64_tr_b16 v[132:133], v29 offset:54304
	ds_read_b64_tr_b16 v[134:135], v29 offset:55584
	s_waitcnt lgkmcnt(10)
	v_mfma_f32_16x16x32_bf16 v[100:103], v[136:139], a[28:31], v[100:103]
	v_mfma_f32_16x16x32_bf16 v[120:123], v[136:139], a[108:111], v[120:123]
	ds_read_b64_tr_b16 v[136:137], v29 offset:59424
	ds_read_b64_tr_b16 v[138:139], v29 offset:60704
	s_waitcnt lgkmcnt(10)
	v_mfma_f32_16x16x32_bf16 v[40:43], v[140:143], a[28:31], v[40:43]
	s_add_u32 m0, s64, 100352
	s_nop 0
	buffer_load_dwordx4 v3, s[48:51], s63 offen lds
	ds_read_b64_tr_b16 v[140:141], v29 offset:49184
	ds_read_b64_tr_b16 v[142:143], v29 offset:50464
	s_waitcnt lgkmcnt(10)
	v_mfma_f32_16x16x32_bf16 v[64:67], v[144:147], a[28:31], v[64:67]
	v_mfma_f32_16x16x32_bf16 v[84:87], v[144:147], a[108:111], v[84:87]
	s_waitcnt lgkmcnt(8)
	v_mfma_f32_16x16x32_bf16 v[104:107], v[148:151], a[28:31], v[104:107]
	v_mfma_f32_16x16x32_bf16 v[124:127], v[148:151], a[108:111], v[124:127]
	s_waitcnt lgkmcnt(6)
	v_mfma_f32_16x16x32_bf16 v[44:47], v[152:155], a[28:31], v[44:47]
	s_waitcnt lgkmcnt(4)
	v_mfma_f32_16x16x32_bf16 v[68:71], v[132:135], a[28:31], v[68:71]
	v_mfma_f32_16x16x32_bf16 v[88:91], v[132:135], a[108:111], v[88:91]
	s_add_u32 m0, s64, 101376
	s_nop 0
	buffer_load_dwordx4 v4, s[48:51], s63 offen lds
	s_waitcnt lgkmcnt(2)
	v_mfma_f32_16x16x32_bf16 v[108:111], v[136:139], a[28:31], v[108:111]
	v_mfma_f32_16x16x32_bf16 v[128:131], v[136:139], a[108:111], v[128:131]
	s_add_u32 s63, s63, 122880
	s_waitcnt lgkmcnt(0)
	v_mfma_f32_16x16x32_bf16 v[48:51], v[140:143], a[28:31], v[48:51]
	s_waitcnt vmcnt(32)
	s_barrier
	ds_read_b64_tr_b16 v[132:133], v30 offset:5120
	ds_read_b64_tr_b16 v[134:135], v30 offset:6400
	ds_read_b64_tr_b16 v[136:137], v30 offset:10240
	ds_read_b64_tr_b16 v[138:139], v30 offset:11520
	ds_read_b64_tr_b16 v[140:141], v30 offset:0
	ds_read_b64_tr_b16 v[142:143], v30 offset:1280
	ds_read_b64_tr_b16 v[144:145], v30 offset:5128
	ds_read_b64_tr_b16 v[146:147], v30 offset:6408
	ds_read_b64_tr_b16 v[148:149], v30 offset:10248
	ds_read_b64_tr_b16 v[150:151], v30 offset:11528
	ds_read_b64_tr_b16 v[152:153], v30 offset:8
	ds_read_b64_tr_b16 v[154:155], v30 offset:1288
	s_waitcnt lgkmcnt(10)
	v_mfma_f32_16x16x32_bf16 v[52:55], v[132:135], a[32:35], v[52:55]
	v_mfma_f32_16x16x32_bf16 v[72:75], v[132:135], a[112:115], v[72:75]
	s_add_u32 m0, s64, 114688
	s_nop 0
	buffer_load_dwordx4 v1, s[48:51], s63 offen lds
	ds_read_b64_tr_b16 v[132:133], v30 offset:5136
	ds_read_b64_tr_b16 v[134:135], v30 offset:6416
	s_waitcnt lgkmcnt(10)
	v_mfma_f32_16x16x32_bf16 v[92:95], v[136:139], a[32:35], v[92:95]
	v_mfma_f32_16x16x32_bf16 v[112:115], v[136:139], a[112:115], v[112:115]
	ds_read_b64_tr_b16 v[136:137], v30 offset:10256
	ds_read_b64_tr_b16 v[138:139], v30 offset:11536
	s_waitcnt lgkmcnt(10)
	v_mfma_f32_16x16x32_bf16 v[32:35], v[140:143], a[32:35], v[32:35]
	ds_read_b64_tr_b16 v[140:141], v30 offset:16
	ds_read_b64_tr_b16 v[142:143], v30 offset:1296
	s_waitcnt lgkmcnt(10)
	v_mfma_f32_16x16x32_bf16 v[56:59], v[144:147], a[32:35], v[56:59]
	v_mfma_f32_16x16x32_bf16 v[76:79], v[144:147], a[112:115], v[76:79]
	ds_read_b64_tr_b16 v[144:145], v30 offset:5144
	ds_read_b64_tr_b16 v[146:147], v30 offset:6424
	s_waitcnt lgkmcnt(10)
	v_mfma_f32_16x16x32_bf16 v[96:99], v[148:151], a[32:35], v[96:99]
	v_mfma_f32_16x16x32_bf16 v[116:119], v[148:151], a[112:115], v[116:119]
	s_add_u32 m0, s64, 115712
	s_nop 0
	buffer_load_dwordx4 v2, s[48:51], s63 offen lds
	ds_read_b64_tr_b16 v[148:149], v30 offset:10264
	ds_read_b64_tr_b16 v[150:151], v30 offset:11544
	s_waitcnt lgkmcnt(10)
	v_mfma_f32_16x16x32_bf16 v[36:39], v[152:155], a[32:35], v[36:39]
	ds_read_b64_tr_b16 v[152:153], v30 offset:24
	ds_read_b64_tr_b16 v[154:155], v30 offset:1304
	s_waitcnt lgkmcnt(10)
	v_mfma_f32_16x16x32_bf16 v[60:63], v[132:135], a[32:35], v[60:63]
	v_mfma_f32_16x16x32_bf16 v[80:83], v[132:135], a[112:115], v[80:83]
	ds_read_b64_tr_b16 v[132:133], v30 offset:5152
	ds_read_b64_tr_b16 v[134:135], v30 offset:6432
	s_waitcnt lgkmcnt(10)
	v_mfma_f32_16x16x32_bf16 v[100:103], v[136:139], a[32:35], v[100:103]
	v_mfma_f32_16x16x32_bf16 v[120:123], v[136:139], a[112:115], v[120:123]
	ds_read_b64_tr_b16 v[136:137], v30 offset:10272
	ds_read_b64_tr_b16 v[138:139], v30 offset:11552
	s_waitcnt lgkmcnt(10)
	v_mfma_f32_16x16x32_bf16 v[40:43], v[140:143], a[32:35], v[40:43]
	s_add_u32 m0, s64, 116736
	s_nop 0
	buffer_load_dwordx4 v3, s[48:51], s63 offen lds
	ds_read_b64_tr_b16 v[140:141], v30 offset:32
	ds_read_b64_tr_b16 v[142:143], v30 offset:1312
	s_waitcnt lgkmcnt(10)
	v_mfma_f32_16x16x32_bf16 v[64:67], v[144:147], a[32:35], v[64:67]
	v_mfma_f32_16x16x32_bf16 v[84:87], v[144:147], a[112:115], v[84:87]
	s_waitcnt lgkmcnt(8)
	v_mfma_f32_16x16x32_bf16 v[104:107], v[148:151], a[32:35], v[104:107]
	v_mfma_f32_16x16x32_bf16 v[124:127], v[148:151], a[112:115], v[124:127]
	s_waitcnt lgkmcnt(6)
	v_mfma_f32_16x16x32_bf16 v[44:47], v[152:155], a[32:35], v[44:47]
	s_waitcnt lgkmcnt(4)
	v_mfma_f32_16x16x32_bf16 v[68:71], v[132:135], a[32:35], v[68:71]
	v_mfma_f32_16x16x32_bf16 v[88:91], v[132:135], a[112:115], v[88:91]
	s_add_u32 m0, s64, 117760
	s_nop 0
	buffer_load_dwordx4 v4, s[48:51], s63 offen lds
	s_waitcnt lgkmcnt(2)
	v_mfma_f32_16x16x32_bf16 v[108:111], v[136:139], a[32:35], v[108:111]
	v_mfma_f32_16x16x32_bf16 v[128:131], v[136:139], a[112:115], v[128:131]
	s_add_u32 s63, s63, 122880
	s_waitcnt lgkmcnt(0)
	v_mfma_f32_16x16x32_bf16 v[48:51], v[140:143], a[32:35], v[48:51]
	s_waitcnt vmcnt(32)
	s_barrier
	ds_read_b64_tr_b16 v[132:133], v30 offset:21504
	ds_read_b64_tr_b16 v[134:135], v30 offset:22784
	ds_read_b64_tr_b16 v[136:137], v30 offset:26624
	ds_read_b64_tr_b16 v[138:139], v30 offset:27904
	ds_read_b64_tr_b16 v[140:141], v30 offset:16384
	ds_read_b64_tr_b16 v[142:143], v30 offset:17664
	ds_read_b64_tr_b16 v[144:145], v30 offset:21512
	ds_read_b64_tr_b16 v[146:147], v30 offset:22792
	ds_read_b64_tr_b16 v[148:149], v30 offset:26632
	ds_read_b64_tr_b16 v[150:151], v30 offset:27912
	ds_read_b64_tr_b16 v[152:153], v30 offset:16392
	ds_read_b64_tr_b16 v[154:155], v30 offset:17672
	s_waitcnt lgkmcnt(10)
	v_mfma_f32_16x16x32_bf16 v[52:55], v[132:135], a[36:39], v[52:55]
	v_mfma_f32_16x16x32_bf16 v[72:75], v[132:135], a[116:119], v[72:75]
	s_add_u32 m0, s64, 131072
	s_nop 0
	buffer_load_dwordx4 v1, s[48:51], s63 offen lds
	ds_read_b64_tr_b16 v[132:133], v30 offset:21520
	ds_read_b64_tr_b16 v[134:135], v30 offset:22800
	s_waitcnt lgkmcnt(10)
	v_mfma_f32_16x16x32_bf16 v[92:95], v[136:139], a[36:39], v[92:95]
	v_mfma_f32_16x16x32_bf16 v[112:115], v[136:139], a[116:119], v[112:115]
	ds_read_b64_tr_b16 v[136:137], v30 offset:26640
	ds_read_b64_tr_b16 v[138:139], v30 offset:27920
	s_waitcnt lgkmcnt(10)
	v_mfma_f32_16x16x32_bf16 v[32:35], v[140:143], a[36:39], v[32:35]
	ds_read_b64_tr_b16 v[140:141], v30 offset:16400
	ds_read_b64_tr_b16 v[142:143], v30 offset:17680
	s_waitcnt lgkmcnt(10)
	v_mfma_f32_16x16x32_bf16 v[56:59], v[144:147], a[36:39], v[56:59]
	v_mfma_f32_16x16x32_bf16 v[76:79], v[144:147], a[116:119], v[76:79]
	ds_read_b64_tr_b16 v[144:145], v30 offset:21528
	ds_read_b64_tr_b16 v[146:147], v30 offset:22808
	s_waitcnt lgkmcnt(10)
	v_mfma_f32_16x16x32_bf16 v[96:99], v[148:151], a[36:39], v[96:99]
	v_mfma_f32_16x16x32_bf16 v[116:119], v[148:151], a[116:119], v[116:119]
	s_add_u32 m0, s64, 132096
	s_nop 0
	buffer_load_dwordx4 v2, s[48:51], s63 offen lds
	ds_read_b64_tr_b16 v[148:149], v30 offset:26648
	ds_read_b64_tr_b16 v[150:151], v30 offset:27928
	s_waitcnt lgkmcnt(10)
	v_mfma_f32_16x16x32_bf16 v[36:39], v[152:155], a[36:39], v[36:39]
	ds_read_b64_tr_b16 v[152:153], v30 offset:16408
	ds_read_b64_tr_b16 v[154:155], v30 offset:17688
	s_waitcnt lgkmcnt(10)
	v_mfma_f32_16x16x32_bf16 v[60:63], v[132:135], a[36:39], v[60:63]
	v_mfma_f32_16x16x32_bf16 v[80:83], v[132:135], a[116:119], v[80:83]
	ds_read_b64_tr_b16 v[132:133], v30 offset:21536
	ds_read_b64_tr_b16 v[134:135], v30 offset:22816
	s_waitcnt lgkmcnt(10)
	v_mfma_f32_16x16x32_bf16 v[100:103], v[136:139], a[36:39], v[100:103]
	v_mfma_f32_16x16x32_bf16 v[120:123], v[136:139], a[116:119], v[120:123]
	ds_read_b64_tr_b16 v[136:137], v30 offset:26656
	ds_read_b64_tr_b16 v[138:139], v30 offset:27936
	s_waitcnt lgkmcnt(10)
	v_mfma_f32_16x16x32_bf16 v[40:43], v[140:143], a[36:39], v[40:43]
	s_add_u32 m0, s64, 133120
	s_nop 0
	buffer_load_dwordx4 v3, s[48:51], s63 offen lds
	ds_read_b64_tr_b16 v[140:141], v30 offset:16416
	ds_read_b64_tr_b16 v[142:143], v30 offset:17696
	s_waitcnt lgkmcnt(10)
	v_mfma_f32_16x16x32_bf16 v[64:67], v[144:147], a[36:39], v[64:67]
	v_mfma_f32_16x16x32_bf16 v[84:87], v[144:147], a[116:119], v[84:87]
	s_waitcnt lgkmcnt(8)
	v_mfma_f32_16x16x32_bf16 v[104:107], v[148:151], a[36:39], v[104:107]
	v_mfma_f32_16x16x32_bf16 v[124:127], v[148:151], a[116:119], v[124:127]
	s_waitcnt lgkmcnt(6)
	v_mfma_f32_16x16x32_bf16 v[44:47], v[152:155], a[36:39], v[44:47]
	s_waitcnt lgkmcnt(4)
	v_mfma_f32_16x16x32_bf16 v[68:71], v[132:135], a[36:39], v[68:71]
	v_mfma_f32_16x16x32_bf16 v[88:91], v[132:135], a[116:119], v[88:91]
	s_add_u32 m0, s64, 134144
	s_nop 0
	buffer_load_dwordx4 v4, s[48:51], s63 offen lds
	s_waitcnt lgkmcnt(2)
	v_mfma_f32_16x16x32_bf16 v[108:111], v[136:139], a[36:39], v[108:111]
	v_mfma_f32_16x16x32_bf16 v[128:131], v[136:139], a[116:119], v[128:131]
	s_add_u32 s63, s63, 122880
	s_waitcnt lgkmcnt(0)
	v_mfma_f32_16x16x32_bf16 v[48:51], v[140:143], a[36:39], v[48:51]
	s_waitcnt vmcnt(32)
	s_barrier
	ds_read_b64_tr_b16 v[132:133], v28 offset:5120
	ds_read_b64_tr_b16 v[134:135], v28 offset:6400
	ds_read_b64_tr_b16 v[136:137], v28 offset:10240
	ds_read_b64_tr_b16 v[138:139], v28 offset:11520
	ds_read_b64_tr_b16 v[140:141], v28 offset:0
	ds_read_b64_tr_b16 v[142:143], v28 offset:1280
	ds_read_b64_tr_b16 v[144:145], v28 offset:5128
	ds_read_b64_tr_b16 v[146:147], v28 offset:6408
	ds_read_b64_tr_b16 v[148:149], v28 offset:10248
	ds_read_b64_tr_b16 v[150:151], v28 offset:11528
	ds_read_b64_tr_b16 v[152:153], v28 offset:8
	ds_read_b64_tr_b16 v[154:155], v28 offset:1288
	s_waitcnt lgkmcnt(10)
	v_mfma_f32_16x16x32_bf16 v[52:55], v[132:135], a[40:43], v[52:55]
	v_mfma_f32_16x16x32_bf16 v[72:75], v[132:135], a[120:123], v[72:75]
	s_add_u32 m0, s64, 147456
	s_nop 0
	buffer_load_dwordx4 v1, s[48:51], s63 offen lds
	ds_read_b64_tr_b16 v[132:133], v28 offset:5136
	ds_read_b64_tr_b16 v[134:135], v28 offset:6416
	s_waitcnt lgkmcnt(10)
	v_mfma_f32_16x16x32_bf16 v[92:95], v[136:139], a[40:43], v[92:95]
	v_mfma_f32_16x16x32_bf16 v[112:115], v[136:139], a[120:123], v[112:115]
	ds_read_b64_tr_b16 v[136:137], v28 offset:10256
	ds_read_b64_tr_b16 v[138:139], v28 offset:11536
	s_waitcnt lgkmcnt(10)
	v_mfma_f32_16x16x32_bf16 v[32:35], v[140:143], a[40:43], v[32:35]
	ds_read_b64_tr_b16 v[140:141], v28 offset:16
	ds_read_b64_tr_b16 v[142:143], v28 offset:1296
	s_waitcnt lgkmcnt(10)
	v_mfma_f32_16x16x32_bf16 v[56:59], v[144:147], a[40:43], v[56:59]
	v_mfma_f32_16x16x32_bf16 v[76:79], v[144:147], a[120:123], v[76:79]
	ds_read_b64_tr_b16 v[144:145], v28 offset:5144
	ds_read_b64_tr_b16 v[146:147], v28 offset:6424
	s_waitcnt lgkmcnt(10)
	v_mfma_f32_16x16x32_bf16 v[96:99], v[148:151], a[40:43], v[96:99]
	v_mfma_f32_16x16x32_bf16 v[116:119], v[148:151], a[120:123], v[116:119]
	s_add_u32 m0, s64, 148480
	s_nop 0
	buffer_load_dwordx4 v2, s[48:51], s63 offen lds
	ds_read_b64_tr_b16 v[148:149], v28 offset:10264
	ds_read_b64_tr_b16 v[150:151], v28 offset:11544
	s_waitcnt lgkmcnt(10)
	v_mfma_f32_16x16x32_bf16 v[36:39], v[152:155], a[40:43], v[36:39]
	ds_read_b64_tr_b16 v[152:153], v28 offset:24
	ds_read_b64_tr_b16 v[154:155], v28 offset:1304
	s_waitcnt lgkmcnt(10)
	v_mfma_f32_16x16x32_bf16 v[60:63], v[132:135], a[40:43], v[60:63]
	v_mfma_f32_16x16x32_bf16 v[80:83], v[132:135], a[120:123], v[80:83]
	ds_read_b64_tr_b16 v[132:133], v28 offset:5152
	ds_read_b64_tr_b16 v[134:135], v28 offset:6432
	s_waitcnt lgkmcnt(10)
	v_mfma_f32_16x16x32_bf16 v[100:103], v[136:139], a[40:43], v[100:103]
	v_mfma_f32_16x16x32_bf16 v[120:123], v[136:139], a[120:123], v[120:123]
	ds_read_b64_tr_b16 v[136:137], v28 offset:10272
	ds_read_b64_tr_b16 v[138:139], v28 offset:11552
	s_waitcnt lgkmcnt(10)
	v_mfma_f32_16x16x32_bf16 v[40:43], v[140:143], a[40:43], v[40:43]
	s_add_u32 m0, s64, 149504
	s_nop 0
	buffer_load_dwordx4 v3, s[48:51], s63 offen lds
	ds_read_b64_tr_b16 v[140:141], v28 offset:32
	ds_read_b64_tr_b16 v[142:143], v28 offset:1312
	s_waitcnt lgkmcnt(10)
	v_mfma_f32_16x16x32_bf16 v[64:67], v[144:147], a[40:43], v[64:67]
	v_mfma_f32_16x16x32_bf16 v[84:87], v[144:147], a[120:123], v[84:87]
	s_waitcnt lgkmcnt(8)
	v_mfma_f32_16x16x32_bf16 v[104:107], v[148:151], a[40:43], v[104:107]
	v_mfma_f32_16x16x32_bf16 v[124:127], v[148:151], a[120:123], v[124:127]
	s_waitcnt lgkmcnt(6)
	v_mfma_f32_16x16x32_bf16 v[44:47], v[152:155], a[40:43], v[44:47]
	s_waitcnt lgkmcnt(4)
	v_mfma_f32_16x16x32_bf16 v[68:71], v[132:135], a[40:43], v[68:71]
	v_mfma_f32_16x16x32_bf16 v[88:91], v[132:135], a[120:123], v[88:91]
	s_add_u32 m0, s64, 150528
	s_nop 0
	buffer_load_dwordx4 v4, s[48:51], s63 offen lds
	s_waitcnt lgkmcnt(2)
	v_mfma_f32_16x16x32_bf16 v[108:111], v[136:139], a[40:43], v[108:111]
	v_mfma_f32_16x16x32_bf16 v[128:131], v[136:139], a[120:123], v[128:131]
	s_sub_u32 s63, s63, 2334560
	s_waitcnt lgkmcnt(0)
	v_mfma_f32_16x16x32_bf16 v[48:51], v[140:143], a[40:43], v[48:51]
	s_waitcnt vmcnt(32)
	s_barrier
	ds_read_b64_tr_b16 v[132:133], v28 offset:21504
	ds_read_b64_tr_b16 v[134:135], v28 offset:22784
	ds_read_b64_tr_b16 v[136:137], v28 offset:26624
	ds_read_b64_tr_b16 v[138:139], v28 offset:27904
	ds_read_b64_tr_b16 v[140:141], v28 offset:16384
	ds_read_b64_tr_b16 v[142:143], v28 offset:17664
	ds_read_b64_tr_b16 v[144:145], v28 offset:21512
	ds_read_b64_tr_b16 v[146:147], v28 offset:22792
	ds_read_b64_tr_b16 v[148:149], v28 offset:26632
	ds_read_b64_tr_b16 v[150:151], v28 offset:27912
	ds_read_b64_tr_b16 v[152:153], v28 offset:16392
	ds_read_b64_tr_b16 v[154:155], v28 offset:17672
	s_waitcnt lgkmcnt(10)
	v_mfma_f32_16x16x32_bf16 v[52:55], v[132:135], a[44:47], v[52:55]
	v_mfma_f32_16x16x32_bf16 v[72:75], v[132:135], a[124:127], v[72:75]
	s_add_u32 m0, s64, 0
	s_nop 0
	buffer_load_dwordx4 v1, s[48:51], s63 offen lds
	ds_read_b64_tr_b16 v[132:133], v28 offset:21520
	ds_read_b64_tr_b16 v[134:135], v28 offset:22800
	s_waitcnt lgkmcnt(10)
	v_mfma_f32_16x16x32_bf16 v[92:95], v[136:139], a[44:47], v[92:95]
	v_mfma_f32_16x16x32_bf16 v[112:115], v[136:139], a[124:127], v[112:115]
	ds_read_b64_tr_b16 v[136:137], v28 offset:26640
	ds_read_b64_tr_b16 v[138:139], v28 offset:27920
	s_waitcnt lgkmcnt(10)
	v_mfma_f32_16x16x32_bf16 v[32:35], v[140:143], a[44:47], v[32:35]
	ds_read_b64_tr_b16 v[140:141], v28 offset:16400
	ds_read_b64_tr_b16 v[142:143], v28 offset:17680
	s_waitcnt lgkmcnt(10)
	v_mfma_f32_16x16x32_bf16 v[56:59], v[144:147], a[44:47], v[56:59]
	v_mfma_f32_16x16x32_bf16 v[76:79], v[144:147], a[124:127], v[76:79]
	ds_read_b64_tr_b16 v[144:145], v28 offset:21528
	ds_read_b64_tr_b16 v[146:147], v28 offset:22808
	s_waitcnt lgkmcnt(10)
	v_mfma_f32_16x16x32_bf16 v[96:99], v[148:151], a[44:47], v[96:99]
	v_mfma_f32_16x16x32_bf16 v[116:119], v[148:151], a[124:127], v[116:119]
	s_add_u32 m0, s64, 1024
	s_nop 0
	buffer_load_dwordx4 v2, s[48:51], s63 offen lds
	ds_read_b64_tr_b16 v[148:149], v28 offset:26648
	ds_read_b64_tr_b16 v[150:151], v28 offset:27928
	s_waitcnt lgkmcnt(10)
	v_mfma_f32_16x16x32_bf16 v[36:39], v[152:155], a[44:47], v[36:39]
	ds_read_b64_tr_b16 v[152:153], v28 offset:16408
	ds_read_b64_tr_b16 v[154:155], v28 offset:17688
	s_waitcnt lgkmcnt(10)
	v_mfma_f32_16x16x32_bf16 v[60:63], v[132:135], a[44:47], v[60:63]
	v_mfma_f32_16x16x32_bf16 v[80:83], v[132:135], a[124:127], v[80:83]
	ds_read_b64_tr_b16 v[132:133], v28 offset:21536
	ds_read_b64_tr_b16 v[134:135], v28 offset:22816
	s_waitcnt lgkmcnt(10)
	v_mfma_f32_16x16x32_bf16 v[100:103], v[136:139], a[44:47], v[100:103]
	v_mfma_f32_16x16x32_bf16 v[120:123], v[136:139], a[124:127], v[120:123]
	ds_read_b64_tr_b16 v[136:137], v28 offset:26656
	ds_read_b64_tr_b16 v[138:139], v28 offset:27936
	s_waitcnt lgkmcnt(10)
	v_mfma_f32_16x16x32_bf16 v[40:43], v[140:143], a[44:47], v[40:43]
	s_add_u32 m0, s64, 2048
	s_nop 0
	buffer_load_dwordx4 v3, s[48:51], s63 offen lds
	ds_read_b64_tr_b16 v[140:141], v28 offset:16416
	ds_read_b64_tr_b16 v[142:143], v28 offset:17696
	s_waitcnt lgkmcnt(10)
	v_mfma_f32_16x16x32_bf16 v[64:67], v[144:147], a[44:47], v[64:67]
	v_mfma_f32_16x16x32_bf16 v[84:87], v[144:147], a[124:127], v[84:87]
	s_waitcnt lgkmcnt(8)
	v_mfma_f32_16x16x32_bf16 v[104:107], v[148:151], a[44:47], v[104:107]
	v_mfma_f32_16x16x32_bf16 v[124:127], v[148:151], a[124:127], v[124:127]
	s_waitcnt lgkmcnt(6)
	v_mfma_f32_16x16x32_bf16 v[44:47], v[152:155], a[44:47], v[44:47]
	s_waitcnt lgkmcnt(4)
	v_mfma_f32_16x16x32_bf16 v[68:71], v[132:135], a[44:47], v[68:71]
	v_mfma_f32_16x16x32_bf16 v[88:91], v[132:135], a[124:127], v[88:91]
	s_add_u32 m0, s64, 3072
	s_nop 0
	buffer_load_dwordx4 v4, s[48:51], s63 offen lds
	s_waitcnt lgkmcnt(2)
	v_mfma_f32_16x16x32_bf16 v[108:111], v[136:139], a[44:47], v[108:111]
	v_mfma_f32_16x16x32_bf16 v[128:131], v[136:139], a[124:127], v[128:131]
	s_add_u32 s63, s63, 122880
	s_waitcnt lgkmcnt(0)
	v_mfma_f32_16x16x32_bf16 v[48:51], v[140:143], a[44:47], v[48:51]
	s_waitcnt vmcnt(32)
	s_barrier
	ds_read_b64_tr_b16 v[132:133], v28 offset:37888
	ds_read_b64_tr_b16 v[134:135], v28 offset:39168
	ds_read_b64_tr_b16 v[136:137], v28 offset:43008
	ds_read_b64_tr_b16 v[138:139], v28 offset:44288
	ds_read_b64_tr_b16 v[140:141], v28 offset:32768
	ds_read_b64_tr_b16 v[142:143], v28 offset:34048
	ds_read_b64_tr_b16 v[144:145], v28 offset:37896
	ds_read_b64_tr_b16 v[146:147], v28 offset:39176
	ds_read_b64_tr_b16 v[148:149], v28 offset:43016
	ds_read_b64_tr_b16 v[150:151], v28 offset:44296
	ds_read_b64_tr_b16 v[152:153], v28 offset:32776
	ds_read_b64_tr_b16 v[154:155], v28 offset:34056
	s_waitcnt lgkmcnt(10)
	v_mfma_f32_16x16x32_bf16 v[52:55], v[132:135], a[48:51], v[52:55]
	v_mfma_f32_16x16x32_bf16 v[72:75], v[132:135], a[128:131], v[72:75]
	s_add_u32 m0, s64, 16384
	s_nop 0
	buffer_load_dwordx4 v1, s[48:51], s63 offen lds
	ds_read_b64_tr_b16 v[132:133], v28 offset:37904
	ds_read_b64_tr_b16 v[134:135], v28 offset:39184
	s_waitcnt lgkmcnt(10)
	v_mfma_f32_16x16x32_bf16 v[92:95], v[136:139], a[48:51], v[92:95]
	v_mfma_f32_16x16x32_bf16 v[112:115], v[136:139], a[128:131], v[112:115]
	ds_read_b64_tr_b16 v[136:137], v28 offset:43024
	ds_read_b64_tr_b16 v[138:139], v28 offset:44304
	s_waitcnt lgkmcnt(10)
	v_mfma_f32_16x16x32_bf16 v[32:35], v[140:143], a[48:51], v[32:35]
	ds_read_b64_tr_b16 v[140:141], v28 offset:32784
	ds_read_b64_tr_b16 v[142:143], v28 offset:34064
	s_waitcnt lgkmcnt(10)
	v_mfma_f32_16x16x32_bf16 v[56:59], v[144:147], a[48:51], v[56:59]
	v_mfma_f32_16x16x32_bf16 v[76:79], v[144:147], a[128:131], v[76:79]
	ds_read_b64_tr_b16 v[144:145], v28 offset:37912
	ds_read_b64_tr_b16 v[146:147], v28 offset:39192
	s_waitcnt lgkmcnt(10)
	v_mfma_f32_16x16x32_bf16 v[96:99], v[148:151], a[48:51], v[96:99]
	v_mfma_f32_16x16x32_bf16 v[116:119], v[148:151], a[128:131], v[116:119]
	s_add_u32 m0, s64, 17408
	s_nop 0
	buffer_load_dwordx4 v2, s[48:51], s63 offen lds
	ds_read_b64_tr_b16 v[148:149], v28 offset:43032
	ds_read_b64_tr_b16 v[150:151], v28 offset:44312
	s_waitcnt lgkmcnt(10)
	v_mfma_f32_16x16x32_bf16 v[36:39], v[152:155], a[48:51], v[36:39]
	ds_read_b64_tr_b16 v[152:153], v28 offset:32792
	ds_read_b64_tr_b16 v[154:155], v28 offset:34072
	s_waitcnt lgkmcnt(10)
	v_mfma_f32_16x16x32_bf16 v[60:63], v[132:135], a[48:51], v[60:63]
	v_mfma_f32_16x16x32_bf16 v[80:83], v[132:135], a[128:131], v[80:83]
	ds_read_b64_tr_b16 v[132:133], v28 offset:37920
	ds_read_b64_tr_b16 v[134:135], v28 offset:39200
	s_waitcnt lgkmcnt(10)
	v_mfma_f32_16x16x32_bf16 v[100:103], v[136:139], a[48:51], v[100:103]
	v_mfma_f32_16x16x32_bf16 v[120:123], v[136:139], a[128:131], v[120:123]
	ds_read_b64_tr_b16 v[136:137], v28 offset:43040
	ds_read_b64_tr_b16 v[138:139], v28 offset:44320
	s_waitcnt lgkmcnt(10)
	v_mfma_f32_16x16x32_bf16 v[40:43], v[140:143], a[48:51], v[40:43]
	s_add_u32 m0, s64, 18432
	s_nop 0
	buffer_load_dwordx4 v3, s[48:51], s63 offen lds
	ds_read_b64_tr_b16 v[140:141], v28 offset:32800
	ds_read_b64_tr_b16 v[142:143], v28 offset:34080
	s_waitcnt lgkmcnt(10)
	v_mfma_f32_16x16x32_bf16 v[64:67], v[144:147], a[48:51], v[64:67]
	v_mfma_f32_16x16x32_bf16 v[84:87], v[144:147], a[128:131], v[84:87]
	s_waitcnt lgkmcnt(8)
	v_mfma_f32_16x16x32_bf16 v[104:107], v[148:151], a[48:51], v[104:107]
	v_mfma_f32_16x16x32_bf16 v[124:127], v[148:151], a[128:131], v[124:127]
	s_waitcnt lgkmcnt(6)
	v_mfma_f32_16x16x32_bf16 v[44:47], v[152:155], a[48:51], v[44:47]
	s_waitcnt lgkmcnt(4)
	v_mfma_f32_16x16x32_bf16 v[68:71], v[132:135], a[48:51], v[68:71]
	v_mfma_f32_16x16x32_bf16 v[88:91], v[132:135], a[128:131], v[88:91]
	s_add_u32 m0, s64, 19456
	s_nop 0
	buffer_load_dwordx4 v4, s[48:51], s63 offen lds
	s_waitcnt lgkmcnt(2)
	v_mfma_f32_16x16x32_bf16 v[108:111], v[136:139], a[48:51], v[108:111]
	v_mfma_f32_16x16x32_bf16 v[128:131], v[136:139], a[128:131], v[128:131]
	s_add_u32 s63, s63, 122880
	s_waitcnt lgkmcnt(0)
	v_mfma_f32_16x16x32_bf16 v[48:51], v[140:143], a[48:51], v[48:51]
	s_waitcnt vmcnt(32)
	s_barrier
	ds_read_b64_tr_b16 v[132:133], v28 offset:54272
	ds_read_b64_tr_b16 v[134:135], v28 offset:55552
	ds_read_b64_tr_b16 v[136:137], v28 offset:59392
	ds_read_b64_tr_b16 v[138:139], v28 offset:60672
	ds_read_b64_tr_b16 v[140:141], v28 offset:49152
	ds_read_b64_tr_b16 v[142:143], v28 offset:50432
	ds_read_b64_tr_b16 v[144:145], v28 offset:54280
	ds_read_b64_tr_b16 v[146:147], v28 offset:55560
	ds_read_b64_tr_b16 v[148:149], v28 offset:59400
	ds_read_b64_tr_b16 v[150:151], v28 offset:60680
	ds_read_b64_tr_b16 v[152:153], v28 offset:49160
	ds_read_b64_tr_b16 v[154:155], v28 offset:50440
	s_waitcnt lgkmcnt(10)
	v_mfma_f32_16x16x32_bf16 v[52:55], v[132:135], a[52:55], v[52:55]
	v_mfma_f32_16x16x32_bf16 v[72:75], v[132:135], a[132:135], v[72:75]
	s_add_u32 m0, s64, 32768
	s_nop 0
	buffer_load_dwordx4 v1, s[48:51], s63 offen lds
	ds_read_b64_tr_b16 v[132:133], v28 offset:54288
	ds_read_b64_tr_b16 v[134:135], v28 offset:55568
	s_waitcnt lgkmcnt(10)
	v_mfma_f32_16x16x32_bf16 v[92:95], v[136:139], a[52:55], v[92:95]
	v_mfma_f32_16x16x32_bf16 v[112:115], v[136:139], a[132:135], v[112:115]
	ds_read_b64_tr_b16 v[136:137], v28 offset:59408
	ds_read_b64_tr_b16 v[138:139], v28 offset:60688
	s_waitcnt lgkmcnt(10)
	v_mfma_f32_16x16x32_bf16 v[32:35], v[140:143], a[52:55], v[32:35]
	ds_read_b64_tr_b16 v[140:141], v28 offset:49168
	ds_read_b64_tr_b16 v[142:143], v28 offset:50448
	s_waitcnt lgkmcnt(10)
	v_mfma_f32_16x16x32_bf16 v[56:59], v[144:147], a[52:55], v[56:59]
	v_mfma_f32_16x16x32_bf16 v[76:79], v[144:147], a[132:135], v[76:79]
	ds_read_b64_tr_b16 v[144:145], v28 offset:54296
	ds_read_b64_tr_b16 v[146:147], v28 offset:55576
	s_waitcnt lgkmcnt(10)
	v_mfma_f32_16x16x32_bf16 v[96:99], v[148:151], a[52:55], v[96:99]
	v_mfma_f32_16x16x32_bf16 v[116:119], v[148:151], a[132:135], v[116:119]
	s_add_u32 m0, s64, 33792
	s_nop 0
	buffer_load_dwordx4 v2, s[48:51], s63 offen lds
	ds_read_b64_tr_b16 v[148:149], v28 offset:59416
	ds_read_b64_tr_b16 v[150:151], v28 offset:60696
	s_waitcnt lgkmcnt(10)
	v_mfma_f32_16x16x32_bf16 v[36:39], v[152:155], a[52:55], v[36:39]
	ds_read_b64_tr_b16 v[152:153], v28 offset:49176
	ds_read_b64_tr_b16 v[154:155], v28 offset:50456
	s_waitcnt lgkmcnt(10)
	v_mfma_f32_16x16x32_bf16 v[60:63], v[132:135], a[52:55], v[60:63]
	v_mfma_f32_16x16x32_bf16 v[80:83], v[132:135], a[132:135], v[80:83]
	ds_read_b64_tr_b16 v[132:133], v28 offset:54304
	ds_read_b64_tr_b16 v[134:135], v28 offset:55584
	s_waitcnt lgkmcnt(10)
	v_mfma_f32_16x16x32_bf16 v[100:103], v[136:139], a[52:55], v[100:103]
	v_mfma_f32_16x16x32_bf16 v[120:123], v[136:139], a[132:135], v[120:123]
	ds_read_b64_tr_b16 v[136:137], v28 offset:59424
	ds_read_b64_tr_b16 v[138:139], v28 offset:60704
	s_waitcnt lgkmcnt(10)
	v_mfma_f32_16x16x32_bf16 v[40:43], v[140:143], a[52:55], v[40:43]
	s_add_u32 m0, s64, 34816
	s_nop 0
	buffer_load_dwordx4 v3, s[48:51], s63 offen lds
	ds_read_b64_tr_b16 v[140:141], v28 offset:49184
	ds_read_b64_tr_b16 v[142:143], v28 offset:50464
	s_waitcnt lgkmcnt(10)
	v_mfma_f32_16x16x32_bf16 v[64:67], v[144:147], a[52:55], v[64:67]
	v_mfma_f32_16x16x32_bf16 v[84:87], v[144:147], a[132:135], v[84:87]
	s_waitcnt lgkmcnt(8)
	v_mfma_f32_16x16x32_bf16 v[104:107], v[148:151], a[52:55], v[104:107]
	v_mfma_f32_16x16x32_bf16 v[124:127], v[148:151], a[132:135], v[124:127]
	s_waitcnt lgkmcnt(6)
	v_mfma_f32_16x16x32_bf16 v[44:47], v[152:155], a[52:55], v[44:47]
	s_waitcnt lgkmcnt(4)
	v_mfma_f32_16x16x32_bf16 v[68:71], v[132:135], a[52:55], v[68:71]
	v_mfma_f32_16x16x32_bf16 v[88:91], v[132:135], a[132:135], v[88:91]
	s_add_u32 m0, s64, 35840
	s_nop 0
	buffer_load_dwordx4 v4, s[48:51], s63 offen lds
	s_waitcnt lgkmcnt(2)
	v_mfma_f32_16x16x32_bf16 v[108:111], v[136:139], a[52:55], v[108:111]
	v_mfma_f32_16x16x32_bf16 v[128:131], v[136:139], a[132:135], v[128:131]
	s_add_u32 s63, s63, 122880
	s_waitcnt lgkmcnt(0)
	v_mfma_f32_16x16x32_bf16 v[48:51], v[140:143], a[52:55], v[48:51]
	s_waitcnt vmcnt(32)
	s_barrier
	ds_read_b64_tr_b16 v[132:133], v29 offset:5120
	ds_read_b64_tr_b16 v[134:135], v29 offset:6400
	ds_read_b64_tr_b16 v[136:137], v29 offset:10240
	ds_read_b64_tr_b16 v[138:139], v29 offset:11520
	ds_read_b64_tr_b16 v[140:141], v29 offset:0
	ds_read_b64_tr_b16 v[142:143], v29 offset:1280
	ds_read_b64_tr_b16 v[144:145], v29 offset:5128
	ds_read_b64_tr_b16 v[146:147], v29 offset:6408
	ds_read_b64_tr_b16 v[148:149], v29 offset:10248
	ds_read_b64_tr_b16 v[150:151], v29 offset:11528
	ds_read_b64_tr_b16 v[152:153], v29 offset:8
	ds_read_b64_tr_b16 v[154:155], v29 offset:1288
	s_waitcnt lgkmcnt(10)
	v_mfma_f32_16x16x32_bf16 v[52:55], v[132:135], a[56:59], v[52:55]
	v_mfma_f32_16x16x32_bf16 v[72:75], v[132:135], a[136:139], v[72:75]
	s_add_u32 m0, s64, 49152
	s_nop 0
	buffer_load_dwordx4 v1, s[48:51], s63 offen lds
	ds_read_b64_tr_b16 v[132:133], v29 offset:5136
	ds_read_b64_tr_b16 v[134:135], v29 offset:6416
	s_waitcnt lgkmcnt(10)
	v_mfma_f32_16x16x32_bf16 v[92:95], v[136:139], a[56:59], v[92:95]
	v_mfma_f32_16x16x32_bf16 v[112:115], v[136:139], a[136:139], v[112:115]
	ds_read_b64_tr_b16 v[136:137], v29 offset:10256
	ds_read_b64_tr_b16 v[138:139], v29 offset:11536
	s_waitcnt lgkmcnt(10)
	v_mfma_f32_16x16x32_bf16 v[32:35], v[140:143], a[56:59], v[32:35]
	ds_read_b64_tr_b16 v[140:141], v29 offset:16
	ds_read_b64_tr_b16 v[142:143], v29 offset:1296
	s_waitcnt lgkmcnt(10)
	v_mfma_f32_16x16x32_bf16 v[56:59], v[144:147], a[56:59], v[56:59]
	v_mfma_f32_16x16x32_bf16 v[76:79], v[144:147], a[136:139], v[76:79]
	ds_read_b64_tr_b16 v[144:145], v29 offset:5144
	ds_read_b64_tr_b16 v[146:147], v29 offset:6424
	s_waitcnt lgkmcnt(10)
	v_mfma_f32_16x16x32_bf16 v[96:99], v[148:151], a[56:59], v[96:99]
	v_mfma_f32_16x16x32_bf16 v[116:119], v[148:151], a[136:139], v[116:119]
	s_add_u32 m0, s64, 50176
	s_nop 0
	buffer_load_dwordx4 v2, s[48:51], s63 offen lds
	ds_read_b64_tr_b16 v[148:149], v29 offset:10264
	ds_read_b64_tr_b16 v[150:151], v29 offset:11544
	s_waitcnt lgkmcnt(10)
	v_mfma_f32_16x16x32_bf16 v[36:39], v[152:155], a[56:59], v[36:39]
	ds_read_b64_tr_b16 v[152:153], v29 offset:24
	ds_read_b64_tr_b16 v[154:155], v29 offset:1304
	s_waitcnt lgkmcnt(10)
	v_mfma_f32_16x16x32_bf16 v[60:63], v[132:135], a[56:59], v[60:63]
	v_mfma_f32_16x16x32_bf16 v[80:83], v[132:135], a[136:139], v[80:83]
	ds_read_b64_tr_b16 v[132:133], v29 offset:5152
	ds_read_b64_tr_b16 v[134:135], v29 offset:6432
	s_waitcnt lgkmcnt(10)
	v_mfma_f32_16x16x32_bf16 v[100:103], v[136:139], a[56:59], v[100:103]
	v_mfma_f32_16x16x32_bf16 v[120:123], v[136:139], a[136:139], v[120:123]
	ds_read_b64_tr_b16 v[136:137], v29 offset:10272
	ds_read_b64_tr_b16 v[138:139], v29 offset:11552
	s_waitcnt lgkmcnt(10)
	v_mfma_f32_16x16x32_bf16 v[40:43], v[140:143], a[56:59], v[40:43]
	s_add_u32 m0, s64, 51200
	s_nop 0
	buffer_load_dwordx4 v3, s[48:51], s63 offen lds
	ds_read_b64_tr_b16 v[140:141], v29 offset:32
	ds_read_b64_tr_b16 v[142:143], v29 offset:1312
	s_waitcnt lgkmcnt(10)
	v_mfma_f32_16x16x32_bf16 v[64:67], v[144:147], a[56:59], v[64:67]
	v_mfma_f32_16x16x32_bf16 v[84:87], v[144:147], a[136:139], v[84:87]
	s_waitcnt lgkmcnt(8)
	v_mfma_f32_16x16x32_bf16 v[104:107], v[148:151], a[56:59], v[104:107]
	v_mfma_f32_16x16x32_bf16 v[124:127], v[148:151], a[136:139], v[124:127]
	s_waitcnt lgkmcnt(6)
	v_mfma_f32_16x16x32_bf16 v[44:47], v[152:155], a[56:59], v[44:47]
	s_waitcnt lgkmcnt(4)
	v_mfma_f32_16x16x32_bf16 v[68:71], v[132:135], a[56:59], v[68:71]
	v_mfma_f32_16x16x32_bf16 v[88:91], v[132:135], a[136:139], v[88:91]
	s_add_u32 m0, s64, 52224
	s_nop 0
	buffer_load_dwordx4 v4, s[48:51], s63 offen lds
	s_waitcnt lgkmcnt(2)
	v_mfma_f32_16x16x32_bf16 v[108:111], v[136:139], a[56:59], v[108:111]
	v_mfma_f32_16x16x32_bf16 v[128:131], v[136:139], a[136:139], v[128:131]
	s_add_u32 s63, s63, 122880
	s_waitcnt lgkmcnt(0)
	v_mfma_f32_16x16x32_bf16 v[48:51], v[140:143], a[56:59], v[48:51]
	s_waitcnt vmcnt(32)
	s_barrier
	ds_read_b64_tr_b16 v[132:133], v29 offset:21504
	ds_read_b64_tr_b16 v[134:135], v29 offset:22784
	ds_read_b64_tr_b16 v[136:137], v29 offset:26624
	ds_read_b64_tr_b16 v[138:139], v29 offset:27904
	ds_read_b64_tr_b16 v[140:141], v29 offset:16384
	ds_read_b64_tr_b16 v[142:143], v29 offset:17664
	ds_read_b64_tr_b16 v[144:145], v29 offset:21512
	ds_read_b64_tr_b16 v[146:147], v29 offset:22792
	ds_read_b64_tr_b16 v[148:149], v29 offset:26632
	ds_read_b64_tr_b16 v[150:151], v29 offset:27912
	ds_read_b64_tr_b16 v[152:153], v29 offset:16392
	ds_read_b64_tr_b16 v[154:155], v29 offset:17672
	s_waitcnt lgkmcnt(10)
	v_mfma_f32_16x16x32_bf16 v[52:55], v[132:135], a[60:63], v[52:55]
	v_mfma_f32_16x16x32_bf16 v[72:75], v[132:135], a[140:143], v[72:75]
	s_add_u32 m0, s64, 65536
	s_nop 0
	buffer_load_dwordx4 v1, s[48:51], s63 offen lds
	ds_read_b64_tr_b16 v[132:133], v29 offset:21520
	ds_read_b64_tr_b16 v[134:135], v29 offset:22800
	s_waitcnt lgkmcnt(10)
	v_mfma_f32_16x16x32_bf16 v[92:95], v[136:139], a[60:63], v[92:95]
	v_mfma_f32_16x16x32_bf16 v[112:115], v[136:139], a[140:143], v[112:115]
	ds_read_b64_tr_b16 v[136:137], v29 offset:26640
	ds_read_b64_tr_b16 v[138:139], v29 offset:27920
	s_waitcnt lgkmcnt(10)
	v_mfma_f32_16x16x32_bf16 v[32:35], v[140:143], a[60:63], v[32:35]
	ds_read_b64_tr_b16 v[140:141], v29 offset:16400
	ds_read_b64_tr_b16 v[142:143], v29 offset:17680
	s_waitcnt lgkmcnt(10)
	v_mfma_f32_16x16x32_bf16 v[56:59], v[144:147], a[60:63], v[56:59]
	v_mfma_f32_16x16x32_bf16 v[76:79], v[144:147], a[140:143], v[76:79]
	ds_read_b64_tr_b16 v[144:145], v29 offset:21528
	ds_read_b64_tr_b16 v[146:147], v29 offset:22808
	s_waitcnt lgkmcnt(10)
	v_mfma_f32_16x16x32_bf16 v[96:99], v[148:151], a[60:63], v[96:99]
	v_mfma_f32_16x16x32_bf16 v[116:119], v[148:151], a[140:143], v[116:119]
	s_add_u32 m0, s64, 66560
	s_nop 0
	buffer_load_dwordx4 v2, s[48:51], s63 offen lds
	ds_read_b64_tr_b16 v[148:149], v29 offset:26648
	ds_read_b64_tr_b16 v[150:151], v29 offset:27928
	s_waitcnt lgkmcnt(10)
	v_mfma_f32_16x16x32_bf16 v[36:39], v[152:155], a[60:63], v[36:39]
	ds_read_b64_tr_b16 v[152:153], v29 offset:16408
	ds_read_b64_tr_b16 v[154:155], v29 offset:17688
	s_waitcnt lgkmcnt(10)
	v_mfma_f32_16x16x32_bf16 v[60:63], v[132:135], a[60:63], v[60:63]
	v_mfma_f32_16x16x32_bf16 v[80:83], v[132:135], a[140:143], v[80:83]
	ds_read_b64_tr_b16 v[132:133], v29 offset:21536
	ds_read_b64_tr_b16 v[134:135], v29 offset:22816
	s_waitcnt lgkmcnt(10)
	v_mfma_f32_16x16x32_bf16 v[100:103], v[136:139], a[60:63], v[100:103]
	v_mfma_f32_16x16x32_bf16 v[120:123], v[136:139], a[140:143], v[120:123]
	ds_read_b64_tr_b16 v[136:137], v29 offset:26656
	ds_read_b64_tr_b16 v[138:139], v29 offset:27936
	s_waitcnt lgkmcnt(10)
	v_mfma_f32_16x16x32_bf16 v[40:43], v[140:143], a[60:63], v[40:43]
	s_add_u32 m0, s64, 67584
	s_nop 0
	buffer_load_dwordx4 v3, s[48:51], s63 offen lds
	ds_read_b64_tr_b16 v[140:141], v29 offset:16416
	ds_read_b64_tr_b16 v[142:143], v29 offset:17696
	s_waitcnt lgkmcnt(10)
	v_mfma_f32_16x16x32_bf16 v[64:67], v[144:147], a[60:63], v[64:67]
	v_mfma_f32_16x16x32_bf16 v[84:87], v[144:147], a[140:143], v[84:87]
	s_waitcnt lgkmcnt(8)
	v_mfma_f32_16x16x32_bf16 v[104:107], v[148:151], a[60:63], v[104:107]
	v_mfma_f32_16x16x32_bf16 v[124:127], v[148:151], a[140:143], v[124:127]
	s_waitcnt lgkmcnt(6)
	v_mfma_f32_16x16x32_bf16 v[44:47], v[152:155], a[60:63], v[44:47]
	s_waitcnt lgkmcnt(4)
	v_mfma_f32_16x16x32_bf16 v[68:71], v[132:135], a[60:63], v[68:71]
	v_mfma_f32_16x16x32_bf16 v[88:91], v[132:135], a[140:143], v[88:91]
	s_add_u32 m0, s64, 68608
	s_nop 0
	buffer_load_dwordx4 v4, s[48:51], s63 offen lds
	s_waitcnt lgkmcnt(2)
	v_mfma_f32_16x16x32_bf16 v[108:111], v[136:139], a[60:63], v[108:111]
	v_mfma_f32_16x16x32_bf16 v[128:131], v[136:139], a[140:143], v[128:131]
	s_add_u32 s63, s63, 122880
	s_waitcnt lgkmcnt(0)
	v_mfma_f32_16x16x32_bf16 v[48:51], v[140:143], a[60:63], v[48:51]
	s_waitcnt vmcnt(32)
	s_barrier
	ds_read_b64_tr_b16 v[132:133], v29 offset:37888
	ds_read_b64_tr_b16 v[134:135], v29 offset:39168
	ds_read_b64_tr_b16 v[136:137], v29 offset:43008
	ds_read_b64_tr_b16 v[138:139], v29 offset:44288
	ds_read_b64_tr_b16 v[140:141], v29 offset:32768
	ds_read_b64_tr_b16 v[142:143], v29 offset:34048
	ds_read_b64_tr_b16 v[144:145], v29 offset:37896
	ds_read_b64_tr_b16 v[146:147], v29 offset:39176
	ds_read_b64_tr_b16 v[148:149], v29 offset:43016
	ds_read_b64_tr_b16 v[150:151], v29 offset:44296
	ds_read_b64_tr_b16 v[152:153], v29 offset:32776
	ds_read_b64_tr_b16 v[154:155], v29 offset:34056
	s_waitcnt lgkmcnt(10)
	v_mfma_f32_16x16x32_bf16 v[52:55], v[132:135], a[64:67], v[52:55]
	v_mfma_f32_16x16x32_bf16 v[72:75], v[132:135], a[144:147], v[72:75]
	s_add_u32 m0, s64, 81920
	s_nop 0
	buffer_load_dwordx4 v1, s[48:51], s63 offen lds
	ds_read_b64_tr_b16 v[132:133], v29 offset:37904
	ds_read_b64_tr_b16 v[134:135], v29 offset:39184
	s_waitcnt lgkmcnt(10)
	v_mfma_f32_16x16x32_bf16 v[92:95], v[136:139], a[64:67], v[92:95]
	v_mfma_f32_16x16x32_bf16 v[112:115], v[136:139], a[144:147], v[112:115]
	ds_read_b64_tr_b16 v[136:137], v29 offset:43024
	ds_read_b64_tr_b16 v[138:139], v29 offset:44304
	s_waitcnt lgkmcnt(10)
	v_mfma_f32_16x16x32_bf16 v[32:35], v[140:143], a[64:67], v[32:35]
	ds_read_b64_tr_b16 v[140:141], v29 offset:32784
	ds_read_b64_tr_b16 v[142:143], v29 offset:34064
	s_waitcnt lgkmcnt(10)
	v_mfma_f32_16x16x32_bf16 v[56:59], v[144:147], a[64:67], v[56:59]
	v_mfma_f32_16x16x32_bf16 v[76:79], v[144:147], a[144:147], v[76:79]
	ds_read_b64_tr_b16 v[144:145], v29 offset:37912
	ds_read_b64_tr_b16 v[146:147], v29 offset:39192
	s_waitcnt lgkmcnt(10)
	v_mfma_f32_16x16x32_bf16 v[96:99], v[148:151], a[64:67], v[96:99]
	v_mfma_f32_16x16x32_bf16 v[116:119], v[148:151], a[144:147], v[116:119]
	s_add_u32 m0, s64, 82944
	s_nop 0
	buffer_load_dwordx4 v2, s[48:51], s63 offen lds
	ds_read_b64_tr_b16 v[148:149], v29 offset:43032
	ds_read_b64_tr_b16 v[150:151], v29 offset:44312
	s_waitcnt lgkmcnt(10)
	v_mfma_f32_16x16x32_bf16 v[36:39], v[152:155], a[64:67], v[36:39]
	ds_read_b64_tr_b16 v[152:153], v29 offset:32792
	ds_read_b64_tr_b16 v[154:155], v29 offset:34072
	s_waitcnt lgkmcnt(10)
	v_mfma_f32_16x16x32_bf16 v[60:63], v[132:135], a[64:67], v[60:63]
	v_mfma_f32_16x16x32_bf16 v[80:83], v[132:135], a[144:147], v[80:83]
	ds_read_b64_tr_b16 v[132:133], v29 offset:37920
	ds_read_b64_tr_b16 v[134:135], v29 offset:39200
	s_waitcnt lgkmcnt(10)
	v_mfma_f32_16x16x32_bf16 v[100:103], v[136:139], a[64:67], v[100:103]
	v_mfma_f32_16x16x32_bf16 v[120:123], v[136:139], a[144:147], v[120:123]
	ds_read_b64_tr_b16 v[136:137], v29 offset:43040
	ds_read_b64_tr_b16 v[138:139], v29 offset:44320
	s_waitcnt lgkmcnt(10)
	v_mfma_f32_16x16x32_bf16 v[40:43], v[140:143], a[64:67], v[40:43]
	s_add_u32 m0, s64, 83968
	s_nop 0
	buffer_load_dwordx4 v3, s[48:51], s63 offen lds
	ds_read_b64_tr_b16 v[140:141], v29 offset:32800
	ds_read_b64_tr_b16 v[142:143], v29 offset:34080
	s_waitcnt lgkmcnt(10)
	v_mfma_f32_16x16x32_bf16 v[64:67], v[144:147], a[64:67], v[64:67]
	v_mfma_f32_16x16x32_bf16 v[84:87], v[144:147], a[144:147], v[84:87]
	s_waitcnt lgkmcnt(8)
	v_mfma_f32_16x16x32_bf16 v[104:107], v[148:151], a[64:67], v[104:107]
	v_mfma_f32_16x16x32_bf16 v[124:127], v[148:151], a[144:147], v[124:127]
	s_waitcnt lgkmcnt(6)
	v_mfma_f32_16x16x32_bf16 v[44:47], v[152:155], a[64:67], v[44:47]
	s_waitcnt lgkmcnt(4)
	v_mfma_f32_16x16x32_bf16 v[68:71], v[132:135], a[64:67], v[68:71]
	v_mfma_f32_16x16x32_bf16 v[88:91], v[132:135], a[144:147], v[88:91]
	s_add_u32 m0, s64, 84992
	s_nop 0
	buffer_load_dwordx4 v4, s[48:51], s63 offen lds
	s_waitcnt lgkmcnt(2)
	v_mfma_f32_16x16x32_bf16 v[108:111], v[136:139], a[64:67], v[108:111]
	v_mfma_f32_16x16x32_bf16 v[128:131], v[136:139], a[144:147], v[128:131]
	s_add_u32 s63, s63, 122880
	s_waitcnt lgkmcnt(0)
	v_mfma_f32_16x16x32_bf16 v[48:51], v[140:143], a[64:67], v[48:51]
	s_waitcnt vmcnt(32)
	s_barrier
	ds_read_b64_tr_b16 v[132:133], v29 offset:54272
	ds_read_b64_tr_b16 v[134:135], v29 offset:55552
	ds_read_b64_tr_b16 v[136:137], v29 offset:59392
	ds_read_b64_tr_b16 v[138:139], v29 offset:60672
	ds_read_b64_tr_b16 v[140:141], v29 offset:49152
	ds_read_b64_tr_b16 v[142:143], v29 offset:50432
	ds_read_b64_tr_b16 v[144:145], v29 offset:54280
	ds_read_b64_tr_b16 v[146:147], v29 offset:55560
	ds_read_b64_tr_b16 v[148:149], v29 offset:59400
	ds_read_b64_tr_b16 v[150:151], v29 offset:60680
	ds_read_b64_tr_b16 v[152:153], v29 offset:49160
	ds_read_b64_tr_b16 v[154:155], v29 offset:50440
	s_waitcnt lgkmcnt(10)
	v_mfma_f32_16x16x32_bf16 v[52:55], v[132:135], a[68:71], v[52:55]
	v_mfma_f32_16x16x32_bf16 v[72:75], v[132:135], a[148:151], v[72:75]
	s_add_u32 m0, s64, 98304
	s_nop 0
	buffer_load_dwordx4 v1, s[48:51], s63 offen lds
	ds_read_b64_tr_b16 v[132:133], v29 offset:54288
	ds_read_b64_tr_b16 v[134:135], v29 offset:55568
	s_waitcnt lgkmcnt(10)
	v_mfma_f32_16x16x32_bf16 v[92:95], v[136:139], a[68:71], v[92:95]
	v_mfma_f32_16x16x32_bf16 v[112:115], v[136:139], a[148:151], v[112:115]
	ds_read_b64_tr_b16 v[136:137], v29 offset:59408
	ds_read_b64_tr_b16 v[138:139], v29 offset:60688
	s_waitcnt lgkmcnt(10)
	v_mfma_f32_16x16x32_bf16 v[32:35], v[140:143], a[68:71], v[32:35]
	ds_read_b64_tr_b16 v[140:141], v29 offset:49168
	ds_read_b64_tr_b16 v[142:143], v29 offset:50448
	s_waitcnt lgkmcnt(10)
	v_mfma_f32_16x16x32_bf16 v[56:59], v[144:147], a[68:71], v[56:59]
	v_mfma_f32_16x16x32_bf16 v[76:79], v[144:147], a[148:151], v[76:79]
	ds_read_b64_tr_b16 v[144:145], v29 offset:54296
	ds_read_b64_tr_b16 v[146:147], v29 offset:55576
	s_waitcnt lgkmcnt(10)
	v_mfma_f32_16x16x32_bf16 v[96:99], v[148:151], a[68:71], v[96:99]
	v_mfma_f32_16x16x32_bf16 v[116:119], v[148:151], a[148:151], v[116:119]
	s_add_u32 m0, s64, 99328
	s_nop 0
	buffer_load_dwordx4 v2, s[48:51], s63 offen lds
	ds_read_b64_tr_b16 v[148:149], v29 offset:59416
	ds_read_b64_tr_b16 v[150:151], v29 offset:60696
	s_waitcnt lgkmcnt(10)
	v_mfma_f32_16x16x32_bf16 v[36:39], v[152:155], a[68:71], v[36:39]
	ds_read_b64_tr_b16 v[152:153], v29 offset:49176
	ds_read_b64_tr_b16 v[154:155], v29 offset:50456
	s_waitcnt lgkmcnt(10)
	v_mfma_f32_16x16x32_bf16 v[60:63], v[132:135], a[68:71], v[60:63]
	v_mfma_f32_16x16x32_bf16 v[80:83], v[132:135], a[148:151], v[80:83]
	ds_read_b64_tr_b16 v[132:133], v29 offset:54304
	ds_read_b64_tr_b16 v[134:135], v29 offset:55584
	s_waitcnt lgkmcnt(10)
	v_mfma_f32_16x16x32_bf16 v[100:103], v[136:139], a[68:71], v[100:103]
	v_mfma_f32_16x16x32_bf16 v[120:123], v[136:139], a[148:151], v[120:123]
	ds_read_b64_tr_b16 v[136:137], v29 offset:59424
	ds_read_b64_tr_b16 v[138:139], v29 offset:60704
	s_waitcnt lgkmcnt(10)
	v_mfma_f32_16x16x32_bf16 v[40:43], v[140:143], a[68:71], v[40:43]
	s_add_u32 m0, s64, 100352
	s_nop 0
	buffer_load_dwordx4 v3, s[48:51], s63 offen lds
	ds_read_b64_tr_b16 v[140:141], v29 offset:49184
	ds_read_b64_tr_b16 v[142:143], v29 offset:50464
	s_waitcnt lgkmcnt(10)
	v_mfma_f32_16x16x32_bf16 v[64:67], v[144:147], a[68:71], v[64:67]
	v_mfma_f32_16x16x32_bf16 v[84:87], v[144:147], a[148:151], v[84:87]
	s_waitcnt lgkmcnt(8)
	v_mfma_f32_16x16x32_bf16 v[104:107], v[148:151], a[68:71], v[104:107]
	v_mfma_f32_16x16x32_bf16 v[124:127], v[148:151], a[148:151], v[124:127]
	s_waitcnt lgkmcnt(6)
	v_mfma_f32_16x16x32_bf16 v[44:47], v[152:155], a[68:71], v[44:47]
	s_waitcnt lgkmcnt(4)
	v_mfma_f32_16x16x32_bf16 v[68:71], v[132:135], a[68:71], v[68:71]
	v_mfma_f32_16x16x32_bf16 v[88:91], v[132:135], a[148:151], v[88:91]
	s_add_u32 m0, s64, 101376
	s_nop 0
	buffer_load_dwordx4 v4, s[48:51], s63 offen lds
	s_waitcnt lgkmcnt(2)
	v_mfma_f32_16x16x32_bf16 v[108:111], v[136:139], a[68:71], v[108:111]
	v_mfma_f32_16x16x32_bf16 v[128:131], v[136:139], a[148:151], v[128:131]
	s_add_u32 s63, s63, 122880
	s_waitcnt lgkmcnt(0)
	v_mfma_f32_16x16x32_bf16 v[48:51], v[140:143], a[68:71], v[48:51]
	s_waitcnt vmcnt(32)
	s_barrier
	ds_read_b64_tr_b16 v[132:133], v30 offset:5120
	ds_read_b64_tr_b16 v[134:135], v30 offset:6400
	ds_read_b64_tr_b16 v[136:137], v30 offset:10240
	ds_read_b64_tr_b16 v[138:139], v30 offset:11520
	ds_read_b64_tr_b16 v[140:141], v30 offset:0
	ds_read_b64_tr_b16 v[142:143], v30 offset:1280
	ds_read_b64_tr_b16 v[144:145], v30 offset:5128
	ds_read_b64_tr_b16 v[146:147], v30 offset:6408
	ds_read_b64_tr_b16 v[148:149], v30 offset:10248
	ds_read_b64_tr_b16 v[150:151], v30 offset:11528
	ds_read_b64_tr_b16 v[152:153], v30 offset:8
	ds_read_b64_tr_b16 v[154:155], v30 offset:1288
	s_waitcnt lgkmcnt(10)
	v_mfma_f32_16x16x32_bf16 v[52:55], v[132:135], a[72:75], v[52:55]
	v_mfma_f32_16x16x32_bf16 v[72:75], v[132:135], a[152:155], v[72:75]
	s_add_u32 m0, s64, 114688
	s_nop 0
	buffer_load_dwordx4 v1, s[48:51], s63 offen lds
	ds_read_b64_tr_b16 v[132:133], v30 offset:5136
	ds_read_b64_tr_b16 v[134:135], v30 offset:6416
	s_waitcnt lgkmcnt(10)
	v_mfma_f32_16x16x32_bf16 v[92:95], v[136:139], a[72:75], v[92:95]
	v_mfma_f32_16x16x32_bf16 v[112:115], v[136:139], a[152:155], v[112:115]
	ds_read_b64_tr_b16 v[136:137], v30 offset:10256
	ds_read_b64_tr_b16 v[138:139], v30 offset:11536
	s_waitcnt lgkmcnt(10)
	v_mfma_f32_16x16x32_bf16 v[32:35], v[140:143], a[72:75], v[32:35]
	ds_read_b64_tr_b16 v[140:141], v30 offset:16
	ds_read_b64_tr_b16 v[142:143], v30 offset:1296
	s_waitcnt lgkmcnt(10)
	v_mfma_f32_16x16x32_bf16 v[56:59], v[144:147], a[72:75], v[56:59]
	v_mfma_f32_16x16x32_bf16 v[76:79], v[144:147], a[152:155], v[76:79]
	ds_read_b64_tr_b16 v[144:145], v30 offset:5144
	ds_read_b64_tr_b16 v[146:147], v30 offset:6424
	s_waitcnt lgkmcnt(10)
	v_mfma_f32_16x16x32_bf16 v[96:99], v[148:151], a[72:75], v[96:99]
	v_mfma_f32_16x16x32_bf16 v[116:119], v[148:151], a[152:155], v[116:119]
	s_add_u32 m0, s64, 115712
	s_nop 0
	buffer_load_dwordx4 v2, s[48:51], s63 offen lds
	ds_read_b64_tr_b16 v[148:149], v30 offset:10264
	ds_read_b64_tr_b16 v[150:151], v30 offset:11544
	s_waitcnt lgkmcnt(10)
	v_mfma_f32_16x16x32_bf16 v[36:39], v[152:155], a[72:75], v[36:39]
	ds_read_b64_tr_b16 v[152:153], v30 offset:24
	ds_read_b64_tr_b16 v[154:155], v30 offset:1304
	s_waitcnt lgkmcnt(10)
	v_mfma_f32_16x16x32_bf16 v[60:63], v[132:135], a[72:75], v[60:63]
	v_mfma_f32_16x16x32_bf16 v[80:83], v[132:135], a[152:155], v[80:83]
	ds_read_b64_tr_b16 v[132:133], v30 offset:5152
	ds_read_b64_tr_b16 v[134:135], v30 offset:6432
	s_waitcnt lgkmcnt(10)
	v_mfma_f32_16x16x32_bf16 v[100:103], v[136:139], a[72:75], v[100:103]
	v_mfma_f32_16x16x32_bf16 v[120:123], v[136:139], a[152:155], v[120:123]
	ds_read_b64_tr_b16 v[136:137], v30 offset:10272
	ds_read_b64_tr_b16 v[138:139], v30 offset:11552
	s_waitcnt lgkmcnt(10)
	v_mfma_f32_16x16x32_bf16 v[40:43], v[140:143], a[72:75], v[40:43]
	s_add_u32 m0, s64, 116736
	s_nop 0
	buffer_load_dwordx4 v3, s[48:51], s63 offen lds
	ds_read_b64_tr_b16 v[140:141], v30 offset:32
	ds_read_b64_tr_b16 v[142:143], v30 offset:1312
	s_waitcnt lgkmcnt(10)
	v_mfma_f32_16x16x32_bf16 v[64:67], v[144:147], a[72:75], v[64:67]
	v_mfma_f32_16x16x32_bf16 v[84:87], v[144:147], a[152:155], v[84:87]
	s_waitcnt lgkmcnt(8)
	v_mfma_f32_16x16x32_bf16 v[104:107], v[148:151], a[72:75], v[104:107]
	v_mfma_f32_16x16x32_bf16 v[124:127], v[148:151], a[152:155], v[124:127]
	s_waitcnt lgkmcnt(6)
	v_mfma_f32_16x16x32_bf16 v[44:47], v[152:155], a[72:75], v[44:47]
	s_waitcnt lgkmcnt(4)
	v_mfma_f32_16x16x32_bf16 v[68:71], v[132:135], a[72:75], v[68:71]
	v_mfma_f32_16x16x32_bf16 v[88:91], v[132:135], a[152:155], v[88:91]
	s_add_u32 m0, s64, 117760
	s_nop 0
	buffer_load_dwordx4 v4, s[48:51], s63 offen lds
	s_waitcnt lgkmcnt(2)
	v_mfma_f32_16x16x32_bf16 v[108:111], v[136:139], a[72:75], v[108:111]
	v_mfma_f32_16x16x32_bf16 v[128:131], v[136:139], a[152:155], v[128:131]
	s_add_u32 s63, s63, 122880
	s_waitcnt lgkmcnt(0)
	v_mfma_f32_16x16x32_bf16 v[48:51], v[140:143], a[72:75], v[48:51]
	s_waitcnt vmcnt(32)
	s_barrier
	ds_read_b64_tr_b16 v[132:133], v30 offset:21504
	ds_read_b64_tr_b16 v[134:135], v30 offset:22784
	ds_read_b64_tr_b16 v[136:137], v30 offset:26624
	ds_read_b64_tr_b16 v[138:139], v30 offset:27904
	ds_read_b64_tr_b16 v[140:141], v30 offset:16384
	ds_read_b64_tr_b16 v[142:143], v30 offset:17664
	ds_read_b64_tr_b16 v[144:145], v30 offset:21512
	ds_read_b64_tr_b16 v[146:147], v30 offset:22792
	ds_read_b64_tr_b16 v[148:149], v30 offset:26632
	ds_read_b64_tr_b16 v[150:151], v30 offset:27912
	ds_read_b64_tr_b16 v[152:153], v30 offset:16392
	ds_read_b64_tr_b16 v[154:155], v30 offset:17672
	s_waitcnt lgkmcnt(10)
	v_mfma_f32_16x16x32_bf16 v[52:55], v[132:135], a[76:79], v[52:55]
	v_mfma_f32_16x16x32_bf16 v[72:75], v[132:135], a[156:159], v[72:75]
	s_add_u32 m0, s64, 131072
	s_nop 0
	buffer_load_dwordx4 v1, s[48:51], s63 offen lds
	ds_read_b64_tr_b16 v[132:133], v30 offset:21520
	ds_read_b64_tr_b16 v[134:135], v30 offset:22800
	s_waitcnt lgkmcnt(10)
	v_mfma_f32_16x16x32_bf16 v[92:95], v[136:139], a[76:79], v[92:95]
	v_mfma_f32_16x16x32_bf16 v[112:115], v[136:139], a[156:159], v[112:115]
	ds_read_b64_tr_b16 v[136:137], v30 offset:26640
	ds_read_b64_tr_b16 v[138:139], v30 offset:27920
	s_waitcnt lgkmcnt(10)
	v_mfma_f32_16x16x32_bf16 v[32:35], v[140:143], a[76:79], v[32:35]
	ds_read_b64_tr_b16 v[140:141], v30 offset:16400
	ds_read_b64_tr_b16 v[142:143], v30 offset:17680
	s_waitcnt lgkmcnt(10)
	v_mfma_f32_16x16x32_bf16 v[56:59], v[144:147], a[76:79], v[56:59]
	v_mfma_f32_16x16x32_bf16 v[76:79], v[144:147], a[156:159], v[76:79]
	ds_read_b64_tr_b16 v[144:145], v30 offset:21528
	ds_read_b64_tr_b16 v[146:147], v30 offset:22808
	s_waitcnt lgkmcnt(10)
	v_mfma_f32_16x16x32_bf16 v[96:99], v[148:151], a[76:79], v[96:99]
	v_mfma_f32_16x16x32_bf16 v[116:119], v[148:151], a[156:159], v[116:119]
	s_add_u32 m0, s64, 132096
	s_nop 0
	buffer_load_dwordx4 v2, s[48:51], s63 offen lds
	ds_read_b64_tr_b16 v[148:149], v30 offset:26648
	ds_read_b64_tr_b16 v[150:151], v30 offset:27928
	s_waitcnt lgkmcnt(10)
	v_mfma_f32_16x16x32_bf16 v[36:39], v[152:155], a[76:79], v[36:39]
	ds_read_b64_tr_b16 v[152:153], v30 offset:16408
	ds_read_b64_tr_b16 v[154:155], v30 offset:17688
	s_waitcnt lgkmcnt(10)
	v_mfma_f32_16x16x32_bf16 v[60:63], v[132:135], a[76:79], v[60:63]
	v_mfma_f32_16x16x32_bf16 v[80:83], v[132:135], a[156:159], v[80:83]
	ds_read_b64_tr_b16 v[132:133], v30 offset:21536
	ds_read_b64_tr_b16 v[134:135], v30 offset:22816
	s_waitcnt lgkmcnt(10)
	v_mfma_f32_16x16x32_bf16 v[100:103], v[136:139], a[76:79], v[100:103]
	v_mfma_f32_16x16x32_bf16 v[120:123], v[136:139], a[156:159], v[120:123]
	ds_read_b64_tr_b16 v[136:137], v30 offset:26656
	ds_read_b64_tr_b16 v[138:139], v30 offset:27936
	s_waitcnt lgkmcnt(10)
	v_mfma_f32_16x16x32_bf16 v[40:43], v[140:143], a[76:79], v[40:43]
	s_add_u32 m0, s64, 133120
	s_nop 0
	buffer_load_dwordx4 v3, s[48:51], s63 offen lds
	ds_read_b64_tr_b16 v[140:141], v30 offset:16416
	ds_read_b64_tr_b16 v[142:143], v30 offset:17696
	s_waitcnt lgkmcnt(10)
	v_mfma_f32_16x16x32_bf16 v[64:67], v[144:147], a[76:79], v[64:67]
	v_mfma_f32_16x16x32_bf16 v[84:87], v[144:147], a[156:159], v[84:87]
	s_waitcnt lgkmcnt(8)
	v_mfma_f32_16x16x32_bf16 v[104:107], v[148:151], a[76:79], v[104:107]
	v_mfma_f32_16x16x32_bf16 v[124:127], v[148:151], a[156:159], v[124:127]
	s_waitcnt lgkmcnt(6)
	v_mfma_f32_16x16x32_bf16 v[44:47], v[152:155], a[76:79], v[44:47]
	s_waitcnt lgkmcnt(4)
	v_mfma_f32_16x16x32_bf16 v[68:71], v[132:135], a[76:79], v[68:71]
	v_mfma_f32_16x16x32_bf16 v[88:91], v[132:135], a[156:159], v[88:91]
	s_add_u32 m0, s64, 134144
	s_nop 0
	buffer_load_dwordx4 v4, s[48:51], s63 offen lds
	s_waitcnt lgkmcnt(2)
	v_mfma_f32_16x16x32_bf16 v[108:111], v[136:139], a[76:79], v[108:111]
	v_mfma_f32_16x16x32_bf16 v[128:131], v[136:139], a[156:159], v[128:131]
	s_add_u32 s63, s63, 122880
	s_waitcnt lgkmcnt(0)
	v_mfma_f32_16x16x32_bf16 v[48:51], v[140:143], a[76:79], v[48:51]
	v_accvgpr_mov_b32 a160, a170
	v_accvgpr_mov_b32 a161, a171
	v_accvgpr_mov_b32 a162, a172
	v_accvgpr_mov_b32 a163, a173
	v_accvgpr_mov_b32 a164, a174
	v_accvgpr_mov_b32 a165, a175
	v_accvgpr_mov_b32 a166, a176
	v_accvgpr_mov_b32 a167, a177
	v_accvgpr_mov_b32 a168, a178
	v_accvgpr_mov_b32 a169, a179
	v_accvgpr_mov_b32 a170, a180
	v_accvgpr_mov_b32 a171, a181
	v_accvgpr_mov_b32 a172, a182
	v_accvgpr_mov_b32 a173, a183
	v_accvgpr_mov_b32 a174, a184
	v_accvgpr_mov_b32 a175, a185
	v_accvgpr_mov_b32 a176, a186
	v_accvgpr_mov_b32 a177, a187
	v_accvgpr_mov_b32 a178, a188
	v_accvgpr_mov_b32 a179, a189
	v_accvgpr_mov_b32 a180, a190
	v_accvgpr_mov_b32 a181, a191
	v_accvgpr_mov_b32 a182, a192
	v_accvgpr_mov_b32 a183, a193
	v_accvgpr_mov_b32 a184, a194
	v_accvgpr_mov_b32 a185, a195
	v_accvgpr_mov_b32 a186, a196
	v_accvgpr_mov_b32 a187, a197
	v_accvgpr_mov_b32 a188, a198
	v_accvgpr_mov_b32 a189, a199
	v_accvgpr_mov_b32 a190, a200
	v_accvgpr_mov_b32 a191, a201
	v_accvgpr_mov_b32 a192, a202
	v_accvgpr_mov_b32 a193, a203
	v_accvgpr_mov_b32 a194, a204
	v_accvgpr_mov_b32 a195, a205
	v_accvgpr_mov_b32 a196, a206
	v_accvgpr_mov_b32 a197, a207
	v_accvgpr_mov_b32 a198, a208
	v_accvgpr_mov_b32 a199, a209
	v_accvgpr_mov_b32 a200, a210
	v_accvgpr_mov_b32 a201, a211
	v_accvgpr_mov_b32 a202, a212
	v_accvgpr_mov_b32 a203, a213
	v_accvgpr_mov_b32 a204, a214
	v_accvgpr_mov_b32 a205, a215
	v_accvgpr_mov_b32 a206, a216
	v_accvgpr_mov_b32 a207, a217
	v_accvgpr_mov_b32 a208, a218
	v_accvgpr_mov_b32 a209, a219
	v_accvgpr_mov_b32 a210, a220
	v_accvgpr_mov_b32 a211, a221
	v_accvgpr_mov_b32 a212, a222
	v_accvgpr_mov_b32 a213, a223
	v_accvgpr_mov_b32 a214, a224
	v_accvgpr_mov_b32 a215, a225
	v_accvgpr_mov_b32 a216, a226
	v_accvgpr_mov_b32 a217, a227
	v_accvgpr_mov_b32 a218, a228
	v_accvgpr_mov_b32 a219, a229
	v_accvgpr_mov_b32 a220, a230
	v_accvgpr_mov_b32 a221, a231
	v_accvgpr_mov_b32 a222, a232
	v_accvgpr_mov_b32 a223, a233
	v_accvgpr_mov_b32 a224, a234
	v_accvgpr_mov_b32 a225, a235
	v_accvgpr_mov_b32 a226, a236
	v_accvgpr_mov_b32 a227, a237
	v_accvgpr_mov_b32 a228, a238
	v_accvgpr_mov_b32 a229, a239
	v_cvt_pk_bf16_f32 v170, v52, v53
	v_cvt_pk_bf16_f32 v171, v54, v55
	v_cvt_pk_bf16_f32 v172, v56, v57
	v_cvt_pk_bf16_f32 v173, v58, v59
	v_cvt_pk_bf16_f32 v174, v60, v61
	v_cvt_pk_bf16_f32 v175, v62, v63
	v_cvt_pk_bf16_f32 v176, v64, v65
	v_cvt_pk_bf16_f32 v177, v66, v67
	v_cvt_pk_bf16_f32 v178, v68, v69
	v_cvt_pk_bf16_f32 v179, v70, v71
	v_cvt_pk_bf16_f32 v180, v72, v73
	v_cvt_pk_bf16_f32 v181, v74, v75
	v_cvt_pk_bf16_f32 v182, v76, v77
	v_cvt_pk_bf16_f32 v183, v78, v79
	v_cvt_pk_bf16_f32 v184, v80, v81
	v_cvt_pk_bf16_f32 v185, v82, v83
	v_cvt_pk_bf16_f32 v186, v84, v85
	v_cvt_pk_bf16_f32 v187, v86, v87
	v_cvt_pk_bf16_f32 v188, v88, v89
	v_cvt_pk_bf16_f32 v189, v90, v91
	v_cvt_pk_bf16_f32 v160, v32, v33
	v_cvt_pk_bf16_f32 v161, v34, v35
	v_cvt_pk_bf16_f32 v162, v36, v37
	v_cvt_pk_bf16_f32 v163, v38, v39
	v_cvt_pk_bf16_f32 v164, v40, v41
	v_cvt_pk_bf16_f32 v165, v42, v43
	v_cvt_pk_bf16_f32 v166, v44, v45
	v_cvt_pk_bf16_f32 v167, v46, v47
	v_cvt_pk_bf16_f32 v168, v48, v49
	v_cvt_pk_bf16_f32 v169, v50, v51
	v_mov_b32 v190, 0
	v_mov_b32 v191, 0
	v_mov_b32 v192, 0
	v_mov_b32 v193, 0
	v_mov_b32 v194, 0
	v_mov_b32 v195, 0
	v_mov_b32 v196, 0
	v_mov_b32 v197, 0
	v_dot2c_f32_bf16 v190, v170, v160
	v_dot2c_f32_bf16_dpp v191, v170, v160 row_shr:2 row_mask:0xf bank_mask:0xf
	v_dot2c_f32_bf16_dpp v192, v170, v160 row_shr:4 row_mask:0xf bank_mask:0xf
	v_dot2c_f32_bf16_dpp v193, v170, v160 row_shr:6 row_mask:0xf bank_mask:0xf
	v_dot2c_f32_bf16_dpp v194, v170, v160 row_shr:8 row_mask:0xf bank_mask:0xf
	v_dot2c_f32_bf16_dpp v195, v170, v160 row_shr:10 row_mask:0xf bank_mask:0xf
	v_dot2c_f32_bf16_dpp v196, v170, v160 row_shr:12 row_mask:0xf bank_mask:0xf
	v_dot2c_f32_bf16_dpp v197, v170, v160 row_shr:14 row_mask:0xf bank_mask:0xf
	v_dot2c_f32_bf16_dpp v191, v180, v160 row_shl:14 row_mask:0xf bank_mask:0xf
	v_dot2c_f32_bf16_dpp v192, v180, v160 row_shl:12 row_mask:0xf bank_mask:0xf
	v_dot2c_f32_bf16_dpp v193, v180, v160 row_shl:10 row_mask:0xf bank_mask:0xf
	v_dot2c_f32_bf16_dpp v194, v180, v160 row_shl:8 row_mask:0xf bank_mask:0xf
	v_dot2c_f32_bf16_dpp v195, v180, v160 row_shl:6 row_mask:0xf bank_mask:0xf
	v_dot2c_f32_bf16_dpp v196, v180, v160 row_shl:4 row_mask:0xf bank_mask:0xf
	v_dot2c_f32_bf16_dpp v197, v180, v160 row_shl:2 row_mask:0xf bank_mask:0xf
	v_dot2c_f32_bf16 v190, v171, v161
	v_dot2c_f32_bf16_dpp v191, v171, v161 row_shr:2 row_mask:0xf bank_mask:0xf
	v_dot2c_f32_bf16_dpp v192, v171, v161 row_shr:4 row_mask:0xf bank_mask:0xf
	v_dot2c_f32_bf16_dpp v193, v171, v161 row_shr:6 row_mask:0xf bank_mask:0xf
	v_dot2c_f32_bf16_dpp v194, v171, v161 row_shr:8 row_mask:0xf bank_mask:0xf
	v_dot2c_f32_bf16_dpp v195, v171, v161 row_shr:10 row_mask:0xf bank_mask:0xf
	v_dot2c_f32_bf16_dpp v196, v171, v161 row_shr:12 row_mask:0xf bank_mask:0xf
	v_dot2c_f32_bf16_dpp v197, v171, v161 row_shr:14 row_mask:0xf bank_mask:0xf
	v_dot2c_f32_bf16_dpp v191, v181, v161 row_shl:14 row_mask:0xf bank_mask:0xf
	v_dot2c_f32_bf16_dpp v192, v181, v161 row_shl:12 row_mask:0xf bank_mask:0xf
	v_dot2c_f32_bf16_dpp v193, v181, v161 row_shl:10 row_mask:0xf bank_mask:0xf
	v_dot2c_f32_bf16_dpp v194, v181, v161 row_shl:8 row_mask:0xf bank_mask:0xf
	v_dot2c_f32_bf16_dpp v195, v181, v161 row_shl:6 row_mask:0xf bank_mask:0xf
	v_dot2c_f32_bf16_dpp v196, v181, v161 row_shl:4 row_mask:0xf bank_mask:0xf
	v_dot2c_f32_bf16_dpp v197, v181, v161 row_shl:2 row_mask:0xf bank_mask:0xf
	v_dot2c_f32_bf16 v190, v172, v162
	v_dot2c_f32_bf16_dpp v191, v172, v162 row_shr:2 row_mask:0xf bank_mask:0xf
	v_dot2c_f32_bf16_dpp v192, v172, v162 row_shr:4 row_mask:0xf bank_mask:0xf
	v_dot2c_f32_bf16_dpp v193, v172, v162 row_shr:6 row_mask:0xf bank_mask:0xf
	v_dot2c_f32_bf16_dpp v194, v172, v162 row_shr:8 row_mask:0xf bank_mask:0xf
	v_dot2c_f32_bf16_dpp v195, v172, v162 row_shr:10 row_mask:0xf bank_mask:0xf
	v_dot2c_f32_bf16_dpp v196, v172, v162 row_shr:12 row_mask:0xf bank_mask:0xf
	v_dot2c_f32_bf16_dpp v197, v172, v162 row_shr:14 row_mask:0xf bank_mask:0xf
	v_dot2c_f32_bf16_dpp v191, v182, v162 row_shl:14 row_mask:0xf bank_mask:0xf
	v_dot2c_f32_bf16_dpp v192, v182, v162 row_shl:12 row_mask:0xf bank_mask:0xf
	v_dot2c_f32_bf16_dpp v193, v182, v162 row_shl:10 row_mask:0xf bank_mask:0xf
	v_dot2c_f32_bf16_dpp v194, v182, v162 row_shl:8 row_mask:0xf bank_mask:0xf
	v_dot2c_f32_bf16_dpp v195, v182, v162 row_shl:6 row_mask:0xf bank_mask:0xf
	v_dot2c_f32_bf16_dpp v196, v182, v162 row_shl:4 row_mask:0xf bank_mask:0xf
	v_dot2c_f32_bf16_dpp v197, v182, v162 row_shl:2 row_mask:0xf bank_mask:0xf
	v_dot2c_f32_bf16 v190, v173, v163
	v_dot2c_f32_bf16_dpp v191, v173, v163 row_shr:2 row_mask:0xf bank_mask:0xf
	v_dot2c_f32_bf16_dpp v192, v173, v163 row_shr:4 row_mask:0xf bank_mask:0xf
	v_dot2c_f32_bf16_dpp v193, v173, v163 row_shr:6 row_mask:0xf bank_mask:0xf
	v_dot2c_f32_bf16_dpp v194, v173, v163 row_shr:8 row_mask:0xf bank_mask:0xf
	v_dot2c_f32_bf16_dpp v195, v173, v163 row_shr:10 row_mask:0xf bank_mask:0xf
	v_dot2c_f32_bf16_dpp v196, v173, v163 row_shr:12 row_mask:0xf bank_mask:0xf
	v_dot2c_f32_bf16_dpp v197, v173, v163 row_shr:14 row_mask:0xf bank_mask:0xf
	v_dot2c_f32_bf16_dpp v191, v183, v163 row_shl:14 row_mask:0xf bank_mask:0xf
	v_dot2c_f32_bf16_dpp v192, v183, v163 row_shl:12 row_mask:0xf bank_mask:0xf
	v_dot2c_f32_bf16_dpp v193, v183, v163 row_shl:10 row_mask:0xf bank_mask:0xf
	v_dot2c_f32_bf16_dpp v194, v183, v163 row_shl:8 row_mask:0xf bank_mask:0xf
	v_dot2c_f32_bf16_dpp v195, v183, v163 row_shl:6 row_mask:0xf bank_mask:0xf
	v_dot2c_f32_bf16_dpp v196, v183, v163 row_shl:4 row_mask:0xf bank_mask:0xf
	v_dot2c_f32_bf16_dpp v197, v183, v163 row_shl:2 row_mask:0xf bank_mask:0xf
	v_dot2c_f32_bf16 v190, v174, v164
	v_dot2c_f32_bf16_dpp v191, v174, v164 row_shr:2 row_mask:0xf bank_mask:0xf
	v_dot2c_f32_bf16_dpp v192, v174, v164 row_shr:4 row_mask:0xf bank_mask:0xf
	v_dot2c_f32_bf16_dpp v193, v174, v164 row_shr:6 row_mask:0xf bank_mask:0xf
	v_dot2c_f32_bf16_dpp v194, v174, v164 row_shr:8 row_mask:0xf bank_mask:0xf
	v_dot2c_f32_bf16_dpp v195, v174, v164 row_shr:10 row_mask:0xf bank_mask:0xf
	v_dot2c_f32_bf16_dpp v196, v174, v164 row_shr:12 row_mask:0xf bank_mask:0xf
	v_dot2c_f32_bf16_dpp v197, v174, v164 row_shr:14 row_mask:0xf bank_mask:0xf
	v_dot2c_f32_bf16_dpp v191, v184, v164 row_shl:14 row_mask:0xf bank_mask:0xf
	v_dot2c_f32_bf16_dpp v192, v184, v164 row_shl:12 row_mask:0xf bank_mask:0xf
	v_dot2c_f32_bf16_dpp v193, v184, v164 row_shl:10 row_mask:0xf bank_mask:0xf
	v_dot2c_f32_bf16_dpp v194, v184, v164 row_shl:8 row_mask:0xf bank_mask:0xf
	v_dot2c_f32_bf16_dpp v195, v184, v164 row_shl:6 row_mask:0xf bank_mask:0xf
	v_dot2c_f32_bf16_dpp v196, v184, v164 row_shl:4 row_mask:0xf bank_mask:0xf
	v_dot2c_f32_bf16_dpp v197, v184, v164 row_shl:2 row_mask:0xf bank_mask:0xf
	v_dot2c_f32_bf16 v190, v175, v165
	v_dot2c_f32_bf16_dpp v191, v175, v165 row_shr:2 row_mask:0xf bank_mask:0xf
	v_dot2c_f32_bf16_dpp v192, v175, v165 row_shr:4 row_mask:0xf bank_mask:0xf
	v_dot2c_f32_bf16_dpp v193, v175, v165 row_shr:6 row_mask:0xf bank_mask:0xf
	v_dot2c_f32_bf16_dpp v194, v175, v165 row_shr:8 row_mask:0xf bank_mask:0xf
	v_dot2c_f32_bf16_dpp v195, v175, v165 row_shr:10 row_mask:0xf bank_mask:0xf
	v_dot2c_f32_bf16_dpp v196, v175, v165 row_shr:12 row_mask:0xf bank_mask:0xf
	v_dot2c_f32_bf16_dpp v197, v175, v165 row_shr:14 row_mask:0xf bank_mask:0xf
	v_dot2c_f32_bf16_dpp v191, v185, v165 row_shl:14 row_mask:0xf bank_mask:0xf
	v_dot2c_f32_bf16_dpp v192, v185, v165 row_shl:12 row_mask:0xf bank_mask:0xf
	v_dot2c_f32_bf16_dpp v193, v185, v165 row_shl:10 row_mask:0xf bank_mask:0xf
	v_dot2c_f32_bf16_dpp v194, v185, v165 row_shl:8 row_mask:0xf bank_mask:0xf
	v_dot2c_f32_bf16_dpp v195, v185, v165 row_shl:6 row_mask:0xf bank_mask:0xf
	v_dot2c_f32_bf16_dpp v196, v185, v165 row_shl:4 row_mask:0xf bank_mask:0xf
	v_dot2c_f32_bf16_dpp v197, v185, v165 row_shl:2 row_mask:0xf bank_mask:0xf
	v_dot2c_f32_bf16 v190, v176, v166
	v_dot2c_f32_bf16_dpp v191, v176, v166 row_shr:2 row_mask:0xf bank_mask:0xf
	v_dot2c_f32_bf16_dpp v192, v176, v166 row_shr:4 row_mask:0xf bank_mask:0xf
	v_dot2c_f32_bf16_dpp v193, v176, v166 row_shr:6 row_mask:0xf bank_mask:0xf
	v_dot2c_f32_bf16_dpp v194, v176, v166 row_shr:8 row_mask:0xf bank_mask:0xf
	v_dot2c_f32_bf16_dpp v195, v176, v166 row_shr:10 row_mask:0xf bank_mask:0xf
	v_dot2c_f32_bf16_dpp v196, v176, v166 row_shr:12 row_mask:0xf bank_mask:0xf
	v_dot2c_f32_bf16_dpp v197, v176, v166 row_shr:14 row_mask:0xf bank_mask:0xf
	v_dot2c_f32_bf16_dpp v191, v186, v166 row_shl:14 row_mask:0xf bank_mask:0xf
	v_dot2c_f32_bf16_dpp v192, v186, v166 row_shl:12 row_mask:0xf bank_mask:0xf
	v_dot2c_f32_bf16_dpp v193, v186, v166 row_shl:10 row_mask:0xf bank_mask:0xf
	v_dot2c_f32_bf16_dpp v194, v186, v166 row_shl:8 row_mask:0xf bank_mask:0xf
	v_dot2c_f32_bf16_dpp v195, v186, v166 row_shl:6 row_mask:0xf bank_mask:0xf
	v_dot2c_f32_bf16_dpp v196, v186, v166 row_shl:4 row_mask:0xf bank_mask:0xf
	v_dot2c_f32_bf16_dpp v197, v186, v166 row_shl:2 row_mask:0xf bank_mask:0xf
	v_dot2c_f32_bf16 v190, v177, v167
	v_dot2c_f32_bf16_dpp v191, v177, v167 row_shr:2 row_mask:0xf bank_mask:0xf
	v_dot2c_f32_bf16_dpp v192, v177, v167 row_shr:4 row_mask:0xf bank_mask:0xf
	v_dot2c_f32_bf16_dpp v193, v177, v167 row_shr:6 row_mask:0xf bank_mask:0xf
	v_dot2c_f32_bf16_dpp v194, v177, v167 row_shr:8 row_mask:0xf bank_mask:0xf
	v_dot2c_f32_bf16_dpp v195, v177, v167 row_shr:10 row_mask:0xf bank_mask:0xf
	v_dot2c_f32_bf16_dpp v196, v177, v167 row_shr:12 row_mask:0xf bank_mask:0xf
	v_dot2c_f32_bf16_dpp v197, v177, v167 row_shr:14 row_mask:0xf bank_mask:0xf
	v_dot2c_f32_bf16_dpp v191, v187, v167 row_shl:14 row_mask:0xf bank_mask:0xf
	v_dot2c_f32_bf16_dpp v192, v187, v167 row_shl:12 row_mask:0xf bank_mask:0xf
	v_dot2c_f32_bf16_dpp v193, v187, v167 row_shl:10 row_mask:0xf bank_mask:0xf
	v_dot2c_f32_bf16_dpp v194, v187, v167 row_shl:8 row_mask:0xf bank_mask:0xf
	v_dot2c_f32_bf16_dpp v195, v187, v167 row_shl:6 row_mask:0xf bank_mask:0xf
	v_dot2c_f32_bf16_dpp v196, v187, v167 row_shl:4 row_mask:0xf bank_mask:0xf
	v_dot2c_f32_bf16_dpp v197, v187, v167 row_shl:2 row_mask:0xf bank_mask:0xf
	v_dot2c_f32_bf16 v190, v178, v168
	v_dot2c_f32_bf16_dpp v191, v178, v168 row_shr:2 row_mask:0xf bank_mask:0xf
	v_dot2c_f32_bf16_dpp v192, v178, v168 row_shr:4 row_mask:0xf bank_mask:0xf
	v_dot2c_f32_bf16_dpp v193, v178, v168 row_shr:6 row_mask:0xf bank_mask:0xf
	v_dot2c_f32_bf16_dpp v194, v178, v168 row_shr:8 row_mask:0xf bank_mask:0xf
	v_dot2c_f32_bf16_dpp v195, v178, v168 row_shr:10 row_mask:0xf bank_mask:0xf
	v_dot2c_f32_bf16_dpp v196, v178, v168 row_shr:12 row_mask:0xf bank_mask:0xf
	v_dot2c_f32_bf16_dpp v197, v178, v168 row_shr:14 row_mask:0xf bank_mask:0xf
	v_dot2c_f32_bf16_dpp v191, v188, v168 row_shl:14 row_mask:0xf bank_mask:0xf
	v_dot2c_f32_bf16_dpp v192, v188, v168 row_shl:12 row_mask:0xf bank_mask:0xf
	v_dot2c_f32_bf16_dpp v193, v188, v168 row_shl:10 row_mask:0xf bank_mask:0xf
	v_dot2c_f32_bf16_dpp v194, v188, v168 row_shl:8 row_mask:0xf bank_mask:0xf
	v_dot2c_f32_bf16_dpp v195, v188, v168 row_shl:6 row_mask:0xf bank_mask:0xf
	v_dot2c_f32_bf16_dpp v196, v188, v168 row_shl:4 row_mask:0xf bank_mask:0xf
	v_dot2c_f32_bf16_dpp v197, v188, v168 row_shl:2 row_mask:0xf bank_mask:0xf
	v_dot2c_f32_bf16 v190, v179, v169
	v_dot2c_f32_bf16_dpp v191, v179, v169 row_shr:2 row_mask:0xf bank_mask:0xf
	v_dot2c_f32_bf16_dpp v192, v179, v169 row_shr:4 row_mask:0xf bank_mask:0xf
	v_dot2c_f32_bf16_dpp v193, v179, v169 row_shr:6 row_mask:0xf bank_mask:0xf
	v_dot2c_f32_bf16_dpp v194, v179, v169 row_shr:8 row_mask:0xf bank_mask:0xf
	v_dot2c_f32_bf16_dpp v195, v179, v169 row_shr:10 row_mask:0xf bank_mask:0xf
	v_dot2c_f32_bf16_dpp v196, v179, v169 row_shr:12 row_mask:0xf bank_mask:0xf
	v_dot2c_f32_bf16_dpp v197, v179, v169 row_shr:14 row_mask:0xf bank_mask:0xf
	v_dot2c_f32_bf16_dpp v191, v189, v169 row_shl:14 row_mask:0xf bank_mask:0xf
	v_dot2c_f32_bf16_dpp v192, v189, v169 row_shl:12 row_mask:0xf bank_mask:0xf
	v_dot2c_f32_bf16_dpp v193, v189, v169 row_shl:10 row_mask:0xf bank_mask:0xf
	v_dot2c_f32_bf16_dpp v194, v189, v169 row_shl:8 row_mask:0xf bank_mask:0xf
	v_dot2c_f32_bf16_dpp v195, v189, v169 row_shl:6 row_mask:0xf bank_mask:0xf
	v_dot2c_f32_bf16_dpp v196, v189, v169 row_shl:4 row_mask:0xf bank_mask:0xf
	v_dot2c_f32_bf16_dpp v197, v189, v169 row_shl:2 row_mask:0xf bank_mask:0xf
	v_cmp_le_u32 vcc, 2, v8
	s_nop 1
	v_cndmask_b32 v191, v9, v191, vcc
	v_cmp_le_u32 vcc, 4, v8
	s_nop 1
	v_cndmask_b32 v192, v9, v192, vcc
	v_cmp_le_u32 vcc, 6, v8
	s_nop 1
	v_cndmask_b32 v193, v9, v193, vcc
	v_cmp_le_u32 vcc, 8, v8
	s_nop 1
	v_cndmask_b32 v194, v9, v194, vcc
	v_cmp_le_u32 vcc, 10, v8
	s_nop 1
	v_cndmask_b32 v195, v9, v195, vcc
	v_cmp_le_u32 vcc, 12, v8
	s_nop 1
	v_cndmask_b32 v196, v9, v196, vcc
	v_cmp_le_u32 vcc, 14, v8
	s_nop 1
	v_cndmask_b32 v197, v9, v197, vcc
	v_max3_f32 v12, v190, v191, v192
	v_max3_f32 v12, v12, v193, v194
	v_max3_f32 v12, v12, v195, v196
	v_max_f32 v12, v12, v197
	v_mul_f32 v12, s65, v12
	v_fma_f32 v190, v190, s65, -v12
	v_fma_f32 v191, v191, s65, -v12
	v_fma_f32 v192, v192, s65, -v12
	v_fma_f32 v193, v193, s65, -v12
	v_fma_f32 v194, v194, s65, -v12
	v_fma_f32 v195, v195, s65, -v12
	v_fma_f32 v196, v196, s65, -v12
	v_fma_f32 v197, v197, s65, -v12
	v_exp_f32 v190, v190
	v_exp_f32 v191, v191
	v_exp_f32 v192, v192
	v_exp_f32 v193, v193
	v_exp_f32 v194, v194
	v_exp_f32 v195, v195
	v_exp_f32 v196, v196
	v_exp_f32 v197, v197
	v_add_f32 v12, v190, v191
	v_add_f32 v12, v12, v192
	v_add_f32 v12, v12, v193
	v_add_f32 v12, v12, v194
	v_add_f32 v12, v12, v195
	v_add_f32 v12, v12, v196
	v_add_f32 v12, v12, v197
	v_rcp_f32 v12, v12
	s_nop 0
	v_mul_f32 v190, v190, v12
	v_mul_f32 v191, v191, v12
	v_mul_f32 v192, v192, v12
	v_mul_f32 v193, v193, v12
	v_mul_f32 v194, v194, v12
	v_mul_f32 v195, v195, v12
	v_mul_f32 v196, v196, v12
	v_mul_f32 v197, v197, v12
	v_mul_f32 v32, v92, v190
	v_mul_f32 v33, v93, v190
	v_mul_f32 v34, v94, v190
	v_mul_f32 v35, v95, v190
	v_mul_f32 v36, v96, v190
	v_mul_f32 v37, v97, v190
	v_mul_f32 v38, v98, v190
	v_mul_f32 v39, v99, v190
	v_mul_f32 v40, v100, v190
	v_mul_f32 v41, v101, v190
	v_mul_f32 v42, v102, v190
	v_mul_f32 v43, v103, v190
	v_mul_f32 v44, v104, v190
	v_mul_f32 v45, v105, v190
	v_mul_f32 v46, v106, v190
	v_mul_f32 v47, v107, v190
	v_mul_f32 v48, v108, v190
	v_mul_f32 v49, v109, v190
	v_mul_f32 v50, v110, v190
	v_mul_f32 v51, v111, v190
	v_fmac_f32_dpp v32, v92, v191 row_shr:2 row_mask:0xf bank_mask:0xf
	v_fmac_f32_dpp v33, v93, v191 row_shr:2 row_mask:0xf bank_mask:0xf
	v_fmac_f32_dpp v34, v94, v191 row_shr:2 row_mask:0xf bank_mask:0xf
	v_fmac_f32_dpp v35, v95, v191 row_shr:2 row_mask:0xf bank_mask:0xf
	v_fmac_f32_dpp v36, v96, v191 row_shr:2 row_mask:0xf bank_mask:0xf
	v_fmac_f32_dpp v37, v97, v191 row_shr:2 row_mask:0xf bank_mask:0xf
	v_fmac_f32_dpp v38, v98, v191 row_shr:2 row_mask:0xf bank_mask:0xf
	v_fmac_f32_dpp v39, v99, v191 row_shr:2 row_mask:0xf bank_mask:0xf
	v_fmac_f32_dpp v40, v100, v191 row_shr:2 row_mask:0xf bank_mask:0xf
	v_fmac_f32_dpp v41, v101, v191 row_shr:2 row_mask:0xf bank_mask:0xf
	v_fmac_f32_dpp v42, v102, v191 row_shr:2 row_mask:0xf bank_mask:0xf
	v_fmac_f32_dpp v43, v103, v191 row_shr:2 row_mask:0xf bank_mask:0xf
	v_fmac_f32_dpp v44, v104, v191 row_shr:2 row_mask:0xf bank_mask:0xf
	v_fmac_f32_dpp v45, v105, v191 row_shr:2 row_mask:0xf bank_mask:0xf
	v_fmac_f32_dpp v46, v106, v191 row_shr:2 row_mask:0xf bank_mask:0xf
	v_fmac_f32_dpp v47, v107, v191 row_shr:2 row_mask:0xf bank_mask:0xf
	v_fmac_f32_dpp v48, v108, v191 row_shr:2 row_mask:0xf bank_mask:0xf
	v_fmac_f32_dpp v49, v109, v191 row_shr:2 row_mask:0xf bank_mask:0xf
	v_fmac_f32_dpp v50, v110, v191 row_shr:2 row_mask:0xf bank_mask:0xf
	v_fmac_f32_dpp v51, v111, v191 row_shr:2 row_mask:0xf bank_mask:0xf
	v_fmac_f32_dpp v32, v112, v191 row_shl:14 row_mask:0xf bank_mask:0xf
	v_fmac_f32_dpp v33, v113, v191 row_shl:14 row_mask:0xf bank_mask:0xf
	v_fmac_f32_dpp v34, v114, v191 row_shl:14 row_mask:0xf bank_mask:0xf
	v_fmac_f32_dpp v35, v115, v191 row_shl:14 row_mask:0xf bank_mask:0xf
	v_fmac_f32_dpp v36, v116, v191 row_shl:14 row_mask:0xf bank_mask:0xf
	v_fmac_f32_dpp v37, v117, v191 row_shl:14 row_mask:0xf bank_mask:0xf
	v_fmac_f32_dpp v38, v118, v191 row_shl:14 row_mask:0xf bank_mask:0xf
	v_fmac_f32_dpp v39, v119, v191 row_shl:14 row_mask:0xf bank_mask:0xf
	v_fmac_f32_dpp v40, v120, v191 row_shl:14 row_mask:0xf bank_mask:0xf
	v_fmac_f32_dpp v41, v121, v191 row_shl:14 row_mask:0xf bank_mask:0xf
	v_fmac_f32_dpp v42, v122, v191 row_shl:14 row_mask:0xf bank_mask:0xf
	v_fmac_f32_dpp v43, v123, v191 row_shl:14 row_mask:0xf bank_mask:0xf
	v_fmac_f32_dpp v44, v124, v191 row_shl:14 row_mask:0xf bank_mask:0xf
	v_fmac_f32_dpp v45, v125, v191 row_shl:14 row_mask:0xf bank_mask:0xf
	v_fmac_f32_dpp v46, v126, v191 row_shl:14 row_mask:0xf bank_mask:0xf
	v_fmac_f32_dpp v47, v127, v191 row_shl:14 row_mask:0xf bank_mask:0xf
	v_fmac_f32_dpp v48, v128, v191 row_shl:14 row_mask:0xf bank_mask:0xf
	v_fmac_f32_dpp v49, v129, v191 row_shl:14 row_mask:0xf bank_mask:0xf
	v_fmac_f32_dpp v50, v130, v191 row_shl:14 row_mask:0xf bank_mask:0xf
	v_fmac_f32_dpp v51, v131, v191 row_shl:14 row_mask:0xf bank_mask:0xf
	v_fmac_f32_dpp v32, v92, v192 row_shr:4 row_mask:0xf bank_mask:0xf
	v_fmac_f32_dpp v33, v93, v192 row_shr:4 row_mask:0xf bank_mask:0xf
	v_fmac_f32_dpp v34, v94, v192 row_shr:4 row_mask:0xf bank_mask:0xf
	v_fmac_f32_dpp v35, v95, v192 row_shr:4 row_mask:0xf bank_mask:0xf
	v_fmac_f32_dpp v36, v96, v192 row_shr:4 row_mask:0xf bank_mask:0xf
	v_fmac_f32_dpp v37, v97, v192 row_shr:4 row_mask:0xf bank_mask:0xf
	v_fmac_f32_dpp v38, v98, v192 row_shr:4 row_mask:0xf bank_mask:0xf
	v_fmac_f32_dpp v39, v99, v192 row_shr:4 row_mask:0xf bank_mask:0xf
	v_fmac_f32_dpp v40, v100, v192 row_shr:4 row_mask:0xf bank_mask:0xf
	v_fmac_f32_dpp v41, v101, v192 row_shr:4 row_mask:0xf bank_mask:0xf
	v_fmac_f32_dpp v42, v102, v192 row_shr:4 row_mask:0xf bank_mask:0xf
	v_fmac_f32_dpp v43, v103, v192 row_shr:4 row_mask:0xf bank_mask:0xf
	v_fmac_f32_dpp v44, v104, v192 row_shr:4 row_mask:0xf bank_mask:0xf
	v_fmac_f32_dpp v45, v105, v192 row_shr:4 row_mask:0xf bank_mask:0xf
	v_fmac_f32_dpp v46, v106, v192 row_shr:4 row_mask:0xf bank_mask:0xf
	v_fmac_f32_dpp v47, v107, v192 row_shr:4 row_mask:0xf bank_mask:0xf
	v_fmac_f32_dpp v48, v108, v192 row_shr:4 row_mask:0xf bank_mask:0xf
	v_fmac_f32_dpp v49, v109, v192 row_shr:4 row_mask:0xf bank_mask:0xf
	v_fmac_f32_dpp v50, v110, v192 row_shr:4 row_mask:0xf bank_mask:0xf
	v_fmac_f32_dpp v51, v111, v192 row_shr:4 row_mask:0xf bank_mask:0xf
	v_fmac_f32_dpp v32, v112, v192 row_shl:12 row_mask:0xf bank_mask:0xf
	v_fmac_f32_dpp v33, v113, v192 row_shl:12 row_mask:0xf bank_mask:0xf
	v_fmac_f32_dpp v34, v114, v192 row_shl:12 row_mask:0xf bank_mask:0xf
	v_fmac_f32_dpp v35, v115, v192 row_shl:12 row_mask:0xf bank_mask:0xf
	v_fmac_f32_dpp v36, v116, v192 row_shl:12 row_mask:0xf bank_mask:0xf
	v_fmac_f32_dpp v37, v117, v192 row_shl:12 row_mask:0xf bank_mask:0xf
	v_fmac_f32_dpp v38, v118, v192 row_shl:12 row_mask:0xf bank_mask:0xf
	v_fmac_f32_dpp v39, v119, v192 row_shl:12 row_mask:0xf bank_mask:0xf
	v_fmac_f32_dpp v40, v120, v192 row_shl:12 row_mask:0xf bank_mask:0xf
	v_fmac_f32_dpp v41, v121, v192 row_shl:12 row_mask:0xf bank_mask:0xf
	v_fmac_f32_dpp v42, v122, v192 row_shl:12 row_mask:0xf bank_mask:0xf
	v_fmac_f32_dpp v43, v123, v192 row_shl:12 row_mask:0xf bank_mask:0xf
	v_fmac_f32_dpp v44, v124, v192 row_shl:12 row_mask:0xf bank_mask:0xf
	v_fmac_f32_dpp v45, v125, v192 row_shl:12 row_mask:0xf bank_mask:0xf
	v_fmac_f32_dpp v46, v126, v192 row_shl:12 row_mask:0xf bank_mask:0xf
	v_fmac_f32_dpp v47, v127, v192 row_shl:12 row_mask:0xf bank_mask:0xf
	v_fmac_f32_dpp v48, v128, v192 row_shl:12 row_mask:0xf bank_mask:0xf
	v_fmac_f32_dpp v49, v129, v192 row_shl:12 row_mask:0xf bank_mask:0xf
	v_fmac_f32_dpp v50, v130, v192 row_shl:12 row_mask:0xf bank_mask:0xf
	v_fmac_f32_dpp v51, v131, v192 row_shl:12 row_mask:0xf bank_mask:0xf
	v_fmac_f32_dpp v32, v92, v193 row_shr:6 row_mask:0xf bank_mask:0xf
	v_fmac_f32_dpp v33, v93, v193 row_shr:6 row_mask:0xf bank_mask:0xf
	v_fmac_f32_dpp v34, v94, v193 row_shr:6 row_mask:0xf bank_mask:0xf
	v_fmac_f32_dpp v35, v95, v193 row_shr:6 row_mask:0xf bank_mask:0xf
	v_fmac_f32_dpp v36, v96, v193 row_shr:6 row_mask:0xf bank_mask:0xf
	v_fmac_f32_dpp v37, v97, v193 row_shr:6 row_mask:0xf bank_mask:0xf
	v_fmac_f32_dpp v38, v98, v193 row_shr:6 row_mask:0xf bank_mask:0xf
	v_fmac_f32_dpp v39, v99, v193 row_shr:6 row_mask:0xf bank_mask:0xf
	v_fmac_f32_dpp v40, v100, v193 row_shr:6 row_mask:0xf bank_mask:0xf
	v_fmac_f32_dpp v41, v101, v193 row_shr:6 row_mask:0xf bank_mask:0xf
	v_fmac_f32_dpp v42, v102, v193 row_shr:6 row_mask:0xf bank_mask:0xf
	v_fmac_f32_dpp v43, v103, v193 row_shr:6 row_mask:0xf bank_mask:0xf
	v_fmac_f32_dpp v44, v104, v193 row_shr:6 row_mask:0xf bank_mask:0xf
	v_fmac_f32_dpp v45, v105, v193 row_shr:6 row_mask:0xf bank_mask:0xf
	v_fmac_f32_dpp v46, v106, v193 row_shr:6 row_mask:0xf bank_mask:0xf
	v_fmac_f32_dpp v47, v107, v193 row_shr:6 row_mask:0xf bank_mask:0xf
	v_fmac_f32_dpp v48, v108, v193 row_shr:6 row_mask:0xf bank_mask:0xf
	v_fmac_f32_dpp v49, v109, v193 row_shr:6 row_mask:0xf bank_mask:0xf
	v_fmac_f32_dpp v50, v110, v193 row_shr:6 row_mask:0xf bank_mask:0xf
	v_fmac_f32_dpp v51, v111, v193 row_shr:6 row_mask:0xf bank_mask:0xf
	v_fmac_f32_dpp v32, v112, v193 row_shl:10 row_mask:0xf bank_mask:0xf
	v_fmac_f32_dpp v33, v113, v193 row_shl:10 row_mask:0xf bank_mask:0xf
	v_fmac_f32_dpp v34, v114, v193 row_shl:10 row_mask:0xf bank_mask:0xf
	v_fmac_f32_dpp v35, v115, v193 row_shl:10 row_mask:0xf bank_mask:0xf
	v_fmac_f32_dpp v36, v116, v193 row_shl:10 row_mask:0xf bank_mask:0xf
	v_fmac_f32_dpp v37, v117, v193 row_shl:10 row_mask:0xf bank_mask:0xf
	v_fmac_f32_dpp v38, v118, v193 row_shl:10 row_mask:0xf bank_mask:0xf
	v_fmac_f32_dpp v39, v119, v193 row_shl:10 row_mask:0xf bank_mask:0xf
	v_fmac_f32_dpp v40, v120, v193 row_shl:10 row_mask:0xf bank_mask:0xf
	v_fmac_f32_dpp v41, v121, v193 row_shl:10 row_mask:0xf bank_mask:0xf
	v_fmac_f32_dpp v42, v122, v193 row_shl:10 row_mask:0xf bank_mask:0xf
	v_fmac_f32_dpp v43, v123, v193 row_shl:10 row_mask:0xf bank_mask:0xf
	v_fmac_f32_dpp v44, v124, v193 row_shl:10 row_mask:0xf bank_mask:0xf
	v_fmac_f32_dpp v45, v125, v193 row_shl:10 row_mask:0xf bank_mask:0xf
	v_fmac_f32_dpp v46, v126, v193 row_shl:10 row_mask:0xf bank_mask:0xf
	v_fmac_f32_dpp v47, v127, v193 row_shl:10 row_mask:0xf bank_mask:0xf
	v_fmac_f32_dpp v48, v128, v193 row_shl:10 row_mask:0xf bank_mask:0xf
	v_fmac_f32_dpp v49, v129, v193 row_shl:10 row_mask:0xf bank_mask:0xf
	v_fmac_f32_dpp v50, v130, v193 row_shl:10 row_mask:0xf bank_mask:0xf
	v_fmac_f32_dpp v51, v131, v193 row_shl:10 row_mask:0xf bank_mask:0xf
	v_fmac_f32_dpp v32, v92, v194 row_shr:8 row_mask:0xf bank_mask:0xf
	v_fmac_f32_dpp v33, v93, v194 row_shr:8 row_mask:0xf bank_mask:0xf
	v_fmac_f32_dpp v34, v94, v194 row_shr:8 row_mask:0xf bank_mask:0xf
	v_fmac_f32_dpp v35, v95, v194 row_shr:8 row_mask:0xf bank_mask:0xf
	v_fmac_f32_dpp v36, v96, v194 row_shr:8 row_mask:0xf bank_mask:0xf
	v_fmac_f32_dpp v37, v97, v194 row_shr:8 row_mask:0xf bank_mask:0xf
	v_fmac_f32_dpp v38, v98, v194 row_shr:8 row_mask:0xf bank_mask:0xf
	v_fmac_f32_dpp v39, v99, v194 row_shr:8 row_mask:0xf bank_mask:0xf
	v_fmac_f32_dpp v40, v100, v194 row_shr:8 row_mask:0xf bank_mask:0xf
	v_fmac_f32_dpp v41, v101, v194 row_shr:8 row_mask:0xf bank_mask:0xf
	v_fmac_f32_dpp v42, v102, v194 row_shr:8 row_mask:0xf bank_mask:0xf
	v_fmac_f32_dpp v43, v103, v194 row_shr:8 row_mask:0xf bank_mask:0xf
	v_fmac_f32_dpp v44, v104, v194 row_shr:8 row_mask:0xf bank_mask:0xf
	v_fmac_f32_dpp v45, v105, v194 row_shr:8 row_mask:0xf bank_mask:0xf
	v_fmac_f32_dpp v46, v106, v194 row_shr:8 row_mask:0xf bank_mask:0xf
	v_fmac_f32_dpp v47, v107, v194 row_shr:8 row_mask:0xf bank_mask:0xf
	v_fmac_f32_dpp v48, v108, v194 row_shr:8 row_mask:0xf bank_mask:0xf
	v_fmac_f32_dpp v49, v109, v194 row_shr:8 row_mask:0xf bank_mask:0xf
	v_fmac_f32_dpp v50, v110, v194 row_shr:8 row_mask:0xf bank_mask:0xf
	v_fmac_f32_dpp v51, v111, v194 row_shr:8 row_mask:0xf bank_mask:0xf
	v_fmac_f32_dpp v32, v112, v194 row_shl:8 row_mask:0xf bank_mask:0xf
	v_fmac_f32_dpp v33, v113, v194 row_shl:8 row_mask:0xf bank_mask:0xf
	v_fmac_f32_dpp v34, v114, v194 row_shl:8 row_mask:0xf bank_mask:0xf
	v_fmac_f32_dpp v35, v115, v194 row_shl:8 row_mask:0xf bank_mask:0xf
	v_fmac_f32_dpp v36, v116, v194 row_shl:8 row_mask:0xf bank_mask:0xf
	v_fmac_f32_dpp v37, v117, v194 row_shl:8 row_mask:0xf bank_mask:0xf
	v_fmac_f32_dpp v38, v118, v194 row_shl:8 row_mask:0xf bank_mask:0xf
	v_fmac_f32_dpp v39, v119, v194 row_shl:8 row_mask:0xf bank_mask:0xf
	v_fmac_f32_dpp v40, v120, v194 row_shl:8 row_mask:0xf bank_mask:0xf
	v_fmac_f32_dpp v41, v121, v194 row_shl:8 row_mask:0xf bank_mask:0xf
	v_fmac_f32_dpp v42, v122, v194 row_shl:8 row_mask:0xf bank_mask:0xf
	v_fmac_f32_dpp v43, v123, v194 row_shl:8 row_mask:0xf bank_mask:0xf
	v_fmac_f32_dpp v44, v124, v194 row_shl:8 row_mask:0xf bank_mask:0xf
	v_fmac_f32_dpp v45, v125, v194 row_shl:8 row_mask:0xf bank_mask:0xf
	v_fmac_f32_dpp v46, v126, v194 row_shl:8 row_mask:0xf bank_mask:0xf
	v_fmac_f32_dpp v47, v127, v194 row_shl:8 row_mask:0xf bank_mask:0xf
	v_fmac_f32_dpp v48, v128, v194 row_shl:8 row_mask:0xf bank_mask:0xf
	v_fmac_f32_dpp v49, v129, v194 row_shl:8 row_mask:0xf bank_mask:0xf
	v_fmac_f32_dpp v50, v130, v194 row_shl:8 row_mask:0xf bank_mask:0xf
	v_fmac_f32_dpp v51, v131, v194 row_shl:8 row_mask:0xf bank_mask:0xf
	v_fmac_f32_dpp v32, v92, v195 row_shr:10 row_mask:0xf bank_mask:0xf
	v_fmac_f32_dpp v33, v93, v195 row_shr:10 row_mask:0xf bank_mask:0xf
	v_fmac_f32_dpp v34, v94, v195 row_shr:10 row_mask:0xf bank_mask:0xf
	v_fmac_f32_dpp v35, v95, v195 row_shr:10 row_mask:0xf bank_mask:0xf
	v_fmac_f32_dpp v36, v96, v195 row_shr:10 row_mask:0xf bank_mask:0xf
	v_fmac_f32_dpp v37, v97, v195 row_shr:10 row_mask:0xf bank_mask:0xf
	v_fmac_f32_dpp v38, v98, v195 row_shr:10 row_mask:0xf bank_mask:0xf
	v_fmac_f32_dpp v39, v99, v195 row_shr:10 row_mask:0xf bank_mask:0xf
	v_fmac_f32_dpp v40, v100, v195 row_shr:10 row_mask:0xf bank_mask:0xf
	v_fmac_f32_dpp v41, v101, v195 row_shr:10 row_mask:0xf bank_mask:0xf
	v_fmac_f32_dpp v42, v102, v195 row_shr:10 row_mask:0xf bank_mask:0xf
	v_fmac_f32_dpp v43, v103, v195 row_shr:10 row_mask:0xf bank_mask:0xf
	v_fmac_f32_dpp v44, v104, v195 row_shr:10 row_mask:0xf bank_mask:0xf
	v_fmac_f32_dpp v45, v105, v195 row_shr:10 row_mask:0xf bank_mask:0xf
	v_fmac_f32_dpp v46, v106, v195 row_shr:10 row_mask:0xf bank_mask:0xf
	v_fmac_f32_dpp v47, v107, v195 row_shr:10 row_mask:0xf bank_mask:0xf
	v_fmac_f32_dpp v48, v108, v195 row_shr:10 row_mask:0xf bank_mask:0xf
	v_fmac_f32_dpp v49, v109, v195 row_shr:10 row_mask:0xf bank_mask:0xf
	v_fmac_f32_dpp v50, v110, v195 row_shr:10 row_mask:0xf bank_mask:0xf
	v_fmac_f32_dpp v51, v111, v195 row_shr:10 row_mask:0xf bank_mask:0xf
	v_fmac_f32_dpp v32, v112, v195 row_shl:6 row_mask:0xf bank_mask:0xf
	v_fmac_f32_dpp v33, v113, v195 row_shl:6 row_mask:0xf bank_mask:0xf
	v_fmac_f32_dpp v34, v114, v195 row_shl:6 row_mask:0xf bank_mask:0xf
	v_fmac_f32_dpp v35, v115, v195 row_shl:6 row_mask:0xf bank_mask:0xf
	v_fmac_f32_dpp v36, v116, v195 row_shl:6 row_mask:0xf bank_mask:0xf
	v_fmac_f32_dpp v37, v117, v195 row_shl:6 row_mask:0xf bank_mask:0xf
	v_fmac_f32_dpp v38, v118, v195 row_shl:6 row_mask:0xf bank_mask:0xf
	v_fmac_f32_dpp v39, v119, v195 row_shl:6 row_mask:0xf bank_mask:0xf
	v_fmac_f32_dpp v40, v120, v195 row_shl:6 row_mask:0xf bank_mask:0xf
	v_fmac_f32_dpp v41, v121, v195 row_shl:6 row_mask:0xf bank_mask:0xf
	v_fmac_f32_dpp v42, v122, v195 row_shl:6 row_mask:0xf bank_mask:0xf
	v_fmac_f32_dpp v43, v123, v195 row_shl:6 row_mask:0xf bank_mask:0xf
	v_fmac_f32_dpp v44, v124, v195 row_shl:6 row_mask:0xf bank_mask:0xf
	v_fmac_f32_dpp v45, v125, v195 row_shl:6 row_mask:0xf bank_mask:0xf
	v_fmac_f32_dpp v46, v126, v195 row_shl:6 row_mask:0xf bank_mask:0xf
	v_fmac_f32_dpp v47, v127, v195 row_shl:6 row_mask:0xf bank_mask:0xf
	v_fmac_f32_dpp v48, v128, v195 row_shl:6 row_mask:0xf bank_mask:0xf
	v_fmac_f32_dpp v49, v129, v195 row_shl:6 row_mask:0xf bank_mask:0xf
	v_fmac_f32_dpp v50, v130, v195 row_shl:6 row_mask:0xf bank_mask:0xf
	v_fmac_f32_dpp v51, v131, v195 row_shl:6 row_mask:0xf bank_mask:0xf
	v_fmac_f32_dpp v32, v92, v196 row_shr:12 row_mask:0xf bank_mask:0xf
	v_fmac_f32_dpp v33, v93, v196 row_shr:12 row_mask:0xf bank_mask:0xf
	v_fmac_f32_dpp v34, v94, v196 row_shr:12 row_mask:0xf bank_mask:0xf
	v_fmac_f32_dpp v35, v95, v196 row_shr:12 row_mask:0xf bank_mask:0xf
	v_fmac_f32_dpp v36, v96, v196 row_shr:12 row_mask:0xf bank_mask:0xf
	v_fmac_f32_dpp v37, v97, v196 row_shr:12 row_mask:0xf bank_mask:0xf
	v_fmac_f32_dpp v38, v98, v196 row_shr:12 row_mask:0xf bank_mask:0xf
	v_fmac_f32_dpp v39, v99, v196 row_shr:12 row_mask:0xf bank_mask:0xf
	v_fmac_f32_dpp v40, v100, v196 row_shr:12 row_mask:0xf bank_mask:0xf
	v_fmac_f32_dpp v41, v101, v196 row_shr:12 row_mask:0xf bank_mask:0xf
	v_fmac_f32_dpp v42, v102, v196 row_shr:12 row_mask:0xf bank_mask:0xf
	v_fmac_f32_dpp v43, v103, v196 row_shr:12 row_mask:0xf bank_mask:0xf
	v_fmac_f32_dpp v44, v104, v196 row_shr:12 row_mask:0xf bank_mask:0xf
	v_fmac_f32_dpp v45, v105, v196 row_shr:12 row_mask:0xf bank_mask:0xf
	v_fmac_f32_dpp v46, v106, v196 row_shr:12 row_mask:0xf bank_mask:0xf
	v_fmac_f32_dpp v47, v107, v196 row_shr:12 row_mask:0xf bank_mask:0xf
	v_fmac_f32_dpp v48, v108, v196 row_shr:12 row_mask:0xf bank_mask:0xf
	v_fmac_f32_dpp v49, v109, v196 row_shr:12 row_mask:0xf bank_mask:0xf
	v_fmac_f32_dpp v50, v110, v196 row_shr:12 row_mask:0xf bank_mask:0xf
	v_fmac_f32_dpp v51, v111, v196 row_shr:12 row_mask:0xf bank_mask:0xf
	v_fmac_f32_dpp v32, v112, v196 row_shl:4 row_mask:0xf bank_mask:0xf
	v_fmac_f32_dpp v33, v113, v196 row_shl:4 row_mask:0xf bank_mask:0xf
	v_fmac_f32_dpp v34, v114, v196 row_shl:4 row_mask:0xf bank_mask:0xf
	v_fmac_f32_dpp v35, v115, v196 row_shl:4 row_mask:0xf bank_mask:0xf
	v_fmac_f32_dpp v36, v116, v196 row_shl:4 row_mask:0xf bank_mask:0xf
	v_fmac_f32_dpp v37, v117, v196 row_shl:4 row_mask:0xf bank_mask:0xf
	v_fmac_f32_dpp v38, v118, v196 row_shl:4 row_mask:0xf bank_mask:0xf
	v_fmac_f32_dpp v39, v119, v196 row_shl:4 row_mask:0xf bank_mask:0xf
	v_fmac_f32_dpp v40, v120, v196 row_shl:4 row_mask:0xf bank_mask:0xf
	v_fmac_f32_dpp v41, v121, v196 row_shl:4 row_mask:0xf bank_mask:0xf
	v_fmac_f32_dpp v42, v122, v196 row_shl:4 row_mask:0xf bank_mask:0xf
	v_fmac_f32_dpp v43, v123, v196 row_shl:4 row_mask:0xf bank_mask:0xf
	v_fmac_f32_dpp v44, v124, v196 row_shl:4 row_mask:0xf bank_mask:0xf
	v_fmac_f32_dpp v45, v125, v196 row_shl:4 row_mask:0xf bank_mask:0xf
	v_fmac_f32_dpp v46, v126, v196 row_shl:4 row_mask:0xf bank_mask:0xf
	v_fmac_f32_dpp v47, v127, v196 row_shl:4 row_mask:0xf bank_mask:0xf
	v_fmac_f32_dpp v48, v128, v196 row_shl:4 row_mask:0xf bank_mask:0xf
	v_fmac_f32_dpp v49, v129, v196 row_shl:4 row_mask:0xf bank_mask:0xf
	v_fmac_f32_dpp v50, v130, v196 row_shl:4 row_mask:0xf bank_mask:0xf
	v_fmac_f32_dpp v51, v131, v196 row_shl:4 row_mask:0xf bank_mask:0xf
	v_fmac_f32_dpp v32, v92, v197 row_shr:14 row_mask:0xf bank_mask:0xf
	v_fmac_f32_dpp v33, v93, v197 row_shr:14 row_mask:0xf bank_mask:0xf
	v_fmac_f32_dpp v34, v94, v197 row_shr:14 row_mask:0xf bank_mask:0xf
	v_fmac_f32_dpp v35, v95, v197 row_shr:14 row_mask:0xf bank_mask:0xf
	v_fmac_f32_dpp v36, v96, v197 row_shr:14 row_mask:0xf bank_mask:0xf
	v_fmac_f32_dpp v37, v97, v197 row_shr:14 row_mask:0xf bank_mask:0xf
	v_fmac_f32_dpp v38, v98, v197 row_shr:14 row_mask:0xf bank_mask:0xf
	v_fmac_f32_dpp v39, v99, v197 row_shr:14 row_mask:0xf bank_mask:0xf
	v_fmac_f32_dpp v40, v100, v197 row_shr:14 row_mask:0xf bank_mask:0xf
	v_fmac_f32_dpp v41, v101, v197 row_shr:14 row_mask:0xf bank_mask:0xf
	v_fmac_f32_dpp v42, v102, v197 row_shr:14 row_mask:0xf bank_mask:0xf
	v_fmac_f32_dpp v43, v103, v197 row_shr:14 row_mask:0xf bank_mask:0xf
	v_fmac_f32_dpp v44, v104, v197 row_shr:14 row_mask:0xf bank_mask:0xf
	v_fmac_f32_dpp v45, v105, v197 row_shr:14 row_mask:0xf bank_mask:0xf
	v_fmac_f32_dpp v46, v106, v197 row_shr:14 row_mask:0xf bank_mask:0xf
	v_fmac_f32_dpp v47, v107, v197 row_shr:14 row_mask:0xf bank_mask:0xf
	v_fmac_f32_dpp v48, v108, v197 row_shr:14 row_mask:0xf bank_mask:0xf
	v_fmac_f32_dpp v49, v109, v197 row_shr:14 row_mask:0xf bank_mask:0xf
	v_fmac_f32_dpp v50, v110, v197 row_shr:14 row_mask:0xf bank_mask:0xf
	v_fmac_f32_dpp v51, v111, v197 row_shr:14 row_mask:0xf bank_mask:0xf
	v_fmac_f32_dpp v32, v112, v197 row_shl:2 row_mask:0xf bank_mask:0xf
	v_fmac_f32_dpp v33, v113, v197 row_shl:2 row_mask:0xf bank_mask:0xf
	v_fmac_f32_dpp v34, v114, v197 row_shl:2 row_mask:0xf bank_mask:0xf
	v_fmac_f32_dpp v35, v115, v197 row_shl:2 row_mask:0xf bank_mask:0xf
	v_fmac_f32_dpp v36, v116, v197 row_shl:2 row_mask:0xf bank_mask:0xf
	v_fmac_f32_dpp v37, v117, v197 row_shl:2 row_mask:0xf bank_mask:0xf
	v_fmac_f32_dpp v38, v118, v197 row_shl:2 row_mask:0xf bank_mask:0xf
	v_fmac_f32_dpp v39, v119, v197 row_shl:2 row_mask:0xf bank_mask:0xf
	v_fmac_f32_dpp v40, v120, v197 row_shl:2 row_mask:0xf bank_mask:0xf
	v_fmac_f32_dpp v41, v121, v197 row_shl:2 row_mask:0xf bank_mask:0xf
	v_fmac_f32_dpp v42, v122, v197 row_shl:2 row_mask:0xf bank_mask:0xf
	v_fmac_f32_dpp v43, v123, v197 row_shl:2 row_mask:0xf bank_mask:0xf
	v_fmac_f32_dpp v44, v124, v197 row_shl:2 row_mask:0xf bank_mask:0xf
	v_fmac_f32_dpp v45, v125, v197 row_shl:2 row_mask:0xf bank_mask:0xf
	v_fmac_f32_dpp v46, v126, v197 row_shl:2 row_mask:0xf bank_mask:0xf
	v_fmac_f32_dpp v47, v127, v197 row_shl:2 row_mask:0xf bank_mask:0xf
	v_fmac_f32_dpp v48, v128, v197 row_shl:2 row_mask:0xf bank_mask:0xf
	v_fmac_f32_dpp v49, v129, v197 row_shl:2 row_mask:0xf bank_mask:0xf
	v_fmac_f32_dpp v50, v130, v197 row_shl:2 row_mask:0xf bank_mask:0xf
	v_fmac_f32_dpp v51, v131, v197 row_shl:2 row_mask:0xf bank_mask:0xf
	v_cvt_pk_bf16_f32 v160, v32, v33
	v_accvgpr_write_b32 a230, v160
	v_cvt_pk_bf16_f32 v161, v34, v35
	v_accvgpr_write_b32 a231, v161
	v_cvt_pk_bf16_f32 v162, v36, v37
	v_accvgpr_write_b32 a232, v162
	v_cvt_pk_bf16_f32 v163, v38, v39
	v_accvgpr_write_b32 a233, v163
	v_cvt_pk_bf16_f32 v164, v40, v41
	v_accvgpr_write_b32 a234, v164
	v_cvt_pk_bf16_f32 v165, v42, v43
	v_accvgpr_write_b32 a235, v165
	v_cvt_pk_bf16_f32 v166, v44, v45
	v_accvgpr_write_b32 a236, v166
	v_cvt_pk_bf16_f32 v167, v46, v47
	v_accvgpr_write_b32 a237, v167
	v_cvt_pk_bf16_f32 v168, v48, v49
	v_accvgpr_write_b32 a238, v168
	v_cvt_pk_bf16_f32 v169, v50, v51
	v_accvgpr_write_b32 a239, v169
	s_add_u32 s62, s62, 1
	s_cmp_lt_u32 s62, 8
	s_cbranch_scc1 L_bg_172
	v_add_u32 v20, 0, v0
	v_mul_u32_u24 v21, 820, v20
	v_lshrrev_b32 v21, 16, v21
	s_and_b32 s6, s5, 1
	s_lshl_b32 s6, s6, 2
	v_add_u32 v22, s6, v21
	v_lshlrev_b32 v22, 1, v22
	v_xor_b32 v20, v20, v22
	s_mul_i32 s6, s5, 25600
	v_lshl_add_u32 v1, v20, 4, s6
	v_add_u32 v20, 64, v0
	v_mul_u32_u24 v21, 820, v20
	v_lshrrev_b32 v21, 16, v21
	s_and_b32 s6, s5, 1
	s_lshl_b32 s6, s6, 2
	v_add_u32 v22, s6, v21
	v_lshlrev_b32 v22, 1, v22
	v_xor_b32 v20, v20, v22
	s_mul_i32 s6, s5, 25600
	v_lshl_add_u32 v2, v20, 4, s6
	v_add_u32 v20, 128, v0
	v_mul_u32_u24 v21, 820, v20
	v_lshrrev_b32 v21, 16, v21
	s_and_b32 s6, s5, 1
	s_lshl_b32 s6, s6, 2
	v_add_u32 v22, s6, v21
	v_lshlrev_b32 v22, 1, v22
	v_xor_b32 v20, v20, v22
	s_mul_i32 s6, s5, 25600
	v_lshl_add_u32 v3, v20, 4, s6
	v_add_u32 v20, 192, v0
	v_mul_u32_u24 v21, 820, v20
	v_lshrrev_b32 v21, 16, v21
	s_and_b32 s6, s5, 1
	s_lshl_b32 s6, s6, 2
	v_add_u32 v22, s6, v21
	v_lshlrev_b32 v22, 1, v22
	v_xor_b32 v20, v20, v22
	s_mul_i32 s6, s5, 25600
	v_lshl_add_u32 v4, v20, 4, s6
	v_add_u32 v20, 256, v0
	v_mul_u32_u24 v21, 820, v20
	v_lshrrev_b32 v21, 16, v21
	s_and_b32 s6, s5, 1
	s_lshl_b32 s6, s6, 2
	v_add_u32 v22, s6, v21
	v_lshlrev_b32 v22, 1, v22
	v_xor_b32 v20, v20, v22
	s_mul_i32 s6, s5, 25600
	v_lshl_add_u32 v5, v20, 4, s6
	v_lshrrev_b32 v12, 4, v0
	s_mul_i32 s67, s5, 10240
	v_mul_u32_u24 v12, 10240, v12
	v_bfe_u32 v13, v0, 2, 2
	v_mul_u32_u24 v13, 1280, v13
	v_and_b32 v14, 3, v0
	v_lshl_add_u32 v13, v14, 3, v13
	v_add_u32 v12, v12, v13
	v_bfe_u32 v13, v0, 2, 3
	v_xor_b32 v14, 0, v13
	v_lshl_add_u32 v16, v14, 5, v12
	v_add_u32 v24, 81920, v16
	v_xor_b32 v14, 1, v13
	v_lshl_add_u32 v17, v14, 5, v12
	v_add_u32 v25, 81920, v17
	v_xor_b32 v14, 2, v13
	v_lshl_add_u32 v18, v14, 5, v12
	v_add_u32 v26, 81920, v18
	v_xor_b32 v14, 3, v13
	v_lshl_add_u32 v19, v14, 5, v12
	v_add_u32 v27, 81920, v19
	v_xor_b32 v14, 4, v13
	v_lshl_add_u32 v20, v14, 5, v12
	v_add_u32 v28, 81920, v20
	v_xor_b32 v14, 5, v13
	v_lshl_add_u32 v21, v14, 5, v12
	v_add_u32 v29, 81920, v21
	v_xor_b32 v14, 6, v13
	v_lshl_add_u32 v22, v14, 5, v12
	v_add_u32 v30, 81920, v22
	v_xor_b32 v14, 7, v13
	v_lshl_add_u32 v23, v14, 5, v12
	v_add_u32 v31, 81920, v23
	s_waitcnt vmcnt(0)
	s_barrier
	s_add_u32 m0, s67, 0
	s_mov_b32 s66, 0
	buffer_load_dwordx4 v1, s[52:55], s66 offen lds
	s_add_u32 m0, s67, 1024
	s_mov_b32 s66, 0
	buffer_load_dwordx4 v2, s[52:55], s66 offen lds
	s_add_u32 m0, s67, 2048
	s_mov_b32 s66, 0
	buffer_load_dwordx4 v3, s[52:55], s66 offen lds
	s_add_u32 m0, s67, 3072
	s_mov_b32 s66, 0
	buffer_load_dwordx4 v4, s[52:55], s66 offen lds
	s_add_u32 m0, s67, 4096
	s_mov_b32 s66, 0
	buffer_load_dwordx4 v5, s[52:55], s66 offen lds
	s_add_u32 m0, s67, 5120
	s_mov_b32 s66, 5120
	buffer_load_dwordx4 v1, s[52:55], s66 offen lds
	s_add_u32 m0, s67, 6144
	s_mov_b32 s66, 5120
	buffer_load_dwordx4 v2, s[52:55], s66 offen lds
	s_add_u32 m0, s67, 7168
	s_mov_b32 s66, 5120
	buffer_load_dwordx4 v3, s[52:55], s66 offen lds
	s_add_u32 m0, s67, 8192
	s_mov_b32 s66, 5120
	buffer_load_dwordx4 v4, s[52:55], s66 offen lds
	s_add_u32 m0, s67, 9216
	s_mov_b32 s66, 5120
	buffer_load_dwordx4 v5, s[52:55], s66 offen lds
	s_add_u32 m0, s67, 40960
	s_mov_b32 s66, 10240
	buffer_load_dwordx4 v1, s[52:55], s66 offen lds
	s_add_u32 m0, s67, 41984
	s_mov_b32 s66, 10240
	buffer_load_dwordx4 v2, s[52:55], s66 offen lds
	s_add_u32 m0, s67, 43008
	s_mov_b32 s66, 10240
	buffer_load_dwordx4 v3, s[52:55], s66 offen lds
	s_add_u32 m0, s67, 44032
	s_mov_b32 s66, 10240
	buffer_load_dwordx4 v4, s[52:55], s66 offen lds
	s_add_u32 m0, s67, 45056
	s_mov_b32 s66, 10240
	buffer_load_dwordx4 v5, s[52:55], s66 offen lds
	s_add_u32 m0, s67, 46080
	s_mov_b32 s66, 15360
	buffer_load_dwordx4 v1, s[52:55], s66 offen lds
	s_add_u32 m0, s67, 47104
	s_mov_b32 s66, 15360
	buffer_load_dwordx4 v2, s[52:55], s66 offen lds
	s_add_u32 m0, s67, 48128
	s_mov_b32 s66, 15360
	buffer_load_dwordx4 v3, s[52:55], s66 offen lds
	s_add_u32 m0, s67, 49152
	s_mov_b32 s66, 15360
	buffer_load_dwordx4 v4, s[52:55], s66 offen lds
	s_add_u32 m0, s67, 50176
	s_mov_b32 s66, 15360
	buffer_load_dwordx4 v5, s[52:55], s66 offen lds
	s_add_u32 m0, s67, 81920
	s_mov_b32 s66, 20480
	buffer_load_dwordx4 v1, s[52:55], s66 offen lds
	s_add_u32 m0, s67, 82944
	s_mov_b32 s66, 20480
	buffer_load_dwordx4 v2, s[52:55], s66 offen lds
	s_add_u32 m0, s67, 83968
	s_mov_b32 s66, 20480
	buffer_load_dwordx4 v3, s[52:55], s66 offen lds
	s_add_u32 m0, s67, 84992
	s_mov_b32 s66, 20480
	buffer_load_dwordx4 v4, s[52:55], s66 offen lds
	s_add_u32 m0, s67, 86016
	s_mov_b32 s66, 20480
	buffer_load_dwordx4 v5, s[52:55], s66 offen lds
	s_add_u32 m0, s67, 87040
	s_mov_b32 s66, 102400
	buffer_load_dwordx4 v1, s[52:55], s66 offen lds
	s_add_u32 m0, s67, 88064
	s_mov_b32 s66, 102400
	buffer_load_dwordx4 v2, s[52:55], s66 offen lds
	s_add_u32 m0, s67, 89088
	s_mov_b32 s66, 102400
	buffer_load_dwordx4 v3, s[52:55], s66 offen lds
	s_add_u32 m0, s67, 90112
	s_mov_b32 s66, 102400
	buffer_load_dwordx4 v4, s[52:55], s66 offen lds
	s_add_u32 m0, s67, 91136
	s_mov_b32 s66, 102400
	buffer_load_dwordx4 v5, s[52:55], s66 offen lds
	s_waitcnt vmcnt(20)
	s_barrier
	ds_read_b64_tr_b16 v[192:193], v16 offset:0
	ds_read_b64_tr_b16 v[194:195], v16 offset:5120
	ds_read_b64_tr_b16 v[196:197], v17 offset:0
	ds_read_b64_tr_b16 v[198:199], v17 offset:5120
	ds_read_b64_tr_b16 v[200:201], v18 offset:0
	ds_read_b64_tr_b16 v[202:203], v18 offset:5120
	ds_read_b64_tr_b16 v[204:205], v19 offset:0
	ds_read_b64_tr_b16 v[206:207], v19 offset:5120
	ds_read_b64_tr_b16 v[208:209], v20 offset:0
	ds_read_b64_tr_b16 v[210:211], v20 offset:5120
	ds_read_b64_tr_b16 v[212:213], v21 offset:0
	ds_read_b64_tr_b16 v[214:215], v21 offset:5120
	ds_read_b64_tr_b16 v[216:217], v22 offset:0
	ds_read_b64_tr_b16 v[218:219], v22 offset:5120
	s_waitcnt lgkmcnt(12)
	v_mfma_f32_16x16x32_bf16 v[32:35], v[192:195], a[160:163], 0
	ds_read_b64_tr_b16 v[220:221], v23 offset:0
	ds_read_b64_tr_b16 v[222:223], v23 offset:5120
	s_add_u32 m0, s67, 122880
	s_mov_b32 s66, 107520
	buffer_load_dwordx4 v1, s[52:55], s66 offen lds
	s_waitcnt lgkmcnt(12)
	v_mfma_f32_16x16x32_bf16 v[36:39], v[196:199], a[160:163], 0
	ds_read_b64_tr_b16 v[192:193], v16 offset:256
	ds_read_b64_tr_b16 v[194:195], v16 offset:5376
	s_waitcnt lgkmcnt(12)
	v_mfma_f32_16x16x32_bf16 v[40:43], v[200:203], a[160:163], 0
	ds_read_b64_tr_b16 v[196:197], v17 offset:256
	ds_read_b64_tr_b16 v[198:199], v17 offset:5376
	s_waitcnt lgkmcnt(12)
	v_mfma_f32_16x16x32_bf16 v[44:47], v[204:207], a[160:163], 0
	ds_read_b64_tr_b16 v[200:201], v18 offset:256
	ds_read_b64_tr_b16 v[202:203], v18 offset:5376
	s_waitcnt lgkmcnt(12)
	v_mfma_f32_16x16x32_bf16 v[48:51], v[208:211], a[160:163], 0
	ds_read_b64_tr_b16 v[204:205], v19 offset:256
	ds_read_b64_tr_b16 v[206:207], v19 offset:5376
	s_add_u32 m0, s67, 123904
	s_mov_b32 s66, 107520
	buffer_load_dwordx4 v2, s[52:55], s66 offen lds
	s_waitcnt lgkmcnt(12)
	v_mfma_f32_16x16x32_bf16 v[52:55], v[212:215], a[160:163], 0
	ds_read_b64_tr_b16 v[208:209], v20 offset:256
	ds_read_b64_tr_b16 v[210:211], v20 offset:5376
	s_waitcnt lgkmcnt(12)
	v_mfma_f32_16x16x32_bf16 v[56:59], v[216:219], a[160:163], 0
	ds_read_b64_tr_b16 v[212:213], v21 offset:256
	ds_read_b64_tr_b16 v[214:215], v21 offset:5376
	s_waitcnt lgkmcnt(12)
	v_mfma_f32_16x16x32_bf16 v[60:63], v[220:223], a[160:163], 0
	ds_read_b64_tr_b16 v[216:217], v22 offset:256
	ds_read_b64_tr_b16 v[218:219], v22 offset:5376
	s_waitcnt lgkmcnt(12)
	v_mfma_f32_16x16x32_bf16 v[64:67], v[192:195], a[160:163], 0
	ds_read_b64_tr_b16 v[220:221], v23 offset:256
	ds_read_b64_tr_b16 v[222:223], v23 offset:5376
	s_add_u32 m0, s67, 124928
	s_mov_b32 s66, 107520
	buffer_load_dwordx4 v3, s[52:55], s66 offen lds
	s_waitcnt lgkmcnt(12)
	v_mfma_f32_16x16x32_bf16 v[68:71], v[196:199], a[160:163], 0
	ds_read_b64_tr_b16 v[192:193], v16 offset:512
	ds_read_b64_tr_b16 v[194:195], v16 offset:5632
	s_waitcnt lgkmcnt(12)
	v_mfma_f32_16x16x32_bf16 v[72:75], v[200:203], a[160:163], 0
	ds_read_b64_tr_b16 v[196:197], v17 offset:512
	ds_read_b64_tr_b16 v[198:199], v17 offset:5632
	s_waitcnt lgkmcnt(12)
	v_mfma_f32_16x16x32_bf16 v[76:79], v[204:207], a[160:163], 0
	ds_read_b64_tr_b16 v[200:201], v18 offset:512
	ds_read_b64_tr_b16 v[202:203], v18 offset:5632
	s_waitcnt lgkmcnt(12)
	v_mfma_f32_16x16x32_bf16 v[80:83], v[208:211], a[160:163], 0
	ds_read_b64_tr_b16 v[204:205], v19 offset:512
	ds_read_b64_tr_b16 v[206:207], v19 offset:5632
	s_add_u32 m0, s67, 125952
	s_mov_b32 s66, 107520
	buffer_load_dwordx4 v4, s[52:55], s66 offen lds
	s_waitcnt lgkmcnt(12)
	v_mfma_f32_16x16x32_bf16 v[84:87], v[212:215], a[160:163], 0
	ds_read_b64_tr_b16 v[208:209], v20 offset:512
	ds_read_b64_tr_b16 v[210:211], v20 offset:5632
	s_waitcnt lgkmcnt(12)
	v_mfma_f32_16x16x32_bf16 v[88:91], v[216:219], a[160:163], 0
	ds_read_b64_tr_b16 v[212:213], v21 offset:512
	ds_read_b64_tr_b16 v[214:215], v21 offset:5632
	s_waitcnt lgkmcnt(12)
	v_mfma_f32_16x16x32_bf16 v[92:95], v[220:223], a[160:163], 0
	ds_read_b64_tr_b16 v[216:217], v22 offset:512
	ds_read_b64_tr_b16 v[218:219], v22 offset:5632
	s_waitcnt lgkmcnt(12)
	v_mfma_f32_16x16x32_bf16 v[96:99], v[192:195], a[160:163], 0
	ds_read_b64_tr_b16 v[220:221], v23 offset:512
	ds_read_b64_tr_b16 v[222:223], v23 offset:5632
	s_add_u32 m0, s67, 126976
	s_mov_b32 s66, 107520
	buffer_load_dwordx4 v5, s[52:55], s66 offen lds
	s_waitcnt lgkmcnt(12)
	v_mfma_f32_16x16x32_bf16 v[100:103], v[196:199], a[160:163], 0
	ds_read_b64_tr_b16 v[192:193], v16 offset:768
	ds_read_b64_tr_b16 v[194:195], v16 offset:5888
	s_waitcnt lgkmcnt(12)
	v_mfma_f32_16x16x32_bf16 v[104:107], v[200:203], a[160:163], 0
	ds_read_b64_tr_b16 v[196:197], v17 offset:768
	ds_read_b64_tr_b16 v[198:199], v17 offset:5888
	s_waitcnt lgkmcnt(12)
	v_mfma_f32_16x16x32_bf16 v[108:111], v[204:207], a[160:163], 0
	ds_read_b64_tr_b16 v[200:201], v18 offset:768
	ds_read_b64_tr_b16 v[202:203], v18 offset:5888
	s_waitcnt lgkmcnt(12)
	v_mfma_f32_16x16x32_bf16 v[112:115], v[208:211], a[160:163], 0
	ds_read_b64_tr_b16 v[204:205], v19 offset:768
	ds_read_b64_tr_b16 v[206:207], v19 offset:5888
	s_add_u32 m0, s67, 128000
	s_mov_b32 s66, 112640
	buffer_load_dwordx4 v1, s[52:55], s66 offen lds
	s_waitcnt lgkmcnt(12)
	v_mfma_f32_16x16x32_bf16 v[116:119], v[212:215], a[160:163], 0
	ds_read_b64_tr_b16 v[208:209], v20 offset:768
	ds_read_b64_tr_b16 v[210:211], v20 offset:5888
	s_waitcnt lgkmcnt(12)
	v_mfma_f32_16x16x32_bf16 v[120:123], v[216:219], a[160:163], 0
	ds_read_b64_tr_b16 v[212:213], v21 offset:768
	ds_read_b64_tr_b16 v[214:215], v21 offset:5888
	s_waitcnt lgkmcnt(12)
	v_mfma_f32_16x16x32_bf16 v[124:127], v[220:223], a[160:163], 0
	ds_read_b64_tr_b16 v[216:217], v22 offset:768
	ds_read_b64_tr_b16 v[218:219], v22 offset:5888
	s_waitcnt lgkmcnt(12)
	v_mfma_f32_16x16x32_bf16 v[128:131], v[192:195], a[160:163], 0
	ds_read_b64_tr_b16 v[220:221], v23 offset:768
	ds_read_b64_tr_b16 v[222:223], v23 offset:5888
	s_add_u32 m0, s67, 129024
	s_mov_b32 s66, 112640
	buffer_load_dwordx4 v2, s[52:55], s66 offen lds
	s_waitcnt lgkmcnt(12)
	v_mfma_f32_16x16x32_bf16 v[132:135], v[196:199], a[160:163], 0
	ds_read_b64_tr_b16 v[192:193], v16 offset:1024
	ds_read_b64_tr_b16 v[194:195], v16 offset:6144
	s_waitcnt lgkmcnt(12)
	v_mfma_f32_16x16x32_bf16 v[136:139], v[200:203], a[160:163], 0
	ds_read_b64_tr_b16 v[196:197], v17 offset:1024
	ds_read_b64_tr_b16 v[198:199], v17 offset:6144
	s_waitcnt lgkmcnt(12)
	v_mfma_f32_16x16x32_bf16 v[140:143], v[204:207], a[160:163], 0
	ds_read_b64_tr_b16 v[200:201], v18 offset:1024
	ds_read_b64_tr_b16 v[202:203], v18 offset:6144
	s_waitcnt lgkmcnt(12)
	v_mfma_f32_16x16x32_bf16 v[144:147], v[208:211], a[160:163], 0
	ds_read_b64_tr_b16 v[204:205], v19 offset:1024
	ds_read_b64_tr_b16 v[206:207], v19 offset:6144
	s_add_u32 m0, s67, 130048
	s_mov_b32 s66, 112640
	buffer_load_dwordx4 v3, s[52:55], s66 offen lds
	s_waitcnt lgkmcnt(12)
	v_mfma_f32_16x16x32_bf16 v[148:151], v[212:215], a[160:163], 0
	ds_read_b64_tr_b16 v[208:209], v20 offset:1024
	ds_read_b64_tr_b16 v[210:211], v20 offset:6144
	s_waitcnt lgkmcnt(12)
	v_mfma_f32_16x16x32_bf16 v[152:155], v[216:219], a[160:163], 0
	ds_read_b64_tr_b16 v[212:213], v21 offset:1024
	ds_read_b64_tr_b16 v[214:215], v21 offset:6144
	s_waitcnt lgkmcnt(12)
	v_mfma_f32_16x16x32_bf16 v[156:159], v[220:223], a[160:163], 0
	ds_read_b64_tr_b16 v[216:217], v22 offset:1024
	ds_read_b64_tr_b16 v[218:219], v22 offset:6144
	s_waitcnt lgkmcnt(12)
	v_mfma_f32_16x16x32_bf16 v[160:163], v[192:195], a[160:163], 0
	ds_read_b64_tr_b16 v[220:221], v23 offset:1024
	ds_read_b64_tr_b16 v[222:223], v23 offset:6144
	s_add_u32 m0, s67, 131072
	s_mov_b32 s66, 112640
	buffer_load_dwordx4 v4, s[52:55], s66 offen lds
	s_waitcnt lgkmcnt(12)
	v_mfma_f32_16x16x32_bf16 v[164:167], v[196:199], a[160:163], 0
	s_waitcnt lgkmcnt(10)
	v_mfma_f32_16x16x32_bf16 v[168:171], v[200:203], a[160:163], 0
	s_waitcnt lgkmcnt(8)
	v_mfma_f32_16x16x32_bf16 v[172:175], v[204:207], a[160:163], 0
	s_waitcnt lgkmcnt(6)
	v_mfma_f32_16x16x32_bf16 v[176:179], v[208:211], a[160:163], 0
	s_add_u32 m0, s67, 132096
	s_mov_b32 s66, 112640
	buffer_load_dwordx4 v5, s[52:55], s66 offen lds
	s_waitcnt lgkmcnt(4)
	v_mfma_f32_16x16x32_bf16 v[180:183], v[212:215], a[160:163], 0
	s_waitcnt lgkmcnt(2)
	v_mfma_f32_16x16x32_bf16 v[184:187], v[216:219], a[160:163], 0
	s_waitcnt lgkmcnt(0)
	v_mfma_f32_16x16x32_bf16 v[188:191], v[220:223], a[160:163], 0
	s_waitcnt vmcnt(20)
	s_barrier
	ds_read_b64_tr_b16 v[192:193], v16 offset:40960
	ds_read_b64_tr_b16 v[194:195], v16 offset:46080
	ds_read_b64_tr_b16 v[196:197], v17 offset:40960
	ds_read_b64_tr_b16 v[198:199], v17 offset:46080
	ds_read_b64_tr_b16 v[200:201], v18 offset:40960
	ds_read_b64_tr_b16 v[202:203], v18 offset:46080
	ds_read_b64_tr_b16 v[204:205], v19 offset:40960
	ds_read_b64_tr_b16 v[206:207], v19 offset:46080
	ds_read_b64_tr_b16 v[208:209], v20 offset:40960
	ds_read_b64_tr_b16 v[210:211], v20 offset:46080
	ds_read_b64_tr_b16 v[212:213], v21 offset:40960
	ds_read_b64_tr_b16 v[214:215], v21 offset:46080
	ds_read_b64_tr_b16 v[216:217], v22 offset:40960
	ds_read_b64_tr_b16 v[218:219], v22 offset:46080
	s_waitcnt lgkmcnt(12)
	v_mfma_f32_16x16x32_bf16 v[32:35], v[192:195], a[164:167], v[32:35]
	ds_read_b64_tr_b16 v[220:221], v23 offset:40960
	ds_read_b64_tr_b16 v[222:223], v23 offset:46080
	s_add_u32 m0, s67, 0
	s_mov_b32 s66, 117760
	buffer_load_dwordx4 v1, s[52:55], s66 offen lds
	s_waitcnt lgkmcnt(12)
	v_mfma_f32_16x16x32_bf16 v[36:39], v[196:199], a[164:167], v[36:39]
	ds_read_b64_tr_b16 v[192:193], v16 offset:41216
	ds_read_b64_tr_b16 v[194:195], v16 offset:46336
	s_waitcnt lgkmcnt(12)
	v_mfma_f32_16x16x32_bf16 v[40:43], v[200:203], a[164:167], v[40:43]
	ds_read_b64_tr_b16 v[196:197], v17 offset:41216
	ds_read_b64_tr_b16 v[198:199], v17 offset:46336
	s_waitcnt lgkmcnt(12)
	v_mfma_f32_16x16x32_bf16 v[44:47], v[204:207], a[164:167], v[44:47]
	ds_read_b64_tr_b16 v[200:201], v18 offset:41216
	ds_read_b64_tr_b16 v[202:203], v18 offset:46336
	s_waitcnt lgkmcnt(12)
	v_mfma_f32_16x16x32_bf16 v[48:51], v[208:211], a[164:167], v[48:51]
	ds_read_b64_tr_b16 v[204:205], v19 offset:41216
	ds_read_b64_tr_b16 v[206:207], v19 offset:46336
	s_add_u32 m0, s67, 1024
	s_mov_b32 s66, 117760
	buffer_load_dwordx4 v2, s[52:55], s66 offen lds
	s_waitcnt lgkmcnt(12)
	v_mfma_f32_16x16x32_bf16 v[52:55], v[212:215], a[164:167], v[52:55]
	ds_read_b64_tr_b16 v[208:209], v20 offset:41216
	ds_read_b64_tr_b16 v[210:211], v20 offset:46336
	s_waitcnt lgkmcnt(12)
	v_mfma_f32_16x16x32_bf16 v[56:59], v[216:219], a[164:167], v[56:59]
	ds_read_b64_tr_b16 v[212:213], v21 offset:41216
	ds_read_b64_tr_b16 v[214:215], v21 offset:46336
	s_waitcnt lgkmcnt(12)
	v_mfma_f32_16x16x32_bf16 v[60:63], v[220:223], a[164:167], v[60:63]
	ds_read_b64_tr_b16 v[216:217], v22 offset:41216
	ds_read_b64_tr_b16 v[218:219], v22 offset:46336
	s_waitcnt lgkmcnt(12)
	v_mfma_f32_16x16x32_bf16 v[64:67], v[192:195], a[164:167], v[64:67]
	ds_read_b64_tr_b16 v[220:221], v23 offset:41216
	ds_read_b64_tr_b16 v[222:223], v23 offset:46336
	s_add_u32 m0, s67, 2048
	s_mov_b32 s66, 117760
	buffer_load_dwordx4 v3, s[52:55], s66 offen lds
	s_waitcnt lgkmcnt(12)
	v_mfma_f32_16x16x32_bf16 v[68:71], v[196:199], a[164:167], v[68:71]
	ds_read_b64_tr_b16 v[192:193], v16 offset:41472
	ds_read_b64_tr_b16 v[194:195], v16 offset:46592
	s_waitcnt lgkmcnt(12)
	v_mfma_f32_16x16x32_bf16 v[72:75], v[200:203], a[164:167], v[72:75]
	ds_read_b64_tr_b16 v[196:197], v17 offset:41472
	ds_read_b64_tr_b16 v[198:199], v17 offset:46592
	s_waitcnt lgkmcnt(12)
	v_mfma_f32_16x16x32_bf16 v[76:79], v[204:207], a[164:167], v[76:79]
	ds_read_b64_tr_b16 v[200:201], v18 offset:41472
	ds_read_b64_tr_b16 v[202:203], v18 offset:46592
	s_waitcnt lgkmcnt(12)
	v_mfma_f32_16x16x32_bf16 v[80:83], v[208:211], a[164:167], v[80:83]
	ds_read_b64_tr_b16 v[204:205], v19 offset:41472
	ds_read_b64_tr_b16 v[206:207], v19 offset:46592
	s_add_u32 m0, s67, 3072
	s_mov_b32 s66, 117760
	buffer_load_dwordx4 v4, s[52:55], s66 offen lds
	s_waitcnt lgkmcnt(12)
	v_mfma_f32_16x16x32_bf16 v[84:87], v[212:215], a[164:167], v[84:87]
	ds_read_b64_tr_b16 v[208:209], v20 offset:41472
	ds_read_b64_tr_b16 v[210:211], v20 offset:46592
	s_waitcnt lgkmcnt(12)
	v_mfma_f32_16x16x32_bf16 v[88:91], v[216:219], a[164:167], v[88:91]
	ds_read_b64_tr_b16 v[212:213], v21 offset:41472
	ds_read_b64_tr_b16 v[214:215], v21 offset:46592
	s_waitcnt lgkmcnt(12)
	v_mfma_f32_16x16x32_bf16 v[92:95], v[220:223], a[164:167], v[92:95]
	ds_read_b64_tr_b16 v[216:217], v22 offset:41472
	ds_read_b64_tr_b16 v[218:219], v22 offset:46592
	s_waitcnt lgkmcnt(12)
	v_mfma_f32_16x16x32_bf16 v[96:99], v[192:195], a[164:167], v[96:99]
	ds_read_b64_tr_b16 v[220:221], v23 offset:41472
	ds_read_b64_tr_b16 v[222:223], v23 offset:46592
	s_add_u32 m0, s67, 4096
	s_mov_b32 s66, 117760
	buffer_load_dwordx4 v5, s[52:55], s66 offen lds
	s_waitcnt lgkmcnt(12)
	v_mfma_f32_16x16x32_bf16 v[100:103], v[196:199], a[164:167], v[100:103]
	ds_read_b64_tr_b16 v[192:193], v16 offset:41728
	ds_read_b64_tr_b16 v[194:195], v16 offset:46848
	s_waitcnt lgkmcnt(12)
	v_mfma_f32_16x16x32_bf16 v[104:107], v[200:203], a[164:167], v[104:107]
	ds_read_b64_tr_b16 v[196:197], v17 offset:41728
	ds_read_b64_tr_b16 v[198:199], v17 offset:46848
	s_waitcnt lgkmcnt(12)
	v_mfma_f32_16x16x32_bf16 v[108:111], v[204:207], a[164:167], v[108:111]
	ds_read_b64_tr_b16 v[200:201], v18 offset:41728
	ds_read_b64_tr_b16 v[202:203], v18 offset:46848
	s_waitcnt lgkmcnt(12)
	v_mfma_f32_16x16x32_bf16 v[112:115], v[208:211], a[164:167], v[112:115]
	ds_read_b64_tr_b16 v[204:205], v19 offset:41728
	ds_read_b64_tr_b16 v[206:207], v19 offset:46848
	s_add_u32 m0, s67, 5120
	s_mov_b32 s66, 122880
	buffer_load_dwordx4 v1, s[52:55], s66 offen lds
	s_waitcnt lgkmcnt(12)
	v_mfma_f32_16x16x32_bf16 v[116:119], v[212:215], a[164:167], v[116:119]
	ds_read_b64_tr_b16 v[208:209], v20 offset:41728
	ds_read_b64_tr_b16 v[210:211], v20 offset:46848
	s_waitcnt lgkmcnt(12)
	v_mfma_f32_16x16x32_bf16 v[120:123], v[216:219], a[164:167], v[120:123]
	ds_read_b64_tr_b16 v[212:213], v21 offset:41728
	ds_read_b64_tr_b16 v[214:215], v21 offset:46848
	s_waitcnt lgkmcnt(12)
	v_mfma_f32_16x16x32_bf16 v[124:127], v[220:223], a[164:167], v[124:127]
	ds_read_b64_tr_b16 v[216:217], v22 offset:41728
	ds_read_b64_tr_b16 v[218:219], v22 offset:46848
	s_waitcnt lgkmcnt(12)
	v_mfma_f32_16x16x32_bf16 v[128:131], v[192:195], a[164:167], v[128:131]
	ds_read_b64_tr_b16 v[220:221], v23 offset:41728
	ds_read_b64_tr_b16 v[222:223], v23 offset:46848
	s_add_u32 m0, s67, 6144
	s_mov_b32 s66, 122880
	buffer_load_dwordx4 v2, s[52:55], s66 offen lds
	s_waitcnt lgkmcnt(12)
	v_mfma_f32_16x16x32_bf16 v[132:135], v[196:199], a[164:167], v[132:135]
	ds_read_b64_tr_b16 v[192:193], v16 offset:41984
	ds_read_b64_tr_b16 v[194:195], v16 offset:47104
	s_waitcnt lgkmcnt(12)
	v_mfma_f32_16x16x32_bf16 v[136:139], v[200:203], a[164:167], v[136:139]
	ds_read_b64_tr_b16 v[196:197], v17 offset:41984
	ds_read_b64_tr_b16 v[198:199], v17 offset:47104
	s_waitcnt lgkmcnt(12)
	v_mfma_f32_16x16x32_bf16 v[140:143], v[204:207], a[164:167], v[140:143]
	ds_read_b64_tr_b16 v[200:201], v18 offset:41984
	ds_read_b64_tr_b16 v[202:203], v18 offset:47104
	s_waitcnt lgkmcnt(12)
	v_mfma_f32_16x16x32_bf16 v[144:147], v[208:211], a[164:167], v[144:147]
	ds_read_b64_tr_b16 v[204:205], v19 offset:41984
	ds_read_b64_tr_b16 v[206:207], v19 offset:47104
	s_add_u32 m0, s67, 7168
	s_mov_b32 s66, 122880
	buffer_load_dwordx4 v3, s[52:55], s66 offen lds
	s_waitcnt lgkmcnt(12)
	v_mfma_f32_16x16x32_bf16 v[148:151], v[212:215], a[164:167], v[148:151]
	ds_read_b64_tr_b16 v[208:209], v20 offset:41984
	ds_read_b64_tr_b16 v[210:211], v20 offset:47104
	s_waitcnt lgkmcnt(12)
	v_mfma_f32_16x16x32_bf16 v[152:155], v[216:219], a[164:167], v[152:155]
	ds_read_b64_tr_b16 v[212:213], v21 offset:41984
	ds_read_b64_tr_b16 v[214:215], v21 offset:47104
	s_waitcnt lgkmcnt(12)
	v_mfma_f32_16x16x32_bf16 v[156:159], v[220:223], a[164:167], v[156:159]
	ds_read_b64_tr_b16 v[216:217], v22 offset:41984
	ds_read_b64_tr_b16 v[218:219], v22 offset:47104
	s_waitcnt lgkmcnt(12)
	v_mfma_f32_16x16x32_bf16 v[160:163], v[192:195], a[164:167], v[160:163]
	ds_read_b64_tr_b16 v[220:221], v23 offset:41984
	ds_read_b64_tr_b16 v[222:223], v23 offset:47104
	s_add_u32 m0, s67, 8192
	s_mov_b32 s66, 122880
	buffer_load_dwordx4 v4, s[52:55], s66 offen lds
	s_waitcnt lgkmcnt(12)
	v_mfma_f32_16x16x32_bf16 v[164:167], v[196:199], a[164:167], v[164:167]
	s_waitcnt lgkmcnt(10)
	v_mfma_f32_16x16x32_bf16 v[168:171], v[200:203], a[164:167], v[168:171]
	s_waitcnt lgkmcnt(8)
	v_mfma_f32_16x16x32_bf16 v[172:175], v[204:207], a[164:167], v[172:175]
	s_waitcnt lgkmcnt(6)
	v_mfma_f32_16x16x32_bf16 v[176:179], v[208:211], a[164:167], v[176:179]
	s_add_u32 m0, s67, 9216
	s_mov_b32 s66, 122880
	buffer_load_dwordx4 v5, s[52:55], s66 offen lds
	s_waitcnt lgkmcnt(4)
	v_mfma_f32_16x16x32_bf16 v[180:183], v[212:215], a[164:167], v[180:183]
	s_waitcnt lgkmcnt(2)
	v_mfma_f32_16x16x32_bf16 v[184:187], v[216:219], a[164:167], v[184:187]
	s_waitcnt lgkmcnt(0)
	v_mfma_f32_16x16x32_bf16 v[188:191], v[220:223], a[164:167], v[188:191]
	s_waitcnt vmcnt(20)
	s_barrier
	ds_read_b64_tr_b16 v[192:193], v24 offset:0
	ds_read_b64_tr_b16 v[194:195], v24 offset:5120
	ds_read_b64_tr_b16 v[196:197], v25 offset:0
	ds_read_b64_tr_b16 v[198:199], v25 offset:5120
	ds_read_b64_tr_b16 v[200:201], v26 offset:0
	ds_read_b64_tr_b16 v[202:203], v26 offset:5120
	ds_read_b64_tr_b16 v[204:205], v27 offset:0
	ds_read_b64_tr_b16 v[206:207], v27 offset:5120
	ds_read_b64_tr_b16 v[208:209], v28 offset:0
	ds_read_b64_tr_b16 v[210:211], v28 offset:5120
	ds_read_b64_tr_b16 v[212:213], v29 offset:0
	ds_read_b64_tr_b16 v[214:215], v29 offset:5120
	ds_read_b64_tr_b16 v[216:217], v30 offset:0
	ds_read_b64_tr_b16 v[218:219], v30 offset:5120
	s_waitcnt lgkmcnt(12)
	v_mfma_f32_16x16x32_bf16 v[32:35], v[192:195], a[168:171], v[32:35]
	ds_read_b64_tr_b16 v[220:221], v31 offset:0
	ds_read_b64_tr_b16 v[222:223], v31 offset:5120
	s_add_u32 m0, s67, 40960
	s_mov_b32 s66, 204800
	buffer_load_dwordx4 v1, s[52:55], s66 offen lds
	s_waitcnt lgkmcnt(12)
	v_mfma_f32_16x16x32_bf16 v[36:39], v[196:199], a[168:171], v[36:39]
	ds_read_b64_tr_b16 v[192:193], v24 offset:256
	ds_read_b64_tr_b16 v[194:195], v24 offset:5376
	s_waitcnt lgkmcnt(12)
	v_mfma_f32_16x16x32_bf16 v[40:43], v[200:203], a[168:171], v[40:43]
	ds_read_b64_tr_b16 v[196:197], v25 offset:256
	ds_read_b64_tr_b16 v[198:199], v25 offset:5376
	s_waitcnt lgkmcnt(12)
	v_mfma_f32_16x16x32_bf16 v[44:47], v[204:207], a[168:171], v[44:47]
	ds_read_b64_tr_b16 v[200:201], v26 offset:256
	ds_read_b64_tr_b16 v[202:203], v26 offset:5376
	s_waitcnt lgkmcnt(12)
	v_mfma_f32_16x16x32_bf16 v[48:51], v[208:211], a[168:171], v[48:51]
	ds_read_b64_tr_b16 v[204:205], v27 offset:256
	ds_read_b64_tr_b16 v[206:207], v27 offset:5376
	s_add_u32 m0, s67, 41984
	s_mov_b32 s66, 204800
	buffer_load_dwordx4 v2, s[52:55], s66 offen lds
	s_waitcnt lgkmcnt(12)
	v_mfma_f32_16x16x32_bf16 v[52:55], v[212:215], a[168:171], v[52:55]
	ds_read_b64_tr_b16 v[208:209], v28 offset:256
	ds_read_b64_tr_b16 v[210:211], v28 offset:5376
	s_waitcnt lgkmcnt(12)
	v_mfma_f32_16x16x32_bf16 v[56:59], v[216:219], a[168:171], v[56:59]
	ds_read_b64_tr_b16 v[212:213], v29 offset:256
	ds_read_b64_tr_b16 v[214:215], v29 offset:5376
	s_waitcnt lgkmcnt(12)
	v_mfma_f32_16x16x32_bf16 v[60:63], v[220:223], a[168:171], v[60:63]
	ds_read_b64_tr_b16 v[216:217], v30 offset:256
	ds_read_b64_tr_b16 v[218:219], v30 offset:5376
	s_waitcnt lgkmcnt(12)
	v_mfma_f32_16x16x32_bf16 v[64:67], v[192:195], a[168:171], v[64:67]
	ds_read_b64_tr_b16 v[220:221], v31 offset:256
	ds_read_b64_tr_b16 v[222:223], v31 offset:5376
	s_add_u32 m0, s67, 43008
	s_mov_b32 s66, 204800
	buffer_load_dwordx4 v3, s[52:55], s66 offen lds
	s_waitcnt lgkmcnt(12)
	v_mfma_f32_16x16x32_bf16 v[68:71], v[196:199], a[168:171], v[68:71]
	ds_read_b64_tr_b16 v[192:193], v24 offset:512
	ds_read_b64_tr_b16 v[194:195], v24 offset:5632
	s_waitcnt lgkmcnt(12)
	v_mfma_f32_16x16x32_bf16 v[72:75], v[200:203], a[168:171], v[72:75]
	ds_read_b64_tr_b16 v[196:197], v25 offset:512
	ds_read_b64_tr_b16 v[198:199], v25 offset:5632
	s_waitcnt lgkmcnt(12)
	v_mfma_f32_16x16x32_bf16 v[76:79], v[204:207], a[168:171], v[76:79]
	ds_read_b64_tr_b16 v[200:201], v26 offset:512
	ds_read_b64_tr_b16 v[202:203], v26 offset:5632
	s_waitcnt lgkmcnt(12)
	v_mfma_f32_16x16x32_bf16 v[80:83], v[208:211], a[168:171], v[80:83]
	ds_read_b64_tr_b16 v[204:205], v27 offset:512
	ds_read_b64_tr_b16 v[206:207], v27 offset:5632
	s_add_u32 m0, s67, 44032
	s_mov_b32 s66, 204800
	buffer_load_dwordx4 v4, s[52:55], s66 offen lds
	s_waitcnt lgkmcnt(12)
	v_mfma_f32_16x16x32_bf16 v[84:87], v[212:215], a[168:171], v[84:87]
	ds_read_b64_tr_b16 v[208:209], v28 offset:512
	ds_read_b64_tr_b16 v[210:211], v28 offset:5632
	s_waitcnt lgkmcnt(12)
	v_mfma_f32_16x16x32_bf16 v[88:91], v[216:219], a[168:171], v[88:91]
	ds_read_b64_tr_b16 v[212:213], v29 offset:512
	ds_read_b64_tr_b16 v[214:215], v29 offset:5632
	s_waitcnt lgkmcnt(12)
	v_mfma_f32_16x16x32_bf16 v[92:95], v[220:223], a[168:171], v[92:95]
	ds_read_b64_tr_b16 v[216:217], v30 offset:512
	ds_read_b64_tr_b16 v[218:219], v30 offset:5632
	s_waitcnt lgkmcnt(12)
	v_mfma_f32_16x16x32_bf16 v[96:99], v[192:195], a[168:171], v[96:99]
	ds_read_b64_tr_b16 v[220:221], v31 offset:512
	ds_read_b64_tr_b16 v[222:223], v31 offset:5632
	s_add_u32 m0, s67, 45056
	s_mov_b32 s66, 204800
	buffer_load_dwordx4 v5, s[52:55], s66 offen lds
	s_waitcnt lgkmcnt(12)
	v_mfma_f32_16x16x32_bf16 v[100:103], v[196:199], a[168:171], v[100:103]
	ds_read_b64_tr_b16 v[192:193], v24 offset:768
	ds_read_b64_tr_b16 v[194:195], v24 offset:5888
	s_waitcnt lgkmcnt(12)
	v_mfma_f32_16x16x32_bf16 v[104:107], v[200:203], a[168:171], v[104:107]
	ds_read_b64_tr_b16 v[196:197], v25 offset:768
	ds_read_b64_tr_b16 v[198:199], v25 offset:5888
	s_waitcnt lgkmcnt(12)
	v_mfma_f32_16x16x32_bf16 v[108:111], v[204:207], a[168:171], v[108:111]
	ds_read_b64_tr_b16 v[200:201], v26 offset:768
	ds_read_b64_tr_b16 v[202:203], v26 offset:5888
	s_waitcnt lgkmcnt(12)
	v_mfma_f32_16x16x32_bf16 v[112:115], v[208:211], a[168:171], v[112:115]
	ds_read_b64_tr_b16 v[204:205], v27 offset:768
	ds_read_b64_tr_b16 v[206:207], v27 offset:5888
	s_add_u32 m0, s67, 46080
	s_mov_b32 s66, 209920
	buffer_load_dwordx4 v1, s[52:55], s66 offen lds
	s_waitcnt lgkmcnt(12)
	v_mfma_f32_16x16x32_bf16 v[116:119], v[212:215], a[168:171], v[116:119]
	ds_read_b64_tr_b16 v[208:209], v28 offset:768
	ds_read_b64_tr_b16 v[210:211], v28 offset:5888
	s_waitcnt lgkmcnt(12)
	v_mfma_f32_16x16x32_bf16 v[120:123], v[216:219], a[168:171], v[120:123]
	ds_read_b64_tr_b16 v[212:213], v29 offset:768
	ds_read_b64_tr_b16 v[214:215], v29 offset:5888
	s_waitcnt lgkmcnt(12)
	v_mfma_f32_16x16x32_bf16 v[124:127], v[220:223], a[168:171], v[124:127]
	ds_read_b64_tr_b16 v[216:217], v30 offset:768
	ds_read_b64_tr_b16 v[218:219], v30 offset:5888
	s_waitcnt lgkmcnt(12)
	v_mfma_f32_16x16x32_bf16 v[128:131], v[192:195], a[168:171], v[128:131]
	ds_read_b64_tr_b16 v[220:221], v31 offset:768
	ds_read_b64_tr_b16 v[222:223], v31 offset:5888
	s_add_u32 m0, s67, 47104
	s_mov_b32 s66, 209920
	buffer_load_dwordx4 v2, s[52:55], s66 offen lds
	s_waitcnt lgkmcnt(12)
	v_mfma_f32_16x16x32_bf16 v[132:135], v[196:199], a[168:171], v[132:135]
	ds_read_b64_tr_b16 v[192:193], v24 offset:1024
	ds_read_b64_tr_b16 v[194:195], v24 offset:6144
	s_waitcnt lgkmcnt(12)
	v_mfma_f32_16x16x32_bf16 v[136:139], v[200:203], a[168:171], v[136:139]
	ds_read_b64_tr_b16 v[196:197], v25 offset:1024
	ds_read_b64_tr_b16 v[198:199], v25 offset:6144
	s_waitcnt lgkmcnt(12)
	v_mfma_f32_16x16x32_bf16 v[140:143], v[204:207], a[168:171], v[140:143]
	ds_read_b64_tr_b16 v[200:201], v26 offset:1024
	ds_read_b64_tr_b16 v[202:203], v26 offset:6144
	s_waitcnt lgkmcnt(12)
	v_mfma_f32_16x16x32_bf16 v[144:147], v[208:211], a[168:171], v[144:147]
	ds_read_b64_tr_b16 v[204:205], v27 offset:1024
	ds_read_b64_tr_b16 v[206:207], v27 offset:6144
	s_add_u32 m0, s67, 48128
	s_mov_b32 s66, 209920
	buffer_load_dwordx4 v3, s[52:55], s66 offen lds
	s_waitcnt lgkmcnt(12)
	v_mfma_f32_16x16x32_bf16 v[148:151], v[212:215], a[168:171], v[148:151]
	ds_read_b64_tr_b16 v[208:209], v28 offset:1024
	ds_read_b64_tr_b16 v[210:211], v28 offset:6144
	s_waitcnt lgkmcnt(12)
	v_mfma_f32_16x16x32_bf16 v[152:155], v[216:219], a[168:171], v[152:155]
	ds_read_b64_tr_b16 v[212:213], v29 offset:1024
	ds_read_b64_tr_b16 v[214:215], v29 offset:6144
	s_waitcnt lgkmcnt(12)
	v_mfma_f32_16x16x32_bf16 v[156:159], v[220:223], a[168:171], v[156:159]
	ds_read_b64_tr_b16 v[216:217], v30 offset:1024
	ds_read_b64_tr_b16 v[218:219], v30 offset:6144
	s_waitcnt lgkmcnt(12)
	v_mfma_f32_16x16x32_bf16 v[160:163], v[192:195], a[168:171], v[160:163]
	ds_read_b64_tr_b16 v[220:221], v31 offset:1024
	ds_read_b64_tr_b16 v[222:223], v31 offset:6144
	s_add_u32 m0, s67, 49152
	s_mov_b32 s66, 209920
	buffer_load_dwordx4 v4, s[52:55], s66 offen lds
	s_waitcnt lgkmcnt(12)
	v_mfma_f32_16x16x32_bf16 v[164:167], v[196:199], a[168:171], v[164:167]
	s_waitcnt lgkmcnt(10)
	v_mfma_f32_16x16x32_bf16 v[168:171], v[200:203], a[168:171], v[168:171]
	s_waitcnt lgkmcnt(8)
	v_mfma_f32_16x16x32_bf16 v[172:175], v[204:207], a[168:171], v[172:175]
	s_waitcnt lgkmcnt(6)
	v_mfma_f32_16x16x32_bf16 v[176:179], v[208:211], a[168:171], v[176:179]
	s_add_u32 m0, s67, 50176
	s_mov_b32 s66, 209920
	buffer_load_dwordx4 v5, s[52:55], s66 offen lds
	s_waitcnt lgkmcnt(4)
	v_mfma_f32_16x16x32_bf16 v[180:183], v[212:215], a[168:171], v[180:183]
	s_waitcnt lgkmcnt(2)
	v_mfma_f32_16x16x32_bf16 v[184:187], v[216:219], a[168:171], v[184:187]
	s_waitcnt lgkmcnt(0)
	v_mfma_f32_16x16x32_bf16 v[188:191], v[220:223], a[168:171], v[188:191]
	s_waitcnt vmcnt(20)
	s_barrier
	ds_read_b64_tr_b16 v[192:193], v24 offset:40960
	ds_read_b64_tr_b16 v[194:195], v24 offset:46080
	ds_read_b64_tr_b16 v[196:197], v25 offset:40960
	ds_read_b64_tr_b16 v[198:199], v25 offset:46080
	ds_read_b64_tr_b16 v[200:201], v26 offset:40960
	ds_read_b64_tr_b16 v[202:203], v26 offset:46080
	ds_read_b64_tr_b16 v[204:205], v27 offset:40960
	ds_read_b64_tr_b16 v[206:207], v27 offset:46080
	ds_read_b64_tr_b16 v[208:209], v28 offset:40960
	ds_read_b64_tr_b16 v[210:211], v28 offset:46080
	ds_read_b64_tr_b16 v[212:213], v29 offset:40960
	ds_read_b64_tr_b16 v[214:215], v29 offset:46080
	ds_read_b64_tr_b16 v[216:217], v30 offset:40960
	ds_read_b64_tr_b16 v[218:219], v30 offset:46080
	s_waitcnt lgkmcnt(12)
	v_mfma_f32_16x16x32_bf16 v[32:35], v[192:195], a[172:175], v[32:35]
	ds_read_b64_tr_b16 v[220:221], v31 offset:40960
	ds_read_b64_tr_b16 v[222:223], v31 offset:46080
	s_add_u32 m0, s67, 81920
	s_mov_b32 s66, 215040
	buffer_load_dwordx4 v1, s[52:55], s66 offen lds
	s_waitcnt lgkmcnt(12)
	v_mfma_f32_16x16x32_bf16 v[36:39], v[196:199], a[172:175], v[36:39]
	ds_read_b64_tr_b16 v[192:193], v24 offset:41216
	ds_read_b64_tr_b16 v[194:195], v24 offset:46336
	s_waitcnt lgkmcnt(12)
	v_mfma_f32_16x16x32_bf16 v[40:43], v[200:203], a[172:175], v[40:43]
	ds_read_b64_tr_b16 v[196:197], v25 offset:41216
	ds_read_b64_tr_b16 v[198:199], v25 offset:46336
	s_waitcnt lgkmcnt(12)
	v_mfma_f32_16x16x32_bf16 v[44:47], v[204:207], a[172:175], v[44:47]
	ds_read_b64_tr_b16 v[200:201], v26 offset:41216
	ds_read_b64_tr_b16 v[202:203], v26 offset:46336
	s_waitcnt lgkmcnt(12)
	v_mfma_f32_16x16x32_bf16 v[48:51], v[208:211], a[172:175], v[48:51]
	ds_read_b64_tr_b16 v[204:205], v27 offset:41216
	ds_read_b64_tr_b16 v[206:207], v27 offset:46336
	s_add_u32 m0, s67, 82944
	s_mov_b32 s66, 215040
	buffer_load_dwordx4 v2, s[52:55], s66 offen lds
	s_waitcnt lgkmcnt(12)
	v_mfma_f32_16x16x32_bf16 v[52:55], v[212:215], a[172:175], v[52:55]
	ds_read_b64_tr_b16 v[208:209], v28 offset:41216
	ds_read_b64_tr_b16 v[210:211], v28 offset:46336
	s_waitcnt lgkmcnt(12)
	v_mfma_f32_16x16x32_bf16 v[56:59], v[216:219], a[172:175], v[56:59]
	ds_read_b64_tr_b16 v[212:213], v29 offset:41216
	ds_read_b64_tr_b16 v[214:215], v29 offset:46336
	s_waitcnt lgkmcnt(12)
	v_mfma_f32_16x16x32_bf16 v[60:63], v[220:223], a[172:175], v[60:63]
	ds_read_b64_tr_b16 v[216:217], v30 offset:41216
	ds_read_b64_tr_b16 v[218:219], v30 offset:46336
	s_waitcnt lgkmcnt(12)
	v_mfma_f32_16x16x32_bf16 v[64:67], v[192:195], a[172:175], v[64:67]
	ds_read_b64_tr_b16 v[220:221], v31 offset:41216
	ds_read_b64_tr_b16 v[222:223], v31 offset:46336
	s_add_u32 m0, s67, 83968
	s_mov_b32 s66, 215040
	buffer_load_dwordx4 v3, s[52:55], s66 offen lds
	s_waitcnt lgkmcnt(12)
	v_mfma_f32_16x16x32_bf16 v[68:71], v[196:199], a[172:175], v[68:71]
	ds_read_b64_tr_b16 v[192:193], v24 offset:41472
	ds_read_b64_tr_b16 v[194:195], v24 offset:46592
	s_waitcnt lgkmcnt(12)
	v_mfma_f32_16x16x32_bf16 v[72:75], v[200:203], a[172:175], v[72:75]
	ds_read_b64_tr_b16 v[196:197], v25 offset:41472
	ds_read_b64_tr_b16 v[198:199], v25 offset:46592
	s_waitcnt lgkmcnt(12)
	v_mfma_f32_16x16x32_bf16 v[76:79], v[204:207], a[172:175], v[76:79]
	ds_read_b64_tr_b16 v[200:201], v26 offset:41472
	ds_read_b64_tr_b16 v[202:203], v26 offset:46592
	s_waitcnt lgkmcnt(12)
	v_mfma_f32_16x16x32_bf16 v[80:83], v[208:211], a[172:175], v[80:83]
	ds_read_b64_tr_b16 v[204:205], v27 offset:41472
	ds_read_b64_tr_b16 v[206:207], v27 offset:46592
	s_add_u32 m0, s67, 84992
	s_mov_b32 s66, 215040
	buffer_load_dwordx4 v4, s[52:55], s66 offen lds
	s_waitcnt lgkmcnt(12)
	v_mfma_f32_16x16x32_bf16 v[84:87], v[212:215], a[172:175], v[84:87]
	ds_read_b64_tr_b16 v[208:209], v28 offset:41472
	ds_read_b64_tr_b16 v[210:211], v28 offset:46592
	s_waitcnt lgkmcnt(12)
	v_mfma_f32_16x16x32_bf16 v[88:91], v[216:219], a[172:175], v[88:91]
	ds_read_b64_tr_b16 v[212:213], v29 offset:41472
	ds_read_b64_tr_b16 v[214:215], v29 offset:46592
	s_waitcnt lgkmcnt(12)
	v_mfma_f32_16x16x32_bf16 v[92:95], v[220:223], a[172:175], v[92:95]
	ds_read_b64_tr_b16 v[216:217], v30 offset:41472
	ds_read_b64_tr_b16 v[218:219], v30 offset:46592
	s_waitcnt lgkmcnt(12)
	v_mfma_f32_16x16x32_bf16 v[96:99], v[192:195], a[172:175], v[96:99]
	ds_read_b64_tr_b16 v[220:221], v31 offset:41472
	ds_read_b64_tr_b16 v[222:223], v31 offset:46592
	s_add_u32 m0, s67, 86016
	s_mov_b32 s66, 215040
	buffer_load_dwordx4 v5, s[52:55], s66 offen lds
	s_waitcnt lgkmcnt(12)
	v_mfma_f32_16x16x32_bf16 v[100:103], v[196:199], a[172:175], v[100:103]
	ds_read_b64_tr_b16 v[192:193], v24 offset:41728
	ds_read_b64_tr_b16 v[194:195], v24 offset:46848
	s_waitcnt lgkmcnt(12)
	v_mfma_f32_16x16x32_bf16 v[104:107], v[200:203], a[172:175], v[104:107]
	ds_read_b64_tr_b16 v[196:197], v25 offset:41728
	ds_read_b64_tr_b16 v[198:199], v25 offset:46848
	s_waitcnt lgkmcnt(12)
	v_mfma_f32_16x16x32_bf16 v[108:111], v[204:207], a[172:175], v[108:111]
	ds_read_b64_tr_b16 v[200:201], v26 offset:41728
	ds_read_b64_tr_b16 v[202:203], v26 offset:46848
	s_waitcnt lgkmcnt(12)
	v_mfma_f32_16x16x32_bf16 v[112:115], v[208:211], a[172:175], v[112:115]
	ds_read_b64_tr_b16 v[204:205], v27 offset:41728
	ds_read_b64_tr_b16 v[206:207], v27 offset:46848
	s_add_u32 m0, s67, 87040
	s_mov_b32 s66, 220160
	buffer_load_dwordx4 v1, s[52:55], s66 offen lds
	s_waitcnt lgkmcnt(12)
	v_mfma_f32_16x16x32_bf16 v[116:119], v[212:215], a[172:175], v[116:119]
	ds_read_b64_tr_b16 v[208:209], v28 offset:41728
	ds_read_b64_tr_b16 v[210:211], v28 offset:46848
	s_waitcnt lgkmcnt(12)
	v_mfma_f32_16x16x32_bf16 v[120:123], v[216:219], a[172:175], v[120:123]
	ds_read_b64_tr_b16 v[212:213], v29 offset:41728
	ds_read_b64_tr_b16 v[214:215], v29 offset:46848
	s_waitcnt lgkmcnt(12)
	v_mfma_f32_16x16x32_bf16 v[124:127], v[220:223], a[172:175], v[124:127]
	ds_read_b64_tr_b16 v[216:217], v30 offset:41728
	ds_read_b64_tr_b16 v[218:219], v30 offset:46848
	s_waitcnt lgkmcnt(12)
	v_mfma_f32_16x16x32_bf16 v[128:131], v[192:195], a[172:175], v[128:131]
	ds_read_b64_tr_b16 v[220:221], v31 offset:41728
	ds_read_b64_tr_b16 v[222:223], v31 offset:46848
	s_add_u32 m0, s67, 88064
	s_mov_b32 s66, 220160
	buffer_load_dwordx4 v2, s[52:55], s66 offen lds
	s_waitcnt lgkmcnt(12)
	v_mfma_f32_16x16x32_bf16 v[132:135], v[196:199], a[172:175], v[132:135]
	ds_read_b64_tr_b16 v[192:193], v24 offset:41984
	ds_read_b64_tr_b16 v[194:195], v24 offset:47104
	s_waitcnt lgkmcnt(12)
	v_mfma_f32_16x16x32_bf16 v[136:139], v[200:203], a[172:175], v[136:139]
	ds_read_b64_tr_b16 v[196:197], v25 offset:41984
	ds_read_b64_tr_b16 v[198:199], v25 offset:47104
	s_waitcnt lgkmcnt(12)
	v_mfma_f32_16x16x32_bf16 v[140:143], v[204:207], a[172:175], v[140:143]
	ds_read_b64_tr_b16 v[200:201], v26 offset:41984
	ds_read_b64_tr_b16 v[202:203], v26 offset:47104
	s_waitcnt lgkmcnt(12)
	v_mfma_f32_16x16x32_bf16 v[144:147], v[208:211], a[172:175], v[144:147]
	ds_read_b64_tr_b16 v[204:205], v27 offset:41984
	ds_read_b64_tr_b16 v[206:207], v27 offset:47104
	s_add_u32 m0, s67, 89088
	s_mov_b32 s66, 220160
	buffer_load_dwordx4 v3, s[52:55], s66 offen lds
	s_waitcnt lgkmcnt(12)
	v_mfma_f32_16x16x32_bf16 v[148:151], v[212:215], a[172:175], v[148:151]
	ds_read_b64_tr_b16 v[208:209], v28 offset:41984
	ds_read_b64_tr_b16 v[210:211], v28 offset:47104
	s_waitcnt lgkmcnt(12)
	v_mfma_f32_16x16x32_bf16 v[152:155], v[216:219], a[172:175], v[152:155]
	ds_read_b64_tr_b16 v[212:213], v29 offset:41984
	ds_read_b64_tr_b16 v[214:215], v29 offset:47104
	s_waitcnt lgkmcnt(12)
	v_mfma_f32_16x16x32_bf16 v[156:159], v[220:223], a[172:175], v[156:159]
	ds_read_b64_tr_b16 v[216:217], v30 offset:41984
	ds_read_b64_tr_b16 v[218:219], v30 offset:47104
	s_waitcnt lgkmcnt(12)
	v_mfma_f32_16x16x32_bf16 v[160:163], v[192:195], a[172:175], v[160:163]
	ds_read_b64_tr_b16 v[220:221], v31 offset:41984
	ds_read_b64_tr_b16 v[222:223], v31 offset:47104
	s_add_u32 m0, s67, 90112
	s_mov_b32 s66, 220160
	buffer_load_dwordx4 v4, s[52:55], s66 offen lds
	s_waitcnt lgkmcnt(12)
	v_mfma_f32_16x16x32_bf16 v[164:167], v[196:199], a[172:175], v[164:167]
	s_waitcnt lgkmcnt(10)
	v_mfma_f32_16x16x32_bf16 v[168:171], v[200:203], a[172:175], v[168:171]
	s_waitcnt lgkmcnt(8)
	v_mfma_f32_16x16x32_bf16 v[172:175], v[204:207], a[172:175], v[172:175]
	s_waitcnt lgkmcnt(6)
	v_mfma_f32_16x16x32_bf16 v[176:179], v[208:211], a[172:175], v[176:179]
	s_add_u32 m0, s67, 91136
	s_mov_b32 s66, 220160
	buffer_load_dwordx4 v5, s[52:55], s66 offen lds
	s_waitcnt lgkmcnt(4)
	v_mfma_f32_16x16x32_bf16 v[180:183], v[212:215], a[172:175], v[180:183]
	s_waitcnt lgkmcnt(2)
	v_mfma_f32_16x16x32_bf16 v[184:187], v[216:219], a[172:175], v[184:187]
	s_waitcnt lgkmcnt(0)
	v_mfma_f32_16x16x32_bf16 v[188:191], v[220:223], a[172:175], v[188:191]
	s_waitcnt vmcnt(20)
	s_barrier
	ds_read_b64_tr_b16 v[192:193], v16 offset:0
	ds_read_b64_tr_b16 v[194:195], v16 offset:5120
	ds_read_b64_tr_b16 v[196:197], v17 offset:0
	ds_read_b64_tr_b16 v[198:199], v17 offset:5120
	ds_read_b64_tr_b16 v[200:201], v18 offset:0
	ds_read_b64_tr_b16 v[202:203], v18 offset:5120
	ds_read_b64_tr_b16 v[204:205], v19 offset:0
	ds_read_b64_tr_b16 v[206:207], v19 offset:5120
	ds_read_b64_tr_b16 v[208:209], v20 offset:0
	ds_read_b64_tr_b16 v[210:211], v20 offset:5120
	ds_read_b64_tr_b16 v[212:213], v21 offset:0
	ds_read_b64_tr_b16 v[214:215], v21 offset:5120
	ds_read_b64_tr_b16 v[216:217], v22 offset:0
	ds_read_b64_tr_b16 v[218:219], v22 offset:5120
	s_waitcnt lgkmcnt(12)
	v_mfma_f32_16x16x32_bf16 v[32:35], v[192:195], a[176:179], v[32:35]
	ds_read_b64_tr_b16 v[220:221], v23 offset:0
	ds_read_b64_tr_b16 v[222:223], v23 offset:5120
	s_add_u32 m0, s67, 122880
	s_mov_b32 s66, 225280
	buffer_load_dwordx4 v1, s[52:55], s66 offen lds
	s_waitcnt lgkmcnt(12)
	v_mfma_f32_16x16x32_bf16 v[36:39], v[196:199], a[176:179], v[36:39]
	ds_read_b64_tr_b16 v[192:193], v16 offset:256
	ds_read_b64_tr_b16 v[194:195], v16 offset:5376
	s_waitcnt lgkmcnt(12)
	v_mfma_f32_16x16x32_bf16 v[40:43], v[200:203], a[176:179], v[40:43]
	ds_read_b64_tr_b16 v[196:197], v17 offset:256
	ds_read_b64_tr_b16 v[198:199], v17 offset:5376
	s_waitcnt lgkmcnt(12)
	v_mfma_f32_16x16x32_bf16 v[44:47], v[204:207], a[176:179], v[44:47]
	ds_read_b64_tr_b16 v[200:201], v18 offset:256
	ds_read_b64_tr_b16 v[202:203], v18 offset:5376
	s_waitcnt lgkmcnt(12)
	v_mfma_f32_16x16x32_bf16 v[48:51], v[208:211], a[176:179], v[48:51]
	ds_read_b64_tr_b16 v[204:205], v19 offset:256
	ds_read_b64_tr_b16 v[206:207], v19 offset:5376
	s_add_u32 m0, s67, 123904
	s_mov_b32 s66, 225280
	buffer_load_dwordx4 v2, s[52:55], s66 offen lds
	s_waitcnt lgkmcnt(12)
	v_mfma_f32_16x16x32_bf16 v[52:55], v[212:215], a[176:179], v[52:55]
	ds_read_b64_tr_b16 v[208:209], v20 offset:256
	ds_read_b64_tr_b16 v[210:211], v20 offset:5376
	s_waitcnt lgkmcnt(12)
	v_mfma_f32_16x16x32_bf16 v[56:59], v[216:219], a[176:179], v[56:59]
	ds_read_b64_tr_b16 v[212:213], v21 offset:256
	ds_read_b64_tr_b16 v[214:215], v21 offset:5376
	s_waitcnt lgkmcnt(12)
	v_mfma_f32_16x16x32_bf16 v[60:63], v[220:223], a[176:179], v[60:63]
	ds_read_b64_tr_b16 v[216:217], v22 offset:256
	ds_read_b64_tr_b16 v[218:219], v22 offset:5376
	s_waitcnt lgkmcnt(12)
	v_mfma_f32_16x16x32_bf16 v[64:67], v[192:195], a[176:179], v[64:67]
	ds_read_b64_tr_b16 v[220:221], v23 offset:256
	ds_read_b64_tr_b16 v[222:223], v23 offset:5376
	s_add_u32 m0, s67, 124928
	s_mov_b32 s66, 225280
	buffer_load_dwordx4 v3, s[52:55], s66 offen lds
	s_waitcnt lgkmcnt(12)
	v_mfma_f32_16x16x32_bf16 v[68:71], v[196:199], a[176:179], v[68:71]
	ds_read_b64_tr_b16 v[192:193], v16 offset:512
	ds_read_b64_tr_b16 v[194:195], v16 offset:5632
	s_waitcnt lgkmcnt(12)
	v_mfma_f32_16x16x32_bf16 v[72:75], v[200:203], a[176:179], v[72:75]
	ds_read_b64_tr_b16 v[196:197], v17 offset:512
	ds_read_b64_tr_b16 v[198:199], v17 offset:5632
	s_waitcnt lgkmcnt(12)
	v_mfma_f32_16x16x32_bf16 v[76:79], v[204:207], a[176:179], v[76:79]
	ds_read_b64_tr_b16 v[200:201], v18 offset:512
	ds_read_b64_tr_b16 v[202:203], v18 offset:5632
	s_waitcnt lgkmcnt(12)
	v_mfma_f32_16x16x32_bf16 v[80:83], v[208:211], a[176:179], v[80:83]
	ds_read_b64_tr_b16 v[204:205], v19 offset:512
	ds_read_b64_tr_b16 v[206:207], v19 offset:5632
	s_add_u32 m0, s67, 125952
	s_mov_b32 s66, 225280
	buffer_load_dwordx4 v4, s[52:55], s66 offen lds
	s_waitcnt lgkmcnt(12)
	v_mfma_f32_16x16x32_bf16 v[84:87], v[212:215], a[176:179], v[84:87]
	ds_read_b64_tr_b16 v[208:209], v20 offset:512
	ds_read_b64_tr_b16 v[210:211], v20 offset:5632
	s_waitcnt lgkmcnt(12)
	v_mfma_f32_16x16x32_bf16 v[88:91], v[216:219], a[176:179], v[88:91]
	ds_read_b64_tr_b16 v[212:213], v21 offset:512
	ds_read_b64_tr_b16 v[214:215], v21 offset:5632
	s_waitcnt lgkmcnt(12)
	v_mfma_f32_16x16x32_bf16 v[92:95], v[220:223], a[176:179], v[92:95]
	ds_read_b64_tr_b16 v[216:217], v22 offset:512
	ds_read_b64_tr_b16 v[218:219], v22 offset:5632
	s_waitcnt lgkmcnt(12)
	v_mfma_f32_16x16x32_bf16 v[96:99], v[192:195], a[176:179], v[96:99]
	ds_read_b64_tr_b16 v[220:221], v23 offset:512
	ds_read_b64_tr_b16 v[222:223], v23 offset:5632
	s_add_u32 m0, s67, 126976
	s_mov_b32 s66, 225280
	buffer_load_dwordx4 v5, s[52:55], s66 offen lds
	s_waitcnt lgkmcnt(12)
	v_mfma_f32_16x16x32_bf16 v[100:103], v[196:199], a[176:179], v[100:103]
	ds_read_b64_tr_b16 v[192:193], v16 offset:768
	ds_read_b64_tr_b16 v[194:195], v16 offset:5888
	s_waitcnt lgkmcnt(12)
	v_mfma_f32_16x16x32_bf16 v[104:107], v[200:203], a[176:179], v[104:107]
	ds_read_b64_tr_b16 v[196:197], v17 offset:768
	ds_read_b64_tr_b16 v[198:199], v17 offset:5888
	s_waitcnt lgkmcnt(12)
	v_mfma_f32_16x16x32_bf16 v[108:111], v[204:207], a[176:179], v[108:111]
	ds_read_b64_tr_b16 v[200:201], v18 offset:768
	ds_read_b64_tr_b16 v[202:203], v18 offset:5888
	s_waitcnt lgkmcnt(12)
	v_mfma_f32_16x16x32_bf16 v[112:115], v[208:211], a[176:179], v[112:115]
	ds_read_b64_tr_b16 v[204:205], v19 offset:768
	ds_read_b64_tr_b16 v[206:207], v19 offset:5888
	s_add_u32 m0, s67, 128000
	s_mov_b32 s66, 307200
	buffer_load_dwordx4 v1, s[52:55], s66 offen lds
	s_waitcnt lgkmcnt(12)
	v_mfma_f32_16x16x32_bf16 v[116:119], v[212:215], a[176:179], v[116:119]
	ds_read_b64_tr_b16 v[208:209], v20 offset:768
	ds_read_b64_tr_b16 v[210:211], v20 offset:5888
	s_waitcnt lgkmcnt(12)
	v_mfma_f32_16x16x32_bf16 v[120:123], v[216:219], a[176:179], v[120:123]
	ds_read_b64_tr_b16 v[212:213], v21 offset:768
	ds_read_b64_tr_b16 v[214:215], v21 offset:5888
	s_waitcnt lgkmcnt(12)
	v_mfma_f32_16x16x32_bf16 v[124:127], v[220:223], a[176:179], v[124:127]
	ds_read_b64_tr_b16 v[216:217], v22 offset:768
	ds_read_b64_tr_b16 v[218:219], v22 offset:5888
	s_waitcnt lgkmcnt(12)
	v_mfma_f32_16x16x32_bf16 v[128:131], v[192:195], a[176:179], v[128:131]
	ds_read_b64_tr_b16 v[220:221], v23 offset:768
	ds_read_b64_tr_b16 v[222:223], v23 offset:5888
	s_add_u32 m0, s67, 129024
	s_mov_b32 s66, 307200
	buffer_load_dwordx4 v2, s[52:55], s66 offen lds
	s_waitcnt lgkmcnt(12)
	v_mfma_f32_16x16x32_bf16 v[132:135], v[196:199], a[176:179], v[132:135]
	ds_read_b64_tr_b16 v[192:193], v16 offset:1024
	ds_read_b64_tr_b16 v[194:195], v16 offset:6144
	s_waitcnt lgkmcnt(12)
	v_mfma_f32_16x16x32_bf16 v[136:139], v[200:203], a[176:179], v[136:139]
	ds_read_b64_tr_b16 v[196:197], v17 offset:1024
	ds_read_b64_tr_b16 v[198:199], v17 offset:6144
	s_waitcnt lgkmcnt(12)
	v_mfma_f32_16x16x32_bf16 v[140:143], v[204:207], a[176:179], v[140:143]
	ds_read_b64_tr_b16 v[200:201], v18 offset:1024
	ds_read_b64_tr_b16 v[202:203], v18 offset:6144
	s_waitcnt lgkmcnt(12)
	v_mfma_f32_16x16x32_bf16 v[144:147], v[208:211], a[176:179], v[144:147]
	ds_read_b64_tr_b16 v[204:205], v19 offset:1024
	ds_read_b64_tr_b16 v[206:207], v19 offset:6144
	s_add_u32 m0, s67, 130048
	s_mov_b32 s66, 307200
	buffer_load_dwordx4 v3, s[52:55], s66 offen lds
	s_waitcnt lgkmcnt(12)
	v_mfma_f32_16x16x32_bf16 v[148:151], v[212:215], a[176:179], v[148:151]
	ds_read_b64_tr_b16 v[208:209], v20 offset:1024
	ds_read_b64_tr_b16 v[210:211], v20 offset:6144
	s_waitcnt lgkmcnt(12)
	v_mfma_f32_16x16x32_bf16 v[152:155], v[216:219], a[176:179], v[152:155]
	ds_read_b64_tr_b16 v[212:213], v21 offset:1024
	ds_read_b64_tr_b16 v[214:215], v21 offset:6144
	s_waitcnt lgkmcnt(12)
	v_mfma_f32_16x16x32_bf16 v[156:159], v[220:223], a[176:179], v[156:159]
	ds_read_b64_tr_b16 v[216:217], v22 offset:1024
	ds_read_b64_tr_b16 v[218:219], v22 offset:6144
	s_waitcnt lgkmcnt(12)
	v_mfma_f32_16x16x32_bf16 v[160:163], v[192:195], a[176:179], v[160:163]
	ds_read_b64_tr_b16 v[220:221], v23 offset:1024
	ds_read_b64_tr_b16 v[222:223], v23 offset:6144
	s_add_u32 m0, s67, 131072
	s_mov_b32 s66, 307200
	buffer_load_dwordx4 v4, s[52:55], s66 offen lds
	s_waitcnt lgkmcnt(12)
	v_mfma_f32_16x16x32_bf16 v[164:167], v[196:199], a[176:179], v[164:167]
	s_waitcnt lgkmcnt(10)
	v_mfma_f32_16x16x32_bf16 v[168:171], v[200:203], a[176:179], v[168:171]
	s_waitcnt lgkmcnt(8)
	v_mfma_f32_16x16x32_bf16 v[172:175], v[204:207], a[176:179], v[172:175]
	s_waitcnt lgkmcnt(6)
	v_mfma_f32_16x16x32_bf16 v[176:179], v[208:211], a[176:179], v[176:179]
	s_add_u32 m0, s67, 132096
	s_mov_b32 s66, 307200
	buffer_load_dwordx4 v5, s[52:55], s66 offen lds
	s_waitcnt lgkmcnt(4)
	v_mfma_f32_16x16x32_bf16 v[180:183], v[212:215], a[176:179], v[180:183]
	s_waitcnt lgkmcnt(2)
	v_mfma_f32_16x16x32_bf16 v[184:187], v[216:219], a[176:179], v[184:187]
	s_waitcnt lgkmcnt(0)
	v_mfma_f32_16x16x32_bf16 v[188:191], v[220:223], a[176:179], v[188:191]
	s_waitcnt vmcnt(20)
	s_barrier
	ds_read_b64_tr_b16 v[192:193], v16 offset:40960
	ds_read_b64_tr_b16 v[194:195], v16 offset:46080
	ds_read_b64_tr_b16 v[196:197], v17 offset:40960
	ds_read_b64_tr_b16 v[198:199], v17 offset:46080
	ds_read_b64_tr_b16 v[200:201], v18 offset:40960
	ds_read_b64_tr_b16 v[202:203], v18 offset:46080
	ds_read_b64_tr_b16 v[204:205], v19 offset:40960
	ds_read_b64_tr_b16 v[206:207], v19 offset:46080
	ds_read_b64_tr_b16 v[208:209], v20 offset:40960
	ds_read_b64_tr_b16 v[210:211], v20 offset:46080
	ds_read_b64_tr_b16 v[212:213], v21 offset:40960
	ds_read_b64_tr_b16 v[214:215], v21 offset:46080
	ds_read_b64_tr_b16 v[216:217], v22 offset:40960
	ds_read_b64_tr_b16 v[218:219], v22 offset:46080
	s_waitcnt lgkmcnt(12)
	v_mfma_f32_16x16x32_bf16 v[32:35], v[192:195], a[180:183], v[32:35]
	ds_read_b64_tr_b16 v[220:221], v23 offset:40960
	ds_read_b64_tr_b16 v[222:223], v23 offset:46080
	s_add_u32 m0, s67, 0
	s_mov_b32 s66, 312320
	buffer_load_dwordx4 v1, s[52:55], s66 offen lds
	s_waitcnt lgkmcnt(12)
	v_mfma_f32_16x16x32_bf16 v[36:39], v[196:199], a[180:183], v[36:39]
	ds_read_b64_tr_b16 v[192:193], v16 offset:41216
	ds_read_b64_tr_b16 v[194:195], v16 offset:46336
	s_waitcnt lgkmcnt(12)
	v_mfma_f32_16x16x32_bf16 v[40:43], v[200:203], a[180:183], v[40:43]
	ds_read_b64_tr_b16 v[196:197], v17 offset:41216
	ds_read_b64_tr_b16 v[198:199], v17 offset:46336
	s_waitcnt lgkmcnt(12)
	v_mfma_f32_16x16x32_bf16 v[44:47], v[204:207], a[180:183], v[44:47]
	ds_read_b64_tr_b16 v[200:201], v18 offset:41216
	ds_read_b64_tr_b16 v[202:203], v18 offset:46336
	s_waitcnt lgkmcnt(12)
	v_mfma_f32_16x16x32_bf16 v[48:51], v[208:211], a[180:183], v[48:51]
	ds_read_b64_tr_b16 v[204:205], v19 offset:41216
	ds_read_b64_tr_b16 v[206:207], v19 offset:46336
	s_add_u32 m0, s67, 1024
	s_mov_b32 s66, 312320
	buffer_load_dwordx4 v2, s[52:55], s66 offen lds
	s_waitcnt lgkmcnt(12)
	v_mfma_f32_16x16x32_bf16 v[52:55], v[212:215], a[180:183], v[52:55]
	ds_read_b64_tr_b16 v[208:209], v20 offset:41216
	ds_read_b64_tr_b16 v[210:211], v20 offset:46336
	s_waitcnt lgkmcnt(12)
	v_mfma_f32_16x16x32_bf16 v[56:59], v[216:219], a[180:183], v[56:59]
	ds_read_b64_tr_b16 v[212:213], v21 offset:41216
	ds_read_b64_tr_b16 v[214:215], v21 offset:46336
	s_waitcnt lgkmcnt(12)
	v_mfma_f32_16x16x32_bf16 v[60:63], v[220:223], a[180:183], v[60:63]
	ds_read_b64_tr_b16 v[216:217], v22 offset:41216
	ds_read_b64_tr_b16 v[218:219], v22 offset:46336
	s_waitcnt lgkmcnt(12)
	v_mfma_f32_16x16x32_bf16 v[64:67], v[192:195], a[180:183], v[64:67]
	ds_read_b64_tr_b16 v[220:221], v23 offset:41216
	ds_read_b64_tr_b16 v[222:223], v23 offset:46336
	s_add_u32 m0, s67, 2048
	s_mov_b32 s66, 312320
	buffer_load_dwordx4 v3, s[52:55], s66 offen lds
	s_waitcnt lgkmcnt(12)
	v_mfma_f32_16x16x32_bf16 v[68:71], v[196:199], a[180:183], v[68:71]
	ds_read_b64_tr_b16 v[192:193], v16 offset:41472
	ds_read_b64_tr_b16 v[194:195], v16 offset:46592
	s_waitcnt lgkmcnt(12)
	v_mfma_f32_16x16x32_bf16 v[72:75], v[200:203], a[180:183], v[72:75]
	ds_read_b64_tr_b16 v[196:197], v17 offset:41472
	ds_read_b64_tr_b16 v[198:199], v17 offset:46592
	s_waitcnt lgkmcnt(12)
	v_mfma_f32_16x16x32_bf16 v[76:79], v[204:207], a[180:183], v[76:79]
	ds_read_b64_tr_b16 v[200:201], v18 offset:41472
	ds_read_b64_tr_b16 v[202:203], v18 offset:46592
	s_waitcnt lgkmcnt(12)
	v_mfma_f32_16x16x32_bf16 v[80:83], v[208:211], a[180:183], v[80:83]
	ds_read_b64_tr_b16 v[204:205], v19 offset:41472
	ds_read_b64_tr_b16 v[206:207], v19 offset:46592
	s_add_u32 m0, s67, 3072
	s_mov_b32 s66, 312320
	buffer_load_dwordx4 v4, s[52:55], s66 offen lds
	s_waitcnt lgkmcnt(12)
	v_mfma_f32_16x16x32_bf16 v[84:87], v[212:215], a[180:183], v[84:87]
	ds_read_b64_tr_b16 v[208:209], v20 offset:41472
	ds_read_b64_tr_b16 v[210:211], v20 offset:46592
	s_waitcnt lgkmcnt(12)
	v_mfma_f32_16x16x32_bf16 v[88:91], v[216:219], a[180:183], v[88:91]
	ds_read_b64_tr_b16 v[212:213], v21 offset:41472
	ds_read_b64_tr_b16 v[214:215], v21 offset:46592
	s_waitcnt lgkmcnt(12)
	v_mfma_f32_16x16x32_bf16 v[92:95], v[220:223], a[180:183], v[92:95]
	ds_read_b64_tr_b16 v[216:217], v22 offset:41472
	ds_read_b64_tr_b16 v[218:219], v22 offset:46592
	s_waitcnt lgkmcnt(12)
	v_mfma_f32_16x16x32_bf16 v[96:99], v[192:195], a[180:183], v[96:99]
	ds_read_b64_tr_b16 v[220:221], v23 offset:41472
	ds_read_b64_tr_b16 v[222:223], v23 offset:46592
	s_add_u32 m0, s67, 4096
	s_mov_b32 s66, 312320
	buffer_load_dwordx4 v5, s[52:55], s66 offen lds
	s_waitcnt lgkmcnt(12)
	v_mfma_f32_16x16x32_bf16 v[100:103], v[196:199], a[180:183], v[100:103]
	ds_read_b64_tr_b16 v[192:193], v16 offset:41728
	ds_read_b64_tr_b16 v[194:195], v16 offset:46848
	s_waitcnt lgkmcnt(12)
	v_mfma_f32_16x16x32_bf16 v[104:107], v[200:203], a[180:183], v[104:107]
	ds_read_b64_tr_b16 v[196:197], v17 offset:41728
	ds_read_b64_tr_b16 v[198:199], v17 offset:46848
	s_waitcnt lgkmcnt(12)
	v_mfma_f32_16x16x32_bf16 v[108:111], v[204:207], a[180:183], v[108:111]
	ds_read_b64_tr_b16 v[200:201], v18 offset:41728
	ds_read_b64_tr_b16 v[202:203], v18 offset:46848
	s_waitcnt lgkmcnt(12)
	v_mfma_f32_16x16x32_bf16 v[112:115], v[208:211], a[180:183], v[112:115]
	ds_read_b64_tr_b16 v[204:205], v19 offset:41728
	ds_read_b64_tr_b16 v[206:207], v19 offset:46848
	s_add_u32 m0, s67, 5120
	s_mov_b32 s66, 317440
	buffer_load_dwordx4 v1, s[52:55], s66 offen lds
	s_waitcnt lgkmcnt(12)
	v_mfma_f32_16x16x32_bf16 v[116:119], v[212:215], a[180:183], v[116:119]
	ds_read_b64_tr_b16 v[208:209], v20 offset:41728
	ds_read_b64_tr_b16 v[210:211], v20 offset:46848
	s_waitcnt lgkmcnt(12)
	v_mfma_f32_16x16x32_bf16 v[120:123], v[216:219], a[180:183], v[120:123]
	ds_read_b64_tr_b16 v[212:213], v21 offset:41728
	ds_read_b64_tr_b16 v[214:215], v21 offset:46848
	s_waitcnt lgkmcnt(12)
	v_mfma_f32_16x16x32_bf16 v[124:127], v[220:223], a[180:183], v[124:127]
	ds_read_b64_tr_b16 v[216:217], v22 offset:41728
	ds_read_b64_tr_b16 v[218:219], v22 offset:46848
	s_waitcnt lgkmcnt(12)
	v_mfma_f32_16x16x32_bf16 v[128:131], v[192:195], a[180:183], v[128:131]
	ds_read_b64_tr_b16 v[220:221], v23 offset:41728
	ds_read_b64_tr_b16 v[222:223], v23 offset:46848
	s_add_u32 m0, s67, 6144
	s_mov_b32 s66, 317440
	buffer_load_dwordx4 v2, s[52:55], s66 offen lds
	s_waitcnt lgkmcnt(12)
	v_mfma_f32_16x16x32_bf16 v[132:135], v[196:199], a[180:183], v[132:135]
	ds_read_b64_tr_b16 v[192:193], v16 offset:41984
	ds_read_b64_tr_b16 v[194:195], v16 offset:47104
	s_waitcnt lgkmcnt(12)
	v_mfma_f32_16x16x32_bf16 v[136:139], v[200:203], a[180:183], v[136:139]
	ds_read_b64_tr_b16 v[196:197], v17 offset:41984
	ds_read_b64_tr_b16 v[198:199], v17 offset:47104
	s_waitcnt lgkmcnt(12)
	v_mfma_f32_16x16x32_bf16 v[140:143], v[204:207], a[180:183], v[140:143]
	ds_read_b64_tr_b16 v[200:201], v18 offset:41984
	ds_read_b64_tr_b16 v[202:203], v18 offset:47104
	s_waitcnt lgkmcnt(12)
	v_mfma_f32_16x16x32_bf16 v[144:147], v[208:211], a[180:183], v[144:147]
	ds_read_b64_tr_b16 v[204:205], v19 offset:41984
	ds_read_b64_tr_b16 v[206:207], v19 offset:47104
	s_add_u32 m0, s67, 7168
	s_mov_b32 s66, 317440
	buffer_load_dwordx4 v3, s[52:55], s66 offen lds
	s_waitcnt lgkmcnt(12)
	v_mfma_f32_16x16x32_bf16 v[148:151], v[212:215], a[180:183], v[148:151]
	ds_read_b64_tr_b16 v[208:209], v20 offset:41984
	ds_read_b64_tr_b16 v[210:211], v20 offset:47104
	s_waitcnt lgkmcnt(12)
	v_mfma_f32_16x16x32_bf16 v[152:155], v[216:219], a[180:183], v[152:155]
	ds_read_b64_tr_b16 v[212:213], v21 offset:41984
	ds_read_b64_tr_b16 v[214:215], v21 offset:47104
	s_waitcnt lgkmcnt(12)
	v_mfma_f32_16x16x32_bf16 v[156:159], v[220:223], a[180:183], v[156:159]
	ds_read_b64_tr_b16 v[216:217], v22 offset:41984
	ds_read_b64_tr_b16 v[218:219], v22 offset:47104
	s_waitcnt lgkmcnt(12)
	v_mfma_f32_16x16x32_bf16 v[160:163], v[192:195], a[180:183], v[160:163]
	ds_read_b64_tr_b16 v[220:221], v23 offset:41984
	ds_read_b64_tr_b16 v[222:223], v23 offset:47104
	s_add_u32 m0, s67, 8192
	s_mov_b32 s66, 317440
	buffer_load_dwordx4 v4, s[52:55], s66 offen lds
	s_waitcnt lgkmcnt(12)
	v_mfma_f32_16x16x32_bf16 v[164:167], v[196:199], a[180:183], v[164:167]
	s_waitcnt lgkmcnt(10)
	v_mfma_f32_16x16x32_bf16 v[168:171], v[200:203], a[180:183], v[168:171]
	s_waitcnt lgkmcnt(8)
	v_mfma_f32_16x16x32_bf16 v[172:175], v[204:207], a[180:183], v[172:175]
	s_waitcnt lgkmcnt(6)
	v_mfma_f32_16x16x32_bf16 v[176:179], v[208:211], a[180:183], v[176:179]
	s_add_u32 m0, s67, 9216
	s_mov_b32 s66, 317440
	buffer_load_dwordx4 v5, s[52:55], s66 offen lds
	s_waitcnt lgkmcnt(4)
	v_mfma_f32_16x16x32_bf16 v[180:183], v[212:215], a[180:183], v[180:183]
	s_waitcnt lgkmcnt(2)
	v_mfma_f32_16x16x32_bf16 v[184:187], v[216:219], a[180:183], v[184:187]
	s_waitcnt lgkmcnt(0)
	v_mfma_f32_16x16x32_bf16 v[188:191], v[220:223], a[180:183], v[188:191]
	s_waitcnt vmcnt(20)
	s_barrier
	ds_read_b64_tr_b16 v[192:193], v24 offset:0
	ds_read_b64_tr_b16 v[194:195], v24 offset:5120
	ds_read_b64_tr_b16 v[196:197], v25 offset:0
	ds_read_b64_tr_b16 v[198:199], v25 offset:5120
	ds_read_b64_tr_b16 v[200:201], v26 offset:0
	ds_read_b64_tr_b16 v[202:203], v26 offset:5120
	ds_read_b64_tr_b16 v[204:205], v27 offset:0
	ds_read_b64_tr_b16 v[206:207], v27 offset:5120
	ds_read_b64_tr_b16 v[208:209], v28 offset:0
	ds_read_b64_tr_b16 v[210:211], v28 offset:5120
	ds_read_b64_tr_b16 v[212:213], v29 offset:0
	ds_read_b64_tr_b16 v[214:215], v29 offset:5120
	ds_read_b64_tr_b16 v[216:217], v30 offset:0
	ds_read_b64_tr_b16 v[218:219], v30 offset:5120
	s_waitcnt lgkmcnt(12)
	v_mfma_f32_16x16x32_bf16 v[32:35], v[192:195], a[184:187], v[32:35]
	ds_read_b64_tr_b16 v[220:221], v31 offset:0
	ds_read_b64_tr_b16 v[222:223], v31 offset:5120
	s_add_u32 m0, s67, 40960
	s_mov_b32 s66, 322560
	buffer_load_dwordx4 v1, s[52:55], s66 offen lds
	s_waitcnt lgkmcnt(12)
	v_mfma_f32_16x16x32_bf16 v[36:39], v[196:199], a[184:187], v[36:39]
	ds_read_b64_tr_b16 v[192:193], v24 offset:256
	ds_read_b64_tr_b16 v[194:195], v24 offset:5376
	s_waitcnt lgkmcnt(12)
	v_mfma_f32_16x16x32_bf16 v[40:43], v[200:203], a[184:187], v[40:43]
	ds_read_b64_tr_b16 v[196:197], v25 offset:256
	ds_read_b64_tr_b16 v[198:199], v25 offset:5376
	s_waitcnt lgkmcnt(12)
	v_mfma_f32_16x16x32_bf16 v[44:47], v[204:207], a[184:187], v[44:47]
	ds_read_b64_tr_b16 v[200:201], v26 offset:256
	ds_read_b64_tr_b16 v[202:203], v26 offset:5376
	s_waitcnt lgkmcnt(12)
	v_mfma_f32_16x16x32_bf16 v[48:51], v[208:211], a[184:187], v[48:51]
	ds_read_b64_tr_b16 v[204:205], v27 offset:256
	ds_read_b64_tr_b16 v[206:207], v27 offset:5376
	s_add_u32 m0, s67, 41984
	s_mov_b32 s66, 322560
	buffer_load_dwordx4 v2, s[52:55], s66 offen lds
	s_waitcnt lgkmcnt(12)
	v_mfma_f32_16x16x32_bf16 v[52:55], v[212:215], a[184:187], v[52:55]
	ds_read_b64_tr_b16 v[208:209], v28 offset:256
	ds_read_b64_tr_b16 v[210:211], v28 offset:5376
	s_waitcnt lgkmcnt(12)
	v_mfma_f32_16x16x32_bf16 v[56:59], v[216:219], a[184:187], v[56:59]
	ds_read_b64_tr_b16 v[212:213], v29 offset:256
	ds_read_b64_tr_b16 v[214:215], v29 offset:5376
	s_waitcnt lgkmcnt(12)
	v_mfma_f32_16x16x32_bf16 v[60:63], v[220:223], a[184:187], v[60:63]
	ds_read_b64_tr_b16 v[216:217], v30 offset:256
	ds_read_b64_tr_b16 v[218:219], v30 offset:5376
	s_waitcnt lgkmcnt(12)
	v_mfma_f32_16x16x32_bf16 v[64:67], v[192:195], a[184:187], v[64:67]
	ds_read_b64_tr_b16 v[220:221], v31 offset:256
	ds_read_b64_tr_b16 v[222:223], v31 offset:5376
	s_add_u32 m0, s67, 43008
	s_mov_b32 s66, 322560
	buffer_load_dwordx4 v3, s[52:55], s66 offen lds
	s_waitcnt lgkmcnt(12)
	v_mfma_f32_16x16x32_bf16 v[68:71], v[196:199], a[184:187], v[68:71]
	ds_read_b64_tr_b16 v[192:193], v24 offset:512
	ds_read_b64_tr_b16 v[194:195], v24 offset:5632
	s_waitcnt lgkmcnt(12)
	v_mfma_f32_16x16x32_bf16 v[72:75], v[200:203], a[184:187], v[72:75]
	ds_read_b64_tr_b16 v[196:197], v25 offset:512
	ds_read_b64_tr_b16 v[198:199], v25 offset:5632
	s_waitcnt lgkmcnt(12)
	v_mfma_f32_16x16x32_bf16 v[76:79], v[204:207], a[184:187], v[76:79]
	ds_read_b64_tr_b16 v[200:201], v26 offset:512
	ds_read_b64_tr_b16 v[202:203], v26 offset:5632
	s_waitcnt lgkmcnt(12)
	v_mfma_f32_16x16x32_bf16 v[80:83], v[208:211], a[184:187], v[80:83]
	ds_read_b64_tr_b16 v[204:205], v27 offset:512
	ds_read_b64_tr_b16 v[206:207], v27 offset:5632
	s_add_u32 m0, s67, 44032
	s_mov_b32 s66, 322560
	buffer_load_dwordx4 v4, s[52:55], s66 offen lds
	s_waitcnt lgkmcnt(12)
	v_mfma_f32_16x16x32_bf16 v[84:87], v[212:215], a[184:187], v[84:87]
	ds_read_b64_tr_b16 v[208:209], v28 offset:512
	ds_read_b64_tr_b16 v[210:211], v28 offset:5632
	s_waitcnt lgkmcnt(12)
	v_mfma_f32_16x16x32_bf16 v[88:91], v[216:219], a[184:187], v[88:91]
	ds_read_b64_tr_b16 v[212:213], v29 offset:512
	ds_read_b64_tr_b16 v[214:215], v29 offset:5632
	s_waitcnt lgkmcnt(12)
	v_mfma_f32_16x16x32_bf16 v[92:95], v[220:223], a[184:187], v[92:95]
	ds_read_b64_tr_b16 v[216:217], v30 offset:512
	ds_read_b64_tr_b16 v[218:219], v30 offset:5632
	s_waitcnt lgkmcnt(12)
	v_mfma_f32_16x16x32_bf16 v[96:99], v[192:195], a[184:187], v[96:99]
	ds_read_b64_tr_b16 v[220:221], v31 offset:512
	ds_read_b64_tr_b16 v[222:223], v31 offset:5632
	s_add_u32 m0, s67, 45056
	s_mov_b32 s66, 322560
	buffer_load_dwordx4 v5, s[52:55], s66 offen lds
	s_waitcnt lgkmcnt(12)
	v_mfma_f32_16x16x32_bf16 v[100:103], v[196:199], a[184:187], v[100:103]
	ds_read_b64_tr_b16 v[192:193], v24 offset:768
	ds_read_b64_tr_b16 v[194:195], v24 offset:5888
	s_waitcnt lgkmcnt(12)
	v_mfma_f32_16x16x32_bf16 v[104:107], v[200:203], a[184:187], v[104:107]
	ds_read_b64_tr_b16 v[196:197], v25 offset:768
	ds_read_b64_tr_b16 v[198:199], v25 offset:5888
	s_waitcnt lgkmcnt(12)
	v_mfma_f32_16x16x32_bf16 v[108:111], v[204:207], a[184:187], v[108:111]
	ds_read_b64_tr_b16 v[200:201], v26 offset:768
	ds_read_b64_tr_b16 v[202:203], v26 offset:5888
	s_waitcnt lgkmcnt(12)
	v_mfma_f32_16x16x32_bf16 v[112:115], v[208:211], a[184:187], v[112:115]
	ds_read_b64_tr_b16 v[204:205], v27 offset:768
	ds_read_b64_tr_b16 v[206:207], v27 offset:5888
	s_add_u32 m0, s67, 46080
	s_mov_b32 s66, 327680
	buffer_load_dwordx4 v1, s[52:55], s66 offen lds
	s_waitcnt lgkmcnt(12)
	v_mfma_f32_16x16x32_bf16 v[116:119], v[212:215], a[184:187], v[116:119]
	ds_read_b64_tr_b16 v[208:209], v28 offset:768
	ds_read_b64_tr_b16 v[210:211], v28 offset:5888
	s_waitcnt lgkmcnt(12)
	v_mfma_f32_16x16x32_bf16 v[120:123], v[216:219], a[184:187], v[120:123]
	ds_read_b64_tr_b16 v[212:213], v29 offset:768
	ds_read_b64_tr_b16 v[214:215], v29 offset:5888
	s_waitcnt lgkmcnt(12)
	v_mfma_f32_16x16x32_bf16 v[124:127], v[220:223], a[184:187], v[124:127]
	ds_read_b64_tr_b16 v[216:217], v30 offset:768
	ds_read_b64_tr_b16 v[218:219], v30 offset:5888
	s_waitcnt lgkmcnt(12)
	v_mfma_f32_16x16x32_bf16 v[128:131], v[192:195], a[184:187], v[128:131]
	ds_read_b64_tr_b16 v[220:221], v31 offset:768
	ds_read_b64_tr_b16 v[222:223], v31 offset:5888
	s_add_u32 m0, s67, 47104
	s_mov_b32 s66, 327680
	buffer_load_dwordx4 v2, s[52:55], s66 offen lds
	s_waitcnt lgkmcnt(12)
	v_mfma_f32_16x16x32_bf16 v[132:135], v[196:199], a[184:187], v[132:135]
	ds_read_b64_tr_b16 v[192:193], v24 offset:1024
	ds_read_b64_tr_b16 v[194:195], v24 offset:6144
	s_waitcnt lgkmcnt(12)
	v_mfma_f32_16x16x32_bf16 v[136:139], v[200:203], a[184:187], v[136:139]
	ds_read_b64_tr_b16 v[196:197], v25 offset:1024
	ds_read_b64_tr_b16 v[198:199], v25 offset:6144
	s_waitcnt lgkmcnt(12)
	v_mfma_f32_16x16x32_bf16 v[140:143], v[204:207], a[184:187], v[140:143]
	ds_read_b64_tr_b16 v[200:201], v26 offset:1024
	ds_read_b64_tr_b16 v[202:203], v26 offset:6144
	s_waitcnt lgkmcnt(12)
	v_mfma_f32_16x16x32_bf16 v[144:147], v[208:211], a[184:187], v[144:147]
	ds_read_b64_tr_b16 v[204:205], v27 offset:1024
	ds_read_b64_tr_b16 v[206:207], v27 offset:6144
	s_add_u32 m0, s67, 48128
	s_mov_b32 s66, 327680
	buffer_load_dwordx4 v3, s[52:55], s66 offen lds
	s_waitcnt lgkmcnt(12)
	v_mfma_f32_16x16x32_bf16 v[148:151], v[212:215], a[184:187], v[148:151]
	ds_read_b64_tr_b16 v[208:209], v28 offset:1024
	ds_read_b64_tr_b16 v[210:211], v28 offset:6144
	s_waitcnt lgkmcnt(12)
	v_mfma_f32_16x16x32_bf16 v[152:155], v[216:219], a[184:187], v[152:155]
	ds_read_b64_tr_b16 v[212:213], v29 offset:1024
	ds_read_b64_tr_b16 v[214:215], v29 offset:6144
	s_waitcnt lgkmcnt(12)
	v_mfma_f32_16x16x32_bf16 v[156:159], v[220:223], a[184:187], v[156:159]
	ds_read_b64_tr_b16 v[216:217], v30 offset:1024
	ds_read_b64_tr_b16 v[218:219], v30 offset:6144
	s_waitcnt lgkmcnt(12)
	v_mfma_f32_16x16x32_bf16 v[160:163], v[192:195], a[184:187], v[160:163]
	ds_read_b64_tr_b16 v[220:221], v31 offset:1024
	ds_read_b64_tr_b16 v[222:223], v31 offset:6144
	s_add_u32 m0, s67, 49152
	s_mov_b32 s66, 327680
	buffer_load_dwordx4 v4, s[52:55], s66 offen lds
	s_waitcnt lgkmcnt(12)
	v_mfma_f32_16x16x32_bf16 v[164:167], v[196:199], a[184:187], v[164:167]
	s_waitcnt lgkmcnt(10)
	v_mfma_f32_16x16x32_bf16 v[168:171], v[200:203], a[184:187], v[168:171]
	s_waitcnt lgkmcnt(8)
	v_mfma_f32_16x16x32_bf16 v[172:175], v[204:207], a[184:187], v[172:175]
	s_waitcnt lgkmcnt(6)
	v_mfma_f32_16x16x32_bf16 v[176:179], v[208:211], a[184:187], v[176:179]
	s_add_u32 m0, s67, 50176
	s_mov_b32 s66, 327680
	buffer_load_dwordx4 v5, s[52:55], s66 offen lds
	s_waitcnt lgkmcnt(4)
	v_mfma_f32_16x16x32_bf16 v[180:183], v[212:215], a[184:187], v[180:183]
	s_waitcnt lgkmcnt(2)
	v_mfma_f32_16x16x32_bf16 v[184:187], v[216:219], a[184:187], v[184:187]
	s_waitcnt lgkmcnt(0)
	v_mfma_f32_16x16x32_bf16 v[188:191], v[220:223], a[184:187], v[188:191]
	s_waitcnt vmcnt(20)
	s_barrier
	ds_read_b64_tr_b16 v[192:193], v24 offset:40960
	ds_read_b64_tr_b16 v[194:195], v24 offset:46080
	ds_read_b64_tr_b16 v[196:197], v25 offset:40960
	ds_read_b64_tr_b16 v[198:199], v25 offset:46080
	ds_read_b64_tr_b16 v[200:201], v26 offset:40960
	ds_read_b64_tr_b16 v[202:203], v26 offset:46080
	ds_read_b64_tr_b16 v[204:205], v27 offset:40960
	ds_read_b64_tr_b16 v[206:207], v27 offset:46080
	ds_read_b64_tr_b16 v[208:209], v28 offset:40960
	ds_read_b64_tr_b16 v[210:211], v28 offset:46080
	ds_read_b64_tr_b16 v[212:213], v29 offset:40960
	ds_read_b64_tr_b16 v[214:215], v29 offset:46080
	ds_read_b64_tr_b16 v[216:217], v30 offset:40960
	ds_read_b64_tr_b16 v[218:219], v30 offset:46080
	s_waitcnt lgkmcnt(12)
	v_mfma_f32_16x16x32_bf16 v[32:35], v[192:195], a[188:191], v[32:35]
	ds_read_b64_tr_b16 v[220:221], v31 offset:40960
	ds_read_b64_tr_b16 v[222:223], v31 offset:46080
	s_add_u32 m0, s67, 81920
	s_mov_b32 s66, 409600
	buffer_load_dwordx4 v1, s[52:55], s66 offen lds
	s_waitcnt lgkmcnt(12)
	v_mfma_f32_16x16x32_bf16 v[36:39], v[196:199], a[188:191], v[36:39]
	ds_read_b64_tr_b16 v[192:193], v24 offset:41216
	ds_read_b64_tr_b16 v[194:195], v24 offset:46336
	s_waitcnt lgkmcnt(12)
	v_mfma_f32_16x16x32_bf16 v[40:43], v[200:203], a[188:191], v[40:43]
	ds_read_b64_tr_b16 v[196:197], v25 offset:41216
	ds_read_b64_tr_b16 v[198:199], v25 offset:46336
	s_waitcnt lgkmcnt(12)
	v_mfma_f32_16x16x32_bf16 v[44:47], v[204:207], a[188:191], v[44:47]
	ds_read_b64_tr_b16 v[200:201], v26 offset:41216
	ds_read_b64_tr_b16 v[202:203], v26 offset:46336
	s_waitcnt lgkmcnt(12)
	v_mfma_f32_16x16x32_bf16 v[48:51], v[208:211], a[188:191], v[48:51]
	ds_read_b64_tr_b16 v[204:205], v27 offset:41216
	ds_read_b64_tr_b16 v[206:207], v27 offset:46336
	s_add_u32 m0, s67, 82944
	s_mov_b32 s66, 409600
	buffer_load_dwordx4 v2, s[52:55], s66 offen lds
	s_waitcnt lgkmcnt(12)
	v_mfma_f32_16x16x32_bf16 v[52:55], v[212:215], a[188:191], v[52:55]
	ds_read_b64_tr_b16 v[208:209], v28 offset:41216
	ds_read_b64_tr_b16 v[210:211], v28 offset:46336
	s_waitcnt lgkmcnt(12)
	v_mfma_f32_16x16x32_bf16 v[56:59], v[216:219], a[188:191], v[56:59]
	ds_read_b64_tr_b16 v[212:213], v29 offset:41216
	ds_read_b64_tr_b16 v[214:215], v29 offset:46336
	s_waitcnt lgkmcnt(12)
	v_mfma_f32_16x16x32_bf16 v[60:63], v[220:223], a[188:191], v[60:63]
	ds_read_b64_tr_b16 v[216:217], v30 offset:41216
	ds_read_b64_tr_b16 v[218:219], v30 offset:46336
	s_waitcnt lgkmcnt(12)
	v_mfma_f32_16x16x32_bf16 v[64:67], v[192:195], a[188:191], v[64:67]
	ds_read_b64_tr_b16 v[220:221], v31 offset:41216
	ds_read_b64_tr_b16 v[222:223], v31 offset:46336
	s_add_u32 m0, s67, 83968
	s_mov_b32 s66, 409600
	buffer_load_dwordx4 v3, s[52:55], s66 offen lds
	s_waitcnt lgkmcnt(12)
	v_mfma_f32_16x16x32_bf16 v[68:71], v[196:199], a[188:191], v[68:71]
	ds_read_b64_tr_b16 v[192:193], v24 offset:41472
	ds_read_b64_tr_b16 v[194:195], v24 offset:46592
	s_waitcnt lgkmcnt(12)
	v_mfma_f32_16x16x32_bf16 v[72:75], v[200:203], a[188:191], v[72:75]
	ds_read_b64_tr_b16 v[196:197], v25 offset:41472
	ds_read_b64_tr_b16 v[198:199], v25 offset:46592
	s_waitcnt lgkmcnt(12)
	v_mfma_f32_16x16x32_bf16 v[76:79], v[204:207], a[188:191], v[76:79]
	ds_read_b64_tr_b16 v[200:201], v26 offset:41472
	ds_read_b64_tr_b16 v[202:203], v26 offset:46592
	s_waitcnt lgkmcnt(12)
	v_mfma_f32_16x16x32_bf16 v[80:83], v[208:211], a[188:191], v[80:83]
	ds_read_b64_tr_b16 v[204:205], v27 offset:41472
	ds_read_b64_tr_b16 v[206:207], v27 offset:46592
	s_add_u32 m0, s67, 84992
	s_mov_b32 s66, 409600
	buffer_load_dwordx4 v4, s[52:55], s66 offen lds
	s_waitcnt lgkmcnt(12)
	v_mfma_f32_16x16x32_bf16 v[84:87], v[212:215], a[188:191], v[84:87]
	ds_read_b64_tr_b16 v[208:209], v28 offset:41472
	ds_read_b64_tr_b16 v[210:211], v28 offset:46592
	s_waitcnt lgkmcnt(12)
	v_mfma_f32_16x16x32_bf16 v[88:91], v[216:219], a[188:191], v[88:91]
	ds_read_b64_tr_b16 v[212:213], v29 offset:41472
	ds_read_b64_tr_b16 v[214:215], v29 offset:46592
	s_waitcnt lgkmcnt(12)
	v_mfma_f32_16x16x32_bf16 v[92:95], v[220:223], a[188:191], v[92:95]
	ds_read_b64_tr_b16 v[216:217], v30 offset:41472
	ds_read_b64_tr_b16 v[218:219], v30 offset:46592
	s_waitcnt lgkmcnt(12)
	v_mfma_f32_16x16x32_bf16 v[96:99], v[192:195], a[188:191], v[96:99]
	ds_read_b64_tr_b16 v[220:221], v31 offset:41472
	ds_read_b64_tr_b16 v[222:223], v31 offset:46592
	s_add_u32 m0, s67, 86016
	s_mov_b32 s66, 409600
	buffer_load_dwordx4 v5, s[52:55], s66 offen lds
	s_waitcnt lgkmcnt(12)
	v_mfma_f32_16x16x32_bf16 v[100:103], v[196:199], a[188:191], v[100:103]
	ds_read_b64_tr_b16 v[192:193], v24 offset:41728
	ds_read_b64_tr_b16 v[194:195], v24 offset:46848
	s_waitcnt lgkmcnt(12)
	v_mfma_f32_16x16x32_bf16 v[104:107], v[200:203], a[188:191], v[104:107]
	ds_read_b64_tr_b16 v[196:197], v25 offset:41728
	ds_read_b64_tr_b16 v[198:199], v25 offset:46848
	s_waitcnt lgkmcnt(12)
	v_mfma_f32_16x16x32_bf16 v[108:111], v[204:207], a[188:191], v[108:111]
	ds_read_b64_tr_b16 v[200:201], v26 offset:41728
	ds_read_b64_tr_b16 v[202:203], v26 offset:46848
	s_waitcnt lgkmcnt(12)
	v_mfma_f32_16x16x32_bf16 v[112:115], v[208:211], a[188:191], v[112:115]
	ds_read_b64_tr_b16 v[204:205], v27 offset:41728
	ds_read_b64_tr_b16 v[206:207], v27 offset:46848
	s_add_u32 m0, s67, 87040
	s_mov_b32 s66, 414720
	buffer_load_dwordx4 v1, s[52:55], s66 offen lds
	s_waitcnt lgkmcnt(12)
	v_mfma_f32_16x16x32_bf16 v[116:119], v[212:215], a[188:191], v[116:119]
	ds_read_b64_tr_b16 v[208:209], v28 offset:41728
	ds_read_b64_tr_b16 v[210:211], v28 offset:46848
	s_waitcnt lgkmcnt(12)
	v_mfma_f32_16x16x32_bf16 v[120:123], v[216:219], a[188:191], v[120:123]
	ds_read_b64_tr_b16 v[212:213], v29 offset:41728
	ds_read_b64_tr_b16 v[214:215], v29 offset:46848
	s_waitcnt lgkmcnt(12)
	v_mfma_f32_16x16x32_bf16 v[124:127], v[220:223], a[188:191], v[124:127]
	ds_read_b64_tr_b16 v[216:217], v30 offset:41728
	ds_read_b64_tr_b16 v[218:219], v30 offset:46848
	s_waitcnt lgkmcnt(12)
	v_mfma_f32_16x16x32_bf16 v[128:131], v[192:195], a[188:191], v[128:131]
	ds_read_b64_tr_b16 v[220:221], v31 offset:41728
	ds_read_b64_tr_b16 v[222:223], v31 offset:46848
	s_add_u32 m0, s67, 88064
	s_mov_b32 s66, 414720
	buffer_load_dwordx4 v2, s[52:55], s66 offen lds
	s_waitcnt lgkmcnt(12)
	v_mfma_f32_16x16x32_bf16 v[132:135], v[196:199], a[188:191], v[132:135]
	ds_read_b64_tr_b16 v[192:193], v24 offset:41984
	ds_read_b64_tr_b16 v[194:195], v24 offset:47104
	s_waitcnt lgkmcnt(12)
	v_mfma_f32_16x16x32_bf16 v[136:139], v[200:203], a[188:191], v[136:139]
	ds_read_b64_tr_b16 v[196:197], v25 offset:41984
	ds_read_b64_tr_b16 v[198:199], v25 offset:47104
	s_waitcnt lgkmcnt(12)
	v_mfma_f32_16x16x32_bf16 v[140:143], v[204:207], a[188:191], v[140:143]
	ds_read_b64_tr_b16 v[200:201], v26 offset:41984
	ds_read_b64_tr_b16 v[202:203], v26 offset:47104
	s_waitcnt lgkmcnt(12)
	v_mfma_f32_16x16x32_bf16 v[144:147], v[208:211], a[188:191], v[144:147]
	ds_read_b64_tr_b16 v[204:205], v27 offset:41984
	ds_read_b64_tr_b16 v[206:207], v27 offset:47104
	s_add_u32 m0, s67, 89088
	s_mov_b32 s66, 414720
	buffer_load_dwordx4 v3, s[52:55], s66 offen lds
	s_waitcnt lgkmcnt(12)
	v_mfma_f32_16x16x32_bf16 v[148:151], v[212:215], a[188:191], v[148:151]
	ds_read_b64_tr_b16 v[208:209], v28 offset:41984
	ds_read_b64_tr_b16 v[210:211], v28 offset:47104
	s_waitcnt lgkmcnt(12)
	v_mfma_f32_16x16x32_bf16 v[152:155], v[216:219], a[188:191], v[152:155]
	ds_read_b64_tr_b16 v[212:213], v29 offset:41984
	ds_read_b64_tr_b16 v[214:215], v29 offset:47104
	s_waitcnt lgkmcnt(12)
	v_mfma_f32_16x16x32_bf16 v[156:159], v[220:223], a[188:191], v[156:159]
	ds_read_b64_tr_b16 v[216:217], v30 offset:41984
	ds_read_b64_tr_b16 v[218:219], v30 offset:47104
	s_waitcnt lgkmcnt(12)
	v_mfma_f32_16x16x32_bf16 v[160:163], v[192:195], a[188:191], v[160:163]
	ds_read_b64_tr_b16 v[220:221], v31 offset:41984
	ds_read_b64_tr_b16 v[222:223], v31 offset:47104
	s_add_u32 m0, s67, 90112
	s_mov_b32 s66, 414720
	buffer_load_dwordx4 v4, s[52:55], s66 offen lds
	s_waitcnt lgkmcnt(12)
	v_mfma_f32_16x16x32_bf16 v[164:167], v[196:199], a[188:191], v[164:167]
	s_waitcnt lgkmcnt(10)
	v_mfma_f32_16x16x32_bf16 v[168:171], v[200:203], a[188:191], v[168:171]
	s_waitcnt lgkmcnt(8)
	v_mfma_f32_16x16x32_bf16 v[172:175], v[204:207], a[188:191], v[172:175]
	s_waitcnt lgkmcnt(6)
	v_mfma_f32_16x16x32_bf16 v[176:179], v[208:211], a[188:191], v[176:179]
	s_add_u32 m0, s67, 91136
	s_mov_b32 s66, 414720
	buffer_load_dwordx4 v5, s[52:55], s66 offen lds
	s_waitcnt lgkmcnt(4)
	v_mfma_f32_16x16x32_bf16 v[180:183], v[212:215], a[188:191], v[180:183]
	s_waitcnt lgkmcnt(2)
	v_mfma_f32_16x16x32_bf16 v[184:187], v[216:219], a[188:191], v[184:187]
	s_waitcnt lgkmcnt(0)
	v_mfma_f32_16x16x32_bf16 v[188:191], v[220:223], a[188:191], v[188:191]
	s_waitcnt vmcnt(20)
	s_barrier
	ds_read_b64_tr_b16 v[192:193], v16 offset:0
	ds_read_b64_tr_b16 v[194:195], v16 offset:5120
	ds_read_b64_tr_b16 v[196:197], v17 offset:0
	ds_read_b64_tr_b16 v[198:199], v17 offset:5120
	ds_read_b64_tr_b16 v[200:201], v18 offset:0
	ds_read_b64_tr_b16 v[202:203], v18 offset:5120
	ds_read_b64_tr_b16 v[204:205], v19 offset:0
	ds_read_b64_tr_b16 v[206:207], v19 offset:5120
	ds_read_b64_tr_b16 v[208:209], v20 offset:0
	ds_read_b64_tr_b16 v[210:211], v20 offset:5120
	ds_read_b64_tr_b16 v[212:213], v21 offset:0
	ds_read_b64_tr_b16 v[214:215], v21 offset:5120
	ds_read_b64_tr_b16 v[216:217], v22 offset:0
	ds_read_b64_tr_b16 v[218:219], v22 offset:5120
	s_waitcnt lgkmcnt(12)
	v_mfma_f32_16x16x32_bf16 v[32:35], v[192:195], a[192:195], v[32:35]
	ds_read_b64_tr_b16 v[220:221], v23 offset:0
	ds_read_b64_tr_b16 v[222:223], v23 offset:5120
	s_add_u32 m0, s67, 122880
	s_mov_b32 s66, 419840
	buffer_load_dwordx4 v1, s[52:55], s66 offen lds
	s_waitcnt lgkmcnt(12)
	v_mfma_f32_16x16x32_bf16 v[36:39], v[196:199], a[192:195], v[36:39]
	ds_read_b64_tr_b16 v[192:193], v16 offset:256
	ds_read_b64_tr_b16 v[194:195], v16 offset:5376
	s_waitcnt lgkmcnt(12)
	v_mfma_f32_16x16x32_bf16 v[40:43], v[200:203], a[192:195], v[40:43]
	ds_read_b64_tr_b16 v[196:197], v17 offset:256
	ds_read_b64_tr_b16 v[198:199], v17 offset:5376
	s_waitcnt lgkmcnt(12)
	v_mfma_f32_16x16x32_bf16 v[44:47], v[204:207], a[192:195], v[44:47]
	ds_read_b64_tr_b16 v[200:201], v18 offset:256
	ds_read_b64_tr_b16 v[202:203], v18 offset:5376
	s_waitcnt lgkmcnt(12)
	v_mfma_f32_16x16x32_bf16 v[48:51], v[208:211], a[192:195], v[48:51]
	ds_read_b64_tr_b16 v[204:205], v19 offset:256
	ds_read_b64_tr_b16 v[206:207], v19 offset:5376
	s_add_u32 m0, s67, 123904
	s_mov_b32 s66, 419840
	buffer_load_dwordx4 v2, s[52:55], s66 offen lds
	s_waitcnt lgkmcnt(12)
	v_mfma_f32_16x16x32_bf16 v[52:55], v[212:215], a[192:195], v[52:55]
	ds_read_b64_tr_b16 v[208:209], v20 offset:256
	ds_read_b64_tr_b16 v[210:211], v20 offset:5376
	s_waitcnt lgkmcnt(12)
	v_mfma_f32_16x16x32_bf16 v[56:59], v[216:219], a[192:195], v[56:59]
	ds_read_b64_tr_b16 v[212:213], v21 offset:256
	ds_read_b64_tr_b16 v[214:215], v21 offset:5376
	s_waitcnt lgkmcnt(12)
	v_mfma_f32_16x16x32_bf16 v[60:63], v[220:223], a[192:195], v[60:63]
	ds_read_b64_tr_b16 v[216:217], v22 offset:256
	ds_read_b64_tr_b16 v[218:219], v22 offset:5376
	s_waitcnt lgkmcnt(12)
	v_mfma_f32_16x16x32_bf16 v[64:67], v[192:195], a[192:195], v[64:67]
	ds_read_b64_tr_b16 v[220:221], v23 offset:256
	ds_read_b64_tr_b16 v[222:223], v23 offset:5376
	s_add_u32 m0, s67, 124928
	s_mov_b32 s66, 419840
	buffer_load_dwordx4 v3, s[52:55], s66 offen lds
	s_waitcnt lgkmcnt(12)
	v_mfma_f32_16x16x32_bf16 v[68:71], v[196:199], a[192:195], v[68:71]
	ds_read_b64_tr_b16 v[192:193], v16 offset:512
	ds_read_b64_tr_b16 v[194:195], v16 offset:5632
	s_waitcnt lgkmcnt(12)
	v_mfma_f32_16x16x32_bf16 v[72:75], v[200:203], a[192:195], v[72:75]
	ds_read_b64_tr_b16 v[196:197], v17 offset:512
	ds_read_b64_tr_b16 v[198:199], v17 offset:5632
	s_waitcnt lgkmcnt(12)
	v_mfma_f32_16x16x32_bf16 v[76:79], v[204:207], a[192:195], v[76:79]
	ds_read_b64_tr_b16 v[200:201], v18 offset:512
	ds_read_b64_tr_b16 v[202:203], v18 offset:5632
	s_waitcnt lgkmcnt(12)
	v_mfma_f32_16x16x32_bf16 v[80:83], v[208:211], a[192:195], v[80:83]
	ds_read_b64_tr_b16 v[204:205], v19 offset:512
	ds_read_b64_tr_b16 v[206:207], v19 offset:5632
	s_add_u32 m0, s67, 125952
	s_mov_b32 s66, 419840
	buffer_load_dwordx4 v4, s[52:55], s66 offen lds
	s_waitcnt lgkmcnt(12)
	v_mfma_f32_16x16x32_bf16 v[84:87], v[212:215], a[192:195], v[84:87]
	ds_read_b64_tr_b16 v[208:209], v20 offset:512
	ds_read_b64_tr_b16 v[210:211], v20 offset:5632
	s_waitcnt lgkmcnt(12)
	v_mfma_f32_16x16x32_bf16 v[88:91], v[216:219], a[192:195], v[88:91]
	ds_read_b64_tr_b16 v[212:213], v21 offset:512
	ds_read_b64_tr_b16 v[214:215], v21 offset:5632
	s_waitcnt lgkmcnt(12)
	v_mfma_f32_16x16x32_bf16 v[92:95], v[220:223], a[192:195], v[92:95]
	ds_read_b64_tr_b16 v[216:217], v22 offset:512
	ds_read_b64_tr_b16 v[218:219], v22 offset:5632
	s_waitcnt lgkmcnt(12)
	v_mfma_f32_16x16x32_bf16 v[96:99], v[192:195], a[192:195], v[96:99]
	ds_read_b64_tr_b16 v[220:221], v23 offset:512
	ds_read_b64_tr_b16 v[222:223], v23 offset:5632
	s_add_u32 m0, s67, 126976
	s_mov_b32 s66, 419840
	buffer_load_dwordx4 v5, s[52:55], s66 offen lds
	s_waitcnt lgkmcnt(12)
	v_mfma_f32_16x16x32_bf16 v[100:103], v[196:199], a[192:195], v[100:103]
	ds_read_b64_tr_b16 v[192:193], v16 offset:768
	ds_read_b64_tr_b16 v[194:195], v16 offset:5888
	s_waitcnt lgkmcnt(12)
	v_mfma_f32_16x16x32_bf16 v[104:107], v[200:203], a[192:195], v[104:107]
	ds_read_b64_tr_b16 v[196:197], v17 offset:768
	ds_read_b64_tr_b16 v[198:199], v17 offset:5888
	s_waitcnt lgkmcnt(12)
	v_mfma_f32_16x16x32_bf16 v[108:111], v[204:207], a[192:195], v[108:111]
	ds_read_b64_tr_b16 v[200:201], v18 offset:768
	ds_read_b64_tr_b16 v[202:203], v18 offset:5888
	s_waitcnt lgkmcnt(12)
	v_mfma_f32_16x16x32_bf16 v[112:115], v[208:211], a[192:195], v[112:115]
	ds_read_b64_tr_b16 v[204:205], v19 offset:768
	ds_read_b64_tr_b16 v[206:207], v19 offset:5888
	s_add_u32 m0, s67, 128000
	s_mov_b32 s66, 424960
	buffer_load_dwordx4 v1, s[52:55], s66 offen lds
	s_waitcnt lgkmcnt(12)
	v_mfma_f32_16x16x32_bf16 v[116:119], v[212:215], a[192:195], v[116:119]
	ds_read_b64_tr_b16 v[208:209], v20 offset:768
	ds_read_b64_tr_b16 v[210:211], v20 offset:5888
	s_waitcnt lgkmcnt(12)
	v_mfma_f32_16x16x32_bf16 v[120:123], v[216:219], a[192:195], v[120:123]
	ds_read_b64_tr_b16 v[212:213], v21 offset:768
	ds_read_b64_tr_b16 v[214:215], v21 offset:5888
	s_waitcnt lgkmcnt(12)
	v_mfma_f32_16x16x32_bf16 v[124:127], v[220:223], a[192:195], v[124:127]
	ds_read_b64_tr_b16 v[216:217], v22 offset:768
	ds_read_b64_tr_b16 v[218:219], v22 offset:5888
	s_waitcnt lgkmcnt(12)
	v_mfma_f32_16x16x32_bf16 v[128:131], v[192:195], a[192:195], v[128:131]
	ds_read_b64_tr_b16 v[220:221], v23 offset:768
	ds_read_b64_tr_b16 v[222:223], v23 offset:5888
	s_add_u32 m0, s67, 129024
	s_mov_b32 s66, 424960
	buffer_load_dwordx4 v2, s[52:55], s66 offen lds
	s_waitcnt lgkmcnt(12)
	v_mfma_f32_16x16x32_bf16 v[132:135], v[196:199], a[192:195], v[132:135]
	ds_read_b64_tr_b16 v[192:193], v16 offset:1024
	ds_read_b64_tr_b16 v[194:195], v16 offset:6144
	s_waitcnt lgkmcnt(12)
	v_mfma_f32_16x16x32_bf16 v[136:139], v[200:203], a[192:195], v[136:139]
	ds_read_b64_tr_b16 v[196:197], v17 offset:1024
	ds_read_b64_tr_b16 v[198:199], v17 offset:6144
	s_waitcnt lgkmcnt(12)
	v_mfma_f32_16x16x32_bf16 v[140:143], v[204:207], a[192:195], v[140:143]
	ds_read_b64_tr_b16 v[200:201], v18 offset:1024
	ds_read_b64_tr_b16 v[202:203], v18 offset:6144
	s_waitcnt lgkmcnt(12)
	v_mfma_f32_16x16x32_bf16 v[144:147], v[208:211], a[192:195], v[144:147]
	ds_read_b64_tr_b16 v[204:205], v19 offset:1024
	ds_read_b64_tr_b16 v[206:207], v19 offset:6144
	s_add_u32 m0, s67, 130048
	s_mov_b32 s66, 424960
	buffer_load_dwordx4 v3, s[52:55], s66 offen lds
	s_waitcnt lgkmcnt(12)
	v_mfma_f32_16x16x32_bf16 v[148:151], v[212:215], a[192:195], v[148:151]
	ds_read_b64_tr_b16 v[208:209], v20 offset:1024
	ds_read_b64_tr_b16 v[210:211], v20 offset:6144
	s_waitcnt lgkmcnt(12)
	v_mfma_f32_16x16x32_bf16 v[152:155], v[216:219], a[192:195], v[152:155]
	ds_read_b64_tr_b16 v[212:213], v21 offset:1024
	ds_read_b64_tr_b16 v[214:215], v21 offset:6144
	s_waitcnt lgkmcnt(12)
	v_mfma_f32_16x16x32_bf16 v[156:159], v[220:223], a[192:195], v[156:159]
	ds_read_b64_tr_b16 v[216:217], v22 offset:1024
	ds_read_b64_tr_b16 v[218:219], v22 offset:6144
	s_waitcnt lgkmcnt(12)
	v_mfma_f32_16x16x32_bf16 v[160:163], v[192:195], a[192:195], v[160:163]
	ds_read_b64_tr_b16 v[220:221], v23 offset:1024
	ds_read_b64_tr_b16 v[222:223], v23 offset:6144
	s_add_u32 m0, s67, 131072
	s_mov_b32 s66, 424960
	buffer_load_dwordx4 v4, s[52:55], s66 offen lds
	s_waitcnt lgkmcnt(12)
	v_mfma_f32_16x16x32_bf16 v[164:167], v[196:199], a[192:195], v[164:167]
	s_waitcnt lgkmcnt(10)
	v_mfma_f32_16x16x32_bf16 v[168:171], v[200:203], a[192:195], v[168:171]
	s_waitcnt lgkmcnt(8)
	v_mfma_f32_16x16x32_bf16 v[172:175], v[204:207], a[192:195], v[172:175]
	s_waitcnt lgkmcnt(6)
	v_mfma_f32_16x16x32_bf16 v[176:179], v[208:211], a[192:195], v[176:179]
	s_add_u32 m0, s67, 132096
	s_mov_b32 s66, 424960
	buffer_load_dwordx4 v5, s[52:55], s66 offen lds
	s_waitcnt lgkmcnt(4)
	v_mfma_f32_16x16x32_bf16 v[180:183], v[212:215], a[192:195], v[180:183]
	s_waitcnt lgkmcnt(2)
	v_mfma_f32_16x16x32_bf16 v[184:187], v[216:219], a[192:195], v[184:187]
	s_waitcnt lgkmcnt(0)
	v_mfma_f32_16x16x32_bf16 v[188:191], v[220:223], a[192:195], v[188:191]
	s_waitcnt vmcnt(20)
	s_barrier
	ds_read_b64_tr_b16 v[192:193], v16 offset:40960
	ds_read_b64_tr_b16 v[194:195], v16 offset:46080
	ds_read_b64_tr_b16 v[196:197], v17 offset:40960
	ds_read_b64_tr_b16 v[198:199], v17 offset:46080
	ds_read_b64_tr_b16 v[200:201], v18 offset:40960
	ds_read_b64_tr_b16 v[202:203], v18 offset:46080
	ds_read_b64_tr_b16 v[204:205], v19 offset:40960
	ds_read_b64_tr_b16 v[206:207], v19 offset:46080
	ds_read_b64_tr_b16 v[208:209], v20 offset:40960
	ds_read_b64_tr_b16 v[210:211], v20 offset:46080
	ds_read_b64_tr_b16 v[212:213], v21 offset:40960
	ds_read_b64_tr_b16 v[214:215], v21 offset:46080
	ds_read_b64_tr_b16 v[216:217], v22 offset:40960
	ds_read_b64_tr_b16 v[218:219], v22 offset:46080
	s_waitcnt lgkmcnt(12)
	v_mfma_f32_16x16x32_bf16 v[32:35], v[192:195], a[196:199], v[32:35]
	ds_read_b64_tr_b16 v[220:221], v23 offset:40960
	ds_read_b64_tr_b16 v[222:223], v23 offset:46080
	s_add_u32 m0, s67, 0
	s_mov_b32 s66, 430080
	buffer_load_dwordx4 v1, s[52:55], s66 offen lds
	s_waitcnt lgkmcnt(12)
	v_mfma_f32_16x16x32_bf16 v[36:39], v[196:199], a[196:199], v[36:39]
	ds_read_b64_tr_b16 v[192:193], v16 offset:41216
	ds_read_b64_tr_b16 v[194:195], v16 offset:46336
	s_waitcnt lgkmcnt(12)
	v_mfma_f32_16x16x32_bf16 v[40:43], v[200:203], a[196:199], v[40:43]
	ds_read_b64_tr_b16 v[196:197], v17 offset:41216
	ds_read_b64_tr_b16 v[198:199], v17 offset:46336
	s_waitcnt lgkmcnt(12)
	v_mfma_f32_16x16x32_bf16 v[44:47], v[204:207], a[196:199], v[44:47]
	ds_read_b64_tr_b16 v[200:201], v18 offset:41216
	ds_read_b64_tr_b16 v[202:203], v18 offset:46336
	s_waitcnt lgkmcnt(12)
	v_mfma_f32_16x16x32_bf16 v[48:51], v[208:211], a[196:199], v[48:51]
	ds_read_b64_tr_b16 v[204:205], v19 offset:41216
	ds_read_b64_tr_b16 v[206:207], v19 offset:46336
	s_add_u32 m0, s67, 1024
	s_mov_b32 s66, 430080
	buffer_load_dwordx4 v2, s[52:55], s66 offen lds
	s_waitcnt lgkmcnt(12)
	v_mfma_f32_16x16x32_bf16 v[52:55], v[212:215], a[196:199], v[52:55]
	ds_read_b64_tr_b16 v[208:209], v20 offset:41216
	ds_read_b64_tr_b16 v[210:211], v20 offset:46336
	s_waitcnt lgkmcnt(12)
	v_mfma_f32_16x16x32_bf16 v[56:59], v[216:219], a[196:199], v[56:59]
	ds_read_b64_tr_b16 v[212:213], v21 offset:41216
	ds_read_b64_tr_b16 v[214:215], v21 offset:46336
	s_waitcnt lgkmcnt(12)
	v_mfma_f32_16x16x32_bf16 v[60:63], v[220:223], a[196:199], v[60:63]
	ds_read_b64_tr_b16 v[216:217], v22 offset:41216
	ds_read_b64_tr_b16 v[218:219], v22 offset:46336
	s_waitcnt lgkmcnt(12)
	v_mfma_f32_16x16x32_bf16 v[64:67], v[192:195], a[196:199], v[64:67]
	ds_read_b64_tr_b16 v[220:221], v23 offset:41216
	ds_read_b64_tr_b16 v[222:223], v23 offset:46336
	s_add_u32 m0, s67, 2048
	s_mov_b32 s66, 430080
	buffer_load_dwordx4 v3, s[52:55], s66 offen lds
	s_waitcnt lgkmcnt(12)
	v_mfma_f32_16x16x32_bf16 v[68:71], v[196:199], a[196:199], v[68:71]
	ds_read_b64_tr_b16 v[192:193], v16 offset:41472
	ds_read_b64_tr_b16 v[194:195], v16 offset:46592
	s_waitcnt lgkmcnt(12)
	v_mfma_f32_16x16x32_bf16 v[72:75], v[200:203], a[196:199], v[72:75]
	ds_read_b64_tr_b16 v[196:197], v17 offset:41472
	ds_read_b64_tr_b16 v[198:199], v17 offset:46592
	s_waitcnt lgkmcnt(12)
	v_mfma_f32_16x16x32_bf16 v[76:79], v[204:207], a[196:199], v[76:79]
	ds_read_b64_tr_b16 v[200:201], v18 offset:41472
	ds_read_b64_tr_b16 v[202:203], v18 offset:46592
	s_waitcnt lgkmcnt(12)
	v_mfma_f32_16x16x32_bf16 v[80:83], v[208:211], a[196:199], v[80:83]
	ds_read_b64_tr_b16 v[204:205], v19 offset:41472
	ds_read_b64_tr_b16 v[206:207], v19 offset:46592
	s_add_u32 m0, s67, 3072
	s_mov_b32 s66, 430080
	buffer_load_dwordx4 v4, s[52:55], s66 offen lds
	s_waitcnt lgkmcnt(12)
	v_mfma_f32_16x16x32_bf16 v[84:87], v[212:215], a[196:199], v[84:87]
	ds_read_b64_tr_b16 v[208:209], v20 offset:41472
	ds_read_b64_tr_b16 v[210:211], v20 offset:46592
	s_waitcnt lgkmcnt(12)
	v_mfma_f32_16x16x32_bf16 v[88:91], v[216:219], a[196:199], v[88:91]
	ds_read_b64_tr_b16 v[212:213], v21 offset:41472
	ds_read_b64_tr_b16 v[214:215], v21 offset:46592
	s_waitcnt lgkmcnt(12)
	v_mfma_f32_16x16x32_bf16 v[92:95], v[220:223], a[196:199], v[92:95]
	ds_read_b64_tr_b16 v[216:217], v22 offset:41472
	ds_read_b64_tr_b16 v[218:219], v22 offset:46592
	s_waitcnt lgkmcnt(12)
	v_mfma_f32_16x16x32_bf16 v[96:99], v[192:195], a[196:199], v[96:99]
	ds_read_b64_tr_b16 v[220:221], v23 offset:41472
	ds_read_b64_tr_b16 v[222:223], v23 offset:46592
	s_add_u32 m0, s67, 4096
	s_mov_b32 s66, 430080
	buffer_load_dwordx4 v5, s[52:55], s66 offen lds
	s_waitcnt lgkmcnt(12)
	v_mfma_f32_16x16x32_bf16 v[100:103], v[196:199], a[196:199], v[100:103]
	ds_read_b64_tr_b16 v[192:193], v16 offset:41728
	ds_read_b64_tr_b16 v[194:195], v16 offset:46848
	s_waitcnt lgkmcnt(12)
	v_mfma_f32_16x16x32_bf16 v[104:107], v[200:203], a[196:199], v[104:107]
	ds_read_b64_tr_b16 v[196:197], v17 offset:41728
	ds_read_b64_tr_b16 v[198:199], v17 offset:46848
	s_waitcnt lgkmcnt(12)
	v_mfma_f32_16x16x32_bf16 v[108:111], v[204:207], a[196:199], v[108:111]
	ds_read_b64_tr_b16 v[200:201], v18 offset:41728
	ds_read_b64_tr_b16 v[202:203], v18 offset:46848
	s_waitcnt lgkmcnt(12)
	v_mfma_f32_16x16x32_bf16 v[112:115], v[208:211], a[196:199], v[112:115]
	ds_read_b64_tr_b16 v[204:205], v19 offset:41728
	ds_read_b64_tr_b16 v[206:207], v19 offset:46848
	s_add_u32 m0, s67, 5120
	s_mov_b32 s66, 512000
	buffer_load_dwordx4 v1, s[52:55], s66 offen lds
	s_waitcnt lgkmcnt(12)
	v_mfma_f32_16x16x32_bf16 v[116:119], v[212:215], a[196:199], v[116:119]
	ds_read_b64_tr_b16 v[208:209], v20 offset:41728
	ds_read_b64_tr_b16 v[210:211], v20 offset:46848
	s_waitcnt lgkmcnt(12)
	v_mfma_f32_16x16x32_bf16 v[120:123], v[216:219], a[196:199], v[120:123]
	ds_read_b64_tr_b16 v[212:213], v21 offset:41728
	ds_read_b64_tr_b16 v[214:215], v21 offset:46848
	s_waitcnt lgkmcnt(12)
	v_mfma_f32_16x16x32_bf16 v[124:127], v[220:223], a[196:199], v[124:127]
	ds_read_b64_tr_b16 v[216:217], v22 offset:41728
	ds_read_b64_tr_b16 v[218:219], v22 offset:46848
	s_waitcnt lgkmcnt(12)
	v_mfma_f32_16x16x32_bf16 v[128:131], v[192:195], a[196:199], v[128:131]
	ds_read_b64_tr_b16 v[220:221], v23 offset:41728
	ds_read_b64_tr_b16 v[222:223], v23 offset:46848
	s_add_u32 m0, s67, 6144
	s_mov_b32 s66, 512000
	buffer_load_dwordx4 v2, s[52:55], s66 offen lds
	s_waitcnt lgkmcnt(12)
	v_mfma_f32_16x16x32_bf16 v[132:135], v[196:199], a[196:199], v[132:135]
	ds_read_b64_tr_b16 v[192:193], v16 offset:41984
	ds_read_b64_tr_b16 v[194:195], v16 offset:47104
	s_waitcnt lgkmcnt(12)
	v_mfma_f32_16x16x32_bf16 v[136:139], v[200:203], a[196:199], v[136:139]
	ds_read_b64_tr_b16 v[196:197], v17 offset:41984
	ds_read_b64_tr_b16 v[198:199], v17 offset:47104
	s_waitcnt lgkmcnt(12)
	v_mfma_f32_16x16x32_bf16 v[140:143], v[204:207], a[196:199], v[140:143]
	ds_read_b64_tr_b16 v[200:201], v18 offset:41984
	ds_read_b64_tr_b16 v[202:203], v18 offset:47104
	s_waitcnt lgkmcnt(12)
	v_mfma_f32_16x16x32_bf16 v[144:147], v[208:211], a[196:199], v[144:147]
	ds_read_b64_tr_b16 v[204:205], v19 offset:41984
	ds_read_b64_tr_b16 v[206:207], v19 offset:47104
	s_add_u32 m0, s67, 7168
	s_mov_b32 s66, 512000
	buffer_load_dwordx4 v3, s[52:55], s66 offen lds
	s_waitcnt lgkmcnt(12)
	v_mfma_f32_16x16x32_bf16 v[148:151], v[212:215], a[196:199], v[148:151]
	ds_read_b64_tr_b16 v[208:209], v20 offset:41984
	ds_read_b64_tr_b16 v[210:211], v20 offset:47104
	s_waitcnt lgkmcnt(12)
	v_mfma_f32_16x16x32_bf16 v[152:155], v[216:219], a[196:199], v[152:155]
	ds_read_b64_tr_b16 v[212:213], v21 offset:41984
	ds_read_b64_tr_b16 v[214:215], v21 offset:47104
	s_waitcnt lgkmcnt(12)
	v_mfma_f32_16x16x32_bf16 v[156:159], v[220:223], a[196:199], v[156:159]
	ds_read_b64_tr_b16 v[216:217], v22 offset:41984
	ds_read_b64_tr_b16 v[218:219], v22 offset:47104
	s_waitcnt lgkmcnt(12)
	v_mfma_f32_16x16x32_bf16 v[160:163], v[192:195], a[196:199], v[160:163]
	ds_read_b64_tr_b16 v[220:221], v23 offset:41984
	ds_read_b64_tr_b16 v[222:223], v23 offset:47104
	s_add_u32 m0, s67, 8192
	s_mov_b32 s66, 512000
	buffer_load_dwordx4 v4, s[52:55], s66 offen lds
	s_waitcnt lgkmcnt(12)
	v_mfma_f32_16x16x32_bf16 v[164:167], v[196:199], a[196:199], v[164:167]
	s_waitcnt lgkmcnt(10)
	v_mfma_f32_16x16x32_bf16 v[168:171], v[200:203], a[196:199], v[168:171]
	s_waitcnt lgkmcnt(8)
	v_mfma_f32_16x16x32_bf16 v[172:175], v[204:207], a[196:199], v[172:175]
	s_waitcnt lgkmcnt(6)
	v_mfma_f32_16x16x32_bf16 v[176:179], v[208:211], a[196:199], v[176:179]
	s_add_u32 m0, s67, 9216
	s_mov_b32 s66, 512000
	buffer_load_dwordx4 v5, s[52:55], s66 offen lds
	s_waitcnt lgkmcnt(4)
	v_mfma_f32_16x16x32_bf16 v[180:183], v[212:215], a[196:199], v[180:183]
	s_waitcnt lgkmcnt(2)
	v_mfma_f32_16x16x32_bf16 v[184:187], v[216:219], a[196:199], v[184:187]
	s_waitcnt lgkmcnt(0)
	v_mfma_f32_16x16x32_bf16 v[188:191], v[220:223], a[196:199], v[188:191]
	s_waitcnt vmcnt(20)
	s_barrier
	ds_read_b64_tr_b16 v[192:193], v24 offset:0
	ds_read_b64_tr_b16 v[194:195], v24 offset:5120
	ds_read_b64_tr_b16 v[196:197], v25 offset:0
	ds_read_b64_tr_b16 v[198:199], v25 offset:5120
	ds_read_b64_tr_b16 v[200:201], v26 offset:0
	ds_read_b64_tr_b16 v[202:203], v26 offset:5120
	ds_read_b64_tr_b16 v[204:205], v27 offset:0
	ds_read_b64_tr_b16 v[206:207], v27 offset:5120
	ds_read_b64_tr_b16 v[208:209], v28 offset:0
	ds_read_b64_tr_b16 v[210:211], v28 offset:5120
	ds_read_b64_tr_b16 v[212:213], v29 offset:0
	ds_read_b64_tr_b16 v[214:215], v29 offset:5120
	ds_read_b64_tr_b16 v[216:217], v30 offset:0
	ds_read_b64_tr_b16 v[218:219], v30 offset:5120
	s_waitcnt lgkmcnt(12)
	v_mfma_f32_16x16x32_bf16 v[32:35], v[192:195], a[200:203], v[32:35]
	ds_read_b64_tr_b16 v[220:221], v31 offset:0
	ds_read_b64_tr_b16 v[222:223], v31 offset:5120
	s_add_u32 m0, s67, 40960
	s_mov_b32 s66, 517120
	buffer_load_dwordx4 v1, s[52:55], s66 offen lds
	s_waitcnt lgkmcnt(12)
	v_mfma_f32_16x16x32_bf16 v[36:39], v[196:199], a[200:203], v[36:39]
	ds_read_b64_tr_b16 v[192:193], v24 offset:256
	ds_read_b64_tr_b16 v[194:195], v24 offset:5376
	s_waitcnt lgkmcnt(12)
	v_mfma_f32_16x16x32_bf16 v[40:43], v[200:203], a[200:203], v[40:43]
	ds_read_b64_tr_b16 v[196:197], v25 offset:256
	ds_read_b64_tr_b16 v[198:199], v25 offset:5376
	s_waitcnt lgkmcnt(12)
	v_mfma_f32_16x16x32_bf16 v[44:47], v[204:207], a[200:203], v[44:47]
	ds_read_b64_tr_b16 v[200:201], v26 offset:256
	ds_read_b64_tr_b16 v[202:203], v26 offset:5376
	s_waitcnt lgkmcnt(12)
	v_mfma_f32_16x16x32_bf16 v[48:51], v[208:211], a[200:203], v[48:51]
	ds_read_b64_tr_b16 v[204:205], v27 offset:256
	ds_read_b64_tr_b16 v[206:207], v27 offset:5376
	s_add_u32 m0, s67, 41984
	s_mov_b32 s66, 517120
	buffer_load_dwordx4 v2, s[52:55], s66 offen lds
	s_waitcnt lgkmcnt(12)
	v_mfma_f32_16x16x32_bf16 v[52:55], v[212:215], a[200:203], v[52:55]
	ds_read_b64_tr_b16 v[208:209], v28 offset:256
	ds_read_b64_tr_b16 v[210:211], v28 offset:5376
	s_waitcnt lgkmcnt(12)
	v_mfma_f32_16x16x32_bf16 v[56:59], v[216:219], a[200:203], v[56:59]
	ds_read_b64_tr_b16 v[212:213], v29 offset:256
	ds_read_b64_tr_b16 v[214:215], v29 offset:5376
	s_waitcnt lgkmcnt(12)
	v_mfma_f32_16x16x32_bf16 v[60:63], v[220:223], a[200:203], v[60:63]
	ds_read_b64_tr_b16 v[216:217], v30 offset:256
	ds_read_b64_tr_b16 v[218:219], v30 offset:5376
	s_waitcnt lgkmcnt(12)
	v_mfma_f32_16x16x32_bf16 v[64:67], v[192:195], a[200:203], v[64:67]
	ds_read_b64_tr_b16 v[220:221], v31 offset:256
	ds_read_b64_tr_b16 v[222:223], v31 offset:5376
	s_add_u32 m0, s67, 43008
	s_mov_b32 s66, 517120
	buffer_load_dwordx4 v3, s[52:55], s66 offen lds
	s_waitcnt lgkmcnt(12)
	v_mfma_f32_16x16x32_bf16 v[68:71], v[196:199], a[200:203], v[68:71]
	ds_read_b64_tr_b16 v[192:193], v24 offset:512
	ds_read_b64_tr_b16 v[194:195], v24 offset:5632
	s_waitcnt lgkmcnt(12)
	v_mfma_f32_16x16x32_bf16 v[72:75], v[200:203], a[200:203], v[72:75]
	ds_read_b64_tr_b16 v[196:197], v25 offset:512
	ds_read_b64_tr_b16 v[198:199], v25 offset:5632
	s_waitcnt lgkmcnt(12)
	v_mfma_f32_16x16x32_bf16 v[76:79], v[204:207], a[200:203], v[76:79]
	ds_read_b64_tr_b16 v[200:201], v26 offset:512
	ds_read_b64_tr_b16 v[202:203], v26 offset:5632
	s_waitcnt lgkmcnt(12)
	v_mfma_f32_16x16x32_bf16 v[80:83], v[208:211], a[200:203], v[80:83]
	ds_read_b64_tr_b16 v[204:205], v27 offset:512
	ds_read_b64_tr_b16 v[206:207], v27 offset:5632
	s_add_u32 m0, s67, 44032
	s_mov_b32 s66, 517120
	buffer_load_dwordx4 v4, s[52:55], s66 offen lds
	s_waitcnt lgkmcnt(12)
	v_mfma_f32_16x16x32_bf16 v[84:87], v[212:215], a[200:203], v[84:87]
	ds_read_b64_tr_b16 v[208:209], v28 offset:512
	ds_read_b64_tr_b16 v[210:211], v28 offset:5632
	s_waitcnt lgkmcnt(12)
	v_mfma_f32_16x16x32_bf16 v[88:91], v[216:219], a[200:203], v[88:91]
	ds_read_b64_tr_b16 v[212:213], v29 offset:512
	ds_read_b64_tr_b16 v[214:215], v29 offset:5632
	s_waitcnt lgkmcnt(12)
	v_mfma_f32_16x16x32_bf16 v[92:95], v[220:223], a[200:203], v[92:95]
	ds_read_b64_tr_b16 v[216:217], v30 offset:512
	ds_read_b64_tr_b16 v[218:219], v30 offset:5632
	s_waitcnt lgkmcnt(12)
	v_mfma_f32_16x16x32_bf16 v[96:99], v[192:195], a[200:203], v[96:99]
	ds_read_b64_tr_b16 v[220:221], v31 offset:512
	ds_read_b64_tr_b16 v[222:223], v31 offset:5632
	s_add_u32 m0, s67, 45056
	s_mov_b32 s66, 517120
	buffer_load_dwordx4 v5, s[52:55], s66 offen lds
	s_waitcnt lgkmcnt(12)
	v_mfma_f32_16x16x32_bf16 v[100:103], v[196:199], a[200:203], v[100:103]
	ds_read_b64_tr_b16 v[192:193], v24 offset:768
	ds_read_b64_tr_b16 v[194:195], v24 offset:5888
	s_waitcnt lgkmcnt(12)
	v_mfma_f32_16x16x32_bf16 v[104:107], v[200:203], a[200:203], v[104:107]
	ds_read_b64_tr_b16 v[196:197], v25 offset:768
	ds_read_b64_tr_b16 v[198:199], v25 offset:5888
	s_waitcnt lgkmcnt(12)
	v_mfma_f32_16x16x32_bf16 v[108:111], v[204:207], a[200:203], v[108:111]
	ds_read_b64_tr_b16 v[200:201], v26 offset:768
	ds_read_b64_tr_b16 v[202:203], v26 offset:5888
	s_waitcnt lgkmcnt(12)
	v_mfma_f32_16x16x32_bf16 v[112:115], v[208:211], a[200:203], v[112:115]
	ds_read_b64_tr_b16 v[204:205], v27 offset:768
	ds_read_b64_tr_b16 v[206:207], v27 offset:5888
	s_add_u32 m0, s67, 46080
	s_mov_b32 s66, 522240
	buffer_load_dwordx4 v1, s[52:55], s66 offen lds
	s_waitcnt lgkmcnt(12)
	v_mfma_f32_16x16x32_bf16 v[116:119], v[212:215], a[200:203], v[116:119]
	ds_read_b64_tr_b16 v[208:209], v28 offset:768
	ds_read_b64_tr_b16 v[210:211], v28 offset:5888
	s_waitcnt lgkmcnt(12)
	v_mfma_f32_16x16x32_bf16 v[120:123], v[216:219], a[200:203], v[120:123]
	ds_read_b64_tr_b16 v[212:213], v29 offset:768
	ds_read_b64_tr_b16 v[214:215], v29 offset:5888
	s_waitcnt lgkmcnt(12)
	v_mfma_f32_16x16x32_bf16 v[124:127], v[220:223], a[200:203], v[124:127]
	ds_read_b64_tr_b16 v[216:217], v30 offset:768
	ds_read_b64_tr_b16 v[218:219], v30 offset:5888
	s_waitcnt lgkmcnt(12)
	v_mfma_f32_16x16x32_bf16 v[128:131], v[192:195], a[200:203], v[128:131]
	ds_read_b64_tr_b16 v[220:221], v31 offset:768
	ds_read_b64_tr_b16 v[222:223], v31 offset:5888
	s_add_u32 m0, s67, 47104
	s_mov_b32 s66, 522240
	buffer_load_dwordx4 v2, s[52:55], s66 offen lds
	s_waitcnt lgkmcnt(12)
	v_mfma_f32_16x16x32_bf16 v[132:135], v[196:199], a[200:203], v[132:135]
	ds_read_b64_tr_b16 v[192:193], v24 offset:1024
	ds_read_b64_tr_b16 v[194:195], v24 offset:6144
	s_waitcnt lgkmcnt(12)
	v_mfma_f32_16x16x32_bf16 v[136:139], v[200:203], a[200:203], v[136:139]
	ds_read_b64_tr_b16 v[196:197], v25 offset:1024
	ds_read_b64_tr_b16 v[198:199], v25 offset:6144
	s_waitcnt lgkmcnt(12)
	v_mfma_f32_16x16x32_bf16 v[140:143], v[204:207], a[200:203], v[140:143]
	ds_read_b64_tr_b16 v[200:201], v26 offset:1024
	ds_read_b64_tr_b16 v[202:203], v26 offset:6144
	s_waitcnt lgkmcnt(12)
	v_mfma_f32_16x16x32_bf16 v[144:147], v[208:211], a[200:203], v[144:147]
	ds_read_b64_tr_b16 v[204:205], v27 offset:1024
	ds_read_b64_tr_b16 v[206:207], v27 offset:6144
	s_add_u32 m0, s67, 48128
	s_mov_b32 s66, 522240
	buffer_load_dwordx4 v3, s[52:55], s66 offen lds
	s_waitcnt lgkmcnt(12)
	v_mfma_f32_16x16x32_bf16 v[148:151], v[212:215], a[200:203], v[148:151]
	ds_read_b64_tr_b16 v[208:209], v28 offset:1024
	ds_read_b64_tr_b16 v[210:211], v28 offset:6144
	s_waitcnt lgkmcnt(12)
	v_mfma_f32_16x16x32_bf16 v[152:155], v[216:219], a[200:203], v[152:155]
	ds_read_b64_tr_b16 v[212:213], v29 offset:1024
	ds_read_b64_tr_b16 v[214:215], v29 offset:6144
	s_waitcnt lgkmcnt(12)
	v_mfma_f32_16x16x32_bf16 v[156:159], v[220:223], a[200:203], v[156:159]
	ds_read_b64_tr_b16 v[216:217], v30 offset:1024
	ds_read_b64_tr_b16 v[218:219], v30 offset:6144
	s_waitcnt lgkmcnt(12)
	v_mfma_f32_16x16x32_bf16 v[160:163], v[192:195], a[200:203], v[160:163]
	ds_read_b64_tr_b16 v[220:221], v31 offset:1024
	ds_read_b64_tr_b16 v[222:223], v31 offset:6144
	s_add_u32 m0, s67, 49152
	s_mov_b32 s66, 522240
	buffer_load_dwordx4 v4, s[52:55], s66 offen lds
	s_waitcnt lgkmcnt(12)
	v_mfma_f32_16x16x32_bf16 v[164:167], v[196:199], a[200:203], v[164:167]
	s_waitcnt lgkmcnt(10)
	v_mfma_f32_16x16x32_bf16 v[168:171], v[200:203], a[200:203], v[168:171]
	s_waitcnt lgkmcnt(8)
	v_mfma_f32_16x16x32_bf16 v[172:175], v[204:207], a[200:203], v[172:175]
	s_waitcnt lgkmcnt(6)
	v_mfma_f32_16x16x32_bf16 v[176:179], v[208:211], a[200:203], v[176:179]
	s_add_u32 m0, s67, 50176
	s_mov_b32 s66, 522240
	buffer_load_dwordx4 v5, s[52:55], s66 offen lds
	s_waitcnt lgkmcnt(4)
	v_mfma_f32_16x16x32_bf16 v[180:183], v[212:215], a[200:203], v[180:183]
	s_waitcnt lgkmcnt(2)
	v_mfma_f32_16x16x32_bf16 v[184:187], v[216:219], a[200:203], v[184:187]
	s_waitcnt lgkmcnt(0)
	v_mfma_f32_16x16x32_bf16 v[188:191], v[220:223], a[200:203], v[188:191]
	s_waitcnt vmcnt(20)
	s_barrier
	ds_read_b64_tr_b16 v[192:193], v24 offset:40960
	ds_read_b64_tr_b16 v[194:195], v24 offset:46080
	ds_read_b64_tr_b16 v[196:197], v25 offset:40960
	ds_read_b64_tr_b16 v[198:199], v25 offset:46080
	ds_read_b64_tr_b16 v[200:201], v26 offset:40960
	ds_read_b64_tr_b16 v[202:203], v26 offset:46080
	ds_read_b64_tr_b16 v[204:205], v27 offset:40960
	ds_read_b64_tr_b16 v[206:207], v27 offset:46080
	ds_read_b64_tr_b16 v[208:209], v28 offset:40960
	ds_read_b64_tr_b16 v[210:211], v28 offset:46080
	ds_read_b64_tr_b16 v[212:213], v29 offset:40960
	ds_read_b64_tr_b16 v[214:215], v29 offset:46080
	ds_read_b64_tr_b16 v[216:217], v30 offset:40960
	ds_read_b64_tr_b16 v[218:219], v30 offset:46080
	s_waitcnt lgkmcnt(12)
	v_mfma_f32_16x16x32_bf16 v[32:35], v[192:195], a[204:207], v[32:35]
	ds_read_b64_tr_b16 v[220:221], v31 offset:40960
	ds_read_b64_tr_b16 v[222:223], v31 offset:46080
	s_add_u32 m0, s67, 81920
	s_mov_b32 s66, 527360
	buffer_load_dwordx4 v1, s[52:55], s66 offen lds
	s_waitcnt lgkmcnt(12)
	v_mfma_f32_16x16x32_bf16 v[36:39], v[196:199], a[204:207], v[36:39]
	ds_read_b64_tr_b16 v[192:193], v24 offset:41216
	ds_read_b64_tr_b16 v[194:195], v24 offset:46336
	s_waitcnt lgkmcnt(12)
	v_mfma_f32_16x16x32_bf16 v[40:43], v[200:203], a[204:207], v[40:43]
	ds_read_b64_tr_b16 v[196:197], v25 offset:41216
	ds_read_b64_tr_b16 v[198:199], v25 offset:46336
	s_waitcnt lgkmcnt(12)
	v_mfma_f32_16x16x32_bf16 v[44:47], v[204:207], a[204:207], v[44:47]
	ds_read_b64_tr_b16 v[200:201], v26 offset:41216
	ds_read_b64_tr_b16 v[202:203], v26 offset:46336
	s_waitcnt lgkmcnt(12)
	v_mfma_f32_16x16x32_bf16 v[48:51], v[208:211], a[204:207], v[48:51]
	ds_read_b64_tr_b16 v[204:205], v27 offset:41216
	ds_read_b64_tr_b16 v[206:207], v27 offset:46336
	s_add_u32 m0, s67, 82944
	s_mov_b32 s66, 527360
	buffer_load_dwordx4 v2, s[52:55], s66 offen lds
	s_waitcnt lgkmcnt(12)
	v_mfma_f32_16x16x32_bf16 v[52:55], v[212:215], a[204:207], v[52:55]
	ds_read_b64_tr_b16 v[208:209], v28 offset:41216
	ds_read_b64_tr_b16 v[210:211], v28 offset:46336
	s_waitcnt lgkmcnt(12)
	v_mfma_f32_16x16x32_bf16 v[56:59], v[216:219], a[204:207], v[56:59]
	ds_read_b64_tr_b16 v[212:213], v29 offset:41216
	ds_read_b64_tr_b16 v[214:215], v29 offset:46336
	s_waitcnt lgkmcnt(12)
	v_mfma_f32_16x16x32_bf16 v[60:63], v[220:223], a[204:207], v[60:63]
	ds_read_b64_tr_b16 v[216:217], v30 offset:41216
	ds_read_b64_tr_b16 v[218:219], v30 offset:46336
	s_waitcnt lgkmcnt(12)
	v_mfma_f32_16x16x32_bf16 v[64:67], v[192:195], a[204:207], v[64:67]
	ds_read_b64_tr_b16 v[220:221], v31 offset:41216
	ds_read_b64_tr_b16 v[222:223], v31 offset:46336
	s_add_u32 m0, s67, 83968
	s_mov_b32 s66, 527360
	buffer_load_dwordx4 v3, s[52:55], s66 offen lds
	s_waitcnt lgkmcnt(12)
	v_mfma_f32_16x16x32_bf16 v[68:71], v[196:199], a[204:207], v[68:71]
	ds_read_b64_tr_b16 v[192:193], v24 offset:41472
	ds_read_b64_tr_b16 v[194:195], v24 offset:46592
	s_waitcnt lgkmcnt(12)
	v_mfma_f32_16x16x32_bf16 v[72:75], v[200:203], a[204:207], v[72:75]
	ds_read_b64_tr_b16 v[196:197], v25 offset:41472
	ds_read_b64_tr_b16 v[198:199], v25 offset:46592
	s_waitcnt lgkmcnt(12)
	v_mfma_f32_16x16x32_bf16 v[76:79], v[204:207], a[204:207], v[76:79]
	ds_read_b64_tr_b16 v[200:201], v26 offset:41472
	ds_read_b64_tr_b16 v[202:203], v26 offset:46592
	s_waitcnt lgkmcnt(12)
	v_mfma_f32_16x16x32_bf16 v[80:83], v[208:211], a[204:207], v[80:83]
	ds_read_b64_tr_b16 v[204:205], v27 offset:41472
	ds_read_b64_tr_b16 v[206:207], v27 offset:46592
	s_add_u32 m0, s67, 84992
	s_mov_b32 s66, 527360
	buffer_load_dwordx4 v4, s[52:55], s66 offen lds
	s_waitcnt lgkmcnt(12)
	v_mfma_f32_16x16x32_bf16 v[84:87], v[212:215], a[204:207], v[84:87]
	ds_read_b64_tr_b16 v[208:209], v28 offset:41472
	ds_read_b64_tr_b16 v[210:211], v28 offset:46592
	s_waitcnt lgkmcnt(12)
	v_mfma_f32_16x16x32_bf16 v[88:91], v[216:219], a[204:207], v[88:91]
	ds_read_b64_tr_b16 v[212:213], v29 offset:41472
	ds_read_b64_tr_b16 v[214:215], v29 offset:46592
	s_waitcnt lgkmcnt(12)
	v_mfma_f32_16x16x32_bf16 v[92:95], v[220:223], a[204:207], v[92:95]
	ds_read_b64_tr_b16 v[216:217], v30 offset:41472
	ds_read_b64_tr_b16 v[218:219], v30 offset:46592
	s_waitcnt lgkmcnt(12)
	v_mfma_f32_16x16x32_bf16 v[96:99], v[192:195], a[204:207], v[96:99]
	ds_read_b64_tr_b16 v[220:221], v31 offset:41472
	ds_read_b64_tr_b16 v[222:223], v31 offset:46592
	s_add_u32 m0, s67, 86016
	s_mov_b32 s66, 527360
	buffer_load_dwordx4 v5, s[52:55], s66 offen lds
	s_waitcnt lgkmcnt(12)
	v_mfma_f32_16x16x32_bf16 v[100:103], v[196:199], a[204:207], v[100:103]
	ds_read_b64_tr_b16 v[192:193], v24 offset:41728
	ds_read_b64_tr_b16 v[194:195], v24 offset:46848
	s_waitcnt lgkmcnt(12)
	v_mfma_f32_16x16x32_bf16 v[104:107], v[200:203], a[204:207], v[104:107]
	ds_read_b64_tr_b16 v[196:197], v25 offset:41728
	ds_read_b64_tr_b16 v[198:199], v25 offset:46848
	s_waitcnt lgkmcnt(12)
	v_mfma_f32_16x16x32_bf16 v[108:111], v[204:207], a[204:207], v[108:111]
	ds_read_b64_tr_b16 v[200:201], v26 offset:41728
	ds_read_b64_tr_b16 v[202:203], v26 offset:46848
	s_waitcnt lgkmcnt(12)
	v_mfma_f32_16x16x32_bf16 v[112:115], v[208:211], a[204:207], v[112:115]
	ds_read_b64_tr_b16 v[204:205], v27 offset:41728
	ds_read_b64_tr_b16 v[206:207], v27 offset:46848
	s_add_u32 m0, s67, 87040
	s_mov_b32 s66, 532480
	buffer_load_dwordx4 v1, s[52:55], s66 offen lds
	s_waitcnt lgkmcnt(12)
	v_mfma_f32_16x16x32_bf16 v[116:119], v[212:215], a[204:207], v[116:119]
	ds_read_b64_tr_b16 v[208:209], v28 offset:41728
	ds_read_b64_tr_b16 v[210:211], v28 offset:46848
	s_waitcnt lgkmcnt(12)
	v_mfma_f32_16x16x32_bf16 v[120:123], v[216:219], a[204:207], v[120:123]
	ds_read_b64_tr_b16 v[212:213], v29 offset:41728
	ds_read_b64_tr_b16 v[214:215], v29 offset:46848
	s_waitcnt lgkmcnt(12)
	v_mfma_f32_16x16x32_bf16 v[124:127], v[220:223], a[204:207], v[124:127]
	ds_read_b64_tr_b16 v[216:217], v30 offset:41728
	ds_read_b64_tr_b16 v[218:219], v30 offset:46848
	s_waitcnt lgkmcnt(12)
	v_mfma_f32_16x16x32_bf16 v[128:131], v[192:195], a[204:207], v[128:131]
	ds_read_b64_tr_b16 v[220:221], v31 offset:41728
	ds_read_b64_tr_b16 v[222:223], v31 offset:46848
	s_add_u32 m0, s67, 88064
	s_mov_b32 s66, 532480
	buffer_load_dwordx4 v2, s[52:55], s66 offen lds
	s_waitcnt lgkmcnt(12)
	v_mfma_f32_16x16x32_bf16 v[132:135], v[196:199], a[204:207], v[132:135]
	ds_read_b64_tr_b16 v[192:193], v24 offset:41984
	ds_read_b64_tr_b16 v[194:195], v24 offset:47104
	s_waitcnt lgkmcnt(12)
	v_mfma_f32_16x16x32_bf16 v[136:139], v[200:203], a[204:207], v[136:139]
	ds_read_b64_tr_b16 v[196:197], v25 offset:41984
	ds_read_b64_tr_b16 v[198:199], v25 offset:47104
	s_waitcnt lgkmcnt(12)
	v_mfma_f32_16x16x32_bf16 v[140:143], v[204:207], a[204:207], v[140:143]
	ds_read_b64_tr_b16 v[200:201], v26 offset:41984
	ds_read_b64_tr_b16 v[202:203], v26 offset:47104
	s_waitcnt lgkmcnt(12)
	v_mfma_f32_16x16x32_bf16 v[144:147], v[208:211], a[204:207], v[144:147]
	ds_read_b64_tr_b16 v[204:205], v27 offset:41984
	ds_read_b64_tr_b16 v[206:207], v27 offset:47104
	s_add_u32 m0, s67, 89088
	s_mov_b32 s66, 532480
	buffer_load_dwordx4 v3, s[52:55], s66 offen lds
	s_waitcnt lgkmcnt(12)
	v_mfma_f32_16x16x32_bf16 v[148:151], v[212:215], a[204:207], v[148:151]
	ds_read_b64_tr_b16 v[208:209], v28 offset:41984
	ds_read_b64_tr_b16 v[210:211], v28 offset:47104
	s_waitcnt lgkmcnt(12)
	v_mfma_f32_16x16x32_bf16 v[152:155], v[216:219], a[204:207], v[152:155]
	ds_read_b64_tr_b16 v[212:213], v29 offset:41984
	ds_read_b64_tr_b16 v[214:215], v29 offset:47104
	s_waitcnt lgkmcnt(12)
	v_mfma_f32_16x16x32_bf16 v[156:159], v[220:223], a[204:207], v[156:159]
	ds_read_b64_tr_b16 v[216:217], v30 offset:41984
	ds_read_b64_tr_b16 v[218:219], v30 offset:47104
	s_waitcnt lgkmcnt(12)
	v_mfma_f32_16x16x32_bf16 v[160:163], v[192:195], a[204:207], v[160:163]
	ds_read_b64_tr_b16 v[220:221], v31 offset:41984
	ds_read_b64_tr_b16 v[222:223], v31 offset:47104
	s_add_u32 m0, s67, 90112
	s_mov_b32 s66, 532480
	buffer_load_dwordx4 v4, s[52:55], s66 offen lds
	s_waitcnt lgkmcnt(12)
	v_mfma_f32_16x16x32_bf16 v[164:167], v[196:199], a[204:207], v[164:167]
	s_waitcnt lgkmcnt(10)
	v_mfma_f32_16x16x32_bf16 v[168:171], v[200:203], a[204:207], v[168:171]
	s_waitcnt lgkmcnt(8)
	v_mfma_f32_16x16x32_bf16 v[172:175], v[204:207], a[204:207], v[172:175]
	s_waitcnt lgkmcnt(6)
	v_mfma_f32_16x16x32_bf16 v[176:179], v[208:211], a[204:207], v[176:179]
	s_add_u32 m0, s67, 91136
	s_mov_b32 s66, 532480
	buffer_load_dwordx4 v5, s[52:55], s66 offen lds
	s_waitcnt lgkmcnt(4)
	v_mfma_f32_16x16x32_bf16 v[180:183], v[212:215], a[204:207], v[180:183]
	s_waitcnt lgkmcnt(2)
	v_mfma_f32_16x16x32_bf16 v[184:187], v[216:219], a[204:207], v[184:187]
	s_waitcnt lgkmcnt(0)
	v_mfma_f32_16x16x32_bf16 v[188:191], v[220:223], a[204:207], v[188:191]
	s_waitcnt vmcnt(20)
	s_barrier
	ds_read_b64_tr_b16 v[192:193], v16 offset:0
	ds_read_b64_tr_b16 v[194:195], v16 offset:5120
	ds_read_b64_tr_b16 v[196:197], v17 offset:0
	ds_read_b64_tr_b16 v[198:199], v17 offset:5120
	ds_read_b64_tr_b16 v[200:201], v18 offset:0
	ds_read_b64_tr_b16 v[202:203], v18 offset:5120
	ds_read_b64_tr_b16 v[204:205], v19 offset:0
	ds_read_b64_tr_b16 v[206:207], v19 offset:5120
	ds_read_b64_tr_b16 v[208:209], v20 offset:0
	ds_read_b64_tr_b16 v[210:211], v20 offset:5120
	ds_read_b64_tr_b16 v[212:213], v21 offset:0
	ds_read_b64_tr_b16 v[214:215], v21 offset:5120
	ds_read_b64_tr_b16 v[216:217], v22 offset:0
	ds_read_b64_tr_b16 v[218:219], v22 offset:5120
	s_waitcnt lgkmcnt(12)
	v_mfma_f32_16x16x32_bf16 v[32:35], v[192:195], a[208:211], v[32:35]
	ds_read_b64_tr_b16 v[220:221], v23 offset:0
	ds_read_b64_tr_b16 v[222:223], v23 offset:5120
	s_add_u32 m0, s67, 122880
	s_mov_b32 s66, 614400
	buffer_load_dwordx4 v1, s[52:55], s66 offen lds
	s_waitcnt lgkmcnt(12)
	v_mfma_f32_16x16x32_bf16 v[36:39], v[196:199], a[208:211], v[36:39]
	ds_read_b64_tr_b16 v[192:193], v16 offset:256
	ds_read_b64_tr_b16 v[194:195], v16 offset:5376
	s_waitcnt lgkmcnt(12)
	v_mfma_f32_16x16x32_bf16 v[40:43], v[200:203], a[208:211], v[40:43]
	ds_read_b64_tr_b16 v[196:197], v17 offset:256
	ds_read_b64_tr_b16 v[198:199], v17 offset:5376
	s_waitcnt lgkmcnt(12)
	v_mfma_f32_16x16x32_bf16 v[44:47], v[204:207], a[208:211], v[44:47]
	ds_read_b64_tr_b16 v[200:201], v18 offset:256
	ds_read_b64_tr_b16 v[202:203], v18 offset:5376
	s_waitcnt lgkmcnt(12)
	v_mfma_f32_16x16x32_bf16 v[48:51], v[208:211], a[208:211], v[48:51]
	ds_read_b64_tr_b16 v[204:205], v19 offset:256
	ds_read_b64_tr_b16 v[206:207], v19 offset:5376
	s_add_u32 m0, s67, 123904
	s_mov_b32 s66, 614400
	buffer_load_dwordx4 v2, s[52:55], s66 offen lds
	s_waitcnt lgkmcnt(12)
	v_mfma_f32_16x16x32_bf16 v[52:55], v[212:215], a[208:211], v[52:55]
	ds_read_b64_tr_b16 v[208:209], v20 offset:256
	ds_read_b64_tr_b16 v[210:211], v20 offset:5376
	s_waitcnt lgkmcnt(12)
	v_mfma_f32_16x16x32_bf16 v[56:59], v[216:219], a[208:211], v[56:59]
	ds_read_b64_tr_b16 v[212:213], v21 offset:256
	ds_read_b64_tr_b16 v[214:215], v21 offset:5376
	s_waitcnt lgkmcnt(12)
	v_mfma_f32_16x16x32_bf16 v[60:63], v[220:223], a[208:211], v[60:63]
	ds_read_b64_tr_b16 v[216:217], v22 offset:256
	ds_read_b64_tr_b16 v[218:219], v22 offset:5376
	s_waitcnt lgkmcnt(12)
	v_mfma_f32_16x16x32_bf16 v[64:67], v[192:195], a[208:211], v[64:67]
	ds_read_b64_tr_b16 v[220:221], v23 offset:256
	ds_read_b64_tr_b16 v[222:223], v23 offset:5376
	s_add_u32 m0, s67, 124928
	s_mov_b32 s66, 614400
	buffer_load_dwordx4 v3, s[52:55], s66 offen lds
	s_waitcnt lgkmcnt(12)
	v_mfma_f32_16x16x32_bf16 v[68:71], v[196:199], a[208:211], v[68:71]
	ds_read_b64_tr_b16 v[192:193], v16 offset:512
	ds_read_b64_tr_b16 v[194:195], v16 offset:5632
	s_waitcnt lgkmcnt(12)
	v_mfma_f32_16x16x32_bf16 v[72:75], v[200:203], a[208:211], v[72:75]
	ds_read_b64_tr_b16 v[196:197], v17 offset:512
	ds_read_b64_tr_b16 v[198:199], v17 offset:5632
	s_waitcnt lgkmcnt(12)
	v_mfma_f32_16x16x32_bf16 v[76:79], v[204:207], a[208:211], v[76:79]
	ds_read_b64_tr_b16 v[200:201], v18 offset:512
	ds_read_b64_tr_b16 v[202:203], v18 offset:5632
	s_waitcnt lgkmcnt(12)
	v_mfma_f32_16x16x32_bf16 v[80:83], v[208:211], a[208:211], v[80:83]
	ds_read_b64_tr_b16 v[204:205], v19 offset:512
	ds_read_b64_tr_b16 v[206:207], v19 offset:5632
	s_add_u32 m0, s67, 125952
	s_mov_b32 s66, 614400
	buffer_load_dwordx4 v4, s[52:55], s66 offen lds
	s_waitcnt lgkmcnt(12)
	v_mfma_f32_16x16x32_bf16 v[84:87], v[212:215], a[208:211], v[84:87]
	ds_read_b64_tr_b16 v[208:209], v20 offset:512
	ds_read_b64_tr_b16 v[210:211], v20 offset:5632
	s_waitcnt lgkmcnt(12)
	v_mfma_f32_16x16x32_bf16 v[88:91], v[216:219], a[208:211], v[88:91]
	ds_read_b64_tr_b16 v[212:213], v21 offset:512
	ds_read_b64_tr_b16 v[214:215], v21 offset:5632
	s_waitcnt lgkmcnt(12)
	v_mfma_f32_16x16x32_bf16 v[92:95], v[220:223], a[208:211], v[92:95]
	ds_read_b64_tr_b16 v[216:217], v22 offset:512
	ds_read_b64_tr_b16 v[218:219], v22 offset:5632
	s_waitcnt lgkmcnt(12)
	v_mfma_f32_16x16x32_bf16 v[96:99], v[192:195], a[208:211], v[96:99]
	ds_read_b64_tr_b16 v[220:221], v23 offset:512
	ds_read_b64_tr_b16 v[222:223], v23 offset:5632
	s_add_u32 m0, s67, 126976
	s_mov_b32 s66, 614400
	buffer_load_dwordx4 v5, s[52:55], s66 offen lds
	s_waitcnt lgkmcnt(12)
	v_mfma_f32_16x16x32_bf16 v[100:103], v[196:199], a[208:211], v[100:103]
	ds_read_b64_tr_b16 v[192:193], v16 offset:768
	ds_read_b64_tr_b16 v[194:195], v16 offset:5888
	s_waitcnt lgkmcnt(12)
	v_mfma_f32_16x16x32_bf16 v[104:107], v[200:203], a[208:211], v[104:107]
	ds_read_b64_tr_b16 v[196:197], v17 offset:768
	ds_read_b64_tr_b16 v[198:199], v17 offset:5888
	s_waitcnt lgkmcnt(12)
	v_mfma_f32_16x16x32_bf16 v[108:111], v[204:207], a[208:211], v[108:111]
	ds_read_b64_tr_b16 v[200:201], v18 offset:768
	ds_read_b64_tr_b16 v[202:203], v18 offset:5888
	s_waitcnt lgkmcnt(12)
	v_mfma_f32_16x16x32_bf16 v[112:115], v[208:211], a[208:211], v[112:115]
	ds_read_b64_tr_b16 v[204:205], v19 offset:768
	ds_read_b64_tr_b16 v[206:207], v19 offset:5888
	s_add_u32 m0, s67, 128000
	s_mov_b32 s66, 619520
	buffer_load_dwordx4 v1, s[52:55], s66 offen lds
	s_waitcnt lgkmcnt(12)
	v_mfma_f32_16x16x32_bf16 v[116:119], v[212:215], a[208:211], v[116:119]
	ds_read_b64_tr_b16 v[208:209], v20 offset:768
	ds_read_b64_tr_b16 v[210:211], v20 offset:5888
	s_waitcnt lgkmcnt(12)
	v_mfma_f32_16x16x32_bf16 v[120:123], v[216:219], a[208:211], v[120:123]
	ds_read_b64_tr_b16 v[212:213], v21 offset:768
	ds_read_b64_tr_b16 v[214:215], v21 offset:5888
	s_waitcnt lgkmcnt(12)
	v_mfma_f32_16x16x32_bf16 v[124:127], v[220:223], a[208:211], v[124:127]
	ds_read_b64_tr_b16 v[216:217], v22 offset:768
	ds_read_b64_tr_b16 v[218:219], v22 offset:5888
	s_waitcnt lgkmcnt(12)
	v_mfma_f32_16x16x32_bf16 v[128:131], v[192:195], a[208:211], v[128:131]
	ds_read_b64_tr_b16 v[220:221], v23 offset:768
	ds_read_b64_tr_b16 v[222:223], v23 offset:5888
	s_add_u32 m0, s67, 129024
	s_mov_b32 s66, 619520
	buffer_load_dwordx4 v2, s[52:55], s66 offen lds
	s_waitcnt lgkmcnt(12)
	v_mfma_f32_16x16x32_bf16 v[132:135], v[196:199], a[208:211], v[132:135]
	ds_read_b64_tr_b16 v[192:193], v16 offset:1024
	ds_read_b64_tr_b16 v[194:195], v16 offset:6144
	s_waitcnt lgkmcnt(12)
	v_mfma_f32_16x16x32_bf16 v[136:139], v[200:203], a[208:211], v[136:139]
	ds_read_b64_tr_b16 v[196:197], v17 offset:1024
	ds_read_b64_tr_b16 v[198:199], v17 offset:6144
	s_waitcnt lgkmcnt(12)
	v_mfma_f32_16x16x32_bf16 v[140:143], v[204:207], a[208:211], v[140:143]
	ds_read_b64_tr_b16 v[200:201], v18 offset:1024
	ds_read_b64_tr_b16 v[202:203], v18 offset:6144
	s_waitcnt lgkmcnt(12)
	v_mfma_f32_16x16x32_bf16 v[144:147], v[208:211], a[208:211], v[144:147]
	ds_read_b64_tr_b16 v[204:205], v19 offset:1024
	ds_read_b64_tr_b16 v[206:207], v19 offset:6144
	s_add_u32 m0, s67, 130048
	s_mov_b32 s66, 619520
	buffer_load_dwordx4 v3, s[52:55], s66 offen lds
	s_waitcnt lgkmcnt(12)
	v_mfma_f32_16x16x32_bf16 v[148:151], v[212:215], a[208:211], v[148:151]
	ds_read_b64_tr_b16 v[208:209], v20 offset:1024
	ds_read_b64_tr_b16 v[210:211], v20 offset:6144
	s_waitcnt lgkmcnt(12)
	v_mfma_f32_16x16x32_bf16 v[152:155], v[216:219], a[208:211], v[152:155]
	ds_read_b64_tr_b16 v[212:213], v21 offset:1024
	ds_read_b64_tr_b16 v[214:215], v21 offset:6144
	s_waitcnt lgkmcnt(12)
	v_mfma_f32_16x16x32_bf16 v[156:159], v[220:223], a[208:211], v[156:159]
	ds_read_b64_tr_b16 v[216:217], v22 offset:1024
	ds_read_b64_tr_b16 v[218:219], v22 offset:6144
	s_waitcnt lgkmcnt(12)
	v_mfma_f32_16x16x32_bf16 v[160:163], v[192:195], a[208:211], v[160:163]
	ds_read_b64_tr_b16 v[220:221], v23 offset:1024
	ds_read_b64_tr_b16 v[222:223], v23 offset:6144
	s_add_u32 m0, s67, 131072
	s_mov_b32 s66, 619520
	buffer_load_dwordx4 v4, s[52:55], s66 offen lds
	s_waitcnt lgkmcnt(12)
	v_mfma_f32_16x16x32_bf16 v[164:167], v[196:199], a[208:211], v[164:167]
	s_waitcnt lgkmcnt(10)
	v_mfma_f32_16x16x32_bf16 v[168:171], v[200:203], a[208:211], v[168:171]
	s_waitcnt lgkmcnt(8)
	v_mfma_f32_16x16x32_bf16 v[172:175], v[204:207], a[208:211], v[172:175]
	s_waitcnt lgkmcnt(6)
	v_mfma_f32_16x16x32_bf16 v[176:179], v[208:211], a[208:211], v[176:179]
	s_add_u32 m0, s67, 132096
	s_mov_b32 s66, 619520
	buffer_load_dwordx4 v5, s[52:55], s66 offen lds
	s_waitcnt lgkmcnt(4)
	v_mfma_f32_16x16x32_bf16 v[180:183], v[212:215], a[208:211], v[180:183]
	s_waitcnt lgkmcnt(2)
	v_mfma_f32_16x16x32_bf16 v[184:187], v[216:219], a[208:211], v[184:187]
	s_waitcnt lgkmcnt(0)
	v_mfma_f32_16x16x32_bf16 v[188:191], v[220:223], a[208:211], v[188:191]
	s_waitcnt vmcnt(20)
	s_barrier
	ds_read_b64_tr_b16 v[192:193], v16 offset:40960
	ds_read_b64_tr_b16 v[194:195], v16 offset:46080
	ds_read_b64_tr_b16 v[196:197], v17 offset:40960
	ds_read_b64_tr_b16 v[198:199], v17 offset:46080
	ds_read_b64_tr_b16 v[200:201], v18 offset:40960
	ds_read_b64_tr_b16 v[202:203], v18 offset:46080
	ds_read_b64_tr_b16 v[204:205], v19 offset:40960
	ds_read_b64_tr_b16 v[206:207], v19 offset:46080
	ds_read_b64_tr_b16 v[208:209], v20 offset:40960
	ds_read_b64_tr_b16 v[210:211], v20 offset:46080
	ds_read_b64_tr_b16 v[212:213], v21 offset:40960
	ds_read_b64_tr_b16 v[214:215], v21 offset:46080
	ds_read_b64_tr_b16 v[216:217], v22 offset:40960
	ds_read_b64_tr_b16 v[218:219], v22 offset:46080
	s_waitcnt lgkmcnt(12)
	v_mfma_f32_16x16x32_bf16 v[32:35], v[192:195], a[212:215], v[32:35]
	ds_read_b64_tr_b16 v[220:221], v23 offset:40960
	ds_read_b64_tr_b16 v[222:223], v23 offset:46080
	s_add_u32 m0, s67, 0
	s_mov_b32 s66, 624640
	buffer_load_dwordx4 v1, s[52:55], s66 offen lds
	s_waitcnt lgkmcnt(12)
	v_mfma_f32_16x16x32_bf16 v[36:39], v[196:199], a[212:215], v[36:39]
	ds_read_b64_tr_b16 v[192:193], v16 offset:41216
	ds_read_b64_tr_b16 v[194:195], v16 offset:46336
	s_waitcnt lgkmcnt(12)
	v_mfma_f32_16x16x32_bf16 v[40:43], v[200:203], a[212:215], v[40:43]
	ds_read_b64_tr_b16 v[196:197], v17 offset:41216
	ds_read_b64_tr_b16 v[198:199], v17 offset:46336
	s_waitcnt lgkmcnt(12)
	v_mfma_f32_16x16x32_bf16 v[44:47], v[204:207], a[212:215], v[44:47]
	ds_read_b64_tr_b16 v[200:201], v18 offset:41216
	ds_read_b64_tr_b16 v[202:203], v18 offset:46336
	s_waitcnt lgkmcnt(12)
	v_mfma_f32_16x16x32_bf16 v[48:51], v[208:211], a[212:215], v[48:51]
	ds_read_b64_tr_b16 v[204:205], v19 offset:41216
	ds_read_b64_tr_b16 v[206:207], v19 offset:46336
	s_add_u32 m0, s67, 1024
	s_mov_b32 s66, 624640
	buffer_load_dwordx4 v2, s[52:55], s66 offen lds
	s_waitcnt lgkmcnt(12)
	v_mfma_f32_16x16x32_bf16 v[52:55], v[212:215], a[212:215], v[52:55]
	ds_read_b64_tr_b16 v[208:209], v20 offset:41216
	ds_read_b64_tr_b16 v[210:211], v20 offset:46336
	s_waitcnt lgkmcnt(12)
	v_mfma_f32_16x16x32_bf16 v[56:59], v[216:219], a[212:215], v[56:59]
	ds_read_b64_tr_b16 v[212:213], v21 offset:41216
	ds_read_b64_tr_b16 v[214:215], v21 offset:46336
	s_waitcnt lgkmcnt(12)
	v_mfma_f32_16x16x32_bf16 v[60:63], v[220:223], a[212:215], v[60:63]
	ds_read_b64_tr_b16 v[216:217], v22 offset:41216
	ds_read_b64_tr_b16 v[218:219], v22 offset:46336
	s_waitcnt lgkmcnt(12)
	v_mfma_f32_16x16x32_bf16 v[64:67], v[192:195], a[212:215], v[64:67]
	ds_read_b64_tr_b16 v[220:221], v23 offset:41216
	ds_read_b64_tr_b16 v[222:223], v23 offset:46336
	s_add_u32 m0, s67, 2048
	s_mov_b32 s66, 624640
	buffer_load_dwordx4 v3, s[52:55], s66 offen lds
	s_waitcnt lgkmcnt(12)
	v_mfma_f32_16x16x32_bf16 v[68:71], v[196:199], a[212:215], v[68:71]
	ds_read_b64_tr_b16 v[192:193], v16 offset:41472
	ds_read_b64_tr_b16 v[194:195], v16 offset:46592
	s_waitcnt lgkmcnt(12)
	v_mfma_f32_16x16x32_bf16 v[72:75], v[200:203], a[212:215], v[72:75]
	ds_read_b64_tr_b16 v[196:197], v17 offset:41472
	ds_read_b64_tr_b16 v[198:199], v17 offset:46592
	s_waitcnt lgkmcnt(12)
	v_mfma_f32_16x16x32_bf16 v[76:79], v[204:207], a[212:215], v[76:79]
	ds_read_b64_tr_b16 v[200:201], v18 offset:41472
	ds_read_b64_tr_b16 v[202:203], v18 offset:46592
	s_waitcnt lgkmcnt(12)
	v_mfma_f32_16x16x32_bf16 v[80:83], v[208:211], a[212:215], v[80:83]
	ds_read_b64_tr_b16 v[204:205], v19 offset:41472
	ds_read_b64_tr_b16 v[206:207], v19 offset:46592
	s_add_u32 m0, s67, 3072
	s_mov_b32 s66, 624640
	buffer_load_dwordx4 v4, s[52:55], s66 offen lds
	s_waitcnt lgkmcnt(12)
	v_mfma_f32_16x16x32_bf16 v[84:87], v[212:215], a[212:215], v[84:87]
	ds_read_b64_tr_b16 v[208:209], v20 offset:41472
	ds_read_b64_tr_b16 v[210:211], v20 offset:46592
	s_waitcnt lgkmcnt(12)
	v_mfma_f32_16x16x32_bf16 v[88:91], v[216:219], a[212:215], v[88:91]
	ds_read_b64_tr_b16 v[212:213], v21 offset:41472
	ds_read_b64_tr_b16 v[214:215], v21 offset:46592
	s_waitcnt lgkmcnt(12)
	v_mfma_f32_16x16x32_bf16 v[92:95], v[220:223], a[212:215], v[92:95]
	ds_read_b64_tr_b16 v[216:217], v22 offset:41472
	ds_read_b64_tr_b16 v[218:219], v22 offset:46592
	s_waitcnt lgkmcnt(12)
	v_mfma_f32_16x16x32_bf16 v[96:99], v[192:195], a[212:215], v[96:99]
	ds_read_b64_tr_b16 v[220:221], v23 offset:41472
	ds_read_b64_tr_b16 v[222:223], v23 offset:46592
	s_add_u32 m0, s67, 4096
	s_mov_b32 s66, 624640
	buffer_load_dwordx4 v5, s[52:55], s66 offen lds
	s_waitcnt lgkmcnt(12)
	v_mfma_f32_16x16x32_bf16 v[100:103], v[196:199], a[212:215], v[100:103]
	ds_read_b64_tr_b16 v[192:193], v16 offset:41728
	ds_read_b64_tr_b16 v[194:195], v16 offset:46848
	s_waitcnt lgkmcnt(12)
	v_mfma_f32_16x16x32_bf16 v[104:107], v[200:203], a[212:215], v[104:107]
	ds_read_b64_tr_b16 v[196:197], v17 offset:41728
	ds_read_b64_tr_b16 v[198:199], v17 offset:46848
	s_waitcnt lgkmcnt(12)
	v_mfma_f32_16x16x32_bf16 v[108:111], v[204:207], a[212:215], v[108:111]
	ds_read_b64_tr_b16 v[200:201], v18 offset:41728
	ds_read_b64_tr_b16 v[202:203], v18 offset:46848
	s_waitcnt lgkmcnt(12)
	v_mfma_f32_16x16x32_bf16 v[112:115], v[208:211], a[212:215], v[112:115]
	ds_read_b64_tr_b16 v[204:205], v19 offset:41728
	ds_read_b64_tr_b16 v[206:207], v19 offset:46848
	s_add_u32 m0, s67, 5120
	s_mov_b32 s66, 629760
	buffer_load_dwordx4 v1, s[52:55], s66 offen lds
	s_waitcnt lgkmcnt(12)
	v_mfma_f32_16x16x32_bf16 v[116:119], v[212:215], a[212:215], v[116:119]
	ds_read_b64_tr_b16 v[208:209], v20 offset:41728
	ds_read_b64_tr_b16 v[210:211], v20 offset:46848
	s_waitcnt lgkmcnt(12)
	v_mfma_f32_16x16x32_bf16 v[120:123], v[216:219], a[212:215], v[120:123]
	ds_read_b64_tr_b16 v[212:213], v21 offset:41728
	ds_read_b64_tr_b16 v[214:215], v21 offset:46848
	s_waitcnt lgkmcnt(12)
	v_mfma_f32_16x16x32_bf16 v[124:127], v[220:223], a[212:215], v[124:127]
	ds_read_b64_tr_b16 v[216:217], v22 offset:41728
	ds_read_b64_tr_b16 v[218:219], v22 offset:46848
	s_waitcnt lgkmcnt(12)
	v_mfma_f32_16x16x32_bf16 v[128:131], v[192:195], a[212:215], v[128:131]
	ds_read_b64_tr_b16 v[220:221], v23 offset:41728
	ds_read_b64_tr_b16 v[222:223], v23 offset:46848
	s_add_u32 m0, s67, 6144
	s_mov_b32 s66, 629760
	buffer_load_dwordx4 v2, s[52:55], s66 offen lds
	s_waitcnt lgkmcnt(12)
	v_mfma_f32_16x16x32_bf16 v[132:135], v[196:199], a[212:215], v[132:135]
	ds_read_b64_tr_b16 v[192:193], v16 offset:41984
	ds_read_b64_tr_b16 v[194:195], v16 offset:47104
	s_waitcnt lgkmcnt(12)
	v_mfma_f32_16x16x32_bf16 v[136:139], v[200:203], a[212:215], v[136:139]
	ds_read_b64_tr_b16 v[196:197], v17 offset:41984
	ds_read_b64_tr_b16 v[198:199], v17 offset:47104
	s_waitcnt lgkmcnt(12)
	v_mfma_f32_16x16x32_bf16 v[140:143], v[204:207], a[212:215], v[140:143]
	ds_read_b64_tr_b16 v[200:201], v18 offset:41984
	ds_read_b64_tr_b16 v[202:203], v18 offset:47104
	s_waitcnt lgkmcnt(12)
	v_mfma_f32_16x16x32_bf16 v[144:147], v[208:211], a[212:215], v[144:147]
	ds_read_b64_tr_b16 v[204:205], v19 offset:41984
	ds_read_b64_tr_b16 v[206:207], v19 offset:47104
	s_add_u32 m0, s67, 7168
	s_mov_b32 s66, 629760
	buffer_load_dwordx4 v3, s[52:55], s66 offen lds
	s_waitcnt lgkmcnt(12)
	v_mfma_f32_16x16x32_bf16 v[148:151], v[212:215], a[212:215], v[148:151]
	ds_read_b64_tr_b16 v[208:209], v20 offset:41984
	ds_read_b64_tr_b16 v[210:211], v20 offset:47104
	s_waitcnt lgkmcnt(12)
	v_mfma_f32_16x16x32_bf16 v[152:155], v[216:219], a[212:215], v[152:155]
	ds_read_b64_tr_b16 v[212:213], v21 offset:41984
	ds_read_b64_tr_b16 v[214:215], v21 offset:47104
	s_waitcnt lgkmcnt(12)
	v_mfma_f32_16x16x32_bf16 v[156:159], v[220:223], a[212:215], v[156:159]
	ds_read_b64_tr_b16 v[216:217], v22 offset:41984
	ds_read_b64_tr_b16 v[218:219], v22 offset:47104
	s_waitcnt lgkmcnt(12)
	v_mfma_f32_16x16x32_bf16 v[160:163], v[192:195], a[212:215], v[160:163]
	ds_read_b64_tr_b16 v[220:221], v23 offset:41984
	ds_read_b64_tr_b16 v[222:223], v23 offset:47104
	s_add_u32 m0, s67, 8192
	s_mov_b32 s66, 629760
	buffer_load_dwordx4 v4, s[52:55], s66 offen lds
	s_waitcnt lgkmcnt(12)
	v_mfma_f32_16x16x32_bf16 v[164:167], v[196:199], a[212:215], v[164:167]
	s_waitcnt lgkmcnt(10)
	v_mfma_f32_16x16x32_bf16 v[168:171], v[200:203], a[212:215], v[168:171]
	s_waitcnt lgkmcnt(8)
	v_mfma_f32_16x16x32_bf16 v[172:175], v[204:207], a[212:215], v[172:175]
	s_waitcnt lgkmcnt(6)
	v_mfma_f32_16x16x32_bf16 v[176:179], v[208:211], a[212:215], v[176:179]
	s_add_u32 m0, s67, 9216
	s_mov_b32 s66, 629760
	buffer_load_dwordx4 v5, s[52:55], s66 offen lds
	s_waitcnt lgkmcnt(4)
	v_mfma_f32_16x16x32_bf16 v[180:183], v[212:215], a[212:215], v[180:183]
	s_waitcnt lgkmcnt(2)
	v_mfma_f32_16x16x32_bf16 v[184:187], v[216:219], a[212:215], v[184:187]
	s_waitcnt lgkmcnt(0)
	v_mfma_f32_16x16x32_bf16 v[188:191], v[220:223], a[212:215], v[188:191]
	s_waitcnt vmcnt(20)
	s_barrier
	ds_read_b64_tr_b16 v[192:193], v24 offset:0
	ds_read_b64_tr_b16 v[194:195], v24 offset:5120
	ds_read_b64_tr_b16 v[196:197], v25 offset:0
	ds_read_b64_tr_b16 v[198:199], v25 offset:5120
	ds_read_b64_tr_b16 v[200:201], v26 offset:0
	ds_read_b64_tr_b16 v[202:203], v26 offset:5120
	ds_read_b64_tr_b16 v[204:205], v27 offset:0
	ds_read_b64_tr_b16 v[206:207], v27 offset:5120
	ds_read_b64_tr_b16 v[208:209], v28 offset:0
	ds_read_b64_tr_b16 v[210:211], v28 offset:5120
	ds_read_b64_tr_b16 v[212:213], v29 offset:0
	ds_read_b64_tr_b16 v[214:215], v29 offset:5120
	ds_read_b64_tr_b16 v[216:217], v30 offset:0
	ds_read_b64_tr_b16 v[218:219], v30 offset:5120
	s_waitcnt lgkmcnt(12)
	v_mfma_f32_16x16x32_bf16 v[32:35], v[192:195], a[216:219], v[32:35]
	ds_read_b64_tr_b16 v[220:221], v31 offset:0
	ds_read_b64_tr_b16 v[222:223], v31 offset:5120
	s_add_u32 m0, s67, 40960
	s_mov_b32 s66, 634880
	buffer_load_dwordx4 v1, s[52:55], s66 offen lds
	s_waitcnt lgkmcnt(12)
	v_mfma_f32_16x16x32_bf16 v[36:39], v[196:199], a[216:219], v[36:39]
	ds_read_b64_tr_b16 v[192:193], v24 offset:256
	ds_read_b64_tr_b16 v[194:195], v24 offset:5376
	s_waitcnt lgkmcnt(12)
	v_mfma_f32_16x16x32_bf16 v[40:43], v[200:203], a[216:219], v[40:43]
	ds_read_b64_tr_b16 v[196:197], v25 offset:256
	ds_read_b64_tr_b16 v[198:199], v25 offset:5376
	s_waitcnt lgkmcnt(12)
	v_mfma_f32_16x16x32_bf16 v[44:47], v[204:207], a[216:219], v[44:47]
	ds_read_b64_tr_b16 v[200:201], v26 offset:256
	ds_read_b64_tr_b16 v[202:203], v26 offset:5376
	s_waitcnt lgkmcnt(12)
	v_mfma_f32_16x16x32_bf16 v[48:51], v[208:211], a[216:219], v[48:51]
	ds_read_b64_tr_b16 v[204:205], v27 offset:256
	ds_read_b64_tr_b16 v[206:207], v27 offset:5376
	s_add_u32 m0, s67, 41984
	s_mov_b32 s66, 634880
	buffer_load_dwordx4 v2, s[52:55], s66 offen lds
	s_waitcnt lgkmcnt(12)
	v_mfma_f32_16x16x32_bf16 v[52:55], v[212:215], a[216:219], v[52:55]
	ds_read_b64_tr_b16 v[208:209], v28 offset:256
	ds_read_b64_tr_b16 v[210:211], v28 offset:5376
	s_waitcnt lgkmcnt(12)
	v_mfma_f32_16x16x32_bf16 v[56:59], v[216:219], a[216:219], v[56:59]
	ds_read_b64_tr_b16 v[212:213], v29 offset:256
	ds_read_b64_tr_b16 v[214:215], v29 offset:5376
	s_waitcnt lgkmcnt(12)
	v_mfma_f32_16x16x32_bf16 v[60:63], v[220:223], a[216:219], v[60:63]
	ds_read_b64_tr_b16 v[216:217], v30 offset:256
	ds_read_b64_tr_b16 v[218:219], v30 offset:5376
	s_waitcnt lgkmcnt(12)
	v_mfma_f32_16x16x32_bf16 v[64:67], v[192:195], a[216:219], v[64:67]
	ds_read_b64_tr_b16 v[220:221], v31 offset:256
	ds_read_b64_tr_b16 v[222:223], v31 offset:5376
	s_add_u32 m0, s67, 43008
	s_mov_b32 s66, 634880
	buffer_load_dwordx4 v3, s[52:55], s66 offen lds
	s_waitcnt lgkmcnt(12)
	v_mfma_f32_16x16x32_bf16 v[68:71], v[196:199], a[216:219], v[68:71]
	ds_read_b64_tr_b16 v[192:193], v24 offset:512
	ds_read_b64_tr_b16 v[194:195], v24 offset:5632
	s_waitcnt lgkmcnt(12)
	v_mfma_f32_16x16x32_bf16 v[72:75], v[200:203], a[216:219], v[72:75]
	ds_read_b64_tr_b16 v[196:197], v25 offset:512
	ds_read_b64_tr_b16 v[198:199], v25 offset:5632
	s_waitcnt lgkmcnt(12)
	v_mfma_f32_16x16x32_bf16 v[76:79], v[204:207], a[216:219], v[76:79]
	ds_read_b64_tr_b16 v[200:201], v26 offset:512
	ds_read_b64_tr_b16 v[202:203], v26 offset:5632
	s_waitcnt lgkmcnt(12)
	v_mfma_f32_16x16x32_bf16 v[80:83], v[208:211], a[216:219], v[80:83]
	ds_read_b64_tr_b16 v[204:205], v27 offset:512
	ds_read_b64_tr_b16 v[206:207], v27 offset:5632
	s_add_u32 m0, s67, 44032
	s_mov_b32 s66, 634880
	buffer_load_dwordx4 v4, s[52:55], s66 offen lds
	s_waitcnt lgkmcnt(12)
	v_mfma_f32_16x16x32_bf16 v[84:87], v[212:215], a[216:219], v[84:87]
	ds_read_b64_tr_b16 v[208:209], v28 offset:512
	ds_read_b64_tr_b16 v[210:211], v28 offset:5632
	s_waitcnt lgkmcnt(12)
	v_mfma_f32_16x16x32_bf16 v[88:91], v[216:219], a[216:219], v[88:91]
	ds_read_b64_tr_b16 v[212:213], v29 offset:512
	ds_read_b64_tr_b16 v[214:215], v29 offset:5632
	s_waitcnt lgkmcnt(12)
	v_mfma_f32_16x16x32_bf16 v[92:95], v[220:223], a[216:219], v[92:95]
	ds_read_b64_tr_b16 v[216:217], v30 offset:512
	ds_read_b64_tr_b16 v[218:219], v30 offset:5632
	s_waitcnt lgkmcnt(12)
	v_mfma_f32_16x16x32_bf16 v[96:99], v[192:195], a[216:219], v[96:99]
	ds_read_b64_tr_b16 v[220:221], v31 offset:512
	ds_read_b64_tr_b16 v[222:223], v31 offset:5632
	s_add_u32 m0, s67, 45056
	s_mov_b32 s66, 634880
	buffer_load_dwordx4 v5, s[52:55], s66 offen lds
	s_waitcnt lgkmcnt(12)
	v_mfma_f32_16x16x32_bf16 v[100:103], v[196:199], a[216:219], v[100:103]
	ds_read_b64_tr_b16 v[192:193], v24 offset:768
	ds_read_b64_tr_b16 v[194:195], v24 offset:5888
	s_waitcnt lgkmcnt(12)
	v_mfma_f32_16x16x32_bf16 v[104:107], v[200:203], a[216:219], v[104:107]
	ds_read_b64_tr_b16 v[196:197], v25 offset:768
	ds_read_b64_tr_b16 v[198:199], v25 offset:5888
	s_waitcnt lgkmcnt(12)
	v_mfma_f32_16x16x32_bf16 v[108:111], v[204:207], a[216:219], v[108:111]
	ds_read_b64_tr_b16 v[200:201], v26 offset:768
	ds_read_b64_tr_b16 v[202:203], v26 offset:5888
	s_waitcnt lgkmcnt(12)
	v_mfma_f32_16x16x32_bf16 v[112:115], v[208:211], a[216:219], v[112:115]
	ds_read_b64_tr_b16 v[204:205], v27 offset:768
	ds_read_b64_tr_b16 v[206:207], v27 offset:5888
	s_add_u32 m0, s67, 46080
	s_mov_b32 s66, 716800
	buffer_load_dwordx4 v1, s[52:55], s66 offen lds
	s_waitcnt lgkmcnt(12)
	v_mfma_f32_16x16x32_bf16 v[116:119], v[212:215], a[216:219], v[116:119]
	ds_read_b64_tr_b16 v[208:209], v28 offset:768
	ds_read_b64_tr_b16 v[210:211], v28 offset:5888
	s_waitcnt lgkmcnt(12)
	v_mfma_f32_16x16x32_bf16 v[120:123], v[216:219], a[216:219], v[120:123]
	ds_read_b64_tr_b16 v[212:213], v29 offset:768
	ds_read_b64_tr_b16 v[214:215], v29 offset:5888
	s_waitcnt lgkmcnt(12)
	v_mfma_f32_16x16x32_bf16 v[124:127], v[220:223], a[216:219], v[124:127]
	ds_read_b64_tr_b16 v[216:217], v30 offset:768
	ds_read_b64_tr_b16 v[218:219], v30 offset:5888
	s_waitcnt lgkmcnt(12)
	v_mfma_f32_16x16x32_bf16 v[128:131], v[192:195], a[216:219], v[128:131]
	ds_read_b64_tr_b16 v[220:221], v31 offset:768
	ds_read_b64_tr_b16 v[222:223], v31 offset:5888
	s_add_u32 m0, s67, 47104
	s_mov_b32 s66, 716800
	buffer_load_dwordx4 v2, s[52:55], s66 offen lds
	s_waitcnt lgkmcnt(12)
	v_mfma_f32_16x16x32_bf16 v[132:135], v[196:199], a[216:219], v[132:135]
	ds_read_b64_tr_b16 v[192:193], v24 offset:1024
	ds_read_b64_tr_b16 v[194:195], v24 offset:6144
	s_waitcnt lgkmcnt(12)
	v_mfma_f32_16x16x32_bf16 v[136:139], v[200:203], a[216:219], v[136:139]
	ds_read_b64_tr_b16 v[196:197], v25 offset:1024
	ds_read_b64_tr_b16 v[198:199], v25 offset:6144
	s_waitcnt lgkmcnt(12)
	v_mfma_f32_16x16x32_bf16 v[140:143], v[204:207], a[216:219], v[140:143]
	ds_read_b64_tr_b16 v[200:201], v26 offset:1024
	ds_read_b64_tr_b16 v[202:203], v26 offset:6144
	s_waitcnt lgkmcnt(12)
	v_mfma_f32_16x16x32_bf16 v[144:147], v[208:211], a[216:219], v[144:147]
	ds_read_b64_tr_b16 v[204:205], v27 offset:1024
	ds_read_b64_tr_b16 v[206:207], v27 offset:6144
	s_add_u32 m0, s67, 48128
	s_mov_b32 s66, 716800
	buffer_load_dwordx4 v3, s[52:55], s66 offen lds
	s_waitcnt lgkmcnt(12)
	v_mfma_f32_16x16x32_bf16 v[148:151], v[212:215], a[216:219], v[148:151]
	ds_read_b64_tr_b16 v[208:209], v28 offset:1024
	ds_read_b64_tr_b16 v[210:211], v28 offset:6144
	s_waitcnt lgkmcnt(12)
	v_mfma_f32_16x16x32_bf16 v[152:155], v[216:219], a[216:219], v[152:155]
	ds_read_b64_tr_b16 v[212:213], v29 offset:1024
	ds_read_b64_tr_b16 v[214:215], v29 offset:6144
	s_waitcnt lgkmcnt(12)
	v_mfma_f32_16x16x32_bf16 v[156:159], v[220:223], a[216:219], v[156:159]
	ds_read_b64_tr_b16 v[216:217], v30 offset:1024
	ds_read_b64_tr_b16 v[218:219], v30 offset:6144
	s_waitcnt lgkmcnt(12)
	v_mfma_f32_16x16x32_bf16 v[160:163], v[192:195], a[216:219], v[160:163]
	ds_read_b64_tr_b16 v[220:221], v31 offset:1024
	ds_read_b64_tr_b16 v[222:223], v31 offset:6144
	s_add_u32 m0, s67, 49152
	s_mov_b32 s66, 716800
	buffer_load_dwordx4 v4, s[52:55], s66 offen lds
	s_waitcnt lgkmcnt(12)
	v_mfma_f32_16x16x32_bf16 v[164:167], v[196:199], a[216:219], v[164:167]
	s_waitcnt lgkmcnt(10)
	v_mfma_f32_16x16x32_bf16 v[168:171], v[200:203], a[216:219], v[168:171]
	s_waitcnt lgkmcnt(8)
	v_mfma_f32_16x16x32_bf16 v[172:175], v[204:207], a[216:219], v[172:175]
	s_waitcnt lgkmcnt(6)
	v_mfma_f32_16x16x32_bf16 v[176:179], v[208:211], a[216:219], v[176:179]
	s_add_u32 m0, s67, 50176
	s_mov_b32 s66, 716800
	buffer_load_dwordx4 v5, s[52:55], s66 offen lds
	s_waitcnt lgkmcnt(4)
	v_mfma_f32_16x16x32_bf16 v[180:183], v[212:215], a[216:219], v[180:183]
	s_waitcnt lgkmcnt(2)
	v_mfma_f32_16x16x32_bf16 v[184:187], v[216:219], a[216:219], v[184:187]
	s_waitcnt lgkmcnt(0)
	v_mfma_f32_16x16x32_bf16 v[188:191], v[220:223], a[216:219], v[188:191]
	s_waitcnt vmcnt(20)
	s_barrier
	ds_read_b64_tr_b16 v[192:193], v24 offset:40960
	ds_read_b64_tr_b16 v[194:195], v24 offset:46080
	ds_read_b64_tr_b16 v[196:197], v25 offset:40960
	ds_read_b64_tr_b16 v[198:199], v25 offset:46080
	ds_read_b64_tr_b16 v[200:201], v26 offset:40960
	ds_read_b64_tr_b16 v[202:203], v26 offset:46080
	ds_read_b64_tr_b16 v[204:205], v27 offset:40960
	ds_read_b64_tr_b16 v[206:207], v27 offset:46080
	ds_read_b64_tr_b16 v[208:209], v28 offset:40960
	ds_read_b64_tr_b16 v[210:211], v28 offset:46080
	ds_read_b64_tr_b16 v[212:213], v29 offset:40960
	ds_read_b64_tr_b16 v[214:215], v29 offset:46080
	ds_read_b64_tr_b16 v[216:217], v30 offset:40960
	ds_read_b64_tr_b16 v[218:219], v30 offset:46080
	s_waitcnt lgkmcnt(12)
	v_mfma_f32_16x16x32_bf16 v[32:35], v[192:195], a[220:223], v[32:35]
	ds_read_b64_tr_b16 v[220:221], v31 offset:40960
	ds_read_b64_tr_b16 v[222:223], v31 offset:46080
	s_add_u32 m0, s67, 81920
	s_mov_b32 s66, 721920
	buffer_load_dwordx4 v1, s[52:55], s66 offen lds
	s_waitcnt lgkmcnt(12)
	v_mfma_f32_16x16x32_bf16 v[36:39], v[196:199], a[220:223], v[36:39]
	ds_read_b64_tr_b16 v[192:193], v24 offset:41216
	ds_read_b64_tr_b16 v[194:195], v24 offset:46336
	s_waitcnt lgkmcnt(12)
	v_mfma_f32_16x16x32_bf16 v[40:43], v[200:203], a[220:223], v[40:43]
	ds_read_b64_tr_b16 v[196:197], v25 offset:41216
	ds_read_b64_tr_b16 v[198:199], v25 offset:46336
	s_waitcnt lgkmcnt(12)
	v_mfma_f32_16x16x32_bf16 v[44:47], v[204:207], a[220:223], v[44:47]
	ds_read_b64_tr_b16 v[200:201], v26 offset:41216
	ds_read_b64_tr_b16 v[202:203], v26 offset:46336
	s_waitcnt lgkmcnt(12)
	v_mfma_f32_16x16x32_bf16 v[48:51], v[208:211], a[220:223], v[48:51]
	ds_read_b64_tr_b16 v[204:205], v27 offset:41216
	ds_read_b64_tr_b16 v[206:207], v27 offset:46336
	s_add_u32 m0, s67, 82944
	s_mov_b32 s66, 721920
	buffer_load_dwordx4 v2, s[52:55], s66 offen lds
	s_waitcnt lgkmcnt(12)
	v_mfma_f32_16x16x32_bf16 v[52:55], v[212:215], a[220:223], v[52:55]
	ds_read_b64_tr_b16 v[208:209], v28 offset:41216
	ds_read_b64_tr_b16 v[210:211], v28 offset:46336
	s_waitcnt lgkmcnt(12)
	v_mfma_f32_16x16x32_bf16 v[56:59], v[216:219], a[220:223], v[56:59]
	ds_read_b64_tr_b16 v[212:213], v29 offset:41216
	ds_read_b64_tr_b16 v[214:215], v29 offset:46336
	s_waitcnt lgkmcnt(12)
	v_mfma_f32_16x16x32_bf16 v[60:63], v[220:223], a[220:223], v[60:63]
	ds_read_b64_tr_b16 v[216:217], v30 offset:41216
	ds_read_b64_tr_b16 v[218:219], v30 offset:46336
	s_waitcnt lgkmcnt(12)
	v_mfma_f32_16x16x32_bf16 v[64:67], v[192:195], a[220:223], v[64:67]
	ds_read_b64_tr_b16 v[220:221], v31 offset:41216
	ds_read_b64_tr_b16 v[222:223], v31 offset:46336
	s_add_u32 m0, s67, 83968
	s_mov_b32 s66, 721920
	buffer_load_dwordx4 v3, s[52:55], s66 offen lds
	s_waitcnt lgkmcnt(12)
	v_mfma_f32_16x16x32_bf16 v[68:71], v[196:199], a[220:223], v[68:71]
	ds_read_b64_tr_b16 v[192:193], v24 offset:41472
	ds_read_b64_tr_b16 v[194:195], v24 offset:46592
	s_waitcnt lgkmcnt(12)
	v_mfma_f32_16x16x32_bf16 v[72:75], v[200:203], a[220:223], v[72:75]
	ds_read_b64_tr_b16 v[196:197], v25 offset:41472
	ds_read_b64_tr_b16 v[198:199], v25 offset:46592
	s_waitcnt lgkmcnt(12)
	v_mfma_f32_16x16x32_bf16 v[76:79], v[204:207], a[220:223], v[76:79]
	ds_read_b64_tr_b16 v[200:201], v26 offset:41472
	ds_read_b64_tr_b16 v[202:203], v26 offset:46592
	s_waitcnt lgkmcnt(12)
	v_mfma_f32_16x16x32_bf16 v[80:83], v[208:211], a[220:223], v[80:83]
	ds_read_b64_tr_b16 v[204:205], v27 offset:41472
	ds_read_b64_tr_b16 v[206:207], v27 offset:46592
	s_add_u32 m0, s67, 84992
	s_mov_b32 s66, 721920
	buffer_load_dwordx4 v4, s[52:55], s66 offen lds
	s_waitcnt lgkmcnt(12)
	v_mfma_f32_16x16x32_bf16 v[84:87], v[212:215], a[220:223], v[84:87]
	ds_read_b64_tr_b16 v[208:209], v28 offset:41472
	ds_read_b64_tr_b16 v[210:211], v28 offset:46592
	s_waitcnt lgkmcnt(12)
	v_mfma_f32_16x16x32_bf16 v[88:91], v[216:219], a[220:223], v[88:91]
	ds_read_b64_tr_b16 v[212:213], v29 offset:41472
	ds_read_b64_tr_b16 v[214:215], v29 offset:46592
	s_waitcnt lgkmcnt(12)
	v_mfma_f32_16x16x32_bf16 v[92:95], v[220:223], a[220:223], v[92:95]
	ds_read_b64_tr_b16 v[216:217], v30 offset:41472
	ds_read_b64_tr_b16 v[218:219], v30 offset:46592
	s_waitcnt lgkmcnt(12)
	v_mfma_f32_16x16x32_bf16 v[96:99], v[192:195], a[220:223], v[96:99]
	ds_read_b64_tr_b16 v[220:221], v31 offset:41472
	ds_read_b64_tr_b16 v[222:223], v31 offset:46592
	s_add_u32 m0, s67, 86016
	s_mov_b32 s66, 721920
	buffer_load_dwordx4 v5, s[52:55], s66 offen lds
	s_waitcnt lgkmcnt(12)
	v_mfma_f32_16x16x32_bf16 v[100:103], v[196:199], a[220:223], v[100:103]
	ds_read_b64_tr_b16 v[192:193], v24 offset:41728
	ds_read_b64_tr_b16 v[194:195], v24 offset:46848
	s_waitcnt lgkmcnt(12)
	v_mfma_f32_16x16x32_bf16 v[104:107], v[200:203], a[220:223], v[104:107]
	ds_read_b64_tr_b16 v[196:197], v25 offset:41728
	ds_read_b64_tr_b16 v[198:199], v25 offset:46848
	s_waitcnt lgkmcnt(12)
	v_mfma_f32_16x16x32_bf16 v[108:111], v[204:207], a[220:223], v[108:111]
	ds_read_b64_tr_b16 v[200:201], v26 offset:41728
	ds_read_b64_tr_b16 v[202:203], v26 offset:46848
	s_waitcnt lgkmcnt(12)
	v_mfma_f32_16x16x32_bf16 v[112:115], v[208:211], a[220:223], v[112:115]
	ds_read_b64_tr_b16 v[204:205], v27 offset:41728
	ds_read_b64_tr_b16 v[206:207], v27 offset:46848
	s_add_u32 m0, s67, 87040
	s_mov_b32 s66, 727040
	buffer_load_dwordx4 v1, s[52:55], s66 offen lds
	s_waitcnt lgkmcnt(12)
	v_mfma_f32_16x16x32_bf16 v[116:119], v[212:215], a[220:223], v[116:119]
	ds_read_b64_tr_b16 v[208:209], v28 offset:41728
	ds_read_b64_tr_b16 v[210:211], v28 offset:46848
	s_waitcnt lgkmcnt(12)
	v_mfma_f32_16x16x32_bf16 v[120:123], v[216:219], a[220:223], v[120:123]
	ds_read_b64_tr_b16 v[212:213], v29 offset:41728
	ds_read_b64_tr_b16 v[214:215], v29 offset:46848
	s_waitcnt lgkmcnt(12)
	v_mfma_f32_16x16x32_bf16 v[124:127], v[220:223], a[220:223], v[124:127]
	ds_read_b64_tr_b16 v[216:217], v30 offset:41728
	ds_read_b64_tr_b16 v[218:219], v30 offset:46848
	s_waitcnt lgkmcnt(12)
	v_mfma_f32_16x16x32_bf16 v[128:131], v[192:195], a[220:223], v[128:131]
	ds_read_b64_tr_b16 v[220:221], v31 offset:41728
	ds_read_b64_tr_b16 v[222:223], v31 offset:46848
	s_add_u32 m0, s67, 88064
	s_mov_b32 s66, 727040
	buffer_load_dwordx4 v2, s[52:55], s66 offen lds
	s_waitcnt lgkmcnt(12)
	v_mfma_f32_16x16x32_bf16 v[132:135], v[196:199], a[220:223], v[132:135]
	ds_read_b64_tr_b16 v[192:193], v24 offset:41984
	ds_read_b64_tr_b16 v[194:195], v24 offset:47104
	s_waitcnt lgkmcnt(12)
	v_mfma_f32_16x16x32_bf16 v[136:139], v[200:203], a[220:223], v[136:139]
	ds_read_b64_tr_b16 v[196:197], v25 offset:41984
	ds_read_b64_tr_b16 v[198:199], v25 offset:47104
	s_waitcnt lgkmcnt(12)
	v_mfma_f32_16x16x32_bf16 v[140:143], v[204:207], a[220:223], v[140:143]
	ds_read_b64_tr_b16 v[200:201], v26 offset:41984
	ds_read_b64_tr_b16 v[202:203], v26 offset:47104
	s_waitcnt lgkmcnt(12)
	v_mfma_f32_16x16x32_bf16 v[144:147], v[208:211], a[220:223], v[144:147]
	ds_read_b64_tr_b16 v[204:205], v27 offset:41984
	ds_read_b64_tr_b16 v[206:207], v27 offset:47104
	s_add_u32 m0, s67, 89088
	s_mov_b32 s66, 727040
	buffer_load_dwordx4 v3, s[52:55], s66 offen lds
	s_waitcnt lgkmcnt(12)
	v_mfma_f32_16x16x32_bf16 v[148:151], v[212:215], a[220:223], v[148:151]
	ds_read_b64_tr_b16 v[208:209], v28 offset:41984
	ds_read_b64_tr_b16 v[210:211], v28 offset:47104
	s_waitcnt lgkmcnt(12)
	v_mfma_f32_16x16x32_bf16 v[152:155], v[216:219], a[220:223], v[152:155]
	ds_read_b64_tr_b16 v[212:213], v29 offset:41984
	ds_read_b64_tr_b16 v[214:215], v29 offset:47104
	s_waitcnt lgkmcnt(12)
	v_mfma_f32_16x16x32_bf16 v[156:159], v[220:223], a[220:223], v[156:159]
	ds_read_b64_tr_b16 v[216:217], v30 offset:41984
	ds_read_b64_tr_b16 v[218:219], v30 offset:47104
	s_waitcnt lgkmcnt(12)
	v_mfma_f32_16x16x32_bf16 v[160:163], v[192:195], a[220:223], v[160:163]
	ds_read_b64_tr_b16 v[220:221], v31 offset:41984
	ds_read_b64_tr_b16 v[222:223], v31 offset:47104
	s_add_u32 m0, s67, 90112
	s_mov_b32 s66, 727040
	buffer_load_dwordx4 v4, s[52:55], s66 offen lds
	s_waitcnt lgkmcnt(12)
	v_mfma_f32_16x16x32_bf16 v[164:167], v[196:199], a[220:223], v[164:167]
	s_waitcnt lgkmcnt(10)
	v_mfma_f32_16x16x32_bf16 v[168:171], v[200:203], a[220:223], v[168:171]
	s_waitcnt lgkmcnt(8)
	v_mfma_f32_16x16x32_bf16 v[172:175], v[204:207], a[220:223], v[172:175]
	s_waitcnt lgkmcnt(6)
	v_mfma_f32_16x16x32_bf16 v[176:179], v[208:211], a[220:223], v[176:179]
	s_add_u32 m0, s67, 91136
	s_mov_b32 s66, 727040
	buffer_load_dwordx4 v5, s[52:55], s66 offen lds
	s_waitcnt lgkmcnt(4)
	v_mfma_f32_16x16x32_bf16 v[180:183], v[212:215], a[220:223], v[180:183]
	s_waitcnt lgkmcnt(2)
	v_mfma_f32_16x16x32_bf16 v[184:187], v[216:219], a[220:223], v[184:187]
	s_waitcnt lgkmcnt(0)
	v_mfma_f32_16x16x32_bf16 v[188:191], v[220:223], a[220:223], v[188:191]
	s_waitcnt vmcnt(20)
	s_barrier
	ds_read_b64_tr_b16 v[192:193], v16 offset:0
	ds_read_b64_tr_b16 v[194:195], v16 offset:5120
	ds_read_b64_tr_b16 v[196:197], v17 offset:0
	ds_read_b64_tr_b16 v[198:199], v17 offset:5120
	ds_read_b64_tr_b16 v[200:201], v18 offset:0
	ds_read_b64_tr_b16 v[202:203], v18 offset:5120
	ds_read_b64_tr_b16 v[204:205], v19 offset:0
	ds_read_b64_tr_b16 v[206:207], v19 offset:5120
	ds_read_b64_tr_b16 v[208:209], v20 offset:0
	ds_read_b64_tr_b16 v[210:211], v20 offset:5120
	ds_read_b64_tr_b16 v[212:213], v21 offset:0
	ds_read_b64_tr_b16 v[214:215], v21 offset:5120
	ds_read_b64_tr_b16 v[216:217], v22 offset:0
	ds_read_b64_tr_b16 v[218:219], v22 offset:5120
	s_waitcnt lgkmcnt(12)
	v_mfma_f32_16x16x32_bf16 v[32:35], v[192:195], a[224:227], v[32:35]
	ds_read_b64_tr_b16 v[220:221], v23 offset:0
	ds_read_b64_tr_b16 v[222:223], v23 offset:5120
	s_add_u32 m0, s67, 122880
	s_mov_b32 s66, 732160
	buffer_load_dwordx4 v1, s[52:55], s66 offen lds
	s_waitcnt lgkmcnt(12)
	v_mfma_f32_16x16x32_bf16 v[36:39], v[196:199], a[224:227], v[36:39]
	ds_read_b64_tr_b16 v[192:193], v16 offset:256
	ds_read_b64_tr_b16 v[194:195], v16 offset:5376
	s_waitcnt lgkmcnt(12)
	v_mfma_f32_16x16x32_bf16 v[40:43], v[200:203], a[224:227], v[40:43]
	ds_read_b64_tr_b16 v[196:197], v17 offset:256
	ds_read_b64_tr_b16 v[198:199], v17 offset:5376
	s_waitcnt lgkmcnt(12)
	v_mfma_f32_16x16x32_bf16 v[44:47], v[204:207], a[224:227], v[44:47]
	ds_read_b64_tr_b16 v[200:201], v18 offset:256
	ds_read_b64_tr_b16 v[202:203], v18 offset:5376
	s_waitcnt lgkmcnt(12)
	v_mfma_f32_16x16x32_bf16 v[48:51], v[208:211], a[224:227], v[48:51]
	ds_read_b64_tr_b16 v[204:205], v19 offset:256
	ds_read_b64_tr_b16 v[206:207], v19 offset:5376
	s_add_u32 m0, s67, 123904
	s_mov_b32 s66, 732160
	buffer_load_dwordx4 v2, s[52:55], s66 offen lds
	s_waitcnt lgkmcnt(12)
	v_mfma_f32_16x16x32_bf16 v[52:55], v[212:215], a[224:227], v[52:55]
	ds_read_b64_tr_b16 v[208:209], v20 offset:256
	ds_read_b64_tr_b16 v[210:211], v20 offset:5376
	s_waitcnt lgkmcnt(12)
	v_mfma_f32_16x16x32_bf16 v[56:59], v[216:219], a[224:227], v[56:59]
	ds_read_b64_tr_b16 v[212:213], v21 offset:256
	ds_read_b64_tr_b16 v[214:215], v21 offset:5376
	s_waitcnt lgkmcnt(12)
	v_mfma_f32_16x16x32_bf16 v[60:63], v[220:223], a[224:227], v[60:63]
	ds_read_b64_tr_b16 v[216:217], v22 offset:256
	ds_read_b64_tr_b16 v[218:219], v22 offset:5376
	s_waitcnt lgkmcnt(12)
	v_mfma_f32_16x16x32_bf16 v[64:67], v[192:195], a[224:227], v[64:67]
	ds_read_b64_tr_b16 v[220:221], v23 offset:256
	ds_read_b64_tr_b16 v[222:223], v23 offset:5376
	s_add_u32 m0, s67, 124928
	s_mov_b32 s66, 732160
	buffer_load_dwordx4 v3, s[52:55], s66 offen lds
	s_waitcnt lgkmcnt(12)
	v_mfma_f32_16x16x32_bf16 v[68:71], v[196:199], a[224:227], v[68:71]
	ds_read_b64_tr_b16 v[192:193], v16 offset:512
	ds_read_b64_tr_b16 v[194:195], v16 offset:5632
	s_waitcnt lgkmcnt(12)
	v_mfma_f32_16x16x32_bf16 v[72:75], v[200:203], a[224:227], v[72:75]
	ds_read_b64_tr_b16 v[196:197], v17 offset:512
	ds_read_b64_tr_b16 v[198:199], v17 offset:5632
	s_waitcnt lgkmcnt(12)
	v_mfma_f32_16x16x32_bf16 v[76:79], v[204:207], a[224:227], v[76:79]
	ds_read_b64_tr_b16 v[200:201], v18 offset:512
	ds_read_b64_tr_b16 v[202:203], v18 offset:5632
	s_waitcnt lgkmcnt(12)
	v_mfma_f32_16x16x32_bf16 v[80:83], v[208:211], a[224:227], v[80:83]
	ds_read_b64_tr_b16 v[204:205], v19 offset:512
	ds_read_b64_tr_b16 v[206:207], v19 offset:5632
	s_add_u32 m0, s67, 125952
	s_mov_b32 s66, 732160
	buffer_load_dwordx4 v4, s[52:55], s66 offen lds
	s_waitcnt lgkmcnt(12)
	v_mfma_f32_16x16x32_bf16 v[84:87], v[212:215], a[224:227], v[84:87]
	ds_read_b64_tr_b16 v[208:209], v20 offset:512
	ds_read_b64_tr_b16 v[210:211], v20 offset:5632
	s_waitcnt lgkmcnt(12)
	v_mfma_f32_16x16x32_bf16 v[88:91], v[216:219], a[224:227], v[88:91]
	ds_read_b64_tr_b16 v[212:213], v21 offset:512
	ds_read_b64_tr_b16 v[214:215], v21 offset:5632
	s_waitcnt lgkmcnt(12)
	v_mfma_f32_16x16x32_bf16 v[92:95], v[220:223], a[224:227], v[92:95]
	ds_read_b64_tr_b16 v[216:217], v22 offset:512
	ds_read_b64_tr_b16 v[218:219], v22 offset:5632
	s_waitcnt lgkmcnt(12)
	v_mfma_f32_16x16x32_bf16 v[96:99], v[192:195], a[224:227], v[96:99]
	ds_read_b64_tr_b16 v[220:221], v23 offset:512
	ds_read_b64_tr_b16 v[222:223], v23 offset:5632
	s_add_u32 m0, s67, 126976
	s_mov_b32 s66, 732160
	buffer_load_dwordx4 v5, s[52:55], s66 offen lds
	s_waitcnt lgkmcnt(12)
	v_mfma_f32_16x16x32_bf16 v[100:103], v[196:199], a[224:227], v[100:103]
	ds_read_b64_tr_b16 v[192:193], v16 offset:768
	ds_read_b64_tr_b16 v[194:195], v16 offset:5888
	s_waitcnt lgkmcnt(12)
	v_mfma_f32_16x16x32_bf16 v[104:107], v[200:203], a[224:227], v[104:107]
	ds_read_b64_tr_b16 v[196:197], v17 offset:768
	ds_read_b64_tr_b16 v[198:199], v17 offset:5888
	s_waitcnt lgkmcnt(12)
	v_mfma_f32_16x16x32_bf16 v[108:111], v[204:207], a[224:227], v[108:111]
	ds_read_b64_tr_b16 v[200:201], v18 offset:768
	ds_read_b64_tr_b16 v[202:203], v18 offset:5888
	s_waitcnt lgkmcnt(12)
	v_mfma_f32_16x16x32_bf16 v[112:115], v[208:211], a[224:227], v[112:115]
	ds_read_b64_tr_b16 v[204:205], v19 offset:768
	ds_read_b64_tr_b16 v[206:207], v19 offset:5888
	s_add_u32 m0, s67, 128000
	s_mov_b32 s66, 737280
	buffer_load_dwordx4 v1, s[52:55], s66 offen lds
	s_waitcnt lgkmcnt(12)
	v_mfma_f32_16x16x32_bf16 v[116:119], v[212:215], a[224:227], v[116:119]
	ds_read_b64_tr_b16 v[208:209], v20 offset:768
	ds_read_b64_tr_b16 v[210:211], v20 offset:5888
	s_waitcnt lgkmcnt(12)
	v_mfma_f32_16x16x32_bf16 v[120:123], v[216:219], a[224:227], v[120:123]
	ds_read_b64_tr_b16 v[212:213], v21 offset:768
	ds_read_b64_tr_b16 v[214:215], v21 offset:5888
	s_waitcnt lgkmcnt(12)
	v_mfma_f32_16x16x32_bf16 v[124:127], v[220:223], a[224:227], v[124:127]
	ds_read_b64_tr_b16 v[216:217], v22 offset:768
	ds_read_b64_tr_b16 v[218:219], v22 offset:5888
	s_waitcnt lgkmcnt(12)
	v_mfma_f32_16x16x32_bf16 v[128:131], v[192:195], a[224:227], v[128:131]
	ds_read_b64_tr_b16 v[220:221], v23 offset:768
	ds_read_b64_tr_b16 v[222:223], v23 offset:5888
	s_add_u32 m0, s67, 129024
	s_mov_b32 s66, 737280
	buffer_load_dwordx4 v2, s[52:55], s66 offen lds
	s_waitcnt lgkmcnt(12)
	v_mfma_f32_16x16x32_bf16 v[132:135], v[196:199], a[224:227], v[132:135]
	ds_read_b64_tr_b16 v[192:193], v16 offset:1024
	ds_read_b64_tr_b16 v[194:195], v16 offset:6144
	s_waitcnt lgkmcnt(12)
	v_mfma_f32_16x16x32_bf16 v[136:139], v[200:203], a[224:227], v[136:139]
	ds_read_b64_tr_b16 v[196:197], v17 offset:1024
	ds_read_b64_tr_b16 v[198:199], v17 offset:6144
	s_waitcnt lgkmcnt(12)
	v_mfma_f32_16x16x32_bf16 v[140:143], v[204:207], a[224:227], v[140:143]
	ds_read_b64_tr_b16 v[200:201], v18 offset:1024
	ds_read_b64_tr_b16 v[202:203], v18 offset:6144
	s_waitcnt lgkmcnt(12)
	v_mfma_f32_16x16x32_bf16 v[144:147], v[208:211], a[224:227], v[144:147]
	ds_read_b64_tr_b16 v[204:205], v19 offset:1024
	ds_read_b64_tr_b16 v[206:207], v19 offset:6144
	s_add_u32 m0, s67, 130048
	s_mov_b32 s66, 737280
	buffer_load_dwordx4 v3, s[52:55], s66 offen lds
	s_waitcnt lgkmcnt(12)
	v_mfma_f32_16x16x32_bf16 v[148:151], v[212:215], a[224:227], v[148:151]
	ds_read_b64_tr_b16 v[208:209], v20 offset:1024
	ds_read_b64_tr_b16 v[210:211], v20 offset:6144
	s_waitcnt lgkmcnt(12)
	v_mfma_f32_16x16x32_bf16 v[152:155], v[216:219], a[224:227], v[152:155]
	ds_read_b64_tr_b16 v[212:213], v21 offset:1024
	ds_read_b64_tr_b16 v[214:215], v21 offset:6144
	s_waitcnt lgkmcnt(12)
	v_mfma_f32_16x16x32_bf16 v[156:159], v[220:223], a[224:227], v[156:159]
	ds_read_b64_tr_b16 v[216:217], v22 offset:1024
	ds_read_b64_tr_b16 v[218:219], v22 offset:6144
	s_waitcnt lgkmcnt(12)
	v_mfma_f32_16x16x32_bf16 v[160:163], v[192:195], a[224:227], v[160:163]
	ds_read_b64_tr_b16 v[220:221], v23 offset:1024
	ds_read_b64_tr_b16 v[222:223], v23 offset:6144
	s_add_u32 m0, s67, 131072
	s_mov_b32 s66, 737280
	buffer_load_dwordx4 v4, s[52:55], s66 offen lds
	s_waitcnt lgkmcnt(12)
	v_mfma_f32_16x16x32_bf16 v[164:167], v[196:199], a[224:227], v[164:167]
	s_waitcnt lgkmcnt(10)
	v_mfma_f32_16x16x32_bf16 v[168:171], v[200:203], a[224:227], v[168:171]
	s_waitcnt lgkmcnt(8)
	v_mfma_f32_16x16x32_bf16 v[172:175], v[204:207], a[224:227], v[172:175]
	s_waitcnt lgkmcnt(6)
	v_mfma_f32_16x16x32_bf16 v[176:179], v[208:211], a[224:227], v[176:179]
	s_add_u32 m0, s67, 132096
	s_mov_b32 s66, 737280
	buffer_load_dwordx4 v5, s[52:55], s66 offen lds
	s_waitcnt lgkmcnt(4)
	v_mfma_f32_16x16x32_bf16 v[180:183], v[212:215], a[224:227], v[180:183]
	s_waitcnt lgkmcnt(2)
	v_mfma_f32_16x16x32_bf16 v[184:187], v[216:219], a[224:227], v[184:187]
	s_waitcnt lgkmcnt(0)
	v_mfma_f32_16x16x32_bf16 v[188:191], v[220:223], a[224:227], v[188:191]
	s_waitcnt vmcnt(20)
	s_barrier
	ds_read_b64_tr_b16 v[192:193], v16 offset:40960
	ds_read_b64_tr_b16 v[194:195], v16 offset:46080
	ds_read_b64_tr_b16 v[196:197], v17 offset:40960
	ds_read_b64_tr_b16 v[198:199], v17 offset:46080
	ds_read_b64_tr_b16 v[200:201], v18 offset:40960
	ds_read_b64_tr_b16 v[202:203], v18 offset:46080
	ds_read_b64_tr_b16 v[204:205], v19 offset:40960
	ds_read_b64_tr_b16 v[206:207], v19 offset:46080
	ds_read_b64_tr_b16 v[208:209], v20 offset:40960
	ds_read_b64_tr_b16 v[210:211], v20 offset:46080
	ds_read_b64_tr_b16 v[212:213], v21 offset:40960
	ds_read_b64_tr_b16 v[214:215], v21 offset:46080
	ds_read_b64_tr_b16 v[216:217], v22 offset:40960
	ds_read_b64_tr_b16 v[218:219], v22 offset:46080
	s_waitcnt lgkmcnt(12)
	v_mfma_f32_16x16x32_bf16 v[32:35], v[192:195], a[228:231], v[32:35]
	ds_read_b64_tr_b16 v[220:221], v23 offset:40960
	ds_read_b64_tr_b16 v[222:223], v23 offset:46080
	s_waitcnt lgkmcnt(12)
	v_mfma_f32_16x16x32_bf16 v[36:39], v[196:199], a[228:231], v[36:39]
	ds_read_b64_tr_b16 v[192:193], v16 offset:41216
	ds_read_b64_tr_b16 v[194:195], v16 offset:46336
	s_waitcnt lgkmcnt(12)
	v_mfma_f32_16x16x32_bf16 v[40:43], v[200:203], a[228:231], v[40:43]
	ds_read_b64_tr_b16 v[196:197], v17 offset:41216
	ds_read_b64_tr_b16 v[198:199], v17 offset:46336
	s_waitcnt lgkmcnt(12)
	v_mfma_f32_16x16x32_bf16 v[44:47], v[204:207], a[228:231], v[44:47]
	ds_read_b64_tr_b16 v[200:201], v18 offset:41216
	ds_read_b64_tr_b16 v[202:203], v18 offset:46336
	s_waitcnt lgkmcnt(12)
	v_mfma_f32_16x16x32_bf16 v[48:51], v[208:211], a[228:231], v[48:51]
	ds_read_b64_tr_b16 v[204:205], v19 offset:41216
	ds_read_b64_tr_b16 v[206:207], v19 offset:46336
	s_waitcnt lgkmcnt(12)
	v_mfma_f32_16x16x32_bf16 v[52:55], v[212:215], a[228:231], v[52:55]
	ds_read_b64_tr_b16 v[208:209], v20 offset:41216
	ds_read_b64_tr_b16 v[210:211], v20 offset:46336
	s_waitcnt lgkmcnt(12)
	v_mfma_f32_16x16x32_bf16 v[56:59], v[216:219], a[228:231], v[56:59]
	ds_read_b64_tr_b16 v[212:213], v21 offset:41216
	ds_read_b64_tr_b16 v[214:215], v21 offset:46336
	s_waitcnt lgkmcnt(12)
	v_mfma_f32_16x16x32_bf16 v[60:63], v[220:223], a[228:231], v[60:63]
	ds_read_b64_tr_b16 v[216:217], v22 offset:41216
	ds_read_b64_tr_b16 v[218:219], v22 offset:46336
	s_waitcnt lgkmcnt(12)
	v_mfma_f32_16x16x32_bf16 v[64:67], v[192:195], a[228:231], v[64:67]
	ds_read_b64_tr_b16 v[220:221], v23 offset:41216
	ds_read_b64_tr_b16 v[222:223], v23 offset:46336
	s_waitcnt lgkmcnt(12)
	v_mfma_f32_16x16x32_bf16 v[68:71], v[196:199], a[228:231], v[68:71]
	ds_read_b64_tr_b16 v[192:193], v16 offset:41472
	ds_read_b64_tr_b16 v[194:195], v16 offset:46592
	s_waitcnt lgkmcnt(12)
	v_mfma_f32_16x16x32_bf16 v[72:75], v[200:203], a[228:231], v[72:75]
	ds_read_b64_tr_b16 v[196:197], v17 offset:41472
	ds_read_b64_tr_b16 v[198:199], v17 offset:46592
	s_waitcnt lgkmcnt(12)
	v_mfma_f32_16x16x32_bf16 v[76:79], v[204:207], a[228:231], v[76:79]
	ds_read_b64_tr_b16 v[200:201], v18 offset:41472
	ds_read_b64_tr_b16 v[202:203], v18 offset:46592
	s_waitcnt lgkmcnt(12)
	v_mfma_f32_16x16x32_bf16 v[80:83], v[208:211], a[228:231], v[80:83]
	ds_read_b64_tr_b16 v[204:205], v19 offset:41472
	ds_read_b64_tr_b16 v[206:207], v19 offset:46592
	s_waitcnt lgkmcnt(12)
	v_mfma_f32_16x16x32_bf16 v[84:87], v[212:215], a[228:231], v[84:87]
	ds_read_b64_tr_b16 v[208:209], v20 offset:41472
	ds_read_b64_tr_b16 v[210:211], v20 offset:46592
	s_waitcnt lgkmcnt(12)
	v_mfma_f32_16x16x32_bf16 v[88:91], v[216:219], a[228:231], v[88:91]
	ds_read_b64_tr_b16 v[212:213], v21 offset:41472
	ds_read_b64_tr_b16 v[214:215], v21 offset:46592
	s_waitcnt lgkmcnt(12)
	v_mfma_f32_16x16x32_bf16 v[92:95], v[220:223], a[228:231], v[92:95]
	ds_read_b64_tr_b16 v[216:217], v22 offset:41472
	ds_read_b64_tr_b16 v[218:219], v22 offset:46592
	s_waitcnt lgkmcnt(12)
	v_mfma_f32_16x16x32_bf16 v[96:99], v[192:195], a[228:231], v[96:99]
	ds_read_b64_tr_b16 v[220:221], v23 offset:41472
	ds_read_b64_tr_b16 v[222:223], v23 offset:46592
	s_waitcnt lgkmcnt(12)
	v_mfma_f32_16x16x32_bf16 v[100:103], v[196:199], a[228:231], v[100:103]
	ds_read_b64_tr_b16 v[192:193], v16 offset:41728
	ds_read_b64_tr_b16 v[194:195], v16 offset:46848
	s_waitcnt lgkmcnt(12)
	v_mfma_f32_16x16x32_bf16 v[104:107], v[200:203], a[228:231], v[104:107]
	ds_read_b64_tr_b16 v[196:197], v17 offset:41728
	ds_read_b64_tr_b16 v[198:199], v17 offset:46848
	s_waitcnt lgkmcnt(12)
	v_mfma_f32_16x16x32_bf16 v[108:111], v[204:207], a[228:231], v[108:111]
	ds_read_b64_tr_b16 v[200:201], v18 offset:41728
	ds_read_b64_tr_b16 v[202:203], v18 offset:46848
	s_waitcnt lgkmcnt(12)
	v_mfma_f32_16x16x32_bf16 v[112:115], v[208:211], a[228:231], v[112:115]
	ds_read_b64_tr_b16 v[204:205], v19 offset:41728
	ds_read_b64_tr_b16 v[206:207], v19 offset:46848
	s_waitcnt lgkmcnt(12)
	v_mfma_f32_16x16x32_bf16 v[116:119], v[212:215], a[228:231], v[116:119]
	ds_read_b64_tr_b16 v[208:209], v20 offset:41728
	ds_read_b64_tr_b16 v[210:211], v20 offset:46848
	s_waitcnt lgkmcnt(12)
	v_mfma_f32_16x16x32_bf16 v[120:123], v[216:219], a[228:231], v[120:123]
	ds_read_b64_tr_b16 v[212:213], v21 offset:41728
	ds_read_b64_tr_b16 v[214:215], v21 offset:46848
	s_waitcnt lgkmcnt(12)
	v_mfma_f32_16x16x32_bf16 v[124:127], v[220:223], a[228:231], v[124:127]
	ds_read_b64_tr_b16 v[216:217], v22 offset:41728
	ds_read_b64_tr_b16 v[218:219], v22 offset:46848
	s_waitcnt lgkmcnt(12)
	v_mfma_f32_16x16x32_bf16 v[128:131], v[192:195], a[228:231], v[128:131]
	ds_read_b64_tr_b16 v[220:221], v23 offset:41728
	ds_read_b64_tr_b16 v[222:223], v23 offset:46848
	s_waitcnt lgkmcnt(12)
	v_mfma_f32_16x16x32_bf16 v[132:135], v[196:199], a[228:231], v[132:135]
	ds_read_b64_tr_b16 v[192:193], v16 offset:41984
	ds_read_b64_tr_b16 v[194:195], v16 offset:47104
	s_waitcnt lgkmcnt(12)
	v_mfma_f32_16x16x32_bf16 v[136:139], v[200:203], a[228:231], v[136:139]
	ds_read_b64_tr_b16 v[196:197], v17 offset:41984
	ds_read_b64_tr_b16 v[198:199], v17 offset:47104
	s_waitcnt lgkmcnt(12)
	v_mfma_f32_16x16x32_bf16 v[140:143], v[204:207], a[228:231], v[140:143]
	ds_read_b64_tr_b16 v[200:201], v18 offset:41984
	ds_read_b64_tr_b16 v[202:203], v18 offset:47104
	s_waitcnt lgkmcnt(12)
	v_mfma_f32_16x16x32_bf16 v[144:147], v[208:211], a[228:231], v[144:147]
	ds_read_b64_tr_b16 v[204:205], v19 offset:41984
	ds_read_b64_tr_b16 v[206:207], v19 offset:47104
	s_waitcnt lgkmcnt(12)
	v_mfma_f32_16x16x32_bf16 v[148:151], v[212:215], a[228:231], v[148:151]
	ds_read_b64_tr_b16 v[208:209], v20 offset:41984
	ds_read_b64_tr_b16 v[210:211], v20 offset:47104
	s_waitcnt lgkmcnt(12)
	v_mfma_f32_16x16x32_bf16 v[152:155], v[216:219], a[228:231], v[152:155]
	ds_read_b64_tr_b16 v[212:213], v21 offset:41984
	ds_read_b64_tr_b16 v[214:215], v21 offset:47104
	s_waitcnt lgkmcnt(12)
	v_mfma_f32_16x16x32_bf16 v[156:159], v[220:223], a[228:231], v[156:159]
	ds_read_b64_tr_b16 v[216:217], v22 offset:41984
	ds_read_b64_tr_b16 v[218:219], v22 offset:47104
	s_waitcnt lgkmcnt(12)
	v_mfma_f32_16x16x32_bf16 v[160:163], v[192:195], a[228:231], v[160:163]
	ds_read_b64_tr_b16 v[220:221], v23 offset:41984
	ds_read_b64_tr_b16 v[222:223], v23 offset:47104
	s_waitcnt lgkmcnt(12)
	v_mfma_f32_16x16x32_bf16 v[164:167], v[196:199], a[228:231], v[164:167]
	s_waitcnt lgkmcnt(10)
	v_mfma_f32_16x16x32_bf16 v[168:171], v[200:203], a[228:231], v[168:171]
	s_waitcnt lgkmcnt(8)
	v_mfma_f32_16x16x32_bf16 v[172:175], v[204:207], a[228:231], v[172:175]
	s_waitcnt lgkmcnt(6)
	v_mfma_f32_16x16x32_bf16 v[176:179], v[208:211], a[228:231], v[176:179]
	s_waitcnt lgkmcnt(4)
	v_mfma_f32_16x16x32_bf16 v[180:183], v[212:215], a[228:231], v[180:183]
	s_waitcnt lgkmcnt(2)
	v_mfma_f32_16x16x32_bf16 v[184:187], v[216:219], a[228:231], v[184:187]
	s_waitcnt lgkmcnt(0)
	v_mfma_f32_16x16x32_bf16 v[188:191], v[220:223], a[228:231], v[188:191]
	s_waitcnt vmcnt(10)
	s_barrier
	ds_read_b64_tr_b16 v[192:193], v24 offset:0
	ds_read_b64_tr_b16 v[194:195], v24 offset:5120
	ds_read_b64_tr_b16 v[196:197], v25 offset:0
	ds_read_b64_tr_b16 v[198:199], v25 offset:5120
	ds_read_b64_tr_b16 v[200:201], v26 offset:0
	ds_read_b64_tr_b16 v[202:203], v26 offset:5120
	ds_read_b64_tr_b16 v[204:205], v27 offset:0
	ds_read_b64_tr_b16 v[206:207], v27 offset:5120
	ds_read_b64_tr_b16 v[208:209], v28 offset:0
	ds_read_b64_tr_b16 v[210:211], v28 offset:5120
	ds_read_b64_tr_b16 v[212:213], v29 offset:0
	ds_read_b64_tr_b16 v[214:215], v29 offset:5120
	ds_read_b64_tr_b16 v[216:217], v30 offset:0
	ds_read_b64_tr_b16 v[218:219], v30 offset:5120
	s_waitcnt lgkmcnt(12)
	v_mfma_f32_16x16x32_bf16 v[32:35], v[192:195], a[232:235], v[32:35]
	ds_read_b64_tr_b16 v[220:221], v31 offset:0
	ds_read_b64_tr_b16 v[222:223], v31 offset:5120
	s_waitcnt lgkmcnt(12)
	v_mfma_f32_16x16x32_bf16 v[36:39], v[196:199], a[232:235], v[36:39]
	ds_read_b64_tr_b16 v[192:193], v24 offset:256
	ds_read_b64_tr_b16 v[194:195], v24 offset:5376
	s_waitcnt lgkmcnt(12)
	v_mfma_f32_16x16x32_bf16 v[40:43], v[200:203], a[232:235], v[40:43]
	ds_read_b64_tr_b16 v[196:197], v25 offset:256
	ds_read_b64_tr_b16 v[198:199], v25 offset:5376
	s_waitcnt lgkmcnt(12)
	v_mfma_f32_16x16x32_bf16 v[44:47], v[204:207], a[232:235], v[44:47]
	ds_read_b64_tr_b16 v[200:201], v26 offset:256
	ds_read_b64_tr_b16 v[202:203], v26 offset:5376
	s_waitcnt lgkmcnt(12)
	v_mfma_f32_16x16x32_bf16 v[48:51], v[208:211], a[232:235], v[48:51]
	ds_read_b64_tr_b16 v[204:205], v27 offset:256
	ds_read_b64_tr_b16 v[206:207], v27 offset:5376
	s_waitcnt lgkmcnt(12)
	v_mfma_f32_16x16x32_bf16 v[52:55], v[212:215], a[232:235], v[52:55]
	ds_read_b64_tr_b16 v[208:209], v28 offset:256
	ds_read_b64_tr_b16 v[210:211], v28 offset:5376
	s_waitcnt lgkmcnt(12)
	v_mfma_f32_16x16x32_bf16 v[56:59], v[216:219], a[232:235], v[56:59]
	ds_read_b64_tr_b16 v[212:213], v29 offset:256
	ds_read_b64_tr_b16 v[214:215], v29 offset:5376
	s_waitcnt lgkmcnt(12)
	v_mfma_f32_16x16x32_bf16 v[60:63], v[220:223], a[232:235], v[60:63]
	ds_read_b64_tr_b16 v[216:217], v30 offset:256
	ds_read_b64_tr_b16 v[218:219], v30 offset:5376
	s_waitcnt lgkmcnt(12)
	v_mfma_f32_16x16x32_bf16 v[64:67], v[192:195], a[232:235], v[64:67]
	ds_read_b64_tr_b16 v[220:221], v31 offset:256
	ds_read_b64_tr_b16 v[222:223], v31 offset:5376
	s_waitcnt lgkmcnt(12)
	v_mfma_f32_16x16x32_bf16 v[68:71], v[196:199], a[232:235], v[68:71]
	ds_read_b64_tr_b16 v[192:193], v24 offset:512
	ds_read_b64_tr_b16 v[194:195], v24 offset:5632
	s_waitcnt lgkmcnt(12)
	v_mfma_f32_16x16x32_bf16 v[72:75], v[200:203], a[232:235], v[72:75]
	ds_read_b64_tr_b16 v[196:197], v25 offset:512
	ds_read_b64_tr_b16 v[198:199], v25 offset:5632
	s_waitcnt lgkmcnt(12)
	v_mfma_f32_16x16x32_bf16 v[76:79], v[204:207], a[232:235], v[76:79]
	ds_read_b64_tr_b16 v[200:201], v26 offset:512
	ds_read_b64_tr_b16 v[202:203], v26 offset:5632
	s_waitcnt lgkmcnt(12)
	v_mfma_f32_16x16x32_bf16 v[80:83], v[208:211], a[232:235], v[80:83]
	ds_read_b64_tr_b16 v[204:205], v27 offset:512
	ds_read_b64_tr_b16 v[206:207], v27 offset:5632
	s_waitcnt lgkmcnt(12)
	v_mfma_f32_16x16x32_bf16 v[84:87], v[212:215], a[232:235], v[84:87]
	ds_read_b64_tr_b16 v[208:209], v28 offset:512
	ds_read_b64_tr_b16 v[210:211], v28 offset:5632
	s_waitcnt lgkmcnt(12)
	v_mfma_f32_16x16x32_bf16 v[88:91], v[216:219], a[232:235], v[88:91]
	ds_read_b64_tr_b16 v[212:213], v29 offset:512
	ds_read_b64_tr_b16 v[214:215], v29 offset:5632
	s_waitcnt lgkmcnt(12)
	v_mfma_f32_16x16x32_bf16 v[92:95], v[220:223], a[232:235], v[92:95]
	ds_read_b64_tr_b16 v[216:217], v30 offset:512
	ds_read_b64_tr_b16 v[218:219], v30 offset:5632
	s_waitcnt lgkmcnt(12)
	v_mfma_f32_16x16x32_bf16 v[96:99], v[192:195], a[232:235], v[96:99]
	ds_read_b64_tr_b16 v[220:221], v31 offset:512
	ds_read_b64_tr_b16 v[222:223], v31 offset:5632
	s_waitcnt lgkmcnt(12)
	v_mfma_f32_16x16x32_bf16 v[100:103], v[196:199], a[232:235], v[100:103]
	ds_read_b64_tr_b16 v[192:193], v24 offset:768
	ds_read_b64_tr_b16 v[194:195], v24 offset:5888
	s_waitcnt lgkmcnt(12)
	v_mfma_f32_16x16x32_bf16 v[104:107], v[200:203], a[232:235], v[104:107]
	ds_read_b64_tr_b16 v[196:197], v25 offset:768
	ds_read_b64_tr_b16 v[198:199], v25 offset:5888
	s_waitcnt lgkmcnt(12)
	v_mfma_f32_16x16x32_bf16 v[108:111], v[204:207], a[232:235], v[108:111]
	ds_read_b64_tr_b16 v[200:201], v26 offset:768
	ds_read_b64_tr_b16 v[202:203], v26 offset:5888
	s_waitcnt lgkmcnt(12)
	v_mfma_f32_16x16x32_bf16 v[112:115], v[208:211], a[232:235], v[112:115]
	ds_read_b64_tr_b16 v[204:205], v27 offset:768
	ds_read_b64_tr_b16 v[206:207], v27 offset:5888
	s_waitcnt lgkmcnt(12)
	v_mfma_f32_16x16x32_bf16 v[116:119], v[212:215], a[232:235], v[116:119]
	ds_read_b64_tr_b16 v[208:209], v28 offset:768
	ds_read_b64_tr_b16 v[210:211], v28 offset:5888
	s_waitcnt lgkmcnt(12)
	v_mfma_f32_16x16x32_bf16 v[120:123], v[216:219], a[232:235], v[120:123]
	ds_read_b64_tr_b16 v[212:213], v29 offset:768
	ds_read_b64_tr_b16 v[214:215], v29 offset:5888
	s_waitcnt lgkmcnt(12)
	v_mfma_f32_16x16x32_bf16 v[124:127], v[220:223], a[232:235], v[124:127]
	ds_read_b64_tr_b16 v[216:217], v30 offset:768
	ds_read_b64_tr_b16 v[218:219], v30 offset:5888
	s_waitcnt lgkmcnt(12)
	v_mfma_f32_16x16x32_bf16 v[128:131], v[192:195], a[232:235], v[128:131]
	ds_read_b64_tr_b16 v[220:221], v31 offset:768
	ds_read_b64_tr_b16 v[222:223], v31 offset:5888
	s_waitcnt lgkmcnt(12)
	v_mfma_f32_16x16x32_bf16 v[132:135], v[196:199], a[232:235], v[132:135]
	ds_read_b64_tr_b16 v[192:193], v24 offset:1024
	ds_read_b64_tr_b16 v[194:195], v24 offset:6144
	s_waitcnt lgkmcnt(12)
	v_mfma_f32_16x16x32_bf16 v[136:139], v[200:203], a[232:235], v[136:139]
	ds_read_b64_tr_b16 v[196:197], v25 offset:1024
	ds_read_b64_tr_b16 v[198:199], v25 offset:6144
	s_waitcnt lgkmcnt(12)
	v_mfma_f32_16x16x32_bf16 v[140:143], v[204:207], a[232:235], v[140:143]
	ds_read_b64_tr_b16 v[200:201], v26 offset:1024
	ds_read_b64_tr_b16 v[202:203], v26 offset:6144
	s_waitcnt lgkmcnt(12)
	v_mfma_f32_16x16x32_bf16 v[144:147], v[208:211], a[232:235], v[144:147]
	ds_read_b64_tr_b16 v[204:205], v27 offset:1024
	ds_read_b64_tr_b16 v[206:207], v27 offset:6144
	s_waitcnt lgkmcnt(12)
	v_mfma_f32_16x16x32_bf16 v[148:151], v[212:215], a[232:235], v[148:151]
	ds_read_b64_tr_b16 v[208:209], v28 offset:1024
	ds_read_b64_tr_b16 v[210:211], v28 offset:6144
	s_waitcnt lgkmcnt(12)
	v_mfma_f32_16x16x32_bf16 v[152:155], v[216:219], a[232:235], v[152:155]
	ds_read_b64_tr_b16 v[212:213], v29 offset:1024
	ds_read_b64_tr_b16 v[214:215], v29 offset:6144
	s_waitcnt lgkmcnt(12)
	v_mfma_f32_16x16x32_bf16 v[156:159], v[220:223], a[232:235], v[156:159]
	ds_read_b64_tr_b16 v[216:217], v30 offset:1024
	ds_read_b64_tr_b16 v[218:219], v30 offset:6144
	s_waitcnt lgkmcnt(12)
	v_mfma_f32_16x16x32_bf16 v[160:163], v[192:195], a[232:235], v[160:163]
	ds_read_b64_tr_b16 v[220:221], v31 offset:1024
	ds_read_b64_tr_b16 v[222:223], v31 offset:6144
	s_waitcnt lgkmcnt(12)
	v_mfma_f32_16x16x32_bf16 v[164:167], v[196:199], a[232:235], v[164:167]
	s_waitcnt lgkmcnt(10)
	v_mfma_f32_16x16x32_bf16 v[168:171], v[200:203], a[232:235], v[168:171]
	s_waitcnt lgkmcnt(8)
	v_mfma_f32_16x16x32_bf16 v[172:175], v[204:207], a[232:235], v[172:175]
	s_waitcnt lgkmcnt(6)
	v_mfma_f32_16x16x32_bf16 v[176:179], v[208:211], a[232:235], v[176:179]
	s_waitcnt lgkmcnt(4)
	v_mfma_f32_16x16x32_bf16 v[180:183], v[212:215], a[232:235], v[180:183]
	s_waitcnt lgkmcnt(2)
	v_mfma_f32_16x16x32_bf16 v[184:187], v[216:219], a[232:235], v[184:187]
	s_waitcnt lgkmcnt(0)
	v_mfma_f32_16x16x32_bf16 v[188:191], v[220:223], a[232:235], v[188:191]
	s_waitcnt vmcnt(0)
	s_barrier
	ds_read_b64_tr_b16 v[192:193], v24 offset:40960
	ds_read_b64_tr_b16 v[194:195], v24 offset:46080
	ds_read_b64_tr_b16 v[196:197], v25 offset:40960
	ds_read_b64_tr_b16 v[198:199], v25 offset:46080
	ds_read_b64_tr_b16 v[200:201], v26 offset:40960
	ds_read_b64_tr_b16 v[202:203], v26 offset:46080
	ds_read_b64_tr_b16 v[204:205], v27 offset:40960
	ds_read_b64_tr_b16 v[206:207], v27 offset:46080
	ds_read_b64_tr_b16 v[208:209], v28 offset:40960
	ds_read_b64_tr_b16 v[210:211], v28 offset:46080
	ds_read_b64_tr_b16 v[212:213], v29 offset:40960
	ds_read_b64_tr_b16 v[214:215], v29 offset:46080
	ds_read_b64_tr_b16 v[216:217], v30 offset:40960
	ds_read_b64_tr_b16 v[218:219], v30 offset:46080
	s_waitcnt lgkmcnt(12)
	v_mfma_f32_16x16x32_bf16 v[32:35], v[192:195], a[236:239], v[32:35]
	ds_read_b64_tr_b16 v[220:221], v31 offset:40960
	ds_read_b64_tr_b16 v[222:223], v31 offset:46080
	s_waitcnt lgkmcnt(12)
	v_mfma_f32_16x16x32_bf16 v[36:39], v[196:199], a[236:239], v[36:39]
	ds_read_b64_tr_b16 v[192:193], v24 offset:41216
	ds_read_b64_tr_b16 v[194:195], v24 offset:46336
	s_waitcnt lgkmcnt(12)
	v_mfma_f32_16x16x32_bf16 v[40:43], v[200:203], a[236:239], v[40:43]
	ds_read_b64_tr_b16 v[196:197], v25 offset:41216
	ds_read_b64_tr_b16 v[198:199], v25 offset:46336
	s_waitcnt lgkmcnt(12)
	v_mfma_f32_16x16x32_bf16 v[44:47], v[204:207], a[236:239], v[44:47]
	ds_read_b64_tr_b16 v[200:201], v26 offset:41216
	ds_read_b64_tr_b16 v[202:203], v26 offset:46336
	s_waitcnt lgkmcnt(12)
	v_mfma_f32_16x16x32_bf16 v[48:51], v[208:211], a[236:239], v[48:51]
	ds_read_b64_tr_b16 v[204:205], v27 offset:41216
	ds_read_b64_tr_b16 v[206:207], v27 offset:46336
	s_waitcnt lgkmcnt(12)
	v_mfma_f32_16x16x32_bf16 v[52:55], v[212:215], a[236:239], v[52:55]
	ds_read_b64_tr_b16 v[208:209], v28 offset:41216
	ds_read_b64_tr_b16 v[210:211], v28 offset:46336
	s_waitcnt lgkmcnt(12)
	v_mfma_f32_16x16x32_bf16 v[56:59], v[216:219], a[236:239], v[56:59]
	ds_read_b64_tr_b16 v[212:213], v29 offset:41216
	ds_read_b64_tr_b16 v[214:215], v29 offset:46336
	s_waitcnt lgkmcnt(12)
	v_mfma_f32_16x16x32_bf16 v[60:63], v[220:223], a[236:239], v[60:63]
	ds_read_b64_tr_b16 v[216:217], v30 offset:41216
	ds_read_b64_tr_b16 v[218:219], v30 offset:46336
	s_waitcnt lgkmcnt(12)
	v_mfma_f32_16x16x32_bf16 v[64:67], v[192:195], a[236:239], v[64:67]
	ds_read_b64_tr_b16 v[220:221], v31 offset:41216
	ds_read_b64_tr_b16 v[222:223], v31 offset:46336
	s_waitcnt lgkmcnt(12)
	v_mfma_f32_16x16x32_bf16 v[68:71], v[196:199], a[236:239], v[68:71]
	ds_read_b64_tr_b16 v[192:193], v24 offset:41472
	ds_read_b64_tr_b16 v[194:195], v24 offset:46592
	s_waitcnt lgkmcnt(12)
	v_mfma_f32_16x16x32_bf16 v[72:75], v[200:203], a[236:239], v[72:75]
	ds_read_b64_tr_b16 v[196:197], v25 offset:41472
	ds_read_b64_tr_b16 v[198:199], v25 offset:46592
	s_waitcnt lgkmcnt(12)
	v_mfma_f32_16x16x32_bf16 v[76:79], v[204:207], a[236:239], v[76:79]
	ds_read_b64_tr_b16 v[200:201], v26 offset:41472
	ds_read_b64_tr_b16 v[202:203], v26 offset:46592
	s_waitcnt lgkmcnt(12)
	v_mfma_f32_16x16x32_bf16 v[80:83], v[208:211], a[236:239], v[80:83]
	ds_read_b64_tr_b16 v[204:205], v27 offset:41472
	ds_read_b64_tr_b16 v[206:207], v27 offset:46592
	s_waitcnt lgkmcnt(12)
	v_mfma_f32_16x16x32_bf16 v[84:87], v[212:215], a[236:239], v[84:87]
	ds_read_b64_tr_b16 v[208:209], v28 offset:41472
	ds_read_b64_tr_b16 v[210:211], v28 offset:46592
	s_waitcnt lgkmcnt(12)
	v_mfma_f32_16x16x32_bf16 v[88:91], v[216:219], a[236:239], v[88:91]
	ds_read_b64_tr_b16 v[212:213], v29 offset:41472
	ds_read_b64_tr_b16 v[214:215], v29 offset:46592
	s_waitcnt lgkmcnt(12)
	v_mfma_f32_16x16x32_bf16 v[92:95], v[220:223], a[236:239], v[92:95]
	ds_read_b64_tr_b16 v[216:217], v30 offset:41472
	ds_read_b64_tr_b16 v[218:219], v30 offset:46592
	s_waitcnt lgkmcnt(12)
	v_mfma_f32_16x16x32_bf16 v[96:99], v[192:195], a[236:239], v[96:99]
	ds_read_b64_tr_b16 v[220:221], v31 offset:41472
	ds_read_b64_tr_b16 v[222:223], v31 offset:46592
	s_waitcnt lgkmcnt(12)
	v_mfma_f32_16x16x32_bf16 v[100:103], v[196:199], a[236:239], v[100:103]
	ds_read_b64_tr_b16 v[192:193], v24 offset:41728
	ds_read_b64_tr_b16 v[194:195], v24 offset:46848
	s_waitcnt lgkmcnt(12)
	v_mfma_f32_16x16x32_bf16 v[104:107], v[200:203], a[236:239], v[104:107]
	ds_read_b64_tr_b16 v[196:197], v25 offset:41728
	ds_read_b64_tr_b16 v[198:199], v25 offset:46848
	s_waitcnt lgkmcnt(12)
	v_mfma_f32_16x16x32_bf16 v[108:111], v[204:207], a[236:239], v[108:111]
	ds_read_b64_tr_b16 v[200:201], v26 offset:41728
	ds_read_b64_tr_b16 v[202:203], v26 offset:46848
	s_waitcnt lgkmcnt(12)
	v_mfma_f32_16x16x32_bf16 v[112:115], v[208:211], a[236:239], v[112:115]
	ds_read_b64_tr_b16 v[204:205], v27 offset:41728
	ds_read_b64_tr_b16 v[206:207], v27 offset:46848
	s_waitcnt lgkmcnt(12)
	v_mfma_f32_16x16x32_bf16 v[116:119], v[212:215], a[236:239], v[116:119]
	ds_read_b64_tr_b16 v[208:209], v28 offset:41728
	ds_read_b64_tr_b16 v[210:211], v28 offset:46848
	s_waitcnt lgkmcnt(12)
	v_mfma_f32_16x16x32_bf16 v[120:123], v[216:219], a[236:239], v[120:123]
	ds_read_b64_tr_b16 v[212:213], v29 offset:41728
	ds_read_b64_tr_b16 v[214:215], v29 offset:46848
	s_waitcnt lgkmcnt(12)
	v_mfma_f32_16x16x32_bf16 v[124:127], v[220:223], a[236:239], v[124:127]
	ds_read_b64_tr_b16 v[216:217], v30 offset:41728
	ds_read_b64_tr_b16 v[218:219], v30 offset:46848
	s_waitcnt lgkmcnt(12)
	v_mfma_f32_16x16x32_bf16 v[128:131], v[192:195], a[236:239], v[128:131]
	ds_read_b64_tr_b16 v[220:221], v31 offset:41728
	ds_read_b64_tr_b16 v[222:223], v31 offset:46848
	s_waitcnt lgkmcnt(12)
	v_mfma_f32_16x16x32_bf16 v[132:135], v[196:199], a[236:239], v[132:135]
	ds_read_b64_tr_b16 v[192:193], v24 offset:41984
	ds_read_b64_tr_b16 v[194:195], v24 offset:47104
	s_waitcnt lgkmcnt(12)
	v_mfma_f32_16x16x32_bf16 v[136:139], v[200:203], a[236:239], v[136:139]
	ds_read_b64_tr_b16 v[196:197], v25 offset:41984
	ds_read_b64_tr_b16 v[198:199], v25 offset:47104
	s_waitcnt lgkmcnt(12)
	v_mfma_f32_16x16x32_bf16 v[140:143], v[204:207], a[236:239], v[140:143]
	ds_read_b64_tr_b16 v[200:201], v26 offset:41984
	ds_read_b64_tr_b16 v[202:203], v26 offset:47104
	s_waitcnt lgkmcnt(12)
	v_mfma_f32_16x16x32_bf16 v[144:147], v[208:211], a[236:239], v[144:147]
	ds_read_b64_tr_b16 v[204:205], v27 offset:41984
	ds_read_b64_tr_b16 v[206:207], v27 offset:47104
	s_waitcnt lgkmcnt(12)
	v_mfma_f32_16x16x32_bf16 v[148:151], v[212:215], a[236:239], v[148:151]
	ds_read_b64_tr_b16 v[208:209], v28 offset:41984
	ds_read_b64_tr_b16 v[210:211], v28 offset:47104
	s_waitcnt lgkmcnt(12)
	v_mfma_f32_16x16x32_bf16 v[152:155], v[216:219], a[236:239], v[152:155]
	ds_read_b64_tr_b16 v[212:213], v29 offset:41984
	ds_read_b64_tr_b16 v[214:215], v29 offset:47104
	s_waitcnt lgkmcnt(12)
	v_mfma_f32_16x16x32_bf16 v[156:159], v[220:223], a[236:239], v[156:159]
	ds_read_b64_tr_b16 v[216:217], v30 offset:41984
	ds_read_b64_tr_b16 v[218:219], v30 offset:47104
	s_waitcnt lgkmcnt(12)
	v_mfma_f32_16x16x32_bf16 v[160:163], v[192:195], a[236:239], v[160:163]
	ds_read_b64_tr_b16 v[220:221], v31 offset:41984
	ds_read_b64_tr_b16 v[222:223], v31 offset:47104
	s_waitcnt lgkmcnt(12)
	v_mfma_f32_16x16x32_bf16 v[164:167], v[196:199], a[236:239], v[164:167]
	s_waitcnt lgkmcnt(10)
	v_mfma_f32_16x16x32_bf16 v[168:171], v[200:203], a[236:239], v[168:171]
	s_waitcnt lgkmcnt(8)
	v_mfma_f32_16x16x32_bf16 v[172:175], v[204:207], a[236:239], v[172:175]
	s_waitcnt lgkmcnt(6)
	v_mfma_f32_16x16x32_bf16 v[176:179], v[208:211], a[236:239], v[176:179]
	s_waitcnt lgkmcnt(4)
	v_mfma_f32_16x16x32_bf16 v[180:183], v[212:215], a[236:239], v[180:183]
	s_waitcnt lgkmcnt(2)
	v_mfma_f32_16x16x32_bf16 v[184:187], v[216:219], a[236:239], v[184:187]
	s_waitcnt lgkmcnt(0)
	v_mfma_f32_16x16x32_bf16 v[188:191], v[220:223], a[236:239], v[188:191]
	v_cvt_pk_bf16_f32 v32, v32, v33
	v_cvt_pk_bf16_f32 v33, v34, v35
	buffer_store_dwordx2 v[32:33], v10, s[56:59], 0 offen offset:0 nt
	v_cvt_pk_bf16_f32 v36, v36, v37
	v_cvt_pk_bf16_f32 v37, v38, v39
	buffer_store_dwordx2 v[36:37], v10, s[56:59], 0 offen offset:32 nt
	v_cvt_pk_bf16_f32 v40, v40, v41
	v_cvt_pk_bf16_f32 v41, v42, v43
	buffer_store_dwordx2 v[40:41], v10, s[56:59], 0 offen offset:64 nt
	v_cvt_pk_bf16_f32 v44, v44, v45
	v_cvt_pk_bf16_f32 v45, v46, v47
	buffer_store_dwordx2 v[44:45], v10, s[56:59], 0 offen offset:96 nt
	v_cvt_pk_bf16_f32 v48, v48, v49
	v_cvt_pk_bf16_f32 v49, v50, v51
	buffer_store_dwordx2 v[48:49], v10, s[56:59], 0 offen offset:128 nt
	v_cvt_pk_bf16_f32 v52, v52, v53
	v_cvt_pk_bf16_f32 v53, v54, v55
	buffer_store_dwordx2 v[52:53], v10, s[56:59], 0 offen offset:160 nt
	v_cvt_pk_bf16_f32 v56, v56, v57
	v_cvt_pk_bf16_f32 v57, v58, v59
	buffer_store_dwordx2 v[56:57], v10, s[56:59], 0 offen offset:192 nt
	v_cvt_pk_bf16_f32 v60, v60, v61
	v_cvt_pk_bf16_f32 v61, v62, v63
	buffer_store_dwordx2 v[60:61], v10, s[56:59], 0 offen offset:224 nt
	v_cvt_pk_bf16_f32 v64, v64, v65
	v_cvt_pk_bf16_f32 v65, v66, v67
	buffer_store_dwordx2 v[64:65], v10, s[56:59], 0 offen offset:256 nt
	v_cvt_pk_bf16_f32 v68, v68, v69
	v_cvt_pk_bf16_f32 v69, v70, v71
	buffer_store_dwordx2 v[68:69], v10, s[56:59], 0 offen offset:288 nt
	v_cvt_pk_bf16_f32 v72, v72, v73
	v_cvt_pk_bf16_f32 v73, v74, v75
	buffer_store_dwordx2 v[72:73], v10, s[56:59], 0 offen offset:320 nt
	v_cvt_pk_bf16_f32 v76, v76, v77
	v_cvt_pk_bf16_f32 v77, v78, v79
	buffer_store_dwordx2 v[76:77], v10, s[56:59], 0 offen offset:352 nt
	v_cvt_pk_bf16_f32 v80, v80, v81
	v_cvt_pk_bf16_f32 v81, v82, v83
	buffer_store_dwordx2 v[80:81], v10, s[56:59], 0 offen offset:384 nt
	v_cvt_pk_bf16_f32 v84, v84, v85
	v_cvt_pk_bf16_f32 v85, v86, v87
	buffer_store_dwordx2 v[84:85], v10, s[56:59], 0 offen offset:416 nt
	v_cvt_pk_bf16_f32 v88, v88, v89
	v_cvt_pk_bf16_f32 v89, v90, v91
	buffer_store_dwordx2 v[88:89], v10, s[56:59], 0 offen offset:448 nt
	v_cvt_pk_bf16_f32 v92, v92, v93
	v_cvt_pk_bf16_f32 v93, v94, v95
	buffer_store_dwordx2 v[92:93], v10, s[56:59], 0 offen offset:480 nt
	v_cvt_pk_bf16_f32 v96, v96, v97
	v_cvt_pk_bf16_f32 v97, v98, v99
	buffer_store_dwordx2 v[96:97], v10, s[56:59], 0 offen offset:512 nt
	v_cvt_pk_bf16_f32 v100, v100, v101
	v_cvt_pk_bf16_f32 v101, v102, v103
	buffer_store_dwordx2 v[100:101], v10, s[56:59], 0 offen offset:544 nt
	v_cvt_pk_bf16_f32 v104, v104, v105
	v_cvt_pk_bf16_f32 v105, v106, v107
	buffer_store_dwordx2 v[104:105], v10, s[56:59], 0 offen offset:576 nt
	v_cvt_pk_bf16_f32 v108, v108, v109
	v_cvt_pk_bf16_f32 v109, v110, v111
	buffer_store_dwordx2 v[108:109], v10, s[56:59], 0 offen offset:608 nt
	v_cvt_pk_bf16_f32 v112, v112, v113
	v_cvt_pk_bf16_f32 v113, v114, v115
	buffer_store_dwordx2 v[112:113], v10, s[56:59], 0 offen offset:640 nt
	v_cvt_pk_bf16_f32 v116, v116, v117
	v_cvt_pk_bf16_f32 v117, v118, v119
	buffer_store_dwordx2 v[116:117], v10, s[56:59], 0 offen offset:672 nt
	v_cvt_pk_bf16_f32 v120, v120, v121
	v_cvt_pk_bf16_f32 v121, v122, v123
	buffer_store_dwordx2 v[120:121], v10, s[56:59], 0 offen offset:704 nt
	v_cvt_pk_bf16_f32 v124, v124, v125
	v_cvt_pk_bf16_f32 v125, v126, v127
	buffer_store_dwordx2 v[124:125], v10, s[56:59], 0 offen offset:736 nt
	v_cvt_pk_bf16_f32 v128, v128, v129
	v_cvt_pk_bf16_f32 v129, v130, v131
	buffer_store_dwordx2 v[128:129], v10, s[56:59], 0 offen offset:768 nt
	v_cvt_pk_bf16_f32 v132, v132, v133
	v_cvt_pk_bf16_f32 v133, v134, v135
	buffer_store_dwordx2 v[132:133], v10, s[56:59], 0 offen offset:800 nt
	v_cvt_pk_bf16_f32 v136, v136, v137
	v_cvt_pk_bf16_f32 v137, v138, v139
	buffer_store_dwordx2 v[136:137], v10, s[56:59], 0 offen offset:832 nt
	v_cvt_pk_bf16_f32 v140, v140, v141
	v_cvt_pk_bf16_f32 v141, v142, v143
	buffer_store_dwordx2 v[140:141], v10, s[56:59], 0 offen offset:864 nt
	v_cvt_pk_bf16_f32 v144, v144, v145
	v_cvt_pk_bf16_f32 v145, v146, v147
	buffer_store_dwordx2 v[144:145], v10, s[56:59], 0 offen offset:896 nt
	v_cvt_pk_bf16_f32 v148, v148, v149
	v_cvt_pk_bf16_f32 v149, v150, v151
	buffer_store_dwordx2 v[148:149], v10, s[56:59], 0 offen offset:928 nt
	v_cvt_pk_bf16_f32 v152, v152, v153
	v_cvt_pk_bf16_f32 v153, v154, v155
	buffer_store_dwordx2 v[152:153], v10, s[56:59], 0 offen offset:960 nt
	v_cvt_pk_bf16_f32 v156, v156, v157
	v_cvt_pk_bf16_f32 v157, v158, v159
	buffer_store_dwordx2 v[156:157], v10, s[56:59], 0 offen offset:992 nt
	v_cvt_pk_bf16_f32 v160, v160, v161
	v_cvt_pk_bf16_f32 v161, v162, v163
	buffer_store_dwordx2 v[160:161], v10, s[56:59], 0 offen offset:1024 nt
	v_cvt_pk_bf16_f32 v164, v164, v165
	v_cvt_pk_bf16_f32 v165, v166, v167
	buffer_store_dwordx2 v[164:165], v10, s[56:59], 0 offen offset:1056 nt
	v_cvt_pk_bf16_f32 v168, v168, v169
	v_cvt_pk_bf16_f32 v169, v170, v171
	buffer_store_dwordx2 v[168:169], v10, s[56:59], 0 offen offset:1088 nt
	v_cvt_pk_bf16_f32 v172, v172, v173
	v_cvt_pk_bf16_f32 v173, v174, v175
	buffer_store_dwordx2 v[172:173], v10, s[56:59], 0 offen offset:1120 nt
	v_cvt_pk_bf16_f32 v176, v176, v177
	v_cvt_pk_bf16_f32 v177, v178, v179
	buffer_store_dwordx2 v[176:177], v10, s[56:59], 0 offen offset:1152 nt
	v_cvt_pk_bf16_f32 v180, v180, v181
	v_cvt_pk_bf16_f32 v181, v182, v183
	buffer_store_dwordx2 v[180:181], v10, s[56:59], 0 offen offset:1184 nt
	v_cvt_pk_bf16_f32 v184, v184, v185
	v_cvt_pk_bf16_f32 v185, v186, v187
	buffer_store_dwordx2 v[184:185], v10, s[56:59], 0 offen offset:1216 nt
	v_cvt_pk_bf16_f32 v188, v188, v189
	v_cvt_pk_bf16_f32 v189, v190, v191
	buffer_store_dwordx2 v[188:189], v10, s[56:59], 0 offen offset:1248 nt
	s_endpgm
L_code_end:
.section .rodata,"a"
.p2align 6
.amdhsa_kernel concat_heads__memory_aug_recurrent_mem_tr__sliding_local_dilated__prompt_kernel
  .amdhsa_next_free_vgpr 512
  .amdhsa_next_free_sgpr 102
  .amdhsa_accum_offset 256
  .amdhsa_group_segment_fixed_size 0
  .amdhsa_kernarg_size 104
  .amdhsa_user_sgpr_count 2
  .amdhsa_user_sgpr_kernarg_segment_ptr 1
  .amdhsa_system_sgpr_workgroup_id_x 1
  .amdhsa_float_denorm_mode_32 3
.end_amdhsa_kernel
```
